```python
import torch

def _softmax(x, axis=-1):
    return torch.softmax(x, dim=axis)
def _gelu(x):
    return torch.nn.functional.gelu(x, approximate="tanh")
def _silu(x):
    return torch.nn.functional.silu(x)
def _sigmoid(x):
    return torch.sigmoid(x)
def _layernorm(x, axis=-1, eps=1e-5):
    m = x.mean(dim=axis, keepdim=True)
    v = x.var(dim=axis, keepdim=True, unbiased=False)
    return (x - m) / torch.sqrt(v + eps)
def _scatter_add(tgt, idx, src, axis=0):
    return tgt.clone().index_add_(axis, idx, src)
def _segment_sum(src, seg, n):
    out = torch.zeros((n,) + src.shape[1:], dtype=src.dtype)
    return out.index_add_(0, seg, src)
def _pad(x, pw):
    flat = tuple(v for pair in reversed(pw) for v in pair)
    return torch.nn.functional.pad(x, flat)

kernel_name = 'standalone__mha_block_cached__near_ridge'

def setup_inputs():

    _w = (lambda a: (lambda t: t.to(torch.bfloat16) if t.is_floating_point() else t)(torch.as_tensor(a)))
    B, Sq, D = 16, 256, 448
    H, Sk, Dh = 16, 1024, 256
    return {
        "x": _w((lambda *s: torch.randn(*s, dtype=torch.bfloat16) * 0.8)(B, Sq, D)),
        "k_cache": _w((lambda *s: torch.randn(*s, dtype=torch.bfloat16) * 0.8)(B, H, Sk, Dh)),
        "v_cache": _w((lambda *s: torch.randn(*s, dtype=torch.bfloat16) * 0.05)(B, H, Sk, Dh)),
        "wq": _w((lambda *s: torch.randn(*s, dtype=torch.bfloat16) * 0.8)(D, H * Dh) * (D ** -0.5)),
        "wo": _w((lambda *s: torch.randn(*s, dtype=torch.bfloat16) * 0.05)(H * Dh, D) * ((H * Dh) ** -0.5)),
    }

def reference(x, k_cache, v_cache, wq, wo):
    B, Sq, D = x.shape
    H, Dh = 16, 256
    q = (lambda x, *d: x.permute(*d))((x @ wq).reshape(B, Sq, H, Dh), 0, 2, 1, 3)
    scores = torch.einsum("bhqd,bhkd->bhqk", q, k_cache) * (Dh ** -0.5)
    p = _softmax(scores, axis=-1)
    o = torch.einsum("bhqk,bhkd->bhqd", p, v_cache)
    return (lambda x, *d: x.permute(*d))(o, 0, 2, 1, 3).reshape(B, Sq, H * Dh) @ wo
```

```asm
; @launch grid=(256,1,1) block=(256,1,1) lds=163840
.amdgcn_target "amdgcn-amd-amdhsa--gfx950"
.text
.globl standalone__mha_block_cached__near_ridge_kernel
.p2align 8
.type standalone__mha_block_cached__near_ridge_kernel,@function
standalone__mha_block_cached__near_ridge_kernel:
s_cmp_ge_u32 s2,256
s_cbranch_scc1 L_END
s_load_dwordx16 s[36:51],s[0:1],0
v_lshrrev_b32 v1,6,v0
v_and_b32 v0,63,v0
v_readfirstlane_b32 s3,v1
s_and_b32 s4,s2,7
s_lshr_b32 s5,s2,3
s_getpc_b64 s[8:9]
s_lshl_b32 s6,s5,2
s_add_u32 s6,s6,s3
s_mul_i32 s6,s6,640
s_mov_b32 s10,81920
s_mov_b32 s11,0x20000
v_min_u32 v201,4,v0
v_lshlrev_b32 v201,7,v201
buffer_load_dword v200,v201,s[8:11],s6 offen
s_lshr_b32 s6,s5,1
s_and_b32 s5,s5,1
s_lshl_b32 s4,s4,1
s_add_u32 s4,s4,s5
s_lshl_b32 s5,s4,4
s_add_u32 s63,s5,s6
s_mul_i32 s32,s3,4352
s_and_b32 s7,s3,1
s_lshl_b32 s7,s7,3
s_add_u32 s33,s32,s7
s_lshr_b32 s7,s7,3
v_and_b32 v1,15,v0
v_lshrrev_b32 v2,4,v0
v_bfe_u32 v3,v0,2,2
v_and_b32 v4,3,v0
v_lshrrev_b32 v5,5,v0
v_and_b32 v6,31,v0
s_lshl_b32 s34,s3,6
v_lshrrev_b32 v7,3,v0
v_and_b32 v8,2,v7
v_add_u32 v7,s34,v7
s_movk_i32 s35,896
v_mul_lo_u32 v7,v7,s35
v_and_b32 v9,7,v0
v_xor_b32 v8,v8,v9
v_lshl_add_u32 v250,v8,4,v7
s_lshl_b32 s91,s32,1
s_movk_i32 s84,7168
s_movk_i32 s85,14336
s_movk_i32 s86,21504
s_movk_i32 s87,28672
s_mov_b32 s88,35840
s_mov_b32 s89,43008
s_mov_b32 s90,50176
s_lshl_b32 s34,s3,3
v_add_u32 v7,s34,v5
v_lshlrev_b32 v7,13,v7
v_lshlrev_b32 v8,3,v5
v_xor_b32 v8,v8,v6
v_lshrrev_b32 v9,4,v8
v_and_b32 v8,15,v8
v_lshl_add_u32 v7,v9,18,v7
v_lshl_add_u32 v249,v8,4,v7
s_waitcnt lgkmcnt(0)
s_mul_i32 s34,s4,229376
s_add_u32 s20,s36,s34
s_addc_u32 s21,s37,0
s_mov_b32 s22,229376
s_mov_b32 s23,0x20000
s_lshl_b32 s34,s6,9
s_sub_u32 s35,3670016,s34
s_add_u32 s16,s42,s34
s_addc_u32 s17,s43,0
s_mov_b32 s18,s35
s_mov_b32 s19,0x20000
s_add_u32 m0,s91,34816
s_nop 0
buffer_load_dwordx4 v250,s[20:23],0 offen  lds
s_add_u32 m0,s91,35904
s_nop 0
buffer_load_dwordx4 v250,s[20:23],s84 offen  lds
s_add_u32 m0,s91,36992
s_nop 0
buffer_load_dwordx4 v250,s[20:23],s85 offen  lds
s_add_u32 m0,s91,38080
s_nop 0
buffer_load_dwordx4 v250,s[20:23],s86 offen  lds
s_add_u32 m0,s91,39168
s_nop 0
buffer_load_dwordx4 v250,s[20:23],s87 offen  lds
s_add_u32 m0,s91,40256
s_nop 0
buffer_load_dwordx4 v250,s[20:23],s88 offen  lds
s_add_u32 m0,s91,41344
s_nop 0
buffer_load_dwordx4 v250,s[20:23],s89 offen  lds
s_add_u32 m0,s91,42432
s_nop 0
buffer_load_dwordx4 v250,s[20:23],s90 offen  lds
s_add_u32 m0,s33,87040
s_mov_b32 s34,0
buffer_load_dwordx4 v249,s[16:19],s34 offen  lds
s_add_u32 m0,s33,88128
s_mov_b32 s35,16384
buffer_load_dwordx4 v249,s[16:19],s35 offen  lds
s_add_u32 m0,s33,89216
s_mov_b32 s34,32768
buffer_load_dwordx4 v249,s[16:19],s34 offen  lds
s_add_u32 m0,s33,90304
s_mov_b32 s35,49152
buffer_load_dwordx4 v249,s[16:19],s35 offen  lds
s_add_u32 m0,s33,104448
s_mov_b32 s34,256
buffer_load_dwordx4 v249,s[16:19],s34 offen  lds
s_add_u32 m0,s33,105536
s_mov_b32 s35,16640
buffer_load_dwordx4 v249,s[16:19],s35 offen  lds
s_add_u32 m0,s33,106624
s_mov_b32 s34,33024
buffer_load_dwordx4 v249,s[16:19],s34 offen  lds
s_add_u32 m0,s33,107712
s_mov_b32 s35,49408
buffer_load_dwordx4 v249,s[16:19],s35 offen  lds
s_add_u32 m0,s91,0
v_add_u32 v250,128,v250
buffer_load_dwordx4 v250,s[20:23],0 offen  lds
s_add_u32 m0,s91,1088
s_nop 0
buffer_load_dwordx4 v250,s[20:23],s84 offen  lds
s_add_u32 m0,s91,2176
s_nop 0
buffer_load_dwordx4 v250,s[20:23],s85 offen  lds
s_add_u32 m0,s91,3264
s_nop 0
buffer_load_dwordx4 v250,s[20:23],s86 offen  lds
s_add_u32 m0,s91,4352
s_nop 0
buffer_load_dwordx4 v250,s[20:23],s87 offen  lds
s_add_u32 m0,s91,5440
s_nop 0
buffer_load_dwordx4 v250,s[20:23],s88 offen  lds
s_add_u32 m0,s91,6528
s_nop 0
buffer_load_dwordx4 v250,s[20:23],s89 offen  lds
s_add_u32 m0,s91,7616
s_nop 0
buffer_load_dwordx4 v250,s[20:23],s90 offen  lds
s_add_u32 m0,s33,121856
s_mov_b32 s34,524288
buffer_load_dwordx4 v249,s[16:19],s34 offen  lds
s_add_u32 m0,s33,122944
s_mov_b32 s35,540672
buffer_load_dwordx4 v249,s[16:19],s35 offen  lds
s_add_u32 m0,s33,124032
s_mov_b32 s34,557056
buffer_load_dwordx4 v249,s[16:19],s34 offen  lds
s_add_u32 m0,s33,125120
s_mov_b32 s35,573440
buffer_load_dwordx4 v249,s[16:19],s35 offen  lds
s_add_u32 m0,s33,139264
s_mov_b32 s34,524544
buffer_load_dwordx4 v249,s[16:19],s34 offen  lds
s_add_u32 m0,s33,140352
s_mov_b32 s35,540928
buffer_load_dwordx4 v249,s[16:19],s35 offen  lds
s_add_u32 m0,s33,141440
s_mov_b32 s34,557312
buffer_load_dwordx4 v249,s[16:19],s34 offen  lds
s_add_u32 m0,s33,142528
s_mov_b32 s35,573696
buffer_load_dwordx4 v249,s[16:19],s35 offen  lds
s_lshl_b32 s34,s63,19
s_add_u32 s8,s38,s34
s_addc_u32 s9,s39,0
s_mov_b32 s10,524288
s_mov_b32 s11,0x20000
s_add_u32 s12,s40,s34
s_addc_u32 s13,s41,0
s_mov_b32 s14,524288
s_mov_b32 s15,0x20000
s_mul_i32 s34,s6,229376
s_add_u32 s24,s44,s34
s_addc_u32 s25,s45,0
s_mov_b32 s26,229376
s_mov_b32 s27,0x20000
s_mul_i32 s34,s4,3670528
s_add_u32 s34,s34,469762048
s_add_u32 s28,s50,s34
s_addc_u32 s29,s51,0
s_mov_b32 s30,3670528
s_mov_b32 s31,0x20000
s_mov_b32 s54,0x47800000
s_mov_b32 s56,0x3db8aa3b
s_mov_b32 s57,0x3db8aa3b
s_mov_b32 s52,0
s_lshl_b32 s52,s52,14
s_mov_b32 s62,s52
s_mov_b32 s53,0
s_movk_i32 s35,1088
v_lshrrev_b32 v7,3,v1
v_and_b32 v8,2,v1
v_xor_b32 v8,v8,v2
v_lshlrev_b32 v8,4,v8
v_and_b32 v9,7,v1
v_lshl_add_u32 v8,v9,7,v8
v_mad_u32_u24 v8,v7,s35,v8
v_lshl_add_u32 v248,s32,1,v8
v_lshrrev_b32 v9,1,v3
v_and_b32 v10,1,v3
v_lshl_add_u32 v8,v2,2,v9
v_mul_lo_u32 v8,v8,s35
v_lshl_add_u32 v8,v4,4,v8
v_and_b32 v11,1,v2
v_lshl_add_u32 v8,v11,3,v8
v_add_u32 v8,69632,v8
v_mul_u32_u24 v11,640,v10
v_add_u32 v244,v8,v11
v_mul_u32_u24 v11,384,v10
v_add_u32 v245,v8,v11
v_add_u32 v246,69632,v244
v_add_u32 v247,69632,v245
v_lshrrev_b32 v8,1,v1
v_mul_lo_u32 v8,v8,s35
v_and_b32 v11,1,v1
v_lshl_add_u32 v8,v11,9,v8
v_lshl_or_b32 v11,v7,1,v11
v_xor_b32 v11,v11,v2
v_add_u32 v8,69632,v8
v_lshl_add_u32 v232,v11,4,v8
v_lshl_add_u32 v8,v2,1,v9
v_mul_lo_u32 v8,v8,s35
v_lshl_add_u32 v8,v4,3,v8
v_mul_u32_u24 v11,544,v10
v_add_u32 v233,v8,v11
v_mul_u32_u24 v11,480,v10
v_add_u32 v234,v8,v11
s_lshl_b32 s34,s3,12
v_lshlrev_b32 v8,9,v5
v_add_u32 v8,s34,v8
s_lshl_b32 s5,s7,1
v_or_b32 v11,s5,v5
v_xor_b32 v11,v11,v6
v_lshl_add_u32 v236,v11,4,v8
v_lshlrev_b32 v11,1,v5
v_xor_b32 v11,v11,v6
v_lshl_add_u32 v237,v11,4,v8
v_lshlrev_b32 v8,8,v3
v_lshl_add_u32 v8,v2,6,v8
v_lshl_add_u32 v8,v4,4,v8
v_add_u32 v242,s34,v8
s_lshl_b32 s34,s3,5
v_lshrrev_b32 v8,3,v0
v_add_u32 v8,s34,v8
s_movk_i32 s5,896
v_mul_lo_u32 v8,v8,s5
v_and_b32 v11,7,v0
v_lshlrev_b32 v12,1,v2
v_xor_b32 v11,v11,v12
v_lshl_add_u32 v235,v11,4,v8
v_lshrrev_b32 v8,1,v2
v_mul_lo_u32 v8,v8,s35
v_and_b32 v11,1,v2
v_lshl_add_u32 v11,v11,2,v3
v_lshl_add_u32 v8,v11,7,v8
v_lshl_add_u32 v8,v4,3,v8
v_lshrrev_b32 v11,1,v11
v_add_u32 v8,121856,v8
v_xor_b32 v12,0,v11
v_lshl_add_u32 v238,v12,5,v8
v_xor_b32 v12,1,v11
v_lshl_add_u32 v239,v12,5,v8
v_xor_b32 v12,2,v11
v_lshl_add_u32 v240,v12,5,v8
v_xor_b32 v12,3,v11
v_lshl_add_u32 v241,v12,5,v8
v_mov_b32 v224,0
v_mov_b32 v225,0
v_mov_b32 v226,0
v_mov_b32 v227,0
s_mul_i32 s55,s6,229376
s_lshl_b32 s34,s3,7
s_lshl_b32 s35,s6,2
s_add_u32 s34,s34,s35
s_add_u32 s98,s34,3670016
s_lshr_b32 s34,s6,2
s_lshl_b32 s34,s34,7
s_add_u32 s99,s34,3670016
s_lshl_b32 s34,s6,10
s_lshl_b32 s35,s3,8
s_add_u32 s100,s34,s35
s_mul_i32 s34,s6,14336
s_mul_i32 s35,s3,3584
s_add_u32 s101,s34,s35
s_lshl_b32 s60,s4,4
s_getreg_b32 s34,hwreg(HW_REG_XCC_ID,0,4)
s_or_b32 s5,s34,0x80
s_mul_i32 s7,s5,0x01010101
s_and_b32 s34,s6,3
s_lshl_b32 s34,s34,2
s_add_u32 s34,s34,s3
s_lshl_b32 s34,s34,2
s_add_u32 s34,s34,s99
s_add_u32 s34,s34,64
v_lshl_add_u32 v8,v0,9,s98
v_writelane_b32 v8,s34,1
v_mul_u32_u24 v9,2,v0
buffer_store_dword v9,v8,s[28:31],0 offen
s_mov_b32 m0,156672
v_bfe_u32 v251,v0,3,2
v_and_b32 v252,7,v0
v_min_u32 v252,4,v252
v_mul_u32_u24 v251,896,v251
v_lshl_add_u32 v251,v252,7,v251
s_lshl_b32 s36,s6,2
s_add_u32 s36,s36,s3
s_mul_i32 s36,s36,3584
s_add_u32 s36,s36,256
buffer_load_dword v251,s[20:23],s36 offen  lds
v_min_u32 v252,19,v0
v_lshrrev_b32 v252,2,v252
v_lshlrev_b32 v252,13,v252
v_lshl_add_u32 v252,v4,7,v252
s_lshl_b32 s37,s4,2
s_add_u32 s37,s37,s3
s_mul_i32 s37,s37,40960
s_add_u32 s37,s37,1048576
buffer_load_dword v252,s[16:19],s37 offen  lds
v_bfe_u32 v253,v0,3,2
v_and_b32 v254,7,v0
v_min_u32 v254,6,v254
v_mul_u32_u24 v253,896,v253
v_lshl_add_u32 v253,v254,7,v253
s_waitcnt vmcnt(23)
s_barrier
ds_read_b128 a[32:35],v248 offset:34816
ds_read_b128 a[36:39],v248 offset:36992
ds_read_b128 a[40:43],v248 offset:39168
ds_read_b128 a[44:47],v248 offset:41344
ds_read_b64_tr_b16 a[64:65],v244 offset:17408
ds_read_b64_tr_b16 a[66:67],v244 offset:19584
ds_read_b128 a[48:51],v248 offset:34880
ds_read_b128 a[52:55],v248 offset:37056
ds_read_b64_tr_b16 a[68:69],v244 offset:17664
ds_read_b64_tr_b16 a[70:71],v244 offset:19840
ds_read_b128 a[56:59],v248 offset:39232
ds_read_b128 a[60:63],v248 offset:41408
ds_read_b64_tr_b16 a[72:73],v244 offset:17416
ds_read_b64_tr_b16 a[74:75],v244 offset:19592
ds_read_b64_tr_b16 a[76:77],v244 offset:17672
ds_read_b64_tr_b16 a[78:79],v244 offset:19848
s_waitcnt lgkmcnt(4)
v_mfma_f32_16x16x32_bf16 v[0:3],a[64:67],a[32:35],0
v_mfma_f32_16x16x32_bf16 v[0:3],a[68:71],a[48:51],v[0:3]
v_mfma_f32_16x16x32_bf16 v[8:11],a[64:67],a[36:39],0
v_mfma_f32_16x16x32_bf16 v[8:11],a[68:71],a[52:55],v[8:11]
v_mfma_f32_16x16x32_bf16 v[16:19],a[64:67],a[40:43],0
s_add_u32 m0,s91,34816
v_add_u32 v250,128,v250
v_mfma_f32_16x16x32_bf16 v[16:19],a[68:71],a[56:59],v[16:19]
buffer_load_dwordx4 v250,s[20:23],0 offen  lds
v_mfma_f32_16x16x32_bf16 v[24:27],a[64:67],a[44:47],0
ds_read_b64_tr_b16 a[64:65],v244 offset:17472
ds_read_b64_tr_b16 a[66:67],v244 offset:19648
v_mfma_f32_16x16x32_bf16 v[24:27],a[68:71],a[60:63],v[24:27]
s_waitcnt lgkmcnt(2)
ds_read_b64_tr_b16 a[68:69],v244 offset:17728
v_mfma_f32_16x16x32_bf16 v[28:31],a[72:75],a[44:47],0
ds_read_b64_tr_b16 a[70:71],v244 offset:19904
s_add_u32 m0,s91,35904
v_mfma_f32_16x16x32_bf16 v[28:31],a[76:79],a[60:63],v[28:31]
buffer_load_dwordx4 v250,s[20:23],s84 offen  lds
v_mfma_f32_16x16x32_bf16 v[20:23],a[72:75],a[40:43],0
v_mfma_f32_16x16x32_bf16 v[20:23],a[76:79],a[56:59],v[20:23]
v_mfma_f32_16x16x32_bf16 v[12:15],a[72:75],a[36:39],0
s_add_u32 m0,s91,36992
v_mfma_f32_16x16x32_bf16 v[12:15],a[76:79],a[52:55],v[12:15]
buffer_load_dwordx4 v250,s[20:23],s85 offen  lds
v_mfma_f32_16x16x32_bf16 v[4:7],a[72:75],a[32:35],0
ds_read_b64_tr_b16 a[72:73],v244 offset:17480
ds_read_b64_tr_b16 a[74:75],v244 offset:19656
v_mfma_f32_16x16x32_bf16 v[4:7],a[76:79],a[48:51],v[4:7]
s_waitcnt lgkmcnt(2)
ds_read_b64_tr_b16 a[76:77],v244 offset:17736
v_mfma_f32_16x16x32_bf16 v[32:35],a[64:67],a[32:35],0
ds_read_b64_tr_b16 a[78:79],v244 offset:19912
s_add_u32 m0,s91,38080
v_mfma_f32_16x16x32_bf16 v[32:35],a[68:71],a[48:51],v[32:35]
buffer_load_dwordx4 v250,s[20:23],s86 offen  lds
v_mfma_f32_16x16x32_bf16 v[40:43],a[64:67],a[36:39],0
v_mfma_f32_16x16x32_bf16 v[40:43],a[68:71],a[52:55],v[40:43]
v_mfma_f32_16x16x32_bf16 v[48:51],a[64:67],a[40:43],0
s_add_u32 m0,s91,39168
v_mfma_f32_16x16x32_bf16 v[48:51],a[68:71],a[56:59],v[48:51]
buffer_load_dwordx4 v250,s[20:23],s87 offen  lds
v_mfma_f32_16x16x32_bf16 v[56:59],a[64:67],a[44:47],0
ds_read_b64_tr_b16 a[64:65],v245 offset:17536
ds_read_b64_tr_b16 a[66:67],v245 offset:19712
v_mfma_f32_16x16x32_bf16 v[56:59],a[68:71],a[60:63],v[56:59]
s_waitcnt lgkmcnt(2)
ds_read_b64_tr_b16 a[68:69],v245 offset:17792
v_mfma_f32_16x16x32_bf16 v[60:63],a[72:75],a[44:47],0
ds_read_b64_tr_b16 a[70:71],v245 offset:19968
s_add_u32 m0,s91,40256
v_mfma_f32_16x16x32_bf16 v[60:63],a[76:79],a[60:63],v[60:63]
buffer_load_dwordx4 v250,s[20:23],s88 offen  lds
v_mfma_f32_16x16x32_bf16 v[52:55],a[72:75],a[40:43],0
v_mfma_f32_16x16x32_bf16 v[52:55],a[76:79],a[56:59],v[52:55]
v_mfma_f32_16x16x32_bf16 v[44:47],a[72:75],a[36:39],0
s_add_u32 m0,s91,41344
v_mfma_f32_16x16x32_bf16 v[44:47],a[76:79],a[52:55],v[44:47]
buffer_load_dwordx4 v250,s[20:23],s89 offen  lds
v_mfma_f32_16x16x32_bf16 v[36:39],a[72:75],a[32:35],0
ds_read_b64_tr_b16 a[72:73],v245 offset:17544
ds_read_b64_tr_b16 a[74:75],v245 offset:19720
v_mfma_f32_16x16x32_bf16 v[36:39],a[76:79],a[48:51],v[36:39]
s_waitcnt lgkmcnt(2)
ds_read_b64_tr_b16 a[76:77],v245 offset:17800
v_mfma_f32_16x16x32_bf16 v[64:67],a[64:67],a[32:35],0
ds_read_b64_tr_b16 a[78:79],v245 offset:19976
s_add_u32 m0,s91,42432
v_mfma_f32_16x16x32_bf16 v[64:67],a[68:71],a[48:51],v[64:67]
buffer_load_dwordx4 v250,s[20:23],s90 offen  lds
v_mfma_f32_16x16x32_bf16 v[72:75],a[64:67],a[36:39],0
v_mfma_f32_16x16x32_bf16 v[72:75],a[68:71],a[52:55],v[72:75]
v_mfma_f32_16x16x32_bf16 v[80:83],a[64:67],a[40:43],0
s_add_u32 m0,s33,69632
s_mov_b32 s35,1048576
v_mfma_f32_16x16x32_bf16 v[80:83],a[68:71],a[56:59],v[80:83]
buffer_load_dwordx4 v249,s[16:19],s35 offen  lds
v_mfma_f32_16x16x32_bf16 v[88:91],a[64:67],a[44:47],0
ds_read_b64_tr_b16 a[64:65],v245 offset:17600
ds_read_b64_tr_b16 a[66:67],v245 offset:19776
v_mfma_f32_16x16x32_bf16 v[88:91],a[68:71],a[60:63],v[88:91]
s_waitcnt lgkmcnt(2)
ds_read_b64_tr_b16 a[68:69],v245 offset:17856
v_mfma_f32_16x16x32_bf16 v[92:95],a[72:75],a[44:47],0
ds_read_b64_tr_b16 a[70:71],v245 offset:20032
s_add_u32 m0,s33,70720
s_mov_b32 s35,1064960
v_mfma_f32_16x16x32_bf16 v[92:95],a[76:79],a[60:63],v[92:95]
buffer_load_dwordx4 v249,s[16:19],s35 offen  lds
v_mfma_f32_16x16x32_bf16 v[84:87],a[72:75],a[40:43],0
v_mfma_f32_16x16x32_bf16 v[84:87],a[76:79],a[56:59],v[84:87]
v_mfma_f32_16x16x32_bf16 v[76:79],a[72:75],a[36:39],0
s_add_u32 m0,s33,71808
s_mov_b32 s35,1081344
v_mfma_f32_16x16x32_bf16 v[76:79],a[76:79],a[52:55],v[76:79]
buffer_load_dwordx4 v249,s[16:19],s35 offen  lds
v_mfma_f32_16x16x32_bf16 v[68:71],a[72:75],a[32:35],0
ds_read_b64_tr_b16 a[72:73],v245 offset:17608
ds_read_b64_tr_b16 a[74:75],v245 offset:19784
v_mfma_f32_16x16x32_bf16 v[68:71],a[76:79],a[48:51],v[68:71]
s_waitcnt lgkmcnt(2)
ds_read_b64_tr_b16 a[76:77],v245 offset:17864
v_mfma_f32_16x16x32_bf16 v[96:99],a[64:67],a[32:35],0
ds_read_b64_tr_b16 a[78:79],v245 offset:20040
s_add_u32 m0,s33,72896
s_mov_b32 s35,1097728
v_mfma_f32_16x16x32_bf16 v[96:99],a[68:71],a[48:51],v[96:99]
buffer_load_dwordx4 v249,s[16:19],s35 offen  lds
v_mfma_f32_16x16x32_bf16 v[104:107],a[64:67],a[36:39],0
s_waitcnt vmcnt(23)
s_barrier
v_mfma_f32_16x16x32_bf16 v[104:107],a[68:71],a[52:55],v[104:107]
v_mfma_f32_16x16x32_bf16 v[112:115],a[64:67],a[40:43],0
ds_read_b128 a[80:83],v248 offset:0
ds_read_b128 a[96:99],v248 offset:64
v_mfma_f32_16x16x32_bf16 v[112:115],a[68:71],a[56:59],v[112:115]
ds_read_b128 a[84:87],v248 offset:2176
ds_read_b128 a[100:103],v248 offset:2240
v_mfma_f32_16x16x32_bf16 v[120:123],a[64:67],a[44:47],0
ds_read_b64_tr_b16 a[64:65],v244 offset:34816
ds_read_b64_tr_b16 a[66:67],v244 offset:36992
v_mfma_f32_16x16x32_bf16 v[120:123],a[68:71],a[60:63],v[120:123]
s_waitcnt lgkmcnt(6)
ds_read_b64_tr_b16 a[68:69],v244 offset:35072
v_mfma_f32_16x16x32_bf16 v[124:127],a[72:75],a[44:47],0
ds_read_b64_tr_b16 a[70:71],v244 offset:37248
v_mfma_f32_16x16x32_bf16 v[124:127],a[76:79],a[60:63],v[124:127]
v_mfma_f32_16x16x32_bf16 v[116:119],a[72:75],a[40:43],0
ds_read_b128 a[88:91],v248 offset:4352
ds_read_b128 a[104:107],v248 offset:4416
v_mfma_f32_16x16x32_bf16 v[116:119],a[76:79],a[56:59],v[116:119]
ds_read_b128 a[92:95],v248 offset:6528
ds_read_b128 a[108:111],v248 offset:6592
v_mfma_f32_16x16x32_bf16 v[108:111],a[72:75],a[36:39],0
v_mfma_f32_16x16x32_bf16 v[108:111],a[76:79],a[52:55],v[108:111]
v_mfma_f32_16x16x32_bf16 v[100:103],a[72:75],a[32:35],0
ds_read_b64_tr_b16 a[72:73],v244 offset:34824
ds_read_b64_tr_b16 a[74:75],v244 offset:37000
v_mfma_f32_16x16x32_bf16 v[100:103],a[76:79],a[48:51],v[100:103]
s_waitcnt lgkmcnt(6)
ds_read_b64_tr_b16 a[76:77],v244 offset:35080
ds_read_b64_tr_b16 a[78:79],v244 offset:37256
v_mfma_f32_16x16x32_bf16 v[128:131],a[64:67],a[32:35],0
v_mfma_f32_16x16x32_bf16 v[128:131],a[68:71],a[48:51],v[128:131]
v_mfma_f32_16x16x32_bf16 v[136:139],a[64:67],a[36:39],0
v_mfma_f32_16x16x32_bf16 v[136:139],a[68:71],a[52:55],v[136:139]
v_mfma_f32_16x16x32_bf16 v[144:147],a[64:67],a[40:43],0
s_add_u32 m0,s91,0
v_add_u32 v250,128,v250
v_mfma_f32_16x16x32_bf16 v[144:147],a[68:71],a[56:59],v[144:147]
buffer_load_dwordx4 v250,s[20:23],0 offen  lds
v_mfma_f32_16x16x32_bf16 v[152:155],a[64:67],a[44:47],0
ds_read_b64_tr_b16 a[64:65],v244 offset:34880
ds_read_b64_tr_b16 a[66:67],v244 offset:37056
v_mfma_f32_16x16x32_bf16 v[152:155],a[68:71],a[60:63],v[152:155]
s_waitcnt lgkmcnt(2)
ds_read_b64_tr_b16 a[68:69],v244 offset:35136
v_mfma_f32_16x16x32_bf16 v[156:159],a[72:75],a[44:47],0
ds_read_b64_tr_b16 a[70:71],v244 offset:37312
s_add_u32 m0,s91,1088
v_mfma_f32_16x16x32_bf16 v[156:159],a[76:79],a[60:63],v[156:159]
buffer_load_dwordx4 v250,s[20:23],s84 offen  lds
v_mfma_f32_16x16x32_bf16 v[148:151],a[72:75],a[40:43],0
v_mfma_f32_16x16x32_bf16 v[148:151],a[76:79],a[56:59],v[148:151]
v_mfma_f32_16x16x32_bf16 v[140:143],a[72:75],a[36:39],0
s_add_u32 m0,s91,2176
v_mfma_f32_16x16x32_bf16 v[140:143],a[76:79],a[52:55],v[140:143]
buffer_load_dwordx4 v250,s[20:23],s85 offen  lds
v_mfma_f32_16x16x32_bf16 v[132:135],a[72:75],a[32:35],0
ds_read_b64_tr_b16 a[72:73],v244 offset:34888
ds_read_b64_tr_b16 a[74:75],v244 offset:37064
v_mfma_f32_16x16x32_bf16 v[132:135],a[76:79],a[48:51],v[132:135]
s_waitcnt lgkmcnt(2)
ds_read_b64_tr_b16 a[76:77],v244 offset:35144
v_mfma_f32_16x16x32_bf16 v[160:163],a[64:67],a[32:35],0
ds_read_b64_tr_b16 a[78:79],v244 offset:37320
s_add_u32 m0,s91,3264
v_mfma_f32_16x16x32_bf16 v[160:163],a[68:71],a[48:51],v[160:163]
buffer_load_dwordx4 v250,s[20:23],s86 offen  lds
v_mfma_f32_16x16x32_bf16 v[168:171],a[64:67],a[36:39],0
v_mfma_f32_16x16x32_bf16 v[168:171],a[68:71],a[52:55],v[168:171]
v_mfma_f32_16x16x32_bf16 v[176:179],a[64:67],a[40:43],0
s_add_u32 m0,s91,4352
v_mfma_f32_16x16x32_bf16 v[176:179],a[68:71],a[56:59],v[176:179]
buffer_load_dwordx4 v250,s[20:23],s87 offen  lds
v_mfma_f32_16x16x32_bf16 v[184:187],a[64:67],a[44:47],0
ds_read_b64_tr_b16 a[64:65],v245 offset:34944
ds_read_b64_tr_b16 a[66:67],v245 offset:37120
v_mfma_f32_16x16x32_bf16 v[184:187],a[68:71],a[60:63],v[184:187]
s_waitcnt lgkmcnt(2)
ds_read_b64_tr_b16 a[68:69],v245 offset:35200
v_mfma_f32_16x16x32_bf16 v[188:191],a[72:75],a[44:47],0
ds_read_b64_tr_b16 a[70:71],v245 offset:37376
s_add_u32 m0,s91,5440
v_mfma_f32_16x16x32_bf16 v[188:191],a[76:79],a[60:63],v[188:191]
buffer_load_dwordx4 v250,s[20:23],s88 offen  lds
v_mfma_f32_16x16x32_bf16 v[180:183],a[72:75],a[40:43],0
v_mfma_f32_16x16x32_bf16 v[180:183],a[76:79],a[56:59],v[180:183]
v_mfma_f32_16x16x32_bf16 v[172:175],a[72:75],a[36:39],0
s_add_u32 m0,s91,6528
v_mfma_f32_16x16x32_bf16 v[172:175],a[76:79],a[52:55],v[172:175]
buffer_load_dwordx4 v250,s[20:23],s89 offen  lds
v_mfma_f32_16x16x32_bf16 v[164:167],a[72:75],a[32:35],0
ds_read_b64_tr_b16 a[72:73],v245 offset:34952
ds_read_b64_tr_b16 a[74:75],v245 offset:37128
v_mfma_f32_16x16x32_bf16 v[164:167],a[76:79],a[48:51],v[164:167]
s_waitcnt lgkmcnt(2)
ds_read_b64_tr_b16 a[76:77],v245 offset:35208
v_mfma_f32_16x16x32_bf16 v[192:195],a[64:67],a[32:35],0
ds_read_b64_tr_b16 a[78:79],v245 offset:37384
s_add_u32 m0,s91,7616
v_mfma_f32_16x16x32_bf16 v[192:195],a[68:71],a[48:51],v[192:195]
buffer_load_dwordx4 v250,s[20:23],s90 offen  lds
v_mfma_f32_16x16x32_bf16 v[200:203],a[64:67],a[36:39],0
v_mfma_f32_16x16x32_bf16 v[200:203],a[68:71],a[52:55],v[200:203]
v_mfma_f32_16x16x32_bf16 v[208:211],a[64:67],a[40:43],0
s_add_u32 m0,s33,87040
s_mov_b32 s35,1048832
v_mfma_f32_16x16x32_bf16 v[208:211],a[68:71],a[56:59],v[208:211]
buffer_load_dwordx4 v249,s[16:19],s35 offen  lds
v_mfma_f32_16x16x32_bf16 v[216:219],a[64:67],a[44:47],0
ds_read_b64_tr_b16 a[64:65],v245 offset:35008
ds_read_b64_tr_b16 a[66:67],v245 offset:37184
v_mfma_f32_16x16x32_bf16 v[216:219],a[68:71],a[60:63],v[216:219]
s_waitcnt lgkmcnt(2)
ds_read_b64_tr_b16 a[68:69],v245 offset:35264
v_mfma_f32_16x16x32_bf16 v[220:223],a[72:75],a[44:47],0
ds_read_b64_tr_b16 a[70:71],v245 offset:37440
s_add_u32 m0,s33,88128
s_mov_b32 s35,1065216
v_mfma_f32_16x16x32_bf16 v[220:223],a[76:79],a[60:63],v[220:223]
buffer_load_dwordx4 v249,s[16:19],s35 offen  lds
v_mfma_f32_16x16x32_bf16 v[212:215],a[72:75],a[40:43],0
v_mfma_f32_16x16x32_bf16 v[212:215],a[76:79],a[56:59],v[212:215]
v_mfma_f32_16x16x32_bf16 v[204:207],a[72:75],a[36:39],0
s_add_u32 m0,s33,89216
s_mov_b32 s35,1081600
v_mfma_f32_16x16x32_bf16 v[204:207],a[76:79],a[52:55],v[204:207]
buffer_load_dwordx4 v249,s[16:19],s35 offen  lds
v_mfma_f32_16x16x32_bf16 v[196:199],a[72:75],a[32:35],0
ds_read_b64_tr_b16 a[72:73],v245 offset:35016
ds_read_b64_tr_b16 a[74:75],v245 offset:37192
v_mfma_f32_16x16x32_bf16 v[196:199],a[76:79],a[48:51],v[196:199]
s_waitcnt lgkmcnt(2)
ds_read_b64_tr_b16 a[76:77],v245 offset:35272
v_mfma_f32_16x16x32_bf16 a[0:3],a[64:67],a[32:35],0
ds_read_b64_tr_b16 a[78:79],v245 offset:37448
s_add_u32 m0,s33,90304
s_mov_b32 s35,1097984
v_mfma_f32_16x16x32_bf16 a[0:3],a[68:71],a[48:51],a[0:3]
buffer_load_dwordx4 v249,s[16:19],s35 offen  lds
v_mfma_f32_16x16x32_bf16 a[8:11],a[64:67],a[36:39],0
s_waitcnt vmcnt(16)
s_barrier
v_mfma_f32_16x16x32_bf16 a[8:11],a[68:71],a[52:55],a[8:11]
v_mfma_f32_16x16x32_bf16 a[16:19],a[64:67],a[40:43],0
ds_read_b128 a[112:115],v248 offset:34816
ds_read_b128 a[128:131],v248 offset:34880
v_mfma_f32_16x16x32_bf16 a[16:19],a[68:71],a[56:59],a[16:19]
ds_read_b128 a[116:119],v248 offset:36992
ds_read_b128 a[132:135],v248 offset:37056
v_mfma_f32_16x16x32_bf16 a[24:27],a[64:67],a[44:47],0
ds_read_b64_tr_b16 a[64:65],v244 offset:52224
ds_read_b64_tr_b16 a[66:67],v244 offset:54400
v_mfma_f32_16x16x32_bf16 a[24:27],a[68:71],a[60:63],a[24:27]
s_waitcnt lgkmcnt(6)
ds_read_b64_tr_b16 a[68:69],v244 offset:52480
v_mfma_f32_16x16x32_bf16 a[28:31],a[72:75],a[44:47],0
ds_read_b64_tr_b16 a[70:71],v244 offset:54656
v_mfma_f32_16x16x32_bf16 a[28:31],a[76:79],a[60:63],a[28:31]
v_mfma_f32_16x16x32_bf16 a[20:23],a[72:75],a[40:43],0
ds_read_b128 a[120:123],v248 offset:39168
ds_read_b128 a[136:139],v248 offset:39232
v_mfma_f32_16x16x32_bf16 a[20:23],a[76:79],a[56:59],a[20:23]
ds_read_b128 a[124:127],v248 offset:41344
ds_read_b128 a[140:143],v248 offset:41408
v_mfma_f32_16x16x32_bf16 a[12:15],a[72:75],a[36:39],0
v_mfma_f32_16x16x32_bf16 a[12:15],a[76:79],a[52:55],a[12:15]
v_mfma_f32_16x16x32_bf16 a[4:7],a[72:75],a[32:35],0
ds_read_b64_tr_b16 a[72:73],v244 offset:52232
ds_read_b64_tr_b16 a[74:75],v244 offset:54408
v_mfma_f32_16x16x32_bf16 a[4:7],a[76:79],a[48:51],a[4:7]
s_waitcnt lgkmcnt(6)
ds_read_b64_tr_b16 a[76:77],v244 offset:52488
ds_read_b64_tr_b16 a[78:79],v244 offset:54664
v_mfma_f32_16x16x32_bf16 v[0:3],a[64:67],a[80:83],v[0:3]
v_mfma_f32_16x16x32_bf16 v[0:3],a[68:71],a[96:99],v[0:3]
v_mfma_f32_16x16x32_bf16 v[8:11],a[64:67],a[84:87],v[8:11]
v_mfma_f32_16x16x32_bf16 v[8:11],a[68:71],a[100:103],v[8:11]
v_mfma_f32_16x16x32_bf16 v[16:19],a[64:67],a[88:91],v[16:19]
s_add_u32 m0,s91,34816
v_add_u32 v250,128,v250
v_mfma_f32_16x16x32_bf16 v[16:19],a[68:71],a[104:107],v[16:19]
buffer_load_dwordx4 v250,s[20:23],0 offen  lds
v_mfma_f32_16x16x32_bf16 v[24:27],a[64:67],a[92:95],v[24:27]
ds_read_b64_tr_b16 a[64:65],v244 offset:52288
ds_read_b64_tr_b16 a[66:67],v244 offset:54464
v_mfma_f32_16x16x32_bf16 v[24:27],a[68:71],a[108:111],v[24:27]
s_waitcnt lgkmcnt(2)
ds_read_b64_tr_b16 a[68:69],v244 offset:52544
v_mfma_f32_16x16x32_bf16 v[28:31],a[72:75],a[92:95],v[28:31]
ds_read_b64_tr_b16 a[70:71],v244 offset:54720
s_add_u32 m0,s91,35904
v_mfma_f32_16x16x32_bf16 v[28:31],a[76:79],a[108:111],v[28:31]
buffer_load_dwordx4 v250,s[20:23],s84 offen  lds
v_mfma_f32_16x16x32_bf16 v[20:23],a[72:75],a[88:91],v[20:23]
v_mfma_f32_16x16x32_bf16 v[20:23],a[76:79],a[104:107],v[20:23]
v_mfma_f32_16x16x32_bf16 v[12:15],a[72:75],a[84:87],v[12:15]
s_add_u32 m0,s91,36992
v_mfma_f32_16x16x32_bf16 v[12:15],a[76:79],a[100:103],v[12:15]
buffer_load_dwordx4 v250,s[20:23],s85 offen  lds
v_mfma_f32_16x16x32_bf16 v[4:7],a[72:75],a[80:83],v[4:7]
ds_read_b64_tr_b16 a[72:73],v244 offset:52296
ds_read_b64_tr_b16 a[74:75],v244 offset:54472
v_mfma_f32_16x16x32_bf16 v[4:7],a[76:79],a[96:99],v[4:7]
s_waitcnt lgkmcnt(2)
ds_read_b64_tr_b16 a[76:77],v244 offset:52552
v_mfma_f32_16x16x32_bf16 v[32:35],a[64:67],a[80:83],v[32:35]
ds_read_b64_tr_b16 a[78:79],v244 offset:54728
s_add_u32 m0,s91,38080
v_mfma_f32_16x16x32_bf16 v[32:35],a[68:71],a[96:99],v[32:35]
buffer_load_dwordx4 v250,s[20:23],s86 offen  lds
v_mfma_f32_16x16x32_bf16 v[40:43],a[64:67],a[84:87],v[40:43]
v_mfma_f32_16x16x32_bf16 v[40:43],a[68:71],a[100:103],v[40:43]
v_mfma_f32_16x16x32_bf16 v[48:51],a[64:67],a[88:91],v[48:51]
s_add_u32 m0,s91,39168
v_mfma_f32_16x16x32_bf16 v[48:51],a[68:71],a[104:107],v[48:51]
buffer_load_dwordx4 v250,s[20:23],s87 offen  lds
v_mfma_f32_16x16x32_bf16 v[56:59],a[64:67],a[92:95],v[56:59]
ds_read_b64_tr_b16 a[64:65],v245 offset:52352
ds_read_b64_tr_b16 a[66:67],v245 offset:54528
v_mfma_f32_16x16x32_bf16 v[56:59],a[68:71],a[108:111],v[56:59]
s_waitcnt lgkmcnt(2)
ds_read_b64_tr_b16 a[68:69],v245 offset:52608
v_mfma_f32_16x16x32_bf16 v[60:63],a[72:75],a[92:95],v[60:63]
ds_read_b64_tr_b16 a[70:71],v245 offset:54784
s_add_u32 m0,s91,40256
v_mfma_f32_16x16x32_bf16 v[60:63],a[76:79],a[108:111],v[60:63]
buffer_load_dwordx4 v250,s[20:23],s88 offen  lds
v_mfma_f32_16x16x32_bf16 v[52:55],a[72:75],a[88:91],v[52:55]
v_mfma_f32_16x16x32_bf16 v[52:55],a[76:79],a[104:107],v[52:55]
v_mfma_f32_16x16x32_bf16 v[44:47],a[72:75],a[84:87],v[44:47]
s_add_u32 m0,s91,41344
v_mfma_f32_16x16x32_bf16 v[44:47],a[76:79],a[100:103],v[44:47]
buffer_load_dwordx4 v250,s[20:23],s89 offen  lds
v_mfma_f32_16x16x32_bf16 v[36:39],a[72:75],a[80:83],v[36:39]
ds_read_b64_tr_b16 a[72:73],v245 offset:52360
ds_read_b64_tr_b16 a[74:75],v245 offset:54536
v_mfma_f32_16x16x32_bf16 v[36:39],a[76:79],a[96:99],v[36:39]
s_waitcnt lgkmcnt(2)
ds_read_b64_tr_b16 a[76:77],v245 offset:52616
v_mfma_f32_16x16x32_bf16 v[64:67],a[64:67],a[80:83],v[64:67]
ds_read_b64_tr_b16 a[78:79],v245 offset:54792
s_add_u32 m0,s91,42432
v_mfma_f32_16x16x32_bf16 v[64:67],a[68:71],a[96:99],v[64:67]
buffer_load_dwordx4 v250,s[20:23],s90 offen  lds
v_mfma_f32_16x16x32_bf16 v[72:75],a[64:67],a[84:87],v[72:75]
v_mfma_f32_16x16x32_bf16 v[72:75],a[68:71],a[100:103],v[72:75]
v_mfma_f32_16x16x32_bf16 v[80:83],a[64:67],a[88:91],v[80:83]
s_add_u32 m0,s33,104448
s_mov_b32 s35,1572864
v_mfma_f32_16x16x32_bf16 v[80:83],a[68:71],a[104:107],v[80:83]
buffer_load_dwordx4 v249,s[16:19],s35 offen  lds
v_mfma_f32_16x16x32_bf16 v[88:91],a[64:67],a[92:95],v[88:91]
ds_read_b64_tr_b16 a[64:65],v245 offset:52416
ds_read_b64_tr_b16 a[66:67],v245 offset:54592
v_mfma_f32_16x16x32_bf16 v[88:91],a[68:71],a[108:111],v[88:91]
s_waitcnt lgkmcnt(2)
ds_read_b64_tr_b16 a[68:69],v245 offset:52672
v_mfma_f32_16x16x32_bf16 v[92:95],a[72:75],a[92:95],v[92:95]
ds_read_b64_tr_b16 a[70:71],v245 offset:54848
s_add_u32 m0,s33,105536
s_mov_b32 s35,1589248
v_mfma_f32_16x16x32_bf16 v[92:95],a[76:79],a[108:111],v[92:95]
buffer_load_dwordx4 v249,s[16:19],s35 offen  lds
v_mfma_f32_16x16x32_bf16 v[84:87],a[72:75],a[88:91],v[84:87]
v_mfma_f32_16x16x32_bf16 v[84:87],a[76:79],a[104:107],v[84:87]
v_mfma_f32_16x16x32_bf16 v[76:79],a[72:75],a[84:87],v[76:79]
s_add_u32 m0,s33,106624
s_mov_b32 s35,1605632
v_mfma_f32_16x16x32_bf16 v[76:79],a[76:79],a[100:103],v[76:79]
buffer_load_dwordx4 v249,s[16:19],s35 offen  lds
v_mfma_f32_16x16x32_bf16 v[68:71],a[72:75],a[80:83],v[68:71]
ds_read_b64_tr_b16 a[72:73],v245 offset:52424
ds_read_b64_tr_b16 a[74:75],v245 offset:54600
v_mfma_f32_16x16x32_bf16 v[68:71],a[76:79],a[96:99],v[68:71]
s_waitcnt lgkmcnt(2)
ds_read_b64_tr_b16 a[76:77],v245 offset:52680
v_mfma_f32_16x16x32_bf16 v[96:99],a[64:67],a[80:83],v[96:99]
ds_read_b64_tr_b16 a[78:79],v245 offset:54856
s_add_u32 m0,s33,107712
s_mov_b32 s35,1622016
v_mfma_f32_16x16x32_bf16 v[96:99],a[68:71],a[96:99],v[96:99]
buffer_load_dwordx4 v249,s[16:19],s35 offen  lds
v_mfma_f32_16x16x32_bf16 v[104:107],a[64:67],a[84:87],v[104:107]
s_waitcnt vmcnt(16)
s_barrier
v_mfma_f32_16x16x32_bf16 v[104:107],a[68:71],a[100:103],v[104:107]
v_mfma_f32_16x16x32_bf16 v[112:115],a[64:67],a[88:91],v[112:115]
ds_read_b128 a[144:147],v248 offset:0
ds_read_b128 a[160:163],v248 offset:64
v_mfma_f32_16x16x32_bf16 v[112:115],a[68:71],a[104:107],v[112:115]
ds_read_b128 a[148:151],v248 offset:2176
ds_read_b128 a[164:167],v248 offset:2240
v_mfma_f32_16x16x32_bf16 v[120:123],a[64:67],a[92:95],v[120:123]
ds_read_b64_tr_b16 a[64:65],v246 offset:0
ds_read_b64_tr_b16 a[66:67],v246 offset:2176
v_mfma_f32_16x16x32_bf16 v[120:123],a[68:71],a[108:111],v[120:123]
s_waitcnt lgkmcnt(6)
ds_read_b64_tr_b16 a[68:69],v246 offset:256
v_mfma_f32_16x16x32_bf16 v[124:127],a[72:75],a[92:95],v[124:127]
ds_read_b64_tr_b16 a[70:71],v246 offset:2432
v_mfma_f32_16x16x32_bf16 v[124:127],a[76:79],a[108:111],v[124:127]
v_mfma_f32_16x16x32_bf16 v[116:119],a[72:75],a[88:91],v[116:119]
ds_read_b128 a[152:155],v248 offset:4352
ds_read_b128 a[168:171],v248 offset:4416
v_mfma_f32_16x16x32_bf16 v[116:119],a[76:79],a[104:107],v[116:119]
ds_read_b128 a[156:159],v248 offset:6528
ds_read_b128 a[172:175],v248 offset:6592
v_mfma_f32_16x16x32_bf16 v[108:111],a[72:75],a[84:87],v[108:111]
v_mfma_f32_16x16x32_bf16 v[108:111],a[76:79],a[100:103],v[108:111]
v_mfma_f32_16x16x32_bf16 v[100:103],a[72:75],a[80:83],v[100:103]
ds_read_b64_tr_b16 a[72:73],v246 offset:8
ds_read_b64_tr_b16 a[74:75],v246 offset:2184
v_mfma_f32_16x16x32_bf16 v[100:103],a[76:79],a[96:99],v[100:103]
s_waitcnt lgkmcnt(6)
ds_read_b64_tr_b16 a[76:77],v246 offset:264
ds_read_b64_tr_b16 a[78:79],v246 offset:2440
v_mfma_f32_16x16x32_bf16 v[128:131],a[64:67],a[80:83],v[128:131]
v_mfma_f32_16x16x32_bf16 v[128:131],a[68:71],a[96:99],v[128:131]
v_mfma_f32_16x16x32_bf16 v[136:139],a[64:67],a[84:87],v[136:139]
v_mfma_f32_16x16x32_bf16 v[136:139],a[68:71],a[100:103],v[136:139]
v_mfma_f32_16x16x32_bf16 v[144:147],a[64:67],a[88:91],v[144:147]
s_add_u32 m0,s91,0
v_add_u32 v250,128,v250
v_mfma_f32_16x16x32_bf16 v[144:147],a[68:71],a[104:107],v[144:147]
buffer_load_dwordx4 v250,s[20:23],0 offen  lds
v_mfma_f32_16x16x32_bf16 v[152:155],a[64:67],a[92:95],v[152:155]
ds_read_b64_tr_b16 a[64:65],v246 offset:64
ds_read_b64_tr_b16 a[66:67],v246 offset:2240
v_mfma_f32_16x16x32_bf16 v[152:155],a[68:71],a[108:111],v[152:155]
s_waitcnt lgkmcnt(2)
ds_read_b64_tr_b16 a[68:69],v246 offset:320
v_mfma_f32_16x16x32_bf16 v[156:159],a[72:75],a[92:95],v[156:159]
ds_read_b64_tr_b16 a[70:71],v246 offset:2496
s_add_u32 m0,s91,1088
v_mfma_f32_16x16x32_bf16 v[156:159],a[76:79],a[108:111],v[156:159]
buffer_load_dwordx4 v250,s[20:23],s84 offen  lds
v_mfma_f32_16x16x32_bf16 v[148:151],a[72:75],a[88:91],v[148:151]
v_mfma_f32_16x16x32_bf16 v[148:151],a[76:79],a[104:107],v[148:151]
v_mfma_f32_16x16x32_bf16 v[140:143],a[72:75],a[84:87],v[140:143]
s_add_u32 m0,s91,2176
v_mfma_f32_16x16x32_bf16 v[140:143],a[76:79],a[100:103],v[140:143]
buffer_load_dwordx4 v250,s[20:23],s85 offen  lds
v_mfma_f32_16x16x32_bf16 v[132:135],a[72:75],a[80:83],v[132:135]
ds_read_b64_tr_b16 a[72:73],v246 offset:72
ds_read_b64_tr_b16 a[74:75],v246 offset:2248
v_mfma_f32_16x16x32_bf16 v[132:135],a[76:79],a[96:99],v[132:135]
s_waitcnt lgkmcnt(2)
ds_read_b64_tr_b16 a[76:77],v246 offset:328
v_mfma_f32_16x16x32_bf16 v[160:163],a[64:67],a[80:83],v[160:163]
ds_read_b64_tr_b16 a[78:79],v246 offset:2504
s_add_u32 m0,s91,3264
v_mfma_f32_16x16x32_bf16 v[160:163],a[68:71],a[96:99],v[160:163]
buffer_load_dwordx4 v250,s[20:23],s86 offen  lds
v_mfma_f32_16x16x32_bf16 v[168:171],a[64:67],a[84:87],v[168:171]
v_mfma_f32_16x16x32_bf16 v[168:171],a[68:71],a[100:103],v[168:171]
v_mfma_f32_16x16x32_bf16 v[176:179],a[64:67],a[88:91],v[176:179]
s_add_u32 m0,s91,4352
v_mfma_f32_16x16x32_bf16 v[176:179],a[68:71],a[104:107],v[176:179]
buffer_load_dwordx4 v250,s[20:23],s87 offen  lds
v_mfma_f32_16x16x32_bf16 v[184:187],a[64:67],a[92:95],v[184:187]
ds_read_b64_tr_b16 a[64:65],v247 offset:128
ds_read_b64_tr_b16 a[66:67],v247 offset:2304
v_mfma_f32_16x16x32_bf16 v[184:187],a[68:71],a[108:111],v[184:187]
s_waitcnt lgkmcnt(2)
ds_read_b64_tr_b16 a[68:69],v247 offset:384
v_mfma_f32_16x16x32_bf16 v[188:191],a[72:75],a[92:95],v[188:191]
ds_read_b64_tr_b16 a[70:71],v247 offset:2560
s_add_u32 m0,s91,5440
v_mfma_f32_16x16x32_bf16 v[188:191],a[76:79],a[108:111],v[188:191]
buffer_load_dwordx4 v250,s[20:23],s88 offen  lds
v_mfma_f32_16x16x32_bf16 v[180:183],a[72:75],a[88:91],v[180:183]
v_mfma_f32_16x16x32_bf16 v[180:183],a[76:79],a[104:107],v[180:183]
v_mfma_f32_16x16x32_bf16 v[172:175],a[72:75],a[84:87],v[172:175]
s_add_u32 m0,s91,6528
v_mfma_f32_16x16x32_bf16 v[172:175],a[76:79],a[100:103],v[172:175]
buffer_load_dwordx4 v250,s[20:23],s89 offen  lds
v_mfma_f32_16x16x32_bf16 v[164:167],a[72:75],a[80:83],v[164:167]
ds_read_b64_tr_b16 a[72:73],v247 offset:136
ds_read_b64_tr_b16 a[74:75],v247 offset:2312
v_mfma_f32_16x16x32_bf16 v[164:167],a[76:79],a[96:99],v[164:167]
s_waitcnt lgkmcnt(2)
ds_read_b64_tr_b16 a[76:77],v247 offset:392
v_mfma_f32_16x16x32_bf16 v[192:195],a[64:67],a[80:83],v[192:195]
ds_read_b64_tr_b16 a[78:79],v247 offset:2568
s_add_u32 m0,s91,7616
v_mfma_f32_16x16x32_bf16 v[192:195],a[68:71],a[96:99],v[192:195]
buffer_load_dwordx4 v250,s[20:23],s90 offen  lds
v_mfma_f32_16x16x32_bf16 v[200:203],a[64:67],a[84:87],v[200:203]
v_mfma_f32_16x16x32_bf16 v[200:203],a[68:71],a[100:103],v[200:203]
v_mfma_f32_16x16x32_bf16 v[208:211],a[64:67],a[88:91],v[208:211]
s_add_u32 m0,s33,121856
s_mov_b32 s35,1573120
v_mfma_f32_16x16x32_bf16 v[208:211],a[68:71],a[104:107],v[208:211]
buffer_load_dwordx4 v249,s[16:19],s35 offen  lds
v_mfma_f32_16x16x32_bf16 v[216:219],a[64:67],a[92:95],v[216:219]
ds_read_b64_tr_b16 a[64:65],v247 offset:192
ds_read_b64_tr_b16 a[66:67],v247 offset:2368
v_mfma_f32_16x16x32_bf16 v[216:219],a[68:71],a[108:111],v[216:219]
s_waitcnt lgkmcnt(2)
ds_read_b64_tr_b16 a[68:69],v247 offset:448
v_mfma_f32_16x16x32_bf16 v[220:223],a[72:75],a[92:95],v[220:223]
ds_read_b64_tr_b16 a[70:71],v247 offset:2624
s_add_u32 m0,s33,122944
s_mov_b32 s35,1589504
v_mfma_f32_16x16x32_bf16 v[220:223],a[76:79],a[108:111],v[220:223]
buffer_load_dwordx4 v249,s[16:19],s35 offen  lds
v_mfma_f32_16x16x32_bf16 v[212:215],a[72:75],a[88:91],v[212:215]
v_mfma_f32_16x16x32_bf16 v[212:215],a[76:79],a[104:107],v[212:215]
v_mfma_f32_16x16x32_bf16 v[204:207],a[72:75],a[84:87],v[204:207]
s_add_u32 m0,s33,124032
s_mov_b32 s35,1605888
v_mfma_f32_16x16x32_bf16 v[204:207],a[76:79],a[100:103],v[204:207]
buffer_load_dwordx4 v249,s[16:19],s35 offen  lds
v_mfma_f32_16x16x32_bf16 v[196:199],a[72:75],a[80:83],v[196:199]
ds_read_b64_tr_b16 a[72:73],v247 offset:200
ds_read_b64_tr_b16 a[74:75],v247 offset:2376
v_mfma_f32_16x16x32_bf16 v[196:199],a[76:79],a[96:99],v[196:199]
s_waitcnt lgkmcnt(2)
ds_read_b64_tr_b16 a[76:77],v247 offset:456
v_mfma_f32_16x16x32_bf16 a[0:3],a[64:67],a[80:83],a[0:3]
ds_read_b64_tr_b16 a[78:79],v247 offset:2632
s_add_u32 m0,s33,125120
s_mov_b32 s35,1622272
v_mfma_f32_16x16x32_bf16 a[0:3],a[68:71],a[96:99],a[0:3]
buffer_load_dwordx4 v249,s[16:19],s35 offen  lds
v_mfma_f32_16x16x32_bf16 a[8:11],a[64:67],a[84:87],a[8:11]
s_waitcnt vmcnt(16)
s_barrier
v_mfma_f32_16x16x32_bf16 a[8:11],a[68:71],a[100:103],a[8:11]
v_mfma_f32_16x16x32_bf16 a[16:19],a[64:67],a[88:91],a[16:19]
ds_read_b128 a[176:179],v248 offset:34816
ds_read_b128 a[192:195],v248 offset:34880
v_mfma_f32_16x16x32_bf16 a[16:19],a[68:71],a[104:107],a[16:19]
ds_read_b128 a[180:183],v248 offset:36992
ds_read_b128 a[196:199],v248 offset:37056
v_mfma_f32_16x16x32_bf16 a[24:27],a[64:67],a[92:95],a[24:27]
ds_read_b64_tr_b16 a[64:65],v244 offset:0
ds_read_b64_tr_b16 a[66:67],v244 offset:2176
v_mfma_f32_16x16x32_bf16 a[24:27],a[68:71],a[108:111],a[24:27]
s_waitcnt lgkmcnt(6)
ds_read_b64_tr_b16 a[68:69],v244 offset:256
v_mfma_f32_16x16x32_bf16 a[28:31],a[72:75],a[92:95],a[28:31]
ds_read_b64_tr_b16 a[70:71],v244 offset:2432
v_mfma_f32_16x16x32_bf16 a[28:31],a[76:79],a[108:111],a[28:31]
v_mfma_f32_16x16x32_bf16 a[20:23],a[72:75],a[88:91],a[20:23]
ds_read_b128 a[184:187],v248 offset:39168
ds_read_b128 a[200:203],v248 offset:39232
v_mfma_f32_16x16x32_bf16 a[20:23],a[76:79],a[104:107],a[20:23]
ds_read_b128 a[188:191],v248 offset:41344
ds_read_b128 a[204:207],v248 offset:41408
v_mfma_f32_16x16x32_bf16 a[12:15],a[72:75],a[84:87],a[12:15]
v_mfma_f32_16x16x32_bf16 a[12:15],a[76:79],a[100:103],a[12:15]
v_mfma_f32_16x16x32_bf16 a[4:7],a[72:75],a[80:83],a[4:7]
ds_read_b64_tr_b16 a[72:73],v244 offset:8
ds_read_b64_tr_b16 a[74:75],v244 offset:2184
v_mfma_f32_16x16x32_bf16 a[4:7],a[76:79],a[96:99],a[4:7]
s_waitcnt lgkmcnt(6)
ds_read_b64_tr_b16 a[76:77],v244 offset:264
ds_read_b64_tr_b16 a[78:79],v244 offset:2440
v_mfma_f32_16x16x32_bf16 v[0:3],a[64:67],a[112:115],v[0:3]
v_mfma_f32_16x16x32_bf16 v[0:3],a[68:71],a[128:131],v[0:3]
v_mfma_f32_16x16x32_bf16 v[8:11],a[64:67],a[116:119],v[8:11]
v_mfma_f32_16x16x32_bf16 v[8:11],a[68:71],a[132:135],v[8:11]
v_mfma_f32_16x16x32_bf16 v[16:19],a[64:67],a[120:123],v[16:19]
s_add_u32 m0,s91,34816
v_add_u32 v250,128,v250
v_mfma_f32_16x16x32_bf16 v[16:19],a[68:71],a[136:139],v[16:19]
buffer_load_dwordx4 v250,s[20:23],0 offen  lds
v_mfma_f32_16x16x32_bf16 v[24:27],a[64:67],a[124:127],v[24:27]
ds_read_b64_tr_b16 a[64:65],v244 offset:64
ds_read_b64_tr_b16 a[66:67],v244 offset:2240
v_mfma_f32_16x16x32_bf16 v[24:27],a[68:71],a[140:143],v[24:27]
s_waitcnt lgkmcnt(2)
ds_read_b64_tr_b16 a[68:69],v244 offset:320
v_mfma_f32_16x16x32_bf16 v[28:31],a[72:75],a[124:127],v[28:31]
ds_read_b64_tr_b16 a[70:71],v244 offset:2496
s_add_u32 m0,s91,35904
v_mfma_f32_16x16x32_bf16 v[28:31],a[76:79],a[140:143],v[28:31]
buffer_load_dwordx4 v250,s[20:23],s84 offen  lds
v_mfma_f32_16x16x32_bf16 v[20:23],a[72:75],a[120:123],v[20:23]
v_mfma_f32_16x16x32_bf16 v[20:23],a[76:79],a[136:139],v[20:23]
v_mfma_f32_16x16x32_bf16 v[12:15],a[72:75],a[116:119],v[12:15]
s_add_u32 m0,s91,36992
v_mfma_f32_16x16x32_bf16 v[12:15],a[76:79],a[132:135],v[12:15]
buffer_load_dwordx4 v250,s[20:23],s85 offen  lds
v_mfma_f32_16x16x32_bf16 v[4:7],a[72:75],a[112:115],v[4:7]
ds_read_b64_tr_b16 a[72:73],v244 offset:72
ds_read_b64_tr_b16 a[74:75],v244 offset:2248
v_mfma_f32_16x16x32_bf16 v[4:7],a[76:79],a[128:131],v[4:7]
s_waitcnt lgkmcnt(2)
ds_read_b64_tr_b16 a[76:77],v244 offset:328
v_mfma_f32_16x16x32_bf16 v[32:35],a[64:67],a[112:115],v[32:35]
ds_read_b64_tr_b16 a[78:79],v244 offset:2504
s_add_u32 m0,s91,38080
v_mfma_f32_16x16x32_bf16 v[32:35],a[68:71],a[128:131],v[32:35]
buffer_load_dwordx4 v250,s[20:23],s86 offen  lds
v_mfma_f32_16x16x32_bf16 v[40:43],a[64:67],a[116:119],v[40:43]
v_mfma_f32_16x16x32_bf16 v[40:43],a[68:71],a[132:135],v[40:43]
v_mfma_f32_16x16x32_bf16 v[48:51],a[64:67],a[120:123],v[48:51]
s_add_u32 m0,s91,39168
v_mfma_f32_16x16x32_bf16 v[48:51],a[68:71],a[136:139],v[48:51]
buffer_load_dwordx4 v250,s[20:23],s87 offen  lds
v_mfma_f32_16x16x32_bf16 v[56:59],a[64:67],a[124:127],v[56:59]
ds_read_b64_tr_b16 a[64:65],v245 offset:128
ds_read_b64_tr_b16 a[66:67],v245 offset:2304
v_mfma_f32_16x16x32_bf16 v[56:59],a[68:71],a[140:143],v[56:59]
s_waitcnt lgkmcnt(2)
ds_read_b64_tr_b16 a[68:69],v245 offset:384
v_mfma_f32_16x16x32_bf16 v[60:63],a[72:75],a[124:127],v[60:63]
ds_read_b64_tr_b16 a[70:71],v245 offset:2560
s_add_u32 m0,s91,40256
v_mfma_f32_16x16x32_bf16 v[60:63],a[76:79],a[140:143],v[60:63]
buffer_load_dwordx4 v250,s[20:23],s88 offen  lds
v_mfma_f32_16x16x32_bf16 v[52:55],a[72:75],a[120:123],v[52:55]
v_mfma_f32_16x16x32_bf16 v[52:55],a[76:79],a[136:139],v[52:55]
v_mfma_f32_16x16x32_bf16 v[44:47],a[72:75],a[116:119],v[44:47]
s_add_u32 m0,s91,41344
v_mfma_f32_16x16x32_bf16 v[44:47],a[76:79],a[132:135],v[44:47]
buffer_load_dwordx4 v250,s[20:23],s89 offen  lds
v_mfma_f32_16x16x32_bf16 v[36:39],a[72:75],a[112:115],v[36:39]
ds_read_b64_tr_b16 a[72:73],v245 offset:136
ds_read_b64_tr_b16 a[74:75],v245 offset:2312
v_mfma_f32_16x16x32_bf16 v[36:39],a[76:79],a[128:131],v[36:39]
s_waitcnt lgkmcnt(2)
ds_read_b64_tr_b16 a[76:77],v245 offset:392
v_mfma_f32_16x16x32_bf16 v[64:67],a[64:67],a[112:115],v[64:67]
ds_read_b64_tr_b16 a[78:79],v245 offset:2568
s_add_u32 m0,s91,42432
v_mfma_f32_16x16x32_bf16 v[64:67],a[68:71],a[128:131],v[64:67]
buffer_load_dwordx4 v250,s[20:23],s90 offen  lds
v_mfma_f32_16x16x32_bf16 v[72:75],a[64:67],a[116:119],v[72:75]
v_mfma_f32_16x16x32_bf16 v[72:75],a[68:71],a[132:135],v[72:75]
v_mfma_f32_16x16x32_bf16 v[80:83],a[64:67],a[120:123],v[80:83]
s_add_u32 m0,s33,139264
s_mov_b32 s35,2097152
v_mfma_f32_16x16x32_bf16 v[80:83],a[68:71],a[136:139],v[80:83]
buffer_load_dwordx4 v249,s[16:19],s35 offen  lds
v_mfma_f32_16x16x32_bf16 v[88:91],a[64:67],a[124:127],v[88:91]
ds_read_b64_tr_b16 a[64:65],v245 offset:192
ds_read_b64_tr_b16 a[66:67],v245 offset:2368
v_mfma_f32_16x16x32_bf16 v[88:91],a[68:71],a[140:143],v[88:91]
s_waitcnt lgkmcnt(2)
ds_read_b64_tr_b16 a[68:69],v245 offset:448
v_mfma_f32_16x16x32_bf16 v[92:95],a[72:75],a[124:127],v[92:95]
ds_read_b64_tr_b16 a[70:71],v245 offset:2624
s_add_u32 m0,s33,140352
s_mov_b32 s35,2113536
v_mfma_f32_16x16x32_bf16 v[92:95],a[76:79],a[140:143],v[92:95]
buffer_load_dwordx4 v249,s[16:19],s35 offen  lds
v_mfma_f32_16x16x32_bf16 v[84:87],a[72:75],a[120:123],v[84:87]
v_mfma_f32_16x16x32_bf16 v[84:87],a[76:79],a[136:139],v[84:87]
v_mfma_f32_16x16x32_bf16 v[76:79],a[72:75],a[116:119],v[76:79]
s_add_u32 m0,s33,141440
s_mov_b32 s35,2129920
v_mfma_f32_16x16x32_bf16 v[76:79],a[76:79],a[132:135],v[76:79]
buffer_load_dwordx4 v249,s[16:19],s35 offen  lds
v_mfma_f32_16x16x32_bf16 v[68:71],a[72:75],a[112:115],v[68:71]
ds_read_b64_tr_b16 a[72:73],v245 offset:200
ds_read_b64_tr_b16 a[74:75],v245 offset:2376
v_mfma_f32_16x16x32_bf16 v[68:71],a[76:79],a[128:131],v[68:71]
s_waitcnt lgkmcnt(2)
ds_read_b64_tr_b16 a[76:77],v245 offset:456
v_mfma_f32_16x16x32_bf16 v[96:99],a[64:67],a[112:115],v[96:99]
ds_read_b64_tr_b16 a[78:79],v245 offset:2632
s_add_u32 m0,s33,142528
s_mov_b32 s35,2146304
v_mfma_f32_16x16x32_bf16 v[96:99],a[68:71],a[128:131],v[96:99]
buffer_load_dwordx4 v249,s[16:19],s35 offen  lds
v_mfma_f32_16x16x32_bf16 v[104:107],a[64:67],a[116:119],v[104:107]
s_waitcnt vmcnt(16)
s_barrier
v_mfma_f32_16x16x32_bf16 v[104:107],a[68:71],a[132:135],v[104:107]
v_mfma_f32_16x16x32_bf16 v[112:115],a[64:67],a[120:123],v[112:115]
ds_read_b128 a[208:211],v248 offset:0
ds_read_b128 a[224:227],v248 offset:64
v_mfma_f32_16x16x32_bf16 v[112:115],a[68:71],a[136:139],v[112:115]
ds_read_b128 a[212:215],v248 offset:2176
ds_read_b128 a[228:231],v248 offset:2240
v_mfma_f32_16x16x32_bf16 v[120:123],a[64:67],a[124:127],v[120:123]
ds_read_b64_tr_b16 a[64:65],v244 offset:17408
ds_read_b64_tr_b16 a[66:67],v244 offset:19584
v_mfma_f32_16x16x32_bf16 v[120:123],a[68:71],a[140:143],v[120:123]
s_waitcnt lgkmcnt(6)
ds_read_b64_tr_b16 a[68:69],v244 offset:17664
v_mfma_f32_16x16x32_bf16 v[124:127],a[72:75],a[124:127],v[124:127]
ds_read_b64_tr_b16 a[70:71],v244 offset:19840
v_mfma_f32_16x16x32_bf16 v[124:127],a[76:79],a[140:143],v[124:127]
v_mfma_f32_16x16x32_bf16 v[116:119],a[72:75],a[120:123],v[116:119]
ds_read_b128 a[216:219],v248 offset:4352
ds_read_b128 a[232:235],v248 offset:4416
v_mfma_f32_16x16x32_bf16 v[116:119],a[76:79],a[136:139],v[116:119]
ds_read_b128 a[220:223],v248 offset:6528
ds_read_b128 a[236:239],v248 offset:6592
v_mfma_f32_16x16x32_bf16 v[108:111],a[72:75],a[116:119],v[108:111]
v_mfma_f32_16x16x32_bf16 v[108:111],a[76:79],a[132:135],v[108:111]
v_mfma_f32_16x16x32_bf16 v[100:103],a[72:75],a[112:115],v[100:103]
ds_read_b64_tr_b16 a[72:73],v244 offset:17416
ds_read_b64_tr_b16 a[74:75],v244 offset:19592
v_mfma_f32_16x16x32_bf16 v[100:103],a[76:79],a[128:131],v[100:103]
s_waitcnt lgkmcnt(6)
ds_read_b64_tr_b16 a[76:77],v244 offset:17672
ds_read_b64_tr_b16 a[78:79],v244 offset:19848
v_mfma_f32_16x16x32_bf16 v[128:131],a[64:67],a[112:115],v[128:131]
v_accvgpr_write_b32 a240,0
v_accvgpr_write_b32 a241,0
v_mfma_f32_16x16x32_bf16 v[128:131],a[68:71],a[128:131],v[128:131]
v_accvgpr_write_b32 a242,0
v_accvgpr_write_b32 a243,0
v_mfma_f32_16x16x32_bf16 v[136:139],a[64:67],a[116:119],v[136:139]
v_accvgpr_write_b32 a244,0
v_accvgpr_write_b32 a245,0
v_mfma_f32_16x16x32_bf16 v[136:139],a[68:71],a[132:135],v[136:139]
v_accvgpr_write_b32 a246,0
v_accvgpr_write_b32 a247,0
v_mfma_f32_16x16x32_bf16 v[144:147],a[64:67],a[120:123],v[144:147]
s_add_u32 m0,s33,69632
s_mov_b32 s35,2097408
v_mfma_f32_16x16x32_bf16 v[144:147],a[68:71],a[136:139],v[144:147]
buffer_load_dwordx4 v249,s[16:19],s35 offen  lds
v_mfma_f32_16x16x32_bf16 v[152:155],a[64:67],a[124:127],v[152:155]
ds_read_b64_tr_b16 a[64:65],v244 offset:17472
ds_read_b64_tr_b16 a[66:67],v244 offset:19648
v_mfma_f32_16x16x32_bf16 v[152:155],a[68:71],a[140:143],v[152:155]
s_waitcnt lgkmcnt(2)
ds_read_b64_tr_b16 a[68:69],v244 offset:17728
v_mfma_f32_16x16x32_bf16 v[156:159],a[72:75],a[124:127],v[156:159]
ds_read_b64_tr_b16 a[70:71],v244 offset:19904
v_accvgpr_write_b32 a248,0
v_mfma_f32_16x16x32_bf16 v[156:159],a[76:79],a[140:143],v[156:159]
v_accvgpr_write_b32 a249,0
v_accvgpr_write_b32 a250,0
v_mfma_f32_16x16x32_bf16 v[148:151],a[72:75],a[120:123],v[148:151]
v_accvgpr_write_b32 a251,0
v_accvgpr_write_b32 a252,0
v_mfma_f32_16x16x32_bf16 v[148:151],a[76:79],a[136:139],v[148:151]
v_accvgpr_write_b32 a253,0
v_accvgpr_write_b32 a254,0
v_mfma_f32_16x16x32_bf16 v[140:143],a[72:75],a[116:119],v[140:143]
v_accvgpr_write_b32 a255,0
v_accvgpr_write_b32 a80,0
v_mfma_f32_16x16x32_bf16 v[140:143],a[76:79],a[132:135],v[140:143]
s_add_u32 m0,s33,70720
v_accvgpr_write_b32 a81,0
v_mfma_f32_16x16x32_bf16 v[132:135],a[72:75],a[112:115],v[132:135]
ds_read_b64_tr_b16 a[72:73],v244 offset:17480
ds_read_b64_tr_b16 a[74:75],v244 offset:19656
v_mfma_f32_16x16x32_bf16 v[132:135],a[76:79],a[128:131],v[132:135]
s_waitcnt lgkmcnt(2)
ds_read_b64_tr_b16 a[76:77],v244 offset:17736
v_mfma_f32_16x16x32_bf16 v[160:163],a[64:67],a[112:115],v[160:163]
ds_read_b64_tr_b16 a[78:79],v244 offset:19912
s_mov_b32 s35,2113792
v_mfma_f32_16x16x32_bf16 v[160:163],a[68:71],a[128:131],v[160:163]
buffer_load_dwordx4 v249,s[16:19],s35 offen  lds
v_mfma_f32_16x16x32_bf16 v[168:171],a[64:67],a[116:119],v[168:171]
v_accvgpr_write_b32 a82,0
v_accvgpr_write_b32 a83,0
v_mfma_f32_16x16x32_bf16 v[168:171],a[68:71],a[132:135],v[168:171]
v_accvgpr_write_b32 a84,0
v_accvgpr_write_b32 a85,0
v_mfma_f32_16x16x32_bf16 v[176:179],a[64:67],a[120:123],v[176:179]
v_accvgpr_write_b32 a86,0
v_accvgpr_write_b32 a87,0
v_mfma_f32_16x16x32_bf16 v[176:179],a[68:71],a[136:139],v[176:179]
v_accvgpr_write_b32 a88,0
v_accvgpr_write_b32 a89,0
v_mfma_f32_16x16x32_bf16 v[184:187],a[64:67],a[124:127],v[184:187]
ds_read_b64_tr_b16 a[64:65],v245 offset:17536
ds_read_b64_tr_b16 a[66:67],v245 offset:19712
v_mfma_f32_16x16x32_bf16 v[184:187],a[68:71],a[140:143],v[184:187]
s_waitcnt lgkmcnt(2)
ds_read_b64_tr_b16 a[68:69],v245 offset:17792
v_mfma_f32_16x16x32_bf16 v[188:191],a[72:75],a[124:127],v[188:191]
ds_read_b64_tr_b16 a[70:71],v245 offset:19968
v_accvgpr_write_b32 a90,0
v_mfma_f32_16x16x32_bf16 v[188:191],a[76:79],a[140:143],v[188:191]
v_accvgpr_write_b32 a91,0
v_accvgpr_write_b32 a92,0
v_mfma_f32_16x16x32_bf16 v[180:183],a[72:75],a[120:123],v[180:183]
v_accvgpr_write_b32 a93,0
v_accvgpr_write_b32 a94,0
v_mfma_f32_16x16x32_bf16 v[180:183],a[76:79],a[136:139],v[180:183]
v_accvgpr_write_b32 a95,0
v_accvgpr_write_b32 a96,0
v_mfma_f32_16x16x32_bf16 v[172:175],a[72:75],a[116:119],v[172:175]
s_add_u32 m0,s33,71808
s_mov_b32 s35,2130176
v_mfma_f32_16x16x32_bf16 v[172:175],a[76:79],a[132:135],v[172:175]
buffer_load_dwordx4 v249,s[16:19],s35 offen  lds
v_mfma_f32_16x16x32_bf16 v[164:167],a[72:75],a[112:115],v[164:167]
ds_read_b64_tr_b16 a[72:73],v245 offset:17544
ds_read_b64_tr_b16 a[74:75],v245 offset:19720
v_mfma_f32_16x16x32_bf16 v[164:167],a[76:79],a[128:131],v[164:167]
s_waitcnt lgkmcnt(2)
ds_read_b64_tr_b16 a[76:77],v245 offset:17800
v_mfma_f32_16x16x32_bf16 v[192:195],a[64:67],a[112:115],v[192:195]
ds_read_b64_tr_b16 a[78:79],v245 offset:19976
v_accvgpr_write_b32 a97,0
v_mfma_f32_16x16x32_bf16 v[192:195],a[68:71],a[128:131],v[192:195]
v_accvgpr_write_b32 a98,0
v_accvgpr_write_b32 a99,0
v_mfma_f32_16x16x32_bf16 v[200:203],a[64:67],a[116:119],v[200:203]
v_accvgpr_write_b32 a100,0
v_accvgpr_write_b32 a101,0
v_mfma_f32_16x16x32_bf16 v[200:203],a[68:71],a[132:135],v[200:203]
v_accvgpr_write_b32 a102,0
v_accvgpr_write_b32 a103,0
v_mfma_f32_16x16x32_bf16 v[208:211],a[64:67],a[120:123],v[208:211]
v_accvgpr_write_b32 a104,0
v_accvgpr_write_b32 a105,0
v_mfma_f32_16x16x32_bf16 v[208:211],a[68:71],a[136:139],v[208:211]
s_add_u32 m0,s33,72896
v_accvgpr_write_b32 a106,0
v_mfma_f32_16x16x32_bf16 v[216:219],a[64:67],a[124:127],v[216:219]
ds_read_b64_tr_b16 a[64:65],v245 offset:17600
ds_read_b64_tr_b16 a[66:67],v245 offset:19776
v_mfma_f32_16x16x32_bf16 v[216:219],a[68:71],a[140:143],v[216:219]
s_waitcnt lgkmcnt(2)
ds_read_b64_tr_b16 a[68:69],v245 offset:17856
v_mfma_f32_16x16x32_bf16 v[220:223],a[72:75],a[124:127],v[220:223]
ds_read_b64_tr_b16 a[70:71],v245 offset:20032
s_mov_b32 s35,2146560
v_mfma_f32_16x16x32_bf16 v[220:223],a[76:79],a[140:143],v[220:223]
buffer_load_dwordx4 v249,s[16:19],s35 offen  lds
v_mfma_f32_16x16x32_bf16 v[212:215],a[72:75],a[120:123],v[212:215]
v_accvgpr_write_b32 a107,0
v_accvgpr_write_b32 a108,0
v_mfma_f32_16x16x32_bf16 v[212:215],a[76:79],a[136:139],v[212:215]
v_accvgpr_write_b32 a109,0
v_accvgpr_write_b32 a110,0
v_mfma_f32_16x16x32_bf16 v[204:207],a[72:75],a[116:119],v[204:207]
v_accvgpr_write_b32 a111,0
v_mfma_f32_16x16x32_bf16 v[204:207],a[76:79],a[132:135],v[204:207]
v_mfma_f32_16x16x32_bf16 v[196:199],a[72:75],a[112:115],v[196:199]
ds_read_b64_tr_b16 a[72:73],v245 offset:17608
ds_read_b64_tr_b16 a[74:75],v245 offset:19784
v_mfma_f32_16x16x32_bf16 v[196:199],a[76:79],a[128:131],v[196:199]
s_waitcnt lgkmcnt(2)
ds_read_b64_tr_b16 a[76:77],v245 offset:17864
v_mfma_f32_16x16x32_bf16 a[0:3],a[64:67],a[112:115],a[0:3]
ds_read_b64_tr_b16 a[78:79],v245 offset:20040
v_mfma_f32_16x16x32_bf16 a[0:3],a[68:71],a[128:131],a[0:3]
v_mfma_f32_16x16x32_bf16 a[8:11],a[64:67],a[116:119],a[8:11]
s_waitcnt vmcnt(8)
s_barrier
v_mfma_f32_16x16x32_bf16 a[8:11],a[68:71],a[132:135],a[8:11]
v_mfma_f32_16x16x32_bf16 a[16:19],a[64:67],a[120:123],a[16:19]
ds_read_b128 a[32:35],v248 offset:34816
ds_read_b128 a[48:51],v248 offset:34880
v_mfma_f32_16x16x32_bf16 a[16:19],a[68:71],a[136:139],a[16:19]
ds_read_b128 a[36:39],v248 offset:36992
ds_read_b128 a[52:55],v248 offset:37056
v_mfma_f32_16x16x32_bf16 a[24:27],a[64:67],a[124:127],a[24:27]
ds_read_b64_tr_b16 a[64:65],v244 offset:34816
ds_read_b64_tr_b16 a[66:67],v244 offset:36992
v_mfma_f32_16x16x32_bf16 a[24:27],a[68:71],a[140:143],a[24:27]
s_waitcnt lgkmcnt(6)
ds_read_b64_tr_b16 a[68:69],v244 offset:35072
v_mfma_f32_16x16x32_bf16 a[28:31],a[72:75],a[124:127],a[28:31]
ds_read_b64_tr_b16 a[70:71],v244 offset:37248
v_mfma_f32_16x16x32_bf16 a[28:31],a[76:79],a[140:143],a[28:31]
v_mfma_f32_16x16x32_bf16 a[20:23],a[72:75],a[120:123],a[20:23]
ds_read_b128 a[40:43],v248 offset:39168
ds_read_b128 a[56:59],v248 offset:39232
v_mfma_f32_16x16x32_bf16 a[20:23],a[76:79],a[136:139],a[20:23]
ds_read_b128 a[44:47],v248 offset:41344
ds_read_b128 a[60:63],v248 offset:41408
v_mfma_f32_16x16x32_bf16 a[12:15],a[72:75],a[116:119],a[12:15]
v_mfma_f32_16x16x32_bf16 a[12:15],a[76:79],a[132:135],a[12:15]
v_mfma_f32_16x16x32_bf16 a[4:7],a[72:75],a[112:115],a[4:7]
ds_read_b64_tr_b16 a[72:73],v244 offset:34824
ds_read_b64_tr_b16 a[74:75],v244 offset:37000
v_mfma_f32_16x16x32_bf16 a[4:7],a[76:79],a[128:131],a[4:7]
s_waitcnt lgkmcnt(6)
ds_read_b64_tr_b16 a[76:77],v244 offset:35080
ds_read_b64_tr_b16 a[78:79],v244 offset:37256
v_mfma_f32_16x16x32_bf16 v[0:3],a[64:67],a[144:147],v[0:3]
v_mfma_f32_16x16x32_bf16 v[0:3],a[68:71],a[160:163],v[0:3]
v_mfma_f32_16x16x32_bf16 v[8:11],a[64:67],a[148:151],v[8:11]
v_mfma_f32_16x16x32_bf16 v[8:11],a[68:71],a[164:167],v[8:11]
v_mfma_f32_16x16x32_bf16 v[16:19],a[64:67],a[152:155],v[16:19]
s_add_u32 m0,s33,87040
s_mov_b32 s35,2621440
v_mfma_f32_16x16x32_bf16 v[16:19],a[68:71],a[168:171],v[16:19]
buffer_load_dwordx4 v249,s[16:19],s35 offen  lds
v_mfma_f32_16x16x32_bf16 v[24:27],a[64:67],a[156:159],v[24:27]
ds_read_b64_tr_b16 a[64:65],v244 offset:34880
ds_read_b64_tr_b16 a[66:67],v244 offset:37056
v_mfma_f32_16x16x32_bf16 v[24:27],a[68:71],a[172:175],v[24:27]
s_waitcnt lgkmcnt(2)
ds_read_b64_tr_b16 a[68:69],v244 offset:35136
v_mfma_f32_16x16x32_bf16 v[28:31],a[72:75],a[156:159],v[28:31]
ds_read_b64_tr_b16 a[70:71],v244 offset:37312
s_add_u32 m0,s32,0
s_mov_b32 s34,0
v_mfma_f32_16x16x32_bf16 v[28:31],a[76:79],a[172:175],v[28:31]
buffer_load_dwordx4 v237,s[12:15],s34 offen offset:0 sc0 sc1 nt lds
v_mfma_f32_16x16x32_bf16 v[20:23],a[72:75],a[152:155],v[20:23]
v_mfma_f32_16x16x32_bf16 v[20:23],a[76:79],a[168:171],v[20:23]
v_mfma_f32_16x16x32_bf16 v[12:15],a[72:75],a[148:151],v[12:15]
v_mfma_f32_16x16x32_bf16 v[12:15],a[76:79],a[164:167],v[12:15]
s_add_u32 m0,s33,88128
v_mfma_f32_16x16x32_bf16 v[4:7],a[72:75],a[144:147],v[4:7]
ds_read_b64_tr_b16 a[72:73],v244 offset:34888
ds_read_b64_tr_b16 a[74:75],v244 offset:37064
v_mfma_f32_16x16x32_bf16 v[4:7],a[76:79],a[160:163],v[4:7]
s_waitcnt lgkmcnt(2)
ds_read_b64_tr_b16 a[76:77],v244 offset:35144
v_mfma_f32_16x16x32_bf16 v[32:35],a[64:67],a[144:147],v[32:35]
ds_read_b64_tr_b16 a[78:79],v244 offset:37320
s_mov_b32 s35,2637824
v_mfma_f32_16x16x32_bf16 v[32:35],a[68:71],a[160:163],v[32:35]
buffer_load_dwordx4 v249,s[16:19],s35 offen  lds
v_mfma_f32_16x16x32_bf16 v[40:43],a[64:67],a[148:151],v[40:43]
v_mfma_f32_16x16x32_bf16 v[40:43],a[68:71],a[164:167],v[40:43]
v_mfma_f32_16x16x32_bf16 v[48:51],a[64:67],a[152:155],v[48:51]
s_add_u32 m0,s32,64
v_mfma_f32_16x16x32_bf16 v[48:51],a[68:71],a[168:171],v[48:51]
buffer_load_dwordx4 v237,s[12:15],s34 offen offset:1024 sc0 sc1 nt lds
v_mfma_f32_16x16x32_bf16 v[56:59],a[64:67],a[156:159],v[56:59]
ds_read_b64_tr_b16 a[64:65],v245 offset:34944
ds_read_b64_tr_b16 a[66:67],v245 offset:37120
v_mfma_f32_16x16x32_bf16 v[56:59],a[68:71],a[172:175],v[56:59]
s_waitcnt lgkmcnt(2)
ds_read_b64_tr_b16 a[68:69],v245 offset:35200
v_mfma_f32_16x16x32_bf16 v[60:63],a[72:75],a[156:159],v[60:63]
ds_read_b64_tr_b16 a[70:71],v245 offset:37376
v_mfma_f32_16x16x32_bf16 v[60:63],a[76:79],a[172:175],v[60:63]
v_mfma_f32_16x16x32_bf16 v[52:55],a[72:75],a[152:155],v[52:55]
v_mfma_f32_16x16x32_bf16 v[52:55],a[76:79],a[168:171],v[52:55]
v_mfma_f32_16x16x32_bf16 v[44:47],a[72:75],a[148:151],v[44:47]
s_add_u32 m0,s33,89216
s_mov_b32 s35,2654208
v_mfma_f32_16x16x32_bf16 v[44:47],a[76:79],a[164:167],v[44:47]
buffer_load_dwordx4 v249,s[16:19],s35 offen  lds
v_mfma_f32_16x16x32_bf16 v[36:39],a[72:75],a[144:147],v[36:39]
ds_read_b64_tr_b16 a[72:73],v245 offset:34952
ds_read_b64_tr_b16 a[74:75],v245 offset:37128
v_mfma_f32_16x16x32_bf16 v[36:39],a[76:79],a[160:163],v[36:39]
s_waitcnt lgkmcnt(2)
ds_read_b64_tr_b16 a[76:77],v245 offset:35208
v_mfma_f32_16x16x32_bf16 v[64:67],a[64:67],a[144:147],v[64:67]
ds_read_b64_tr_b16 a[78:79],v245 offset:37384
s_add_u32 m0,s32,128
v_mfma_f32_16x16x32_bf16 v[64:67],a[68:71],a[160:163],v[64:67]
buffer_load_dwordx4 v237,s[12:15],s34 offen offset:2048 sc0 sc1 nt lds
v_mfma_f32_16x16x32_bf16 v[72:75],a[64:67],a[148:151],v[72:75]
v_mfma_f32_16x16x32_bf16 v[72:75],a[68:71],a[164:167],v[72:75]
v_mfma_f32_16x16x32_bf16 v[80:83],a[64:67],a[152:155],v[80:83]
v_mfma_f32_16x16x32_bf16 v[80:83],a[68:71],a[168:171],v[80:83]
s_add_u32 m0,s33,90304
v_mfma_f32_16x16x32_bf16 v[88:91],a[64:67],a[156:159],v[88:91]
ds_read_b64_tr_b16 a[64:65],v245 offset:35008
ds_read_b64_tr_b16 a[66:67],v245 offset:37184
v_mfma_f32_16x16x32_bf16 v[88:91],a[68:71],a[172:175],v[88:91]
s_waitcnt lgkmcnt(2)
ds_read_b64_tr_b16 a[68:69],v245 offset:35264
v_mfma_f32_16x16x32_bf16 v[92:95],a[72:75],a[156:159],v[92:95]
ds_read_b64_tr_b16 a[70:71],v245 offset:37440
s_mov_b32 s35,2670592
v_mfma_f32_16x16x32_bf16 v[92:95],a[76:79],a[172:175],v[92:95]
buffer_load_dwordx4 v249,s[16:19],s35 offen  lds
v_mfma_f32_16x16x32_bf16 v[84:87],a[72:75],a[152:155],v[84:87]
v_mfma_f32_16x16x32_bf16 v[84:87],a[76:79],a[168:171],v[84:87]
v_mfma_f32_16x16x32_bf16 v[76:79],a[72:75],a[148:151],v[76:79]
s_add_u32 m0,s32,192
v_mfma_f32_16x16x32_bf16 v[76:79],a[76:79],a[164:167],v[76:79]
buffer_load_dwordx4 v237,s[12:15],s34 offen offset:3072 sc0 sc1 nt lds
v_mfma_f32_16x16x32_bf16 v[68:71],a[72:75],a[144:147],v[68:71]
ds_read_b64_tr_b16 a[72:73],v245 offset:35016
ds_read_b64_tr_b16 a[74:75],v245 offset:37192
v_mfma_f32_16x16x32_bf16 v[68:71],a[76:79],a[160:163],v[68:71]
s_waitcnt lgkmcnt(2)
ds_read_b64_tr_b16 a[76:77],v245 offset:35272
v_mfma_f32_16x16x32_bf16 v[96:99],a[64:67],a[144:147],v[96:99]
ds_read_b64_tr_b16 a[78:79],v245 offset:37448
v_mfma_f32_16x16x32_bf16 v[96:99],a[68:71],a[160:163],v[96:99]
v_mfma_f32_16x16x32_bf16 v[104:107],a[64:67],a[148:151],v[104:107]
s_waitcnt vmcnt(24)
s_barrier
v_mfma_f32_16x16x32_bf16 v[104:107],a[68:71],a[164:167],v[104:107]
v_mfma_f32_16x16x32_bf16 v[112:115],a[64:67],a[152:155],v[112:115]
v_mfma_f32_16x16x32_bf16 v[112:115],a[68:71],a[168:171],v[112:115]
v_mfma_f32_16x16x32_bf16 v[120:123],a[64:67],a[156:159],v[120:123]
ds_read_b64_tr_b16 a[64:65],v244 offset:52224
ds_read_b64_tr_b16 a[66:67],v244 offset:54400
v_mfma_f32_16x16x32_bf16 v[120:123],a[68:71],a[172:175],v[120:123]
s_waitcnt lgkmcnt(2)
ds_read_b64_tr_b16 a[68:69],v244 offset:52480
v_mfma_f32_16x16x32_bf16 v[124:127],a[72:75],a[156:159],v[124:127]
ds_read_b64_tr_b16 a[70:71],v244 offset:54656
v_mfma_f32_16x16x32_bf16 v[124:127],a[76:79],a[172:175],v[124:127]
v_mfma_f32_16x16x32_bf16 v[116:119],a[72:75],a[152:155],v[116:119]
v_mfma_f32_16x16x32_bf16 v[116:119],a[76:79],a[168:171],v[116:119]
v_mfma_f32_16x16x32_bf16 v[108:111],a[72:75],a[148:151],v[108:111]
v_mfma_f32_16x16x32_bf16 v[108:111],a[76:79],a[164:167],v[108:111]
v_mfma_f32_16x16x32_bf16 v[100:103],a[72:75],a[144:147],v[100:103]
ds_read_b64_tr_b16 a[72:73],v244 offset:52232
ds_read_b64_tr_b16 a[74:75],v244 offset:54408
v_mfma_f32_16x16x32_bf16 v[100:103],a[76:79],a[160:163],v[100:103]
s_waitcnt lgkmcnt(2)
ds_read_b64_tr_b16 a[76:77],v244 offset:52488
ds_read_b64_tr_b16 a[78:79],v244 offset:54664
v_mfma_f32_16x16x32_bf16 v[128:131],a[64:67],a[144:147],v[128:131]
v_accvgpr_write_b32 a112,0
v_accvgpr_write_b32 a113,0
v_mfma_f32_16x16x32_bf16 v[128:131],a[68:71],a[160:163],v[128:131]
v_accvgpr_write_b32 a114,0
v_accvgpr_write_b32 a115,0
v_mfma_f32_16x16x32_bf16 v[136:139],a[64:67],a[148:151],v[136:139]
v_accvgpr_write_b32 a116,0
v_accvgpr_write_b32 a117,0
v_mfma_f32_16x16x32_bf16 v[136:139],a[68:71],a[164:167],v[136:139]
v_accvgpr_write_b32 a118,0
v_accvgpr_write_b32 a119,0
v_mfma_f32_16x16x32_bf16 v[144:147],a[64:67],a[152:155],v[144:147]
s_add_u32 m0,s33,104448
s_mov_b32 s35,2621696
v_mfma_f32_16x16x32_bf16 v[144:147],a[68:71],a[168:171],v[144:147]
buffer_load_dwordx4 v249,s[16:19],s35 offen  lds
v_mfma_f32_16x16x32_bf16 v[152:155],a[64:67],a[156:159],v[152:155]
ds_read_b64_tr_b16 a[64:65],v244 offset:52288
ds_read_b64_tr_b16 a[66:67],v244 offset:54464
v_mfma_f32_16x16x32_bf16 v[152:155],a[68:71],a[172:175],v[152:155]
s_waitcnt lgkmcnt(2)
ds_read_b64_tr_b16 a[68:69],v244 offset:52544
v_mfma_f32_16x16x32_bf16 v[156:159],a[72:75],a[156:159],v[156:159]
ds_read_b64_tr_b16 a[70:71],v244 offset:54720
s_add_u32 m0,s32,17408
s_mov_b32 s34,16384
v_mfma_f32_16x16x32_bf16 v[156:159],a[76:79],a[172:175],v[156:159]
buffer_load_dwordx4 v237,s[12:15],s34 offen offset:0 sc0 sc1 nt lds
v_mfma_f32_16x16x32_bf16 v[148:151],a[72:75],a[152:155],v[148:151]
v_accvgpr_write_b32 a120,0
v_accvgpr_write_b32 a121,0
v_mfma_f32_16x16x32_bf16 v[148:151],a[76:79],a[168:171],v[148:151]
v_accvgpr_write_b32 a122,0
v_accvgpr_write_b32 a123,0
v_mfma_f32_16x16x32_bf16 v[140:143],a[72:75],a[148:151],v[140:143]
v_accvgpr_write_b32 a124,0
v_accvgpr_write_b32 a125,0
v_mfma_f32_16x16x32_bf16 v[140:143],a[76:79],a[164:167],v[140:143]
s_add_u32 m0,s33,105536
v_accvgpr_write_b32 a126,0
v_mfma_f32_16x16x32_bf16 v[132:135],a[72:75],a[144:147],v[132:135]
ds_read_b64_tr_b16 a[72:73],v244 offset:52296
ds_read_b64_tr_b16 a[74:75],v244 offset:54472
v_mfma_f32_16x16x32_bf16 v[132:135],a[76:79],a[160:163],v[132:135]
s_waitcnt lgkmcnt(2)
ds_read_b64_tr_b16 a[76:77],v244 offset:52552
v_mfma_f32_16x16x32_bf16 v[160:163],a[64:67],a[144:147],v[160:163]
ds_read_b64_tr_b16 a[78:79],v244 offset:54728
s_mov_b32 s35,2638080
v_mfma_f32_16x16x32_bf16 v[160:163],a[68:71],a[160:163],v[160:163]
buffer_load_dwordx4 v249,s[16:19],s35 offen  lds
v_mfma_f32_16x16x32_bf16 v[168:171],a[64:67],a[148:151],v[168:171]
v_accvgpr_write_b32 a127,0
v_accvgpr_write_b32 a128,0
v_mfma_f32_16x16x32_bf16 v[168:171],a[68:71],a[164:167],v[168:171]
v_accvgpr_write_b32 a129,0
v_accvgpr_write_b32 a130,0
v_mfma_f32_16x16x32_bf16 v[176:179],a[64:67],a[152:155],v[176:179]
s_add_u32 m0,s32,17472
v_accvgpr_write_b32 a131,0
v_mfma_f32_16x16x32_bf16 v[176:179],a[68:71],a[168:171],v[176:179]
buffer_load_dwordx4 v237,s[12:15],s34 offen offset:1024 sc0 sc1 nt lds
v_mfma_f32_16x16x32_bf16 v[184:187],a[64:67],a[156:159],v[184:187]
ds_read_b64_tr_b16 a[64:65],v245 offset:52352
ds_read_b64_tr_b16 a[66:67],v245 offset:54528
v_mfma_f32_16x16x32_bf16 v[184:187],a[68:71],a[172:175],v[184:187]
s_waitcnt lgkmcnt(2)
ds_read_b64_tr_b16 a[68:69],v245 offset:52608
v_mfma_f32_16x16x32_bf16 v[188:191],a[72:75],a[156:159],v[188:191]
ds_read_b64_tr_b16 a[70:71],v245 offset:54784
v_accvgpr_write_b32 a132,0
v_mfma_f32_16x16x32_bf16 v[188:191],a[76:79],a[172:175],v[188:191]
v_accvgpr_write_b32 a133,0
v_accvgpr_write_b32 a134,0
v_mfma_f32_16x16x32_bf16 v[180:183],a[72:75],a[152:155],v[180:183]
v_accvgpr_write_b32 a135,0
v_accvgpr_write_b32 a136,0
v_mfma_f32_16x16x32_bf16 v[180:183],a[76:79],a[168:171],v[180:183]
v_accvgpr_write_b32 a137,0
v_accvgpr_write_b32 a138,0
v_mfma_f32_16x16x32_bf16 v[172:175],a[72:75],a[148:151],v[172:175]
s_add_u32 m0,s33,106624
s_mov_b32 s35,2654464
v_mfma_f32_16x16x32_bf16 v[172:175],a[76:79],a[164:167],v[172:175]
buffer_load_dwordx4 v249,s[16:19],s35 offen  lds
v_mfma_f32_16x16x32_bf16 v[164:167],a[72:75],a[144:147],v[164:167]
ds_read_b64_tr_b16 a[72:73],v245 offset:52360
ds_read_b64_tr_b16 a[74:75],v245 offset:54536
v_mfma_f32_16x16x32_bf16 v[164:167],a[76:79],a[160:163],v[164:167]
s_waitcnt lgkmcnt(2)
ds_read_b64_tr_b16 a[76:77],v245 offset:52616
v_mfma_f32_16x16x32_bf16 v[192:195],a[64:67],a[144:147],v[192:195]
ds_read_b64_tr_b16 a[78:79],v245 offset:54792
s_add_u32 m0,s32,17536
v_mfma_f32_16x16x32_bf16 v[192:195],a[68:71],a[160:163],v[192:195]
buffer_load_dwordx4 v237,s[12:15],s34 offen offset:2048 sc0 sc1 nt lds
v_mfma_f32_16x16x32_bf16 v[200:203],a[64:67],a[148:151],v[200:203]
v_accvgpr_write_b32 a139,0
v_accvgpr_write_b32 a140,0
v_mfma_f32_16x16x32_bf16 v[200:203],a[68:71],a[164:167],v[200:203]
v_accvgpr_write_b32 a141,0
v_accvgpr_write_b32 a142,0
v_mfma_f32_16x16x32_bf16 v[208:211],a[64:67],a[152:155],v[208:211]
v_accvgpr_write_b32 a143,0
v_mfma_f32_16x16x32_bf16 v[208:211],a[68:71],a[168:171],v[208:211]
s_add_u32 m0,s33,107712
v_mfma_f32_16x16x32_bf16 v[216:219],a[64:67],a[156:159],v[216:219]
ds_read_b64_tr_b16 a[64:65],v245 offset:52416
ds_read_b64_tr_b16 a[66:67],v245 offset:54592
v_mfma_f32_16x16x32_bf16 v[216:219],a[68:71],a[172:175],v[216:219]
s_waitcnt lgkmcnt(2)
ds_read_b64_tr_b16 a[68:69],v245 offset:52672
v_mfma_f32_16x16x32_bf16 v[220:223],a[72:75],a[156:159],v[220:223]
ds_read_b64_tr_b16 a[70:71],v245 offset:54848
s_mov_b32 s35,2670848
v_mfma_f32_16x16x32_bf16 v[220:223],a[76:79],a[172:175],v[220:223]
buffer_load_dwordx4 v249,s[16:19],s35 offen  lds
v_mfma_f32_16x16x32_bf16 v[212:215],a[72:75],a[152:155],v[212:215]
v_mfma_f32_16x16x32_bf16 v[212:215],a[76:79],a[168:171],v[212:215]
v_mfma_f32_16x16x32_bf16 v[204:207],a[72:75],a[148:151],v[204:207]
s_add_u32 m0,s32,17600
v_mfma_f32_16x16x32_bf16 v[204:207],a[76:79],a[164:167],v[204:207]
buffer_load_dwordx4 v237,s[12:15],s34 offen offset:3072 sc0 sc1 nt lds
v_mfma_f32_16x16x32_bf16 v[196:199],a[72:75],a[144:147],v[196:199]
ds_read_b64_tr_b16 a[72:73],v245 offset:52424
ds_read_b64_tr_b16 a[74:75],v245 offset:54600
v_mfma_f32_16x16x32_bf16 v[196:199],a[76:79],a[160:163],v[196:199]
s_waitcnt lgkmcnt(2)
ds_read_b64_tr_b16 a[76:77],v245 offset:52680
v_mfma_f32_16x16x32_bf16 a[0:3],a[64:67],a[144:147],a[0:3]
ds_read_b64_tr_b16 a[78:79],v245 offset:54856
v_mfma_f32_16x16x32_bf16 a[0:3],a[68:71],a[160:163],a[0:3]
v_mfma_f32_16x16x32_bf16 a[8:11],a[64:67],a[148:151],a[8:11]
s_waitcnt vmcnt(20)
s_barrier
v_mfma_f32_16x16x32_bf16 a[8:11],a[68:71],a[164:167],a[8:11]
v_mfma_f32_16x16x32_bf16 a[16:19],a[64:67],a[152:155],a[16:19]
v_mfma_f32_16x16x32_bf16 a[16:19],a[68:71],a[168:171],a[16:19]
v_mfma_f32_16x16x32_bf16 a[24:27],a[64:67],a[156:159],a[24:27]
ds_read_b64_tr_b16 a[64:65],v246 offset:0
ds_read_b64_tr_b16 a[66:67],v246 offset:2176
v_mfma_f32_16x16x32_bf16 a[24:27],a[68:71],a[172:175],a[24:27]
s_waitcnt lgkmcnt(2)
ds_read_b64_tr_b16 a[68:69],v246 offset:256
v_mfma_f32_16x16x32_bf16 a[28:31],a[72:75],a[156:159],a[28:31]
ds_read_b64_tr_b16 a[70:71],v246 offset:2432
v_mfma_f32_16x16x32_bf16 a[28:31],a[76:79],a[172:175],a[28:31]
v_mfma_f32_16x16x32_bf16 a[20:23],a[72:75],a[152:155],a[20:23]
v_mfma_f32_16x16x32_bf16 a[20:23],a[76:79],a[168:171],a[20:23]
v_mfma_f32_16x16x32_bf16 a[12:15],a[72:75],a[148:151],a[12:15]
v_mfma_f32_16x16x32_bf16 a[12:15],a[76:79],a[164:167],a[12:15]
v_mfma_f32_16x16x32_bf16 a[4:7],a[72:75],a[144:147],a[4:7]
ds_read_b64_tr_b16 a[72:73],v246 offset:8
ds_read_b64_tr_b16 a[74:75],v246 offset:2184
v_mfma_f32_16x16x32_bf16 a[4:7],a[76:79],a[160:163],a[4:7]
s_waitcnt lgkmcnt(2)
ds_read_b64_tr_b16 a[76:77],v246 offset:264
ds_read_b64_tr_b16 a[78:79],v246 offset:2440
v_mfma_f32_16x16x32_bf16 v[0:3],a[64:67],a[176:179],v[0:3]
v_mfma_f32_16x16x32_bf16 v[0:3],a[68:71],a[192:195],v[0:3]
v_mfma_f32_16x16x32_bf16 v[8:11],a[64:67],a[180:183],v[8:11]
v_mfma_f32_16x16x32_bf16 v[8:11],a[68:71],a[196:199],v[8:11]
v_mfma_f32_16x16x32_bf16 v[16:19],a[64:67],a[184:187],v[16:19]
s_add_u32 m0,s33,121856
s_mov_b32 s35,3145728
v_mfma_f32_16x16x32_bf16 v[16:19],a[68:71],a[200:203],v[16:19]
buffer_load_dwordx4 v249,s[16:19],s35 offen  lds
v_mfma_f32_16x16x32_bf16 v[24:27],a[64:67],a[188:191],v[24:27]
ds_read_b64_tr_b16 a[64:65],v246 offset:64
ds_read_b64_tr_b16 a[66:67],v246 offset:2240
v_mfma_f32_16x16x32_bf16 v[24:27],a[68:71],a[204:207],v[24:27]
s_waitcnt lgkmcnt(2)
ds_read_b64_tr_b16 a[68:69],v246 offset:320
v_mfma_f32_16x16x32_bf16 v[28:31],a[72:75],a[188:191],v[28:31]
ds_read_b64_tr_b16 a[70:71],v246 offset:2496
s_add_u32 m0,s32,34816
s_mov_b32 s34,32768
v_mfma_f32_16x16x32_bf16 v[28:31],a[76:79],a[204:207],v[28:31]
buffer_load_dwordx4 v237,s[12:15],s34 offen offset:0 sc0 sc1 nt lds
v_mfma_f32_16x16x32_bf16 v[20:23],a[72:75],a[184:187],v[20:23]
v_mfma_f32_16x16x32_bf16 v[20:23],a[76:79],a[200:203],v[20:23]
v_mfma_f32_16x16x32_bf16 v[12:15],a[72:75],a[180:183],v[12:15]
v_mfma_f32_16x16x32_bf16 v[12:15],a[76:79],a[196:199],v[12:15]
s_add_u32 m0,s33,122944
v_mfma_f32_16x16x32_bf16 v[4:7],a[72:75],a[176:179],v[4:7]
ds_read_b64_tr_b16 a[72:73],v246 offset:72
ds_read_b64_tr_b16 a[74:75],v246 offset:2248
v_mfma_f32_16x16x32_bf16 v[4:7],a[76:79],a[192:195],v[4:7]
s_waitcnt lgkmcnt(2)
ds_read_b64_tr_b16 a[76:77],v246 offset:328
v_mfma_f32_16x16x32_bf16 v[32:35],a[64:67],a[176:179],v[32:35]
ds_read_b64_tr_b16 a[78:79],v246 offset:2504
s_mov_b32 s35,3162112
v_mfma_f32_16x16x32_bf16 v[32:35],a[68:71],a[192:195],v[32:35]
buffer_load_dwordx4 v249,s[16:19],s35 offen  lds
v_mfma_f32_16x16x32_bf16 v[40:43],a[64:67],a[180:183],v[40:43]
v_mfma_f32_16x16x32_bf16 v[40:43],a[68:71],a[196:199],v[40:43]
v_mfma_f32_16x16x32_bf16 v[48:51],a[64:67],a[184:187],v[48:51]
s_add_u32 m0,s32,34880
v_mfma_f32_16x16x32_bf16 v[48:51],a[68:71],a[200:203],v[48:51]
buffer_load_dwordx4 v237,s[12:15],s34 offen offset:1024 sc0 sc1 nt lds
v_mfma_f32_16x16x32_bf16 v[56:59],a[64:67],a[188:191],v[56:59]
ds_read_b64_tr_b16 a[64:65],v247 offset:128
ds_read_b64_tr_b16 a[66:67],v247 offset:2304
v_mfma_f32_16x16x32_bf16 v[56:59],a[68:71],a[204:207],v[56:59]
s_waitcnt lgkmcnt(2)
ds_read_b64_tr_b16 a[68:69],v247 offset:384
v_mfma_f32_16x16x32_bf16 v[60:63],a[72:75],a[188:191],v[60:63]
ds_read_b64_tr_b16 a[70:71],v247 offset:2560
v_mfma_f32_16x16x32_bf16 v[60:63],a[76:79],a[204:207],v[60:63]
v_mfma_f32_16x16x32_bf16 v[52:55],a[72:75],a[184:187],v[52:55]
v_mfma_f32_16x16x32_bf16 v[52:55],a[76:79],a[200:203],v[52:55]
v_mfma_f32_16x16x32_bf16 v[44:47],a[72:75],a[180:183],v[44:47]
s_add_u32 m0,s33,124032
s_mov_b32 s35,3178496
v_mfma_f32_16x16x32_bf16 v[44:47],a[76:79],a[196:199],v[44:47]
buffer_load_dwordx4 v249,s[16:19],s35 offen  lds
v_mfma_f32_16x16x32_bf16 v[36:39],a[72:75],a[176:179],v[36:39]
ds_read_b64_tr_b16 a[72:73],v247 offset:136
ds_read_b64_tr_b16 a[74:75],v247 offset:2312
v_mfma_f32_16x16x32_bf16 v[36:39],a[76:79],a[192:195],v[36:39]
s_waitcnt lgkmcnt(2)
ds_read_b64_tr_b16 a[76:77],v247 offset:392
v_mfma_f32_16x16x32_bf16 v[64:67],a[64:67],a[176:179],v[64:67]
ds_read_b64_tr_b16 a[78:79],v247 offset:2568
s_add_u32 m0,s32,34944
v_mfma_f32_16x16x32_bf16 v[64:67],a[68:71],a[192:195],v[64:67]
buffer_load_dwordx4 v237,s[12:15],s34 offen offset:2048 sc0 sc1 nt lds
v_mfma_f32_16x16x32_bf16 v[72:75],a[64:67],a[180:183],v[72:75]
v_mfma_f32_16x16x32_bf16 v[72:75],a[68:71],a[196:199],v[72:75]
v_mfma_f32_16x16x32_bf16 v[80:83],a[64:67],a[184:187],v[80:83]
v_mfma_f32_16x16x32_bf16 v[80:83],a[68:71],a[200:203],v[80:83]
s_add_u32 m0,s33,125120
v_mfma_f32_16x16x32_bf16 v[88:91],a[64:67],a[188:191],v[88:91]
ds_read_b64_tr_b16 a[64:65],v247 offset:192
ds_read_b64_tr_b16 a[66:67],v247 offset:2368
v_mfma_f32_16x16x32_bf16 v[88:91],a[68:71],a[204:207],v[88:91]
s_waitcnt lgkmcnt(2)
ds_read_b64_tr_b16 a[68:69],v247 offset:448
v_mfma_f32_16x16x32_bf16 v[92:95],a[72:75],a[188:191],v[92:95]
ds_read_b64_tr_b16 a[70:71],v247 offset:2624
s_mov_b32 s35,3194880
v_mfma_f32_16x16x32_bf16 v[92:95],a[76:79],a[204:207],v[92:95]
buffer_load_dwordx4 v249,s[16:19],s35 offen  lds
v_mfma_f32_16x16x32_bf16 v[84:87],a[72:75],a[184:187],v[84:87]
v_mfma_f32_16x16x32_bf16 v[84:87],a[76:79],a[200:203],v[84:87]
v_mfma_f32_16x16x32_bf16 v[76:79],a[72:75],a[180:183],v[76:79]
s_add_u32 m0,s32,35008
v_mfma_f32_16x16x32_bf16 v[76:79],a[76:79],a[196:199],v[76:79]
buffer_load_dwordx4 v237,s[12:15],s34 offen offset:3072 sc0 sc1 nt lds
v_mfma_f32_16x16x32_bf16 v[68:71],a[72:75],a[176:179],v[68:71]
ds_read_b64_tr_b16 a[72:73],v247 offset:200
ds_read_b64_tr_b16 a[74:75],v247 offset:2376
v_mfma_f32_16x16x32_bf16 v[68:71],a[76:79],a[192:195],v[68:71]
s_waitcnt lgkmcnt(2)
ds_read_b64_tr_b16 a[76:77],v247 offset:456
v_mfma_f32_16x16x32_bf16 v[96:99],a[64:67],a[176:179],v[96:99]
ds_read_b64_tr_b16 a[78:79],v247 offset:2632
v_mfma_f32_16x16x32_bf16 v[96:99],a[68:71],a[192:195],v[96:99]
v_mfma_f32_16x16x32_bf16 v[104:107],a[64:67],a[180:183],v[104:107]
s_waitcnt vmcnt(24)
s_barrier
v_mfma_f32_16x16x32_bf16 v[104:107],a[68:71],a[196:199],v[104:107]
v_mfma_f32_16x16x32_bf16 v[112:115],a[64:67],a[184:187],v[112:115]
v_mfma_f32_16x16x32_bf16 v[112:115],a[68:71],a[200:203],v[112:115]
v_mfma_f32_16x16x32_bf16 v[120:123],a[64:67],a[188:191],v[120:123]
ds_read_b64_tr_b16 a[64:65],v244 offset:0
ds_read_b64_tr_b16 a[66:67],v244 offset:2176
v_mfma_f32_16x16x32_bf16 v[120:123],a[68:71],a[204:207],v[120:123]
s_waitcnt lgkmcnt(2)
ds_read_b64_tr_b16 a[68:69],v244 offset:256
v_mfma_f32_16x16x32_bf16 v[124:127],a[72:75],a[188:191],v[124:127]
ds_read_b64_tr_b16 a[70:71],v244 offset:2432
v_mfma_f32_16x16x32_bf16 v[124:127],a[76:79],a[204:207],v[124:127]
v_mfma_f32_16x16x32_bf16 v[116:119],a[72:75],a[184:187],v[116:119]
v_mfma_f32_16x16x32_bf16 v[116:119],a[76:79],a[200:203],v[116:119]
v_mfma_f32_16x16x32_bf16 v[108:111],a[72:75],a[180:183],v[108:111]
v_mfma_f32_16x16x32_bf16 v[108:111],a[76:79],a[196:199],v[108:111]
v_mfma_f32_16x16x32_bf16 v[100:103],a[72:75],a[176:179],v[100:103]
ds_read_b64_tr_b16 a[72:73],v244 offset:8
ds_read_b64_tr_b16 a[74:75],v244 offset:2184
v_mfma_f32_16x16x32_bf16 v[100:103],a[76:79],a[192:195],v[100:103]
s_waitcnt lgkmcnt(2)
ds_read_b64_tr_b16 a[76:77],v244 offset:264
ds_read_b64_tr_b16 a[78:79],v244 offset:2440
v_mfma_f32_16x16x32_bf16 v[128:131],a[64:67],a[176:179],v[128:131]
v_accvgpr_write_b32 a144,0
v_accvgpr_write_b32 a145,0
v_mfma_f32_16x16x32_bf16 v[128:131],a[68:71],a[192:195],v[128:131]
v_accvgpr_write_b32 a146,0
v_accvgpr_write_b32 a147,0
v_mfma_f32_16x16x32_bf16 v[136:139],a[64:67],a[180:183],v[136:139]
v_accvgpr_write_b32 a148,0
v_accvgpr_write_b32 a149,0
v_mfma_f32_16x16x32_bf16 v[136:139],a[68:71],a[196:199],v[136:139]
v_accvgpr_write_b32 a150,0
v_accvgpr_write_b32 a151,0
v_mfma_f32_16x16x32_bf16 v[144:147],a[64:67],a[184:187],v[144:147]
s_add_u32 m0,s33,139264
s_mov_b32 s35,3145984
v_mfma_f32_16x16x32_bf16 v[144:147],a[68:71],a[200:203],v[144:147]
buffer_load_dwordx4 v249,s[16:19],s35 offen  lds
v_mfma_f32_16x16x32_bf16 v[152:155],a[64:67],a[188:191],v[152:155]
ds_read_b64_tr_b16 a[64:65],v244 offset:64
ds_read_b64_tr_b16 a[66:67],v244 offset:2240
v_mfma_f32_16x16x32_bf16 v[152:155],a[68:71],a[204:207],v[152:155]
s_waitcnt lgkmcnt(2)
ds_read_b64_tr_b16 a[68:69],v244 offset:320
v_mfma_f32_16x16x32_bf16 v[156:159],a[72:75],a[188:191],v[156:159]
ds_read_b64_tr_b16 a[70:71],v244 offset:2496
s_add_u32 m0,s32,52224
s_mov_b32 s34,49152
v_mfma_f32_16x16x32_bf16 v[156:159],a[76:79],a[204:207],v[156:159]
buffer_load_dwordx4 v237,s[12:15],s34 offen offset:0 sc0 sc1 nt lds
v_mfma_f32_16x16x32_bf16 v[148:151],a[72:75],a[184:187],v[148:151]
v_accvgpr_write_b32 a152,0
v_accvgpr_write_b32 a153,0
v_mfma_f32_16x16x32_bf16 v[148:151],a[76:79],a[200:203],v[148:151]
v_accvgpr_write_b32 a154,0
v_accvgpr_write_b32 a155,0
v_mfma_f32_16x16x32_bf16 v[140:143],a[72:75],a[180:183],v[140:143]
v_accvgpr_write_b32 a156,0
v_accvgpr_write_b32 a157,0
v_mfma_f32_16x16x32_bf16 v[140:143],a[76:79],a[196:199],v[140:143]
s_add_u32 m0,s33,140352
v_accvgpr_write_b32 a158,0
v_mfma_f32_16x16x32_bf16 v[132:135],a[72:75],a[176:179],v[132:135]
ds_read_b64_tr_b16 a[72:73],v244 offset:72
ds_read_b64_tr_b16 a[74:75],v244 offset:2248
v_mfma_f32_16x16x32_bf16 v[132:135],a[76:79],a[192:195],v[132:135]
s_waitcnt lgkmcnt(2)
ds_read_b64_tr_b16 a[76:77],v244 offset:328
v_mfma_f32_16x16x32_bf16 v[160:163],a[64:67],a[176:179],v[160:163]
ds_read_b64_tr_b16 a[78:79],v244 offset:2504
s_mov_b32 s35,3162368
v_mfma_f32_16x16x32_bf16 v[160:163],a[68:71],a[192:195],v[160:163]
buffer_load_dwordx4 v249,s[16:19],s35 offen  lds
v_mfma_f32_16x16x32_bf16 v[168:171],a[64:67],a[180:183],v[168:171]
v_accvgpr_write_b32 a159,0
v_accvgpr_write_b32 a160,0
v_mfma_f32_16x16x32_bf16 v[168:171],a[68:71],a[196:199],v[168:171]
v_accvgpr_write_b32 a161,0
v_accvgpr_write_b32 a162,0
v_mfma_f32_16x16x32_bf16 v[176:179],a[64:67],a[184:187],v[176:179]
s_add_u32 m0,s32,52288
v_accvgpr_write_b32 a163,0
v_mfma_f32_16x16x32_bf16 v[176:179],a[68:71],a[200:203],v[176:179]
buffer_load_dwordx4 v237,s[12:15],s34 offen offset:1024 sc0 sc1 nt lds
v_mfma_f32_16x16x32_bf16 v[184:187],a[64:67],a[188:191],v[184:187]
ds_read_b64_tr_b16 a[64:65],v245 offset:128
ds_read_b64_tr_b16 a[66:67],v245 offset:2304
v_mfma_f32_16x16x32_bf16 v[184:187],a[68:71],a[204:207],v[184:187]
s_waitcnt lgkmcnt(2)
ds_read_b64_tr_b16 a[68:69],v245 offset:384
v_mfma_f32_16x16x32_bf16 v[188:191],a[72:75],a[188:191],v[188:191]
ds_read_b64_tr_b16 a[70:71],v245 offset:2560
v_accvgpr_write_b32 a164,0
v_mfma_f32_16x16x32_bf16 v[188:191],a[76:79],a[204:207],v[188:191]
v_accvgpr_write_b32 a165,0
v_accvgpr_write_b32 a166,0
v_mfma_f32_16x16x32_bf16 v[180:183],a[72:75],a[184:187],v[180:183]
v_accvgpr_write_b32 a167,0
v_accvgpr_write_b32 a168,0
v_mfma_f32_16x16x32_bf16 v[180:183],a[76:79],a[200:203],v[180:183]
v_accvgpr_write_b32 a169,0
v_accvgpr_write_b32 a170,0
v_mfma_f32_16x16x32_bf16 v[172:175],a[72:75],a[180:183],v[172:175]
s_add_u32 m0,s33,141440
s_mov_b32 s35,3178752
v_mfma_f32_16x16x32_bf16 v[172:175],a[76:79],a[196:199],v[172:175]
buffer_load_dwordx4 v249,s[16:19],s35 offen  lds
v_mfma_f32_16x16x32_bf16 v[164:167],a[72:75],a[176:179],v[164:167]
ds_read_b64_tr_b16 a[72:73],v245 offset:136
ds_read_b64_tr_b16 a[74:75],v245 offset:2312
v_mfma_f32_16x16x32_bf16 v[164:167],a[76:79],a[192:195],v[164:167]
s_waitcnt lgkmcnt(2)
ds_read_b64_tr_b16 a[76:77],v245 offset:392
v_mfma_f32_16x16x32_bf16 v[192:195],a[64:67],a[176:179],v[192:195]
ds_read_b64_tr_b16 a[78:79],v245 offset:2568
s_add_u32 m0,s32,52352
v_mfma_f32_16x16x32_bf16 v[192:195],a[68:71],a[192:195],v[192:195]
buffer_load_dwordx4 v237,s[12:15],s34 offen offset:2048 sc0 sc1 nt lds
v_mfma_f32_16x16x32_bf16 v[200:203],a[64:67],a[180:183],v[200:203]
v_accvgpr_write_b32 a171,0
v_accvgpr_write_b32 a172,0
v_mfma_f32_16x16x32_bf16 v[200:203],a[68:71],a[196:199],v[200:203]
v_accvgpr_write_b32 a173,0
v_accvgpr_write_b32 a174,0
v_mfma_f32_16x16x32_bf16 v[208:211],a[64:67],a[184:187],v[208:211]
v_accvgpr_write_b32 a175,0
v_mfma_f32_16x16x32_bf16 v[208:211],a[68:71],a[200:203],v[208:211]
s_add_u32 m0,s33,142528
v_mfma_f32_16x16x32_bf16 v[216:219],a[64:67],a[188:191],v[216:219]
ds_read_b64_tr_b16 a[64:65],v245 offset:192
ds_read_b64_tr_b16 a[66:67],v245 offset:2368
v_mfma_f32_16x16x32_bf16 v[216:219],a[68:71],a[204:207],v[216:219]
s_waitcnt lgkmcnt(2)
ds_read_b64_tr_b16 a[68:69],v245 offset:448
v_mfma_f32_16x16x32_bf16 v[220:223],a[72:75],a[188:191],v[220:223]
ds_read_b64_tr_b16 a[70:71],v245 offset:2624
s_mov_b32 s35,3195136
v_mfma_f32_16x16x32_bf16 v[220:223],a[76:79],a[204:207],v[220:223]
buffer_load_dwordx4 v249,s[16:19],s35 offen  lds
v_mfma_f32_16x16x32_bf16 v[212:215],a[72:75],a[184:187],v[212:215]
v_mfma_f32_16x16x32_bf16 v[212:215],a[76:79],a[200:203],v[212:215]
v_mfma_f32_16x16x32_bf16 v[204:207],a[72:75],a[180:183],v[204:207]
s_add_u32 m0,s32,52416
v_mfma_f32_16x16x32_bf16 v[204:207],a[76:79],a[196:199],v[204:207]
buffer_load_dwordx4 v237,s[12:15],s34 offen offset:3072 sc0 sc1 nt lds
v_mfma_f32_16x16x32_bf16 v[196:199],a[72:75],a[176:179],v[196:199]
ds_read_b64_tr_b16 a[72:73],v245 offset:200
ds_read_b64_tr_b16 a[74:75],v245 offset:2376
v_mfma_f32_16x16x32_bf16 v[196:199],a[76:79],a[192:195],v[196:199]
s_waitcnt lgkmcnt(2)
ds_read_b64_tr_b16 a[76:77],v245 offset:456
v_mfma_f32_16x16x32_bf16 a[0:3],a[64:67],a[176:179],a[0:3]
ds_read_b64_tr_b16 a[78:79],v245 offset:2632
v_mfma_f32_16x16x32_bf16 a[0:3],a[68:71],a[192:195],a[0:3]
v_mfma_f32_16x16x32_bf16 a[8:11],a[64:67],a[180:183],a[8:11]
s_waitcnt vmcnt(25)
s_barrier
v_mfma_f32_16x16x32_bf16 a[8:11],a[68:71],a[196:199],a[8:11]
v_mfma_f32_16x16x32_bf16 a[16:19],a[64:67],a[184:187],a[16:19]
v_mfma_f32_16x16x32_bf16 a[16:19],a[68:71],a[200:203],a[16:19]
v_mfma_f32_16x16x32_bf16 a[24:27],a[64:67],a[188:191],a[24:27]
ds_read_b64_tr_b16 a[64:65],v244 offset:17408
ds_read_b64_tr_b16 a[66:67],v244 offset:19584
v_mfma_f32_16x16x32_bf16 a[24:27],a[68:71],a[204:207],a[24:27]
s_waitcnt lgkmcnt(2)
ds_read_b64_tr_b16 a[68:69],v244 offset:17664
v_mfma_f32_16x16x32_bf16 a[28:31],a[72:75],a[188:191],a[28:31]
ds_read_b64_tr_b16 a[70:71],v244 offset:19840
v_mfma_f32_16x16x32_bf16 a[28:31],a[76:79],a[204:207],a[28:31]
v_mfma_f32_16x16x32_bf16 a[20:23],a[72:75],a[184:187],a[20:23]
v_mfma_f32_16x16x32_bf16 a[20:23],a[76:79],a[200:203],a[20:23]
v_mfma_f32_16x16x32_bf16 a[12:15],a[72:75],a[180:183],a[12:15]
v_mfma_f32_16x16x32_bf16 a[12:15],a[76:79],a[196:199],a[12:15]
v_mfma_f32_16x16x32_bf16 a[4:7],a[72:75],a[176:179],a[4:7]
ds_read_b64_tr_b16 a[72:73],v244 offset:17416
ds_read_b64_tr_b16 a[74:75],v244 offset:19592
v_mfma_f32_16x16x32_bf16 a[4:7],a[76:79],a[192:195],a[4:7]
s_waitcnt lgkmcnt(2)
ds_read_b64_tr_b16 a[76:77],v244 offset:17672
ds_read_b64_tr_b16 a[78:79],v244 offset:19848
v_mfma_f32_16x16x32_bf16 v[0:3],a[64:67],a[208:211],v[0:3]
v_mfma_f32_16x16x32_bf16 v[0:3],a[68:71],a[224:227],v[0:3]
v_mfma_f32_16x16x32_bf16 v[8:11],a[64:67],a[212:215],v[8:11]
v_mfma_f32_16x16x32_bf16 v[8:11],a[68:71],a[228:231],v[8:11]
v_mfma_f32_16x16x32_bf16 v[16:19],a[64:67],a[216:219],v[16:19]
s_add_u32 m0,s32,69632
s_mov_b32 s34,0
v_mfma_f32_16x16x32_bf16 v[16:19],a[68:71],a[232:235],v[16:19]
buffer_load_dwordx4 v236,s[8:11],s34 offen offset:0 sc0 sc1 nt lds
v_mfma_f32_16x16x32_bf16 v[24:27],a[64:67],a[220:223],v[24:27]
ds_read_b64_tr_b16 a[64:65],v244 offset:17472
ds_read_b64_tr_b16 a[66:67],v244 offset:19648
v_mfma_f32_16x16x32_bf16 v[24:27],a[68:71],a[236:239],v[24:27]
s_waitcnt lgkmcnt(2)
ds_read_b64_tr_b16 a[68:69],v244 offset:17728
v_mfma_f32_16x16x32_bf16 v[28:31],a[72:75],a[220:223],v[28:31]
ds_read_b64_tr_b16 a[70:71],v244 offset:19904
v_mfma_f32_16x16x32_bf16 v[28:31],a[76:79],a[236:239],v[28:31]
v_mfma_f32_16x16x32_bf16 v[20:23],a[72:75],a[216:219],v[20:23]
v_mfma_f32_16x16x32_bf16 v[20:23],a[76:79],a[232:235],v[20:23]
v_mfma_f32_16x16x32_bf16 v[12:15],a[72:75],a[212:215],v[12:15]
v_mfma_f32_16x16x32_bf16 v[12:15],a[76:79],a[228:231],v[12:15]
v_mfma_f32_16x16x32_bf16 v[4:7],a[72:75],a[208:211],v[4:7]
ds_read_b64_tr_b16 a[72:73],v244 offset:17480
ds_read_b64_tr_b16 a[74:75],v244 offset:19656
v_mfma_f32_16x16x32_bf16 v[4:7],a[76:79],a[224:227],v[4:7]
s_waitcnt lgkmcnt(2)
ds_read_b64_tr_b16 a[76:77],v244 offset:17736
v_mfma_f32_16x16x32_bf16 v[32:35],a[64:67],a[208:211],v[32:35]
ds_read_b64_tr_b16 a[78:79],v244 offset:19912
s_add_u32 m0,s32,69696
v_mfma_f32_16x16x32_bf16 v[32:35],a[68:71],a[224:227],v[32:35]
buffer_load_dwordx4 v236,s[8:11],s34 offen offset:1024 sc0 sc1 nt lds
v_mfma_f32_16x16x32_bf16 v[40:43],a[64:67],a[212:215],v[40:43]
v_mfma_f32_16x16x32_bf16 v[40:43],a[68:71],a[228:231],v[40:43]
v_mfma_f32_16x16x32_bf16 v[48:51],a[64:67],a[216:219],v[48:51]
v_mfma_f32_16x16x32_bf16 v[48:51],a[68:71],a[232:235],v[48:51]
v_mfma_f32_16x16x32_bf16 v[56:59],a[64:67],a[220:223],v[56:59]
ds_read_b64_tr_b16 a[64:65],v245 offset:17536
ds_read_b64_tr_b16 a[66:67],v245 offset:19712
v_mfma_f32_16x16x32_bf16 v[56:59],a[68:71],a[236:239],v[56:59]
s_waitcnt lgkmcnt(2)
ds_read_b64_tr_b16 a[68:69],v245 offset:17792
v_mfma_f32_16x16x32_bf16 v[60:63],a[72:75],a[220:223],v[60:63]
ds_read_b64_tr_b16 a[70:71],v245 offset:19968
v_mfma_f32_16x16x32_bf16 v[60:63],a[76:79],a[236:239],v[60:63]
v_mfma_f32_16x16x32_bf16 v[52:55],a[72:75],a[216:219],v[52:55]
v_mfma_f32_16x16x32_bf16 v[52:55],a[76:79],a[232:235],v[52:55]
v_mfma_f32_16x16x32_bf16 v[44:47],a[72:75],a[212:215],v[44:47]
s_add_u32 m0,s32,69760
v_mfma_f32_16x16x32_bf16 v[44:47],a[76:79],a[228:231],v[44:47]
buffer_load_dwordx4 v236,s[8:11],s34 offen offset:2048 sc0 sc1 nt lds
v_mfma_f32_16x16x32_bf16 v[36:39],a[72:75],a[208:211],v[36:39]
ds_read_b64_tr_b16 a[72:73],v245 offset:17544
ds_read_b64_tr_b16 a[74:75],v245 offset:19720
v_mfma_f32_16x16x32_bf16 v[36:39],a[76:79],a[224:227],v[36:39]
s_waitcnt lgkmcnt(2)
ds_read_b64_tr_b16 a[76:77],v245 offset:17800
v_mfma_f32_16x16x32_bf16 v[64:67],a[64:67],a[208:211],v[64:67]
ds_read_b64_tr_b16 a[78:79],v245 offset:19976
v_mfma_f32_16x16x32_bf16 v[64:67],a[68:71],a[224:227],v[64:67]
v_mfma_f32_16x16x32_bf16 v[72:75],a[64:67],a[212:215],v[72:75]
v_mfma_f32_16x16x32_bf16 v[72:75],a[68:71],a[228:231],v[72:75]
v_mfma_f32_16x16x32_bf16 v[80:83],a[64:67],a[216:219],v[80:83]
v_mfma_f32_16x16x32_bf16 v[80:83],a[68:71],a[232:235],v[80:83]
v_mfma_f32_16x16x32_bf16 v[88:91],a[64:67],a[220:223],v[88:91]
ds_read_b64_tr_b16 a[64:65],v245 offset:17600
ds_read_b64_tr_b16 a[66:67],v245 offset:19776
v_mfma_f32_16x16x32_bf16 v[88:91],a[68:71],a[236:239],v[88:91]
s_waitcnt lgkmcnt(2)
ds_read_b64_tr_b16 a[68:69],v245 offset:17856
v_mfma_f32_16x16x32_bf16 v[92:95],a[72:75],a[220:223],v[92:95]
ds_read_b64_tr_b16 a[70:71],v245 offset:20032
s_add_u32 m0,s32,69824
v_mfma_f32_16x16x32_bf16 v[92:95],a[76:79],a[236:239],v[92:95]
buffer_load_dwordx4 v236,s[8:11],s34 offen offset:3072 sc0 sc1 nt lds
v_mfma_f32_16x16x32_bf16 v[84:87],a[72:75],a[216:219],v[84:87]
v_mfma_f32_16x16x32_bf16 v[84:87],a[76:79],a[232:235],v[84:87]
v_mfma_f32_16x16x32_bf16 v[76:79],a[72:75],a[212:215],v[76:79]
v_mfma_f32_16x16x32_bf16 v[76:79],a[76:79],a[228:231],v[76:79]
v_mfma_f32_16x16x32_bf16 v[68:71],a[72:75],a[208:211],v[68:71]
ds_read_b64_tr_b16 a[72:73],v245 offset:17608
ds_read_b64_tr_b16 a[74:75],v245 offset:19784
v_mfma_f32_16x16x32_bf16 v[68:71],a[76:79],a[224:227],v[68:71]
s_waitcnt lgkmcnt(2)
ds_read_b64_tr_b16 a[76:77],v245 offset:17864
v_mfma_f32_16x16x32_bf16 v[96:99],a[64:67],a[208:211],v[96:99]
ds_read_b64_tr_b16 a[78:79],v245 offset:20040
v_mfma_f32_16x16x32_bf16 v[96:99],a[68:71],a[224:227],v[96:99]
v_mfma_f32_16x16x32_bf16 v[104:107],a[64:67],a[212:215],v[104:107]
s_waitcnt vmcnt(21)
s_barrier
v_mfma_f32_16x16x32_bf16 v[104:107],a[68:71],a[228:231],v[104:107]
v_mfma_f32_16x16x32_bf16 v[112:115],a[64:67],a[216:219],v[112:115]
v_mfma_f32_16x16x32_bf16 v[112:115],a[68:71],a[232:235],v[112:115]
v_mfma_f32_16x16x32_bf16 v[120:123],a[64:67],a[220:223],v[120:123]
ds_read_b64_tr_b16 a[64:65],v244 offset:34816
ds_read_b64_tr_b16 a[66:67],v244 offset:36992
v_mfma_f32_16x16x32_bf16 v[120:123],a[68:71],a[236:239],v[120:123]
s_waitcnt lgkmcnt(2)
ds_read_b64_tr_b16 a[68:69],v244 offset:35072
v_mfma_f32_16x16x32_bf16 v[124:127],a[72:75],a[220:223],v[124:127]
ds_read_b64_tr_b16 a[70:71],v244 offset:37248
v_mfma_f32_16x16x32_bf16 v[124:127],a[76:79],a[236:239],v[124:127]
v_mfma_f32_16x16x32_bf16 v[116:119],a[72:75],a[216:219],v[116:119]
v_mfma_f32_16x16x32_bf16 v[116:119],a[76:79],a[232:235],v[116:119]
v_mfma_f32_16x16x32_bf16 v[108:111],a[72:75],a[212:215],v[108:111]
v_mfma_f32_16x16x32_bf16 v[108:111],a[76:79],a[228:231],v[108:111]
v_mfma_f32_16x16x32_bf16 v[100:103],a[72:75],a[208:211],v[100:103]
ds_read_b64_tr_b16 a[72:73],v244 offset:34824
ds_read_b64_tr_b16 a[74:75],v244 offset:37000
v_mfma_f32_16x16x32_bf16 v[100:103],a[76:79],a[224:227],v[100:103]
s_waitcnt lgkmcnt(2)
ds_read_b64_tr_b16 a[76:77],v244 offset:35080
ds_read_b64_tr_b16 a[78:79],v244 offset:37256
v_mfma_f32_16x16x32_bf16 v[128:131],a[64:67],a[208:211],v[128:131]
v_accvgpr_write_b32 a176,0
v_accvgpr_write_b32 a177,0
v_mfma_f32_16x16x32_bf16 v[128:131],a[68:71],a[224:227],v[128:131]
v_accvgpr_write_b32 a178,0
v_accvgpr_write_b32 a179,0
v_mfma_f32_16x16x32_bf16 v[136:139],a[64:67],a[212:215],v[136:139]
v_accvgpr_write_b32 a180,0
v_accvgpr_write_b32 a181,0
v_mfma_f32_16x16x32_bf16 v[136:139],a[68:71],a[228:231],v[136:139]
v_accvgpr_write_b32 a182,0
v_accvgpr_write_b32 a183,0
v_mfma_f32_16x16x32_bf16 v[144:147],a[64:67],a[216:219],v[144:147]
s_add_u32 m0,s32,87040
s_mov_b32 s34,16384
v_mfma_f32_16x16x32_bf16 v[144:147],a[68:71],a[232:235],v[144:147]
buffer_load_dwordx4 v236,s[8:11],s34 offen offset:0 sc0 sc1 nt lds
v_mfma_f32_16x16x32_bf16 v[152:155],a[64:67],a[220:223],v[152:155]
ds_read_b64_tr_b16 a[64:65],v244 offset:34880
ds_read_b64_tr_b16 a[66:67],v244 offset:37056
v_mfma_f32_16x16x32_bf16 v[152:155],a[68:71],a[236:239],v[152:155]
s_waitcnt lgkmcnt(2)
ds_read_b64_tr_b16 a[68:69],v244 offset:35136
v_mfma_f32_16x16x32_bf16 v[156:159],a[72:75],a[220:223],v[156:159]
ds_read_b64_tr_b16 a[70:71],v244 offset:37312
v_accvgpr_write_b32 a184,0
v_mfma_f32_16x16x32_bf16 v[156:159],a[76:79],a[236:239],v[156:159]
v_accvgpr_write_b32 a185,0
v_accvgpr_write_b32 a186,0
v_mfma_f32_16x16x32_bf16 v[148:151],a[72:75],a[216:219],v[148:151]
v_accvgpr_write_b32 a187,0
v_accvgpr_write_b32 a188,0
v_mfma_f32_16x16x32_bf16 v[148:151],a[76:79],a[232:235],v[148:151]
v_accvgpr_write_b32 a189,0
v_accvgpr_write_b32 a190,0
v_mfma_f32_16x16x32_bf16 v[140:143],a[72:75],a[212:215],v[140:143]
v_accvgpr_write_b32 a191,0
v_accvgpr_write_b32 a192,0
v_mfma_f32_16x16x32_bf16 v[140:143],a[76:79],a[228:231],v[140:143]
v_accvgpr_write_b32 a193,0
v_accvgpr_write_b32 a194,0
v_mfma_f32_16x16x32_bf16 v[132:135],a[72:75],a[208:211],v[132:135]
ds_read_b64_tr_b16 a[72:73],v244 offset:34888
ds_read_b64_tr_b16 a[74:75],v244 offset:37064
v_mfma_f32_16x16x32_bf16 v[132:135],a[76:79],a[224:227],v[132:135]
s_waitcnt lgkmcnt(2)
ds_read_b64_tr_b16 a[76:77],v244 offset:35144
v_mfma_f32_16x16x32_bf16 v[160:163],a[64:67],a[208:211],v[160:163]
ds_read_b64_tr_b16 a[78:79],v244 offset:37320
s_add_u32 m0,s32,87104
v_mfma_f32_16x16x32_bf16 v[160:163],a[68:71],a[224:227],v[160:163]
buffer_load_dwordx4 v236,s[8:11],s34 offen offset:1024 sc0 sc1 nt lds
v_mfma_f32_16x16x32_bf16 v[168:171],a[64:67],a[212:215],v[168:171]
v_accvgpr_write_b32 a195,0
v_accvgpr_write_b32 a196,0
v_mfma_f32_16x16x32_bf16 v[168:171],a[68:71],a[228:231],v[168:171]
v_accvgpr_write_b32 a197,0
v_accvgpr_write_b32 a198,0
v_mfma_f32_16x16x32_bf16 v[176:179],a[64:67],a[216:219],v[176:179]
v_accvgpr_write_b32 a199,0
v_accvgpr_write_b32 a200,0
v_mfma_f32_16x16x32_bf16 v[176:179],a[68:71],a[232:235],v[176:179]
v_accvgpr_write_b32 a201,0
v_accvgpr_write_b32 a202,0
v_mfma_f32_16x16x32_bf16 v[184:187],a[64:67],a[220:223],v[184:187]
ds_read_b64_tr_b16 a[64:65],v245 offset:34944
ds_read_b64_tr_b16 a[66:67],v245 offset:37120
v_mfma_f32_16x16x32_bf16 v[184:187],a[68:71],a[236:239],v[184:187]
s_waitcnt lgkmcnt(2)
ds_read_b64_tr_b16 a[68:69],v245 offset:35200
v_mfma_f32_16x16x32_bf16 v[188:191],a[72:75],a[220:223],v[188:191]
ds_read_b64_tr_b16 a[70:71],v245 offset:37376
v_accvgpr_write_b32 a203,0
v_mfma_f32_16x16x32_bf16 v[188:191],a[76:79],a[236:239],v[188:191]
v_accvgpr_write_b32 a204,0
v_accvgpr_write_b32 a205,0
v_mfma_f32_16x16x32_bf16 v[180:183],a[72:75],a[216:219],v[180:183]
v_accvgpr_write_b32 a206,0
v_accvgpr_write_b32 a207,0
v_mfma_f32_16x16x32_bf16 v[180:183],a[76:79],a[232:235],v[180:183]
v_mfma_f32_16x16x32_bf16 v[172:175],a[72:75],a[212:215],v[172:175]
s_add_u32 m0,s32,87168
v_mfma_f32_16x16x32_bf16 v[172:175],a[76:79],a[228:231],v[172:175]
buffer_load_dwordx4 v236,s[8:11],s34 offen offset:2048 sc0 sc1 nt lds
v_mfma_f32_16x16x32_bf16 v[164:167],a[72:75],a[208:211],v[164:167]
ds_read_b64_tr_b16 a[72:73],v245 offset:34952
ds_read_b64_tr_b16 a[74:75],v245 offset:37128
v_mfma_f32_16x16x32_bf16 v[164:167],a[76:79],a[224:227],v[164:167]
s_waitcnt lgkmcnt(2)
ds_read_b64_tr_b16 a[76:77],v245 offset:35208
v_mfma_f32_16x16x32_bf16 v[192:195],a[64:67],a[208:211],v[192:195]
ds_read_b64_tr_b16 a[78:79],v245 offset:37384
v_mfma_f32_16x16x32_bf16 v[192:195],a[68:71],a[224:227],v[192:195]
v_mfma_f32_16x16x32_bf16 v[200:203],a[64:67],a[212:215],v[200:203]
v_mfma_f32_16x16x32_bf16 v[200:203],a[68:71],a[228:231],v[200:203]
v_mfma_f32_16x16x32_bf16 v[208:211],a[64:67],a[216:219],v[208:211]
v_mfma_f32_16x16x32_bf16 v[208:211],a[68:71],a[232:235],v[208:211]
v_mfma_f32_16x16x32_bf16 v[216:219],a[64:67],a[220:223],v[216:219]
ds_read_b64_tr_b16 a[64:65],v245 offset:35008
ds_read_b64_tr_b16 a[66:67],v245 offset:37184
v_mfma_f32_16x16x32_bf16 v[216:219],a[68:71],a[236:239],v[216:219]
s_waitcnt lgkmcnt(2)
ds_read_b64_tr_b16 a[68:69],v245 offset:35264
v_mfma_f32_16x16x32_bf16 v[220:223],a[72:75],a[220:223],v[220:223]
ds_read_b64_tr_b16 a[70:71],v245 offset:37440
s_add_u32 m0,s32,87232
v_mfma_f32_16x16x32_bf16 v[220:223],a[76:79],a[236:239],v[220:223]
buffer_load_dwordx4 v236,s[8:11],s34 offen offset:3072 sc0 sc1 nt lds
v_mfma_f32_16x16x32_bf16 v[212:215],a[72:75],a[216:219],v[212:215]
v_mfma_f32_16x16x32_bf16 v[212:215],a[76:79],a[232:235],v[212:215]
v_mfma_f32_16x16x32_bf16 v[204:207],a[72:75],a[212:215],v[204:207]
v_mfma_f32_16x16x32_bf16 v[204:207],a[76:79],a[228:231],v[204:207]
v_mfma_f32_16x16x32_bf16 v[196:199],a[72:75],a[208:211],v[196:199]
ds_read_b64_tr_b16 a[72:73],v245 offset:35016
ds_read_b64_tr_b16 a[74:75],v245 offset:37192
v_mfma_f32_16x16x32_bf16 v[196:199],a[76:79],a[224:227],v[196:199]
s_waitcnt lgkmcnt(2)
ds_read_b64_tr_b16 a[76:77],v245 offset:35272
v_mfma_f32_16x16x32_bf16 a[0:3],a[64:67],a[208:211],a[0:3]
ds_read_b64_tr_b16 a[78:79],v245 offset:37448
v_mfma_f32_16x16x32_bf16 a[0:3],a[68:71],a[224:227],a[0:3]
v_mfma_f32_16x16x32_bf16 a[8:11],a[64:67],a[212:215],a[8:11]
s_waitcnt vmcnt(17)
s_barrier
v_mfma_f32_16x16x32_bf16 a[8:11],a[68:71],a[228:231],a[8:11]
v_mfma_f32_16x16x32_bf16 a[16:19],a[64:67],a[216:219],a[16:19]
v_mfma_f32_16x16x32_bf16 a[16:19],a[68:71],a[232:235],a[16:19]
v_mfma_f32_16x16x32_bf16 a[24:27],a[64:67],a[220:223],a[24:27]
ds_read_b64_tr_b16 a[64:65],v244 offset:52224
ds_read_b64_tr_b16 a[66:67],v244 offset:54400
v_mfma_f32_16x16x32_bf16 a[24:27],a[68:71],a[236:239],a[24:27]
s_waitcnt lgkmcnt(2)
ds_read_b64_tr_b16 a[68:69],v244 offset:52480
v_mfma_f32_16x16x32_bf16 a[28:31],a[72:75],a[220:223],a[28:31]
ds_read_b64_tr_b16 a[70:71],v244 offset:54656
v_mfma_f32_16x16x32_bf16 a[28:31],a[76:79],a[236:239],a[28:31]
v_mfma_f32_16x16x32_bf16 a[20:23],a[72:75],a[216:219],a[20:23]
v_mfma_f32_16x16x32_bf16 a[20:23],a[76:79],a[232:235],a[20:23]
v_mfma_f32_16x16x32_bf16 a[12:15],a[72:75],a[212:215],a[12:15]
v_mfma_f32_16x16x32_bf16 a[12:15],a[76:79],a[228:231],a[12:15]
v_mfma_f32_16x16x32_bf16 a[4:7],a[72:75],a[208:211],a[4:7]
ds_read_b64_tr_b16 a[72:73],v244 offset:52232
ds_read_b64_tr_b16 a[74:75],v244 offset:54408
v_mfma_f32_16x16x32_bf16 a[4:7],a[76:79],a[224:227],a[4:7]
s_waitcnt lgkmcnt(2)
ds_read_b64_tr_b16 a[76:77],v244 offset:52488
ds_read_b64_tr_b16 a[78:79],v244 offset:54664
v_mfma_f32_16x16x32_bf16 v[0:3],a[64:67],a[32:35],v[0:3]
v_accvgpr_write_b32 a208,0
v_accvgpr_write_b32 a209,0
v_mfma_f32_16x16x32_bf16 v[0:3],a[68:71],a[48:51],v[0:3]
v_accvgpr_write_b32 a210,0
v_accvgpr_write_b32 a211,0
v_mfma_f32_16x16x32_bf16 v[8:11],a[64:67],a[36:39],v[8:11]
v_accvgpr_write_b32 a212,0
v_accvgpr_write_b32 a213,0
v_mfma_f32_16x16x32_bf16 v[8:11],a[68:71],a[52:55],v[8:11]
v_accvgpr_write_b32 a214,0
v_accvgpr_write_b32 a215,0
v_mfma_f32_16x16x32_bf16 v[16:19],a[64:67],a[40:43],v[16:19]
s_add_u32 m0,s32,104448
s_mov_b32 s34,32768
v_mfma_f32_16x16x32_bf16 v[16:19],a[68:71],a[56:59],v[16:19]
buffer_load_dwordx4 v236,s[8:11],s34 offen offset:0 sc0 sc1 nt lds
v_mfma_f32_16x16x32_bf16 v[24:27],a[64:67],a[44:47],v[24:27]
ds_read_b64_tr_b16 a[64:65],v244 offset:52288
ds_read_b64_tr_b16 a[66:67],v244 offset:54464
v_mfma_f32_16x16x32_bf16 v[24:27],a[68:71],a[60:63],v[24:27]
s_waitcnt lgkmcnt(2)
ds_read_b64_tr_b16 a[68:69],v244 offset:52544
v_mfma_f32_16x16x32_bf16 v[28:31],a[72:75],a[44:47],v[28:31]
ds_read_b64_tr_b16 a[70:71],v244 offset:54720
s_mov_b32 s20,s48
v_mfma_f32_16x16x32_bf16 v[28:31],a[76:79],a[60:63],v[28:31]
s_mov_b32 s21,s49
s_movk_i32 s22,256
v_mfma_f32_16x16x32_bf16 v[20:23],a[72:75],a[40:43],v[20:23]
s_mul_i32 s35,s4,229376
s_add_u32 s16,s46,s35
v_mfma_f32_16x16x32_bf16 v[20:23],a[76:79],a[56:59],v[20:23]
s_addc_u32 s17,s47,0
s_mov_b32 s18,229376
v_mfma_f32_16x16x32_bf16 v[12:15],a[72:75],a[36:39],v[12:15]
v_accvgpr_write_b32 a216,0
v_accvgpr_write_b32 a217,0
v_mfma_f32_16x16x32_bf16 v[12:15],a[76:79],a[52:55],v[12:15]
v_accvgpr_write_b32 a218,0
v_accvgpr_write_b32 a219,0
v_mfma_f32_16x16x32_bf16 v[4:7],a[72:75],a[32:35],v[4:7]
ds_read_b64_tr_b16 a[72:73],v244 offset:52296
ds_read_b64_tr_b16 a[74:75],v244 offset:54472
v_mfma_f32_16x16x32_bf16 v[4:7],a[76:79],a[48:51],v[4:7]
s_waitcnt lgkmcnt(2)
ds_read_b64_tr_b16 a[76:77],v244 offset:52552
v_mfma_f32_16x16x32_bf16 v[32:35],a[64:67],a[32:35],v[32:35]
ds_read_b64_tr_b16 a[78:79],v244 offset:54728
s_add_u32 m0,s32,104512
v_mfma_f32_16x16x32_bf16 v[32:35],a[68:71],a[48:51],v[32:35]
buffer_load_dwordx4 v236,s[8:11],s34 offen offset:1024 sc0 sc1 nt lds
v_mfma_f32_16x16x32_bf16 v[40:43],a[64:67],a[36:39],v[40:43]
v_accvgpr_write_b32 a220,0
v_accvgpr_write_b32 a221,0
v_mfma_f32_16x16x32_bf16 v[40:43],a[68:71],a[52:55],v[40:43]
v_accvgpr_write_b32 a222,0
v_accvgpr_write_b32 a223,0
v_mfma_f32_16x16x32_bf16 v[48:51],a[64:67],a[40:43],v[48:51]
v_accvgpr_write_b32 a224,0
v_accvgpr_write_b32 a225,0
v_mfma_f32_16x16x32_bf16 v[48:51],a[68:71],a[56:59],v[48:51]
v_accvgpr_write_b32 a226,0
v_accvgpr_write_b32 a227,0
v_mfma_f32_16x16x32_bf16 v[56:59],a[64:67],a[44:47],v[56:59]
ds_read_b64_tr_b16 a[64:65],v245 offset:52352
ds_read_b64_tr_b16 a[66:67],v245 offset:54528
v_mfma_f32_16x16x32_bf16 v[56:59],a[68:71],a[60:63],v[56:59]
s_waitcnt lgkmcnt(2)
ds_read_b64_tr_b16 a[68:69],v245 offset:52608
v_mfma_f32_16x16x32_bf16 v[60:63],a[72:75],a[44:47],v[60:63]
ds_read_b64_tr_b16 a[70:71],v245 offset:54784
v_accvgpr_write_b32 a228,0
v_mfma_f32_16x16x32_bf16 v[60:63],a[76:79],a[60:63],v[60:63]
v_accvgpr_write_b32 a229,0
v_accvgpr_write_b32 a230,0
v_mfma_f32_16x16x32_bf16 v[52:55],a[72:75],a[40:43],v[52:55]
v_accvgpr_write_b32 a231,0
v_accvgpr_write_b32 a232,0
v_mfma_f32_16x16x32_bf16 v[52:55],a[76:79],a[56:59],v[52:55]
v_accvgpr_write_b32 a233,0
v_accvgpr_write_b32 a234,0
v_mfma_f32_16x16x32_bf16 v[44:47],a[72:75],a[36:39],v[44:47]
s_add_u32 m0,s32,104576
v_accvgpr_write_b32 a235,0
v_mfma_f32_16x16x32_bf16 v[44:47],a[76:79],a[52:55],v[44:47]
buffer_load_dwordx4 v236,s[8:11],s34 offen offset:2048 sc0 sc1 nt lds
v_mfma_f32_16x16x32_bf16 v[36:39],a[72:75],a[32:35],v[36:39]
ds_read_b64_tr_b16 a[72:73],v245 offset:52360
ds_read_b64_tr_b16 a[74:75],v245 offset:54536
v_mfma_f32_16x16x32_bf16 v[36:39],a[76:79],a[48:51],v[36:39]
s_waitcnt lgkmcnt(2)
ds_read_b64_tr_b16 a[76:77],v245 offset:52616
v_mfma_f32_16x16x32_bf16 v[64:67],a[64:67],a[32:35],v[64:67]
ds_read_b64_tr_b16 a[78:79],v245 offset:54792
v_accvgpr_write_b32 a236,0
v_mfma_f32_16x16x32_bf16 v[64:67],a[68:71],a[48:51],v[64:67]
v_accvgpr_write_b32 a237,0
v_accvgpr_write_b32 a238,0
v_mfma_f32_16x16x32_bf16 v[72:75],a[64:67],a[36:39],v[72:75]
v_accvgpr_write_b32 a239,0
v_mfma_f32_16x16x32_bf16 v[72:75],a[68:71],a[52:55],v[72:75]
v_mfma_f32_16x16x32_bf16 v[80:83],a[64:67],a[40:43],v[80:83]
v_mfma_f32_16x16x32_bf16 v[80:83],a[68:71],a[56:59],v[80:83]
v_mfma_f32_16x16x32_bf16 v[88:91],a[64:67],a[44:47],v[88:91]
ds_read_b64_tr_b16 a[64:65],v245 offset:52416
ds_read_b64_tr_b16 a[66:67],v245 offset:54592
v_mfma_f32_16x16x32_bf16 v[88:91],a[68:71],a[60:63],v[88:91]
s_waitcnt lgkmcnt(2)
ds_read_b64_tr_b16 a[68:69],v245 offset:52672
v_mfma_f32_16x16x32_bf16 v[92:95],a[72:75],a[44:47],v[92:95]
ds_read_b64_tr_b16 a[70:71],v245 offset:54848
s_add_u32 m0,s32,104640
v_mfma_f32_16x16x32_bf16 v[92:95],a[76:79],a[60:63],v[92:95]
buffer_load_dwordx4 v236,s[8:11],s34 offen offset:3072 sc0 sc1 nt lds
v_mfma_f32_16x16x32_bf16 v[84:87],a[72:75],a[40:43],v[84:87]
v_mfma_f32_16x16x32_bf16 v[84:87],a[76:79],a[56:59],v[84:87]
v_mfma_f32_16x16x32_bf16 v[76:79],a[72:75],a[36:39],v[76:79]
v_mfma_f32_16x16x32_bf16 v[76:79],a[76:79],a[52:55],v[76:79]
v_mfma_f32_16x16x32_bf16 v[68:71],a[72:75],a[32:35],v[68:71]
ds_read_b64_tr_b16 a[72:73],v245 offset:52424
ds_read_b64_tr_b16 a[74:75],v245 offset:54600
v_mfma_f32_16x16x32_bf16 v[68:71],a[76:79],a[48:51],v[68:71]
s_waitcnt lgkmcnt(2)
ds_read_b64_tr_b16 a[76:77],v245 offset:52680
v_mfma_f32_16x16x32_bf16 v[96:99],a[64:67],a[32:35],v[96:99]
ds_read_b64_tr_b16 a[78:79],v245 offset:54856
v_mfma_f32_16x16x32_bf16 v[96:99],a[68:71],a[48:51],v[96:99]
v_mfma_f32_16x16x32_bf16 v[104:107],a[64:67],a[36:39],v[104:107]
s_waitcnt vmcnt(13)
s_barrier
v_mfma_f32_16x16x32_bf16 v[104:107],a[68:71],a[52:55],v[104:107]
v_mfma_f32_16x16x32_bf16 v[112:115],a[64:67],a[40:43],v[112:115]
v_mfma_f32_16x16x32_bf16 v[112:115],a[68:71],a[56:59],v[112:115]
v_mfma_f32_16x16x32_bf16 v[120:123],a[64:67],a[44:47],v[120:123]
ds_read_b64_tr_b16 a[64:65],v246 offset:0
ds_read_b64_tr_b16 a[66:67],v246 offset:2176
v_mfma_f32_16x16x32_bf16 v[120:123],a[68:71],a[60:63],v[120:123]
s_waitcnt lgkmcnt(2)
ds_read_b64_tr_b16 a[68:69],v246 offset:256
v_mfma_f32_16x16x32_bf16 v[124:127],a[72:75],a[44:47],v[124:127]
ds_read_b64_tr_b16 a[70:71],v246 offset:2432
v_mfma_f32_16x16x32_bf16 v[124:127],a[76:79],a[60:63],v[124:127]
v_mfma_f32_16x16x32_bf16 v[116:119],a[72:75],a[40:43],v[116:119]
v_mfma_f32_16x16x32_bf16 v[116:119],a[76:79],a[56:59],v[116:119]
v_mfma_f32_16x16x32_bf16 v[108:111],a[72:75],a[36:39],v[108:111]
v_mfma_f32_16x16x32_bf16 v[108:111],a[76:79],a[52:55],v[108:111]
v_mfma_f32_16x16x32_bf16 v[100:103],a[72:75],a[32:35],v[100:103]
ds_read_b64_tr_b16 a[72:73],v246 offset:8
ds_read_b64_tr_b16 a[74:75],v246 offset:2184
v_mfma_f32_16x16x32_bf16 v[100:103],a[76:79],a[48:51],v[100:103]
s_waitcnt lgkmcnt(2)
ds_read_b64_tr_b16 a[76:77],v246 offset:264
ds_read_b64_tr_b16 a[78:79],v246 offset:2440
v_mfma_f32_16x16x32_bf16 v[128:131],a[64:67],a[32:35],v[128:131]
s_mov_b32 s84,156672
s_mov_b32 s85,0x80000
v_mfma_f32_16x16x32_bf16 v[128:131],a[68:71],a[48:51],v[128:131]
s_movk_i32 s86,17408
s_movk_i32 s87,16384
v_mfma_f32_16x16x32_bf16 v[136:139],a[64:67],a[36:39],v[136:139]
s_add_u32 s48,s32,69632
s_add_u32 s49,s32,156672
v_mfma_f32_16x16x32_bf16 v[136:139],a[68:71],a[52:55],v[136:139]
s_mov_b32 s38,s48
s_mov_b32 s39,81920
v_mfma_f32_16x16x32_bf16 v[144:147],a[64:67],a[40:43],v[144:147]
s_add_u32 m0,s32,121856
s_mov_b32 s34,49152
v_mfma_f32_16x16x32_bf16 v[144:147],a[68:71],a[56:59],v[144:147]
buffer_load_dwordx4 v236,s[8:11],s34 offen offset:0 sc0 sc1 nt lds
v_mfma_f32_16x16x32_bf16 v[152:155],a[64:67],a[44:47],v[152:155]
ds_read_b64_tr_b16 a[64:65],v246 offset:64
ds_read_b64_tr_b16 a[66:67],v246 offset:2240
v_mfma_f32_16x16x32_bf16 v[152:155],a[68:71],a[60:63],v[152:155]
s_waitcnt lgkmcnt(2)
ds_read_b64_tr_b16 a[68:69],v246 offset:320
v_mfma_f32_16x16x32_bf16 v[156:159],a[72:75],a[44:47],v[156:159]
ds_read_b64_tr_b16 a[70:71],v246 offset:2496
s_mov_b32 s40,s32
v_mfma_f32_16x16x32_bf16 v[156:159],a[76:79],a[60:63],v[156:159]
s_mov_b32 s41,65536
s_lshl_b32 s88,s3,6
v_mfma_f32_16x16x32_bf16 v[148:151],a[72:75],a[40:43],v[148:151]
s_mov_b32 s46,0
s_mov_b32 s47,1
v_mfma_f32_16x16x32_bf16 v[148:151],a[76:79],a[56:59],v[148:151]
s_mul_i32 s42,s88,8
s_lshr_b32 s42,s42,8
v_mfma_f32_16x16x32_bf16 v[140:143],a[72:75],a[36:39],v[140:143]
s_add_u32 s42,s42,1
s_bitset1_b32 s46,s42
v_mfma_f32_16x16x32_bf16 v[140:143],a[76:79],a[52:55],v[140:143]
s_mul_i32 s42,s88,8
s_lshr_b32 s42,s42,8
v_mfma_f32_16x16x32_bf16 v[132:135],a[72:75],a[32:35],v[132:135]
ds_read_b64_tr_b16 a[72:73],v246 offset:72
ds_read_b64_tr_b16 a[74:75],v246 offset:2248
v_mfma_f32_16x16x32_bf16 v[132:135],a[76:79],a[48:51],v[132:135]
s_waitcnt lgkmcnt(2)
ds_read_b64_tr_b16 a[76:77],v246 offset:328
v_mfma_f32_16x16x32_bf16 v[160:163],a[64:67],a[32:35],v[160:163]
ds_read_b64_tr_b16 a[78:79],v246 offset:2504
s_add_u32 m0,s32,121920
v_mfma_f32_16x16x32_bf16 v[160:163],a[68:71],a[48:51],v[160:163]
buffer_load_dwordx4 v236,s[8:11],s34 offen offset:1024 sc0 sc1 nt lds
v_mfma_f32_16x16x32_bf16 v[168:171],a[64:67],a[36:39],v[168:171]
s_add_u32 s42,s42,19
s_bitset1_b32 s46,s42
v_mfma_f32_16x16x32_bf16 v[168:171],a[68:71],a[52:55],v[168:171]
s_mul_i32 s42,s88,8
s_lshr_b32 s42,s42,8
v_mfma_f32_16x16x32_bf16 v[176:179],a[64:67],a[40:43],v[176:179]
s_add_u32 s42,s42,10
s_bitset1_b32 s47,s42
v_mfma_f32_16x16x32_bf16 v[176:179],a[68:71],a[56:59],v[176:179]
v_mfma_f32_16x16x32_bf16 v[184:187],a[64:67],a[44:47],v[184:187]
ds_read_b64_tr_b16 a[64:65],v247 offset:128
ds_read_b64_tr_b16 a[66:67],v247 offset:2304
v_mfma_f32_16x16x32_bf16 v[184:187],a[68:71],a[60:63],v[184:187]
s_waitcnt lgkmcnt(2)
ds_read_b64_tr_b16 a[68:69],v247 offset:384
v_mfma_f32_16x16x32_bf16 v[188:191],a[72:75],a[44:47],v[188:191]
ds_read_b64_tr_b16 a[70:71],v247 offset:2560
v_mfma_f32_16x16x32_bf16 v[188:191],a[76:79],a[60:63],v[188:191]
v_mfma_f32_16x16x32_bf16 v[180:183],a[72:75],a[40:43],v[180:183]
v_mfma_f32_16x16x32_bf16 v[180:183],a[76:79],a[56:59],v[180:183]
v_mfma_f32_16x16x32_bf16 v[172:175],a[72:75],a[36:39],v[172:175]
s_add_u32 m0,s32,121984
v_mfma_f32_16x16x32_bf16 v[172:175],a[76:79],a[52:55],v[172:175]
buffer_load_dwordx4 v236,s[8:11],s34 offen offset:2048 sc0 sc1 nt lds
v_mfma_f32_16x16x32_bf16 v[164:167],a[72:75],a[32:35],v[164:167]
ds_read_b64_tr_b16 a[72:73],v247 offset:136
ds_read_b64_tr_b16 a[74:75],v247 offset:2312
v_mfma_f32_16x16x32_bf16 v[164:167],a[76:79],a[48:51],v[164:167]
s_waitcnt lgkmcnt(2)
ds_read_b64_tr_b16 a[76:77],v247 offset:392
v_mfma_f32_16x16x32_bf16 v[192:195],a[64:67],a[32:35],v[192:195]
ds_read_b64_tr_b16 a[78:79],v247 offset:2568
s_and_b32 s33,s6,3
v_mfma_f32_16x16x32_bf16 v[192:195],a[68:71],a[48:51],v[192:195]
s_lshl_b32 s33,s33,2
s_add_u32 s33,s33,s3
v_mfma_f32_16x16x32_bf16 v[200:203],a[64:67],a[36:39],v[200:203]
s_lshl_b32 s33,s33,2
s_add_u32 s33,s33,s99
v_mfma_f32_16x16x32_bf16 v[200:203],a[68:71],a[52:55],v[200:203]
s_add_u32 s33,s33,64
s_lshl_b32 s63,s3,7
v_mfma_f32_16x16x32_bf16 v[208:211],a[64:67],a[40:43],v[208:211]
s_add_u32 s63,s63,3670080
s_sub_u32 s63,s63,s99
v_mfma_f32_16x16x32_bf16 v[208:211],a[68:71],a[56:59],v[208:211]
v_mfma_f32_16x16x32_bf16 v[216:219],a[64:67],a[44:47],v[216:219]
ds_read_b64_tr_b16 a[64:65],v247 offset:192
ds_read_b64_tr_b16 a[66:67],v247 offset:2368
v_mfma_f32_16x16x32_bf16 v[216:219],a[68:71],a[60:63],v[216:219]
s_waitcnt lgkmcnt(2)
ds_read_b64_tr_b16 a[68:69],v247 offset:448
v_mfma_f32_16x16x32_bf16 v[220:223],a[72:75],a[44:47],v[220:223]
ds_read_b64_tr_b16 a[70:71],v247 offset:2624
s_add_u32 m0,s32,122048
v_mfma_f32_16x16x32_bf16 v[220:223],a[76:79],a[60:63],v[220:223]
buffer_load_dwordx4 v236,s[8:11],s34 offen offset:3072 sc0 sc1 nt lds
v_mfma_f32_16x16x32_bf16 v[212:215],a[72:75],a[40:43],v[212:215]
v_mfma_f32_16x16x32_bf16 v[212:215],a[76:79],a[56:59],v[212:215]
v_mfma_f32_16x16x32_bf16 v[204:207],a[72:75],a[36:39],v[204:207]
v_mfma_f32_16x16x32_bf16 v[204:207],a[76:79],a[52:55],v[204:207]
v_mfma_f32_16x16x32_bf16 v[196:199],a[72:75],a[32:35],v[196:199]
ds_read_b64_tr_b16 a[72:73],v247 offset:200
ds_read_b64_tr_b16 a[74:75],v247 offset:2376
v_mfma_f32_16x16x32_bf16 v[196:199],a[76:79],a[48:51],v[196:199]
s_waitcnt lgkmcnt(2)
ds_read_b64_tr_b16 a[76:77],v247 offset:456
v_mfma_f32_16x16x32_bf16 a[0:3],a[64:67],a[32:35],a[0:3]
ds_read_b64_tr_b16 a[78:79],v247 offset:2632
v_mfma_f32_16x16x32_bf16 a[0:3],a[68:71],a[48:51],a[0:3]
v_mfma_f32_16x16x32_bf16 a[8:11],a[64:67],a[36:39],a[8:11]
v_mfma_f32_16x16x32_bf16 a[8:11],a[68:71],a[52:55],a[8:11]
v_mfma_f32_16x16x32_bf16 a[16:19],a[64:67],a[40:43],a[16:19]
v_mfma_f32_16x16x32_bf16 a[16:19],a[68:71],a[56:59],a[16:19]
v_mfma_f32_16x16x32_bf16 a[24:27],a[64:67],a[44:47],a[24:27]
v_mfma_f32_16x16x32_bf16 a[24:27],a[68:71],a[60:63],a[24:27]
s_waitcnt lgkmcnt(0)
v_mfma_f32_16x16x32_bf16 a[28:31],a[72:75],a[44:47],a[28:31]
v_mfma_f32_16x16x32_bf16 a[28:31],a[76:79],a[60:63],a[28:31]
v_mfma_f32_16x16x32_bf16 a[20:23],a[72:75],a[40:43],a[20:23]
v_mfma_f32_16x16x32_bf16 a[20:23],a[76:79],a[56:59],a[20:23]
v_mfma_f32_16x16x32_bf16 a[12:15],a[72:75],a[36:39],a[12:15]
v_mfma_f32_16x16x32_bf16 a[12:15],a[76:79],a[52:55],a[12:15]
v_mfma_f32_16x16x32_bf16 a[4:7],a[72:75],a[32:35],a[4:7]
v_mfma_f32_16x16x32_bf16 a[4:7],a[76:79],a[48:51],a[4:7]
s_nop 3
v_pk_mul_f32 v[0:1],v[0:1],s[56:57]
v_pk_mul_f32 v[2:3],v[2:3],s[56:57]
v_pk_mul_f32 v[4:5],v[4:5],s[56:57]
v_pk_mul_f32 v[6:7],v[6:7],s[56:57]
v_cvt_pk_bf16_f32 v0,v0,v1
v_cvt_pk_bf16_f32 v1,v2,v3
v_cvt_pk_bf16_f32 v2,v4,v5
v_cvt_pk_bf16_f32 v3,v6,v7
v_pk_mul_f32 v[8:9],v[8:9],s[56:57]
v_pk_mul_f32 v[10:11],v[10:11],s[56:57]
v_pk_mul_f32 v[12:13],v[12:13],s[56:57]
v_pk_mul_f32 v[14:15],v[14:15],s[56:57]
v_cvt_pk_bf16_f32 v4,v8,v9
v_cvt_pk_bf16_f32 v5,v10,v11
v_cvt_pk_bf16_f32 v6,v12,v13
v_cvt_pk_bf16_f32 v7,v14,v15
v_pk_mul_f32 v[16:17],v[16:17],s[56:57]
v_pk_mul_f32 v[18:19],v[18:19],s[56:57]
v_pk_mul_f32 v[20:21],v[20:21],s[56:57]
v_pk_mul_f32 v[22:23],v[22:23],s[56:57]
v_cvt_pk_bf16_f32 v8,v16,v17
v_cvt_pk_bf16_f32 v9,v18,v19
v_cvt_pk_bf16_f32 v10,v20,v21
v_cvt_pk_bf16_f32 v11,v22,v23
v_pk_mul_f32 v[24:25],v[24:25],s[56:57]
v_pk_mul_f32 v[26:27],v[26:27],s[56:57]
v_pk_mul_f32 v[28:29],v[28:29],s[56:57]
v_pk_mul_f32 v[30:31],v[30:31],s[56:57]
v_cvt_pk_bf16_f32 v12,v24,v25
v_cvt_pk_bf16_f32 v13,v26,v27
v_cvt_pk_bf16_f32 v14,v28,v29
v_cvt_pk_bf16_f32 v15,v30,v31
v_pk_mul_f32 v[32:33],v[32:33],s[56:57]
v_pk_mul_f32 v[34:35],v[34:35],s[56:57]
v_pk_mul_f32 v[36:37],v[36:37],s[56:57]
v_pk_mul_f32 v[38:39],v[38:39],s[56:57]
v_cvt_pk_bf16_f32 v16,v32,v33
v_cvt_pk_bf16_f32 v17,v34,v35
v_cvt_pk_bf16_f32 v18,v36,v37
v_cvt_pk_bf16_f32 v19,v38,v39
v_pk_mul_f32 v[40:41],v[40:41],s[56:57]
v_pk_mul_f32 v[42:43],v[42:43],s[56:57]
v_pk_mul_f32 v[44:45],v[44:45],s[56:57]
v_pk_mul_f32 v[46:47],v[46:47],s[56:57]
v_cvt_pk_bf16_f32 v20,v40,v41
v_cvt_pk_bf16_f32 v21,v42,v43
v_cvt_pk_bf16_f32 v22,v44,v45
v_cvt_pk_bf16_f32 v23,v46,v47
v_pk_mul_f32 v[48:49],v[48:49],s[56:57]
v_pk_mul_f32 v[50:51],v[50:51],s[56:57]
v_pk_mul_f32 v[52:53],v[52:53],s[56:57]
v_pk_mul_f32 v[54:55],v[54:55],s[56:57]
v_cvt_pk_bf16_f32 v24,v48,v49
v_cvt_pk_bf16_f32 v25,v50,v51
v_cvt_pk_bf16_f32 v26,v52,v53
v_cvt_pk_bf16_f32 v27,v54,v55
v_pk_mul_f32 v[56:57],v[56:57],s[56:57]
v_pk_mul_f32 v[58:59],v[58:59],s[56:57]
v_pk_mul_f32 v[60:61],v[60:61],s[56:57]
v_pk_mul_f32 v[62:63],v[62:63],s[56:57]
v_cvt_pk_bf16_f32 v28,v56,v57
v_cvt_pk_bf16_f32 v29,v58,v59
v_cvt_pk_bf16_f32 v30,v60,v61
v_cvt_pk_bf16_f32 v31,v62,v63
v_pk_mul_f32 v[64:65],v[64:65],s[56:57]
v_pk_mul_f32 v[66:67],v[66:67],s[56:57]
v_pk_mul_f32 v[68:69],v[68:69],s[56:57]
v_pk_mul_f32 v[70:71],v[70:71],s[56:57]
v_cvt_pk_bf16_f32 v32,v64,v65
v_cvt_pk_bf16_f32 v33,v66,v67
v_cvt_pk_bf16_f32 v34,v68,v69
v_cvt_pk_bf16_f32 v35,v70,v71
v_pk_mul_f32 v[72:73],v[72:73],s[56:57]
v_pk_mul_f32 v[74:75],v[74:75],s[56:57]
v_pk_mul_f32 v[76:77],v[76:77],s[56:57]
v_pk_mul_f32 v[78:79],v[78:79],s[56:57]
v_cvt_pk_bf16_f32 v36,v72,v73
v_cvt_pk_bf16_f32 v37,v74,v75
v_cvt_pk_bf16_f32 v38,v76,v77
v_cvt_pk_bf16_f32 v39,v78,v79
v_pk_mul_f32 v[80:81],v[80:81],s[56:57]
v_pk_mul_f32 v[82:83],v[82:83],s[56:57]
v_pk_mul_f32 v[84:85],v[84:85],s[56:57]
v_pk_mul_f32 v[86:87],v[86:87],s[56:57]
v_cvt_pk_bf16_f32 v40,v80,v81
v_cvt_pk_bf16_f32 v41,v82,v83
v_cvt_pk_bf16_f32 v42,v84,v85
v_cvt_pk_bf16_f32 v43,v86,v87
v_pk_mul_f32 v[88:89],v[88:89],s[56:57]
v_pk_mul_f32 v[90:91],v[90:91],s[56:57]
v_pk_mul_f32 v[92:93],v[92:93],s[56:57]
v_pk_mul_f32 v[94:95],v[94:95],s[56:57]
v_cvt_pk_bf16_f32 v44,v88,v89
v_cvt_pk_bf16_f32 v45,v90,v91
v_cvt_pk_bf16_f32 v46,v92,v93
v_cvt_pk_bf16_f32 v47,v94,v95
v_pk_mul_f32 v[96:97],v[96:97],s[56:57]
v_pk_mul_f32 v[98:99],v[98:99],s[56:57]
v_pk_mul_f32 v[100:101],v[100:101],s[56:57]
v_pk_mul_f32 v[102:103],v[102:103],s[56:57]
v_cvt_pk_bf16_f32 v48,v96,v97
v_cvt_pk_bf16_f32 v49,v98,v99
v_cvt_pk_bf16_f32 v50,v100,v101
v_cvt_pk_bf16_f32 v51,v102,v103
v_pk_mul_f32 v[104:105],v[104:105],s[56:57]
v_pk_mul_f32 v[106:107],v[106:107],s[56:57]
v_pk_mul_f32 v[108:109],v[108:109],s[56:57]
v_pk_mul_f32 v[110:111],v[110:111],s[56:57]
v_cvt_pk_bf16_f32 v52,v104,v105
v_cvt_pk_bf16_f32 v53,v106,v107
v_cvt_pk_bf16_f32 v54,v108,v109
v_cvt_pk_bf16_f32 v55,v110,v111
v_pk_mul_f32 v[112:113],v[112:113],s[56:57]
v_pk_mul_f32 v[114:115],v[114:115],s[56:57]
v_pk_mul_f32 v[116:117],v[116:117],s[56:57]
v_pk_mul_f32 v[118:119],v[118:119],s[56:57]
v_cvt_pk_bf16_f32 v56,v112,v113
v_cvt_pk_bf16_f32 v57,v114,v115
v_cvt_pk_bf16_f32 v58,v116,v117
v_cvt_pk_bf16_f32 v59,v118,v119
v_pk_mul_f32 v[120:121],v[120:121],s[56:57]
v_pk_mul_f32 v[122:123],v[122:123],s[56:57]
v_pk_mul_f32 v[124:125],v[124:125],s[56:57]
v_pk_mul_f32 v[126:127],v[126:127],s[56:57]
v_cvt_pk_bf16_f32 v60,v120,v121
v_cvt_pk_bf16_f32 v61,v122,v123
v_cvt_pk_bf16_f32 v62,v124,v125
v_cvt_pk_bf16_f32 v63,v126,v127
v_pk_mul_f32 v[128:129],v[128:129],s[56:57]
v_pk_mul_f32 v[130:131],v[130:131],s[56:57]
v_pk_mul_f32 v[132:133],v[132:133],s[56:57]
v_pk_mul_f32 v[134:135],v[134:135],s[56:57]
v_cvt_pk_bf16_f32 v64,v128,v129
v_cvt_pk_bf16_f32 v65,v130,v131
v_cvt_pk_bf16_f32 v66,v132,v133
v_cvt_pk_bf16_f32 v67,v134,v135
v_pk_mul_f32 v[136:137],v[136:137],s[56:57]
v_pk_mul_f32 v[138:139],v[138:139],s[56:57]
v_pk_mul_f32 v[140:141],v[140:141],s[56:57]
v_pk_mul_f32 v[142:143],v[142:143],s[56:57]
v_cvt_pk_bf16_f32 v68,v136,v137
v_cvt_pk_bf16_f32 v69,v138,v139
v_cvt_pk_bf16_f32 v70,v140,v141
v_cvt_pk_bf16_f32 v71,v142,v143
v_pk_mul_f32 v[144:145],v[144:145],s[56:57]
v_pk_mul_f32 v[146:147],v[146:147],s[56:57]
v_pk_mul_f32 v[148:149],v[148:149],s[56:57]
v_pk_mul_f32 v[150:151],v[150:151],s[56:57]
v_cvt_pk_bf16_f32 v72,v144,v145
v_cvt_pk_bf16_f32 v73,v146,v147
v_cvt_pk_bf16_f32 v74,v148,v149
v_cvt_pk_bf16_f32 v75,v150,v151
v_pk_mul_f32 v[152:153],v[152:153],s[56:57]
v_pk_mul_f32 v[154:155],v[154:155],s[56:57]
v_pk_mul_f32 v[156:157],v[156:157],s[56:57]
v_pk_mul_f32 v[158:159],v[158:159],s[56:57]
v_cvt_pk_bf16_f32 v76,v152,v153
v_cvt_pk_bf16_f32 v77,v154,v155
v_cvt_pk_bf16_f32 v78,v156,v157
v_cvt_pk_bf16_f32 v79,v158,v159
v_pk_mul_f32 v[160:161],v[160:161],s[56:57]
v_pk_mul_f32 v[162:163],v[162:163],s[56:57]
v_pk_mul_f32 v[164:165],v[164:165],s[56:57]
v_pk_mul_f32 v[166:167],v[166:167],s[56:57]
v_cvt_pk_bf16_f32 v80,v160,v161
v_cvt_pk_bf16_f32 v81,v162,v163
v_cvt_pk_bf16_f32 v82,v164,v165
v_cvt_pk_bf16_f32 v83,v166,v167
v_pk_mul_f32 v[168:169],v[168:169],s[56:57]
v_pk_mul_f32 v[170:171],v[170:171],s[56:57]
v_pk_mul_f32 v[172:173],v[172:173],s[56:57]
v_pk_mul_f32 v[174:175],v[174:175],s[56:57]
v_cvt_pk_bf16_f32 v84,v168,v169
v_cvt_pk_bf16_f32 v85,v170,v171
v_cvt_pk_bf16_f32 v86,v172,v173
v_cvt_pk_bf16_f32 v87,v174,v175
v_pk_mul_f32 v[176:177],v[176:177],s[56:57]
v_pk_mul_f32 v[178:179],v[178:179],s[56:57]
v_pk_mul_f32 v[180:181],v[180:181],s[56:57]
v_pk_mul_f32 v[182:183],v[182:183],s[56:57]
v_cvt_pk_bf16_f32 v88,v176,v177
v_cvt_pk_bf16_f32 v89,v178,v179
v_cvt_pk_bf16_f32 v90,v180,v181
v_cvt_pk_bf16_f32 v91,v182,v183
v_pk_mul_f32 v[184:185],v[184:185],s[56:57]
v_pk_mul_f32 v[186:187],v[186:187],s[56:57]
v_pk_mul_f32 v[188:189],v[188:189],s[56:57]
v_pk_mul_f32 v[190:191],v[190:191],s[56:57]
v_cvt_pk_bf16_f32 v92,v184,v185
v_cvt_pk_bf16_f32 v93,v186,v187
v_cvt_pk_bf16_f32 v94,v188,v189
v_cvt_pk_bf16_f32 v95,v190,v191
v_pk_mul_f32 v[192:193],v[192:193],s[56:57]
v_pk_mul_f32 v[194:195],v[194:195],s[56:57]
v_pk_mul_f32 v[196:197],v[196:197],s[56:57]
v_pk_mul_f32 v[198:199],v[198:199],s[56:57]
v_cvt_pk_bf16_f32 v96,v192,v193
v_cvt_pk_bf16_f32 v97,v194,v195
v_cvt_pk_bf16_f32 v98,v196,v197
v_cvt_pk_bf16_f32 v99,v198,v199
v_pk_mul_f32 v[200:201],v[200:201],s[56:57]
v_pk_mul_f32 v[202:203],v[202:203],s[56:57]
v_pk_mul_f32 v[204:205],v[204:205],s[56:57]
v_pk_mul_f32 v[206:207],v[206:207],s[56:57]
v_cvt_pk_bf16_f32 v100,v200,v201
v_cvt_pk_bf16_f32 v101,v202,v203
v_cvt_pk_bf16_f32 v102,v204,v205
v_cvt_pk_bf16_f32 v103,v206,v207
v_pk_mul_f32 v[208:209],v[208:209],s[56:57]
v_pk_mul_f32 v[210:211],v[210:211],s[56:57]
v_pk_mul_f32 v[212:213],v[212:213],s[56:57]
v_pk_mul_f32 v[214:215],v[214:215],s[56:57]
v_cvt_pk_bf16_f32 v104,v208,v209
v_cvt_pk_bf16_f32 v105,v210,v211
v_cvt_pk_bf16_f32 v106,v212,v213
v_cvt_pk_bf16_f32 v107,v214,v215
v_pk_mul_f32 v[216:217],v[216:217],s[56:57]
v_pk_mul_f32 v[218:219],v[218:219],s[56:57]
v_pk_mul_f32 v[220:221],v[220:221],s[56:57]
v_pk_mul_f32 v[222:223],v[222:223],s[56:57]
v_cvt_pk_bf16_f32 v108,v216,v217
v_cvt_pk_bf16_f32 v109,v218,v219
v_cvt_pk_bf16_f32 v110,v220,v221
v_cvt_pk_bf16_f32 v111,v222,v223
s_waitcnt vmcnt(12)
s_barrier
ds_read_b128 v[208:211],v232 offset:0
ds_read_b128 v[212:215],v232 offset:64
ds_read_b128 v[216:219],v232 offset:128
ds_read_b128 v[220:223],v232 offset:192
v_accvgpr_read_b32 v128,a0
v_accvgpr_read_b32 v129,a1
v_accvgpr_read_b32 v130,a2
v_accvgpr_read_b32 v131,a3
v_accvgpr_read_b32 v132,a4
v_accvgpr_read_b32 v133,a5
v_accvgpr_read_b32 v134,a6
v_accvgpr_read_b32 v135,a7
v_accvgpr_read_b32 v136,a8
v_accvgpr_read_b32 v137,a9
v_accvgpr_read_b32 v138,a10
v_accvgpr_read_b32 v139,a11
v_accvgpr_read_b32 v140,a12
v_accvgpr_read_b32 v141,a13
v_accvgpr_read_b32 v142,a14
v_accvgpr_read_b32 v143,a15
v_accvgpr_read_b32 v144,a16
v_accvgpr_read_b32 v145,a17
v_accvgpr_read_b32 v146,a18
v_accvgpr_read_b32 v147,a19
v_accvgpr_read_b32 v148,a20
v_accvgpr_read_b32 v149,a21
v_accvgpr_read_b32 v150,a22
v_accvgpr_read_b32 v151,a23
v_accvgpr_read_b32 v152,a24
v_accvgpr_read_b32 v153,a25
v_accvgpr_read_b32 v154,a26
v_accvgpr_read_b32 v155,a27
v_accvgpr_read_b32 v156,a28
v_accvgpr_read_b32 v157,a29
v_accvgpr_read_b32 v158,a30
v_accvgpr_read_b32 v159,a31
v_pk_mul_f32 v[128:129],v[128:129],s[56:57]
v_pk_mul_f32 v[130:131],v[130:131],s[56:57]
v_pk_mul_f32 v[132:133],v[132:133],s[56:57]
v_pk_mul_f32 v[134:135],v[134:135],s[56:57]
v_cvt_pk_bf16_f32 v112,v128,v129
v_cvt_pk_bf16_f32 v113,v130,v131
v_cvt_pk_bf16_f32 v114,v132,v133
v_cvt_pk_bf16_f32 v115,v134,v135
v_pk_mul_f32 v[136:137],v[136:137],s[56:57]
v_pk_mul_f32 v[138:139],v[138:139],s[56:57]
v_pk_mul_f32 v[140:141],v[140:141],s[56:57]
v_pk_mul_f32 v[142:143],v[142:143],s[56:57]
v_cvt_pk_bf16_f32 v116,v136,v137
v_cvt_pk_bf16_f32 v117,v138,v139
v_cvt_pk_bf16_f32 v118,v140,v141
v_cvt_pk_bf16_f32 v119,v142,v143
v_pk_mul_f32 v[144:145],v[144:145],s[56:57]
v_pk_mul_f32 v[146:147],v[146:147],s[56:57]
v_pk_mul_f32 v[148:149],v[148:149],s[56:57]
v_pk_mul_f32 v[150:151],v[150:151],s[56:57]
v_cvt_pk_bf16_f32 v120,v144,v145
v_cvt_pk_bf16_f32 v121,v146,v147
v_cvt_pk_bf16_f32 v122,v148,v149
v_cvt_pk_bf16_f32 v123,v150,v151
v_pk_mul_f32 v[152:153],v[152:153],s[56:57]
v_pk_mul_f32 v[154:155],v[154:155],s[56:57]
v_pk_mul_f32 v[156:157],v[156:157],s[56:57]
v_pk_mul_f32 v[158:159],v[158:159],s[56:57]
v_cvt_pk_bf16_f32 v124,v152,v153
v_cvt_pk_bf16_f32 v125,v154,v155
v_cvt_pk_bf16_f32 v126,v156,v157
v_cvt_pk_bf16_f32 v127,v158,v159
s_waitcnt lgkmcnt(2)
v_mfma_f32_16x16x32_bf16 v[128:131],v[208:211],v[0:3],0
s_mov_b32 s52,49152
s_mov_b32 s62,17408
v_mfma_f32_16x16x32_bf16 v[128:131],v[212:215],v[16:19],v[128:131]
v_accvgpr_write_b32 a32,0
v_accvgpr_write_b32 a33,0
v_mfma_f32_16x16x32_bf16 v[136:139],v[208:211],v[4:7],0
v_accvgpr_write_b32 a34,0
v_accvgpr_write_b32 a35,0
v_mfma_f32_16x16x32_bf16 v[136:139],v[212:215],v[20:23],v[136:139]
v_accvgpr_write_b32 a36,0
v_accvgpr_write_b32 a37,0
v_mfma_f32_16x16x32_bf16 v[144:147],v[208:211],v[8:11],0
s_add_u32 m0,s32,139264
s_mov_b32 s34,65536
v_mfma_f32_16x16x32_bf16 v[144:147],v[212:215],v[24:27],v[144:147]
buffer_load_dwordx4 v236,s[8:11],s34 offen offset:0 sc0 sc1 nt lds
v_mfma_f32_16x16x32_bf16 v[152:155],v[208:211],v[12:15],0
ds_read_b128 v[208:211],v232 offset:256
v_accvgpr_write_b32 a38,0
v_mfma_f32_16x16x32_bf16 v[152:155],v[212:215],v[28:31],v[152:155]
s_waitcnt lgkmcnt(1)
ds_read_b128 v[212:215],v232 offset:320
v_mfma_f32_16x16x32_bf16 v[128:131],v[216:219],v[32:35],v[128:131]
v_accvgpr_write_b32 a39,0
v_accvgpr_write_b32 a40,0
v_mfma_f32_16x16x32_bf16 v[128:131],v[220:223],v[48:51],v[128:131]
v_accvgpr_write_b32 a41,0
v_accvgpr_write_b32 a42,0
v_mfma_f32_16x16x32_bf16 v[136:139],v[216:219],v[36:39],v[136:139]
v_accvgpr_write_b32 a43,0
v_accvgpr_write_b32 a44,0
v_mfma_f32_16x16x32_bf16 v[136:139],v[220:223],v[52:55],v[136:139]
v_accvgpr_write_b32 a45,0
v_accvgpr_write_b32 a46,0
v_mfma_f32_16x16x32_bf16 v[144:147],v[216:219],v[40:43],v[144:147]
v_accvgpr_write_b32 a47,0
v_accvgpr_write_b32 a48,0
v_mfma_f32_16x16x32_bf16 v[144:147],v[220:223],v[56:59],v[144:147]
v_accvgpr_write_b32 a49,0
v_accvgpr_write_b32 a50,0
v_mfma_f32_16x16x32_bf16 v[152:155],v[216:219],v[44:47],v[152:155]
ds_read_b128 v[216:219],v232 offset:384
v_accvgpr_write_b32 a51,0
v_mfma_f32_16x16x32_bf16 v[152:155],v[220:223],v[60:63],v[152:155]
s_waitcnt lgkmcnt(1)
ds_read_b128 v[220:223],v232 offset:448
v_mfma_f32_16x16x32_bf16 v[128:131],v[208:211],v[64:67],v[128:131]
s_add_u32 m0,s32,139328
v_accvgpr_write_b32 a52,0
v_mfma_f32_16x16x32_bf16 v[128:131],v[212:215],v[80:83],v[128:131]
buffer_load_dwordx4 v236,s[8:11],s34 offen offset:1024 sc0 sc1 nt lds
v_mfma_f32_16x16x32_bf16 v[136:139],v[208:211],v[68:71],v[136:139]
v_accvgpr_write_b32 a53,0
v_accvgpr_write_b32 a54,0
v_mfma_f32_16x16x32_bf16 v[136:139],v[212:215],v[84:87],v[136:139]
v_accvgpr_write_b32 a55,0
v_accvgpr_write_b32 a56,0
v_mfma_f32_16x16x32_bf16 v[144:147],v[208:211],v[72:75],v[144:147]
v_accvgpr_write_b32 a57,0
v_accvgpr_write_b32 a58,0
v_mfma_f32_16x16x32_bf16 v[144:147],v[212:215],v[88:91],v[144:147]
v_accvgpr_write_b32 a59,0
v_accvgpr_write_b32 a60,0
v_mfma_f32_16x16x32_bf16 v[152:155],v[208:211],v[76:79],v[152:155]
ds_read_b128 v[208:211],v232 offset:8704
v_accvgpr_write_b32 a61,0
v_mfma_f32_16x16x32_bf16 v[152:155],v[212:215],v[92:95],v[152:155]
s_waitcnt lgkmcnt(1)
ds_read_b128 v[212:215],v232 offset:8768
v_mfma_f32_16x16x32_bf16 v[128:131],v[216:219],v[96:99],v[128:131]
v_accvgpr_write_b32 a62,0
v_accvgpr_write_b32 a63,0
v_mfma_f32_16x16x32_bf16 v[128:131],v[220:223],v[112:115],v[128:131]
v_accvgpr_write_b32 a64,0
v_accvgpr_write_b32 a65,0
v_mfma_f32_16x16x32_bf16 v[136:139],v[216:219],v[100:103],v[136:139]
v_accvgpr_write_b32 a66,0
v_accvgpr_write_b32 a67,0
v_mfma_f32_16x16x32_bf16 v[136:139],v[220:223],v[116:119],v[136:139]
v_accvgpr_write_b32 a68,0
v_accvgpr_write_b32 a69,0
v_mfma_f32_16x16x32_bf16 v[144:147],v[216:219],v[104:107],v[144:147]
v_accvgpr_write_b32 a70,0
v_accvgpr_write_b32 a71,0
v_mfma_f32_16x16x32_bf16 v[144:147],v[220:223],v[120:123],v[144:147]
v_accvgpr_write_b32 a72,0
v_accvgpr_write_b32 a73,0
v_mfma_f32_16x16x32_bf16 v[152:155],v[216:219],v[108:111],v[152:155]
ds_read_b128 v[216:219],v232 offset:8832
v_accvgpr_write_b32 a74,0
v_mfma_f32_16x16x32_bf16 v[152:155],v[220:223],v[124:127],v[152:155]
s_waitcnt lgkmcnt(1)
ds_read_b128 v[220:223],v232 offset:8896
v_mfma_f32_16x16x32_bf16 v[132:135],v[208:211],v[0:3],0
s_add_u32 m0,s32,139392
v_accvgpr_write_b32 a75,0
v_mfma_f32_16x16x32_bf16 v[132:135],v[212:215],v[16:19],v[132:135]
buffer_load_dwordx4 v236,s[8:11],s34 offen offset:2048 sc0 sc1 nt lds
v_mfma_f32_16x16x32_bf16 v[140:143],v[208:211],v[4:7],0
v_accvgpr_write_b32 a76,0
v_accvgpr_write_b32 a77,0
v_mfma_f32_16x16x32_bf16 v[140:143],v[212:215],v[20:23],v[140:143]
v_accvgpr_write_b32 a78,0
v_accvgpr_write_b32 a79,0
v_mfma_f32_16x16x32_bf16 v[148:151],v[208:211],v[8:11],0
v_accvgpr_write_b32 a0,0
v_accvgpr_write_b32 a1,0
v_mfma_f32_16x16x32_bf16 v[148:151],v[212:215],v[24:27],v[148:151]
v_accvgpr_write_b32 a2,0
v_accvgpr_write_b32 a3,0
v_mfma_f32_16x16x32_bf16 v[156:159],v[208:211],v[12:15],0
ds_read_b128 v[208:211],v232 offset:8960
v_accvgpr_write_b32 a4,0
v_mfma_f32_16x16x32_bf16 v[156:159],v[212:215],v[28:31],v[156:159]
s_waitcnt lgkmcnt(1)
ds_read_b128 v[212:215],v232 offset:9024
v_mfma_f32_16x16x32_bf16 v[132:135],v[216:219],v[32:35],v[132:135]
v_accvgpr_write_b32 a5,0
v_accvgpr_write_b32 a6,0
v_mfma_f32_16x16x32_bf16 v[132:135],v[220:223],v[48:51],v[132:135]
v_accvgpr_write_b32 a7,0
v_accvgpr_write_b32 a8,0
v_mfma_f32_16x16x32_bf16 v[140:143],v[216:219],v[36:39],v[140:143]
v_accvgpr_write_b32 a9,0
v_accvgpr_write_b32 a10,0
v_mfma_f32_16x16x32_bf16 v[140:143],v[220:223],v[52:55],v[140:143]
v_accvgpr_write_b32 a11,0
v_accvgpr_write_b32 a12,0
v_mfma_f32_16x16x32_bf16 v[148:151],v[216:219],v[40:43],v[148:151]
s_add_u32 m0,s32,139456
v_accvgpr_write_b32 a13,0
v_mfma_f32_16x16x32_bf16 v[148:151],v[220:223],v[56:59],v[148:151]
buffer_load_dwordx4 v236,s[8:11],s34 offen offset:3072 sc0 sc1 nt lds
v_mfma_f32_16x16x32_bf16 v[156:159],v[216:219],v[44:47],v[156:159]
ds_read_b128 v[216:219],v232 offset:9088
v_accvgpr_write_b32 a14,0
v_mfma_f32_16x16x32_bf16 v[156:159],v[220:223],v[60:63],v[156:159]
s_waitcnt lgkmcnt(1)
ds_read_b128 v[220:223],v232 offset:9152
v_mfma_f32_16x16x32_bf16 v[132:135],v[208:211],v[64:67],v[132:135]
v_add_u32 v232,17408,v232
v_accvgpr_write_b32 a15,0
v_mfma_f32_16x16x32_bf16 v[132:135],v[212:215],v[80:83],v[132:135]
v_accvgpr_write_b32 a16,0
v_accvgpr_write_b32 a17,0
v_mfma_f32_16x16x32_bf16 v[140:143],v[208:211],v[68:71],v[140:143]
s_waitcnt vmcnt(12)
s_barrier
v_mfma_f32_16x16x32_bf16 v[140:143],v[212:215],v[84:87],v[140:143]
v_accvgpr_write_b32 a18,0
v_accvgpr_write_b32 a19,0
v_mfma_f32_16x16x32_bf16 v[148:151],v[208:211],v[72:75],v[148:151]
v_accvgpr_write_b32 a20,0
v_accvgpr_write_b32 a21,0
v_mfma_f32_16x16x32_bf16 v[148:151],v[212:215],v[88:91],v[148:151]
s_lshl_b32 s37,s4,2
v_accvgpr_write_b32 a22,0
v_mfma_f32_16x16x32_bf16 v[156:159],v[208:211],v[76:79],v[156:159]
ds_read_b128 v[208:211],v232 offset:0
s_add_u32 s37,s37,s3
v_mfma_f32_16x16x32_bf16 v[156:159],v[212:215],v[92:95],v[156:159]
s_waitcnt lgkmcnt(1)
ds_read_b128 v[212:215],v232 offset:64
v_mfma_f32_16x16x32_bf16 v[132:135],v[216:219],v[96:99],v[132:135]
s_mul_i32 s37,s37,3584
s_mov_b32 m0,156672
v_mfma_f32_16x16x32_bf16 v[132:135],v[220:223],v[112:115],v[132:135]
buffer_load_dword v253,s[24:27],s37 offen  lds
v_mfma_f32_16x16x32_bf16 v[140:143],v[216:219],v[100:103],v[140:143]
v_accvgpr_write_b32 a23,0
v_accvgpr_write_b32 a24,0
v_mfma_f32_16x16x32_bf16 v[140:143],v[220:223],v[116:119],v[140:143]
v_accvgpr_write_b32 a25,0
v_accvgpr_write_b32 a26,0
v_mfma_f32_16x16x32_bf16 v[148:151],v[216:219],v[104:107],v[148:151]
v_accvgpr_write_b32 a27,0
v_accvgpr_write_b32 a28,0
v_mfma_f32_16x16x32_bf16 v[148:151],v[220:223],v[120:123],v[148:151]
v_accvgpr_write_b32 a29,0
v_accvgpr_write_b32 a30,0
v_mfma_f32_16x16x32_bf16 v[156:159],v[216:219],v[108:111],v[156:159]
ds_read_b128 v[216:219],v232 offset:128
v_accvgpr_write_b32 a31,0
v_mfma_f32_16x16x32_bf16 v[156:159],v[220:223],v[124:127],v[156:159]
s_waitcnt lgkmcnt(1)
ds_read_b128 v[220:223],v232 offset:192
v_mbcnt_lo_u32_b32 v252,-1,0
v_mov_b32 v253,s5
v_or_b32 v252,s3,v252
v_lshl_add_u32 v252,v252,8,s6
buffer_store_byte v253,v252,s[20:23],s60 offen
s_nop 1
v_max3_f32 v244,v128,v129,v130
v_max3_f32 v245,v136,v137,v138
v_max3_f32 v246,v144,v145,v146
v_max3_f32 v247,v152,v153,v154
v_max3_f32 v244,v244,v131,v132
v_max3_f32 v245,v245,v139,v140
v_max3_f32 v246,v246,v147,v148
v_max3_f32 v247,v247,v155,v156
v_max3_f32 v244,v244,v133,v134
v_max3_f32 v245,v245,v141,v142
v_max3_f32 v246,v246,v149,v150
v_max3_f32 v247,v247,v157,v158
v_max_f32 v244,v244,v135
v_max_f32 v245,v245,v143
v_max_f32 v246,v246,v151
v_max_f32 v247,v247,v159
v_mov_b32 v248,v244
v_mov_b32 v249,v245
v_mov_b32 v250,v246
v_mov_b32 v251,v247
v_permlane32_swap_b32 v244,v248
v_permlane32_swap_b32 v245,v249
v_permlane32_swap_b32 v246,v250
v_permlane32_swap_b32 v247,v251
v_max_f32 v244,v244,v248
v_max_f32 v245,v245,v249
v_max_f32 v246,v246,v250
v_max_f32 v247,v247,v251
v_mov_b32 v248,v244
v_mov_b32 v249,v245
v_mov_b32 v250,v246
v_mov_b32 v251,v247
v_permlane16_swap_b32 v244,v248
v_permlane16_swap_b32 v245,v249
v_permlane16_swap_b32 v246,v250
v_permlane16_swap_b32 v247,v251
v_max_f32 v244,v244,v248
v_max_f32 v245,v245,v249
v_max_f32 v246,v246,v250
v_max_f32 v247,v247,v251
v_sub_f32 v192,0,v244
v_sub_f32 v193,0,v244
v_sub_f32 v194,0,v244
v_sub_f32 v195,0,v244
v_sub_f32 v196,0,v245
v_sub_f32 v197,0,v245
v_sub_f32 v198,0,v245
v_sub_f32 v199,0,v245
v_sub_f32 v200,0,v246
v_sub_f32 v201,0,v246
v_sub_f32 v202,0,v246
v_sub_f32 v203,0,v246
v_sub_f32 v204,0,v247
v_sub_f32 v205,0,v247
v_sub_f32 v206,0,v247
v_sub_f32 v207,0,v247
v_sub_f32 v128,v128,v244
v_sub_f32 v129,v129,v244
v_sub_f32 v130,v130,v244
v_sub_f32 v131,v131,v244
v_sub_f32 v132,v132,v244
v_sub_f32 v133,v133,v244
v_sub_f32 v134,v134,v244
v_sub_f32 v135,v135,v244
v_sub_f32 v136,v136,v245
v_sub_f32 v137,v137,v245
v_sub_f32 v138,v138,v245
v_sub_f32 v139,v139,v245
v_sub_f32 v140,v140,v245
v_sub_f32 v141,v141,v245
v_sub_f32 v142,v142,v245
v_sub_f32 v143,v143,v245
v_sub_f32 v144,v144,v246
v_sub_f32 v145,v145,v246
v_sub_f32 v146,v146,v246
v_sub_f32 v147,v147,v246
v_sub_f32 v148,v148,v246
v_sub_f32 v149,v149,v246
v_sub_f32 v150,v150,v246
v_sub_f32 v151,v151,v246
v_sub_f32 v152,v152,v247
v_sub_f32 v153,v153,v247
v_sub_f32 v154,v154,v247
v_sub_f32 v155,v155,v247
v_sub_f32 v156,v156,v247
v_sub_f32 v157,v157,v247
v_sub_f32 v158,v158,v247
v_sub_f32 v159,v159,v247
v_exp_f32 v128,v128
v_exp_f32 v136,v136
v_exp_f32 v129,v129
v_exp_f32 v137,v137
v_add_f32 v228,v128,v129
v_add_f32 v229,v136,v137
v_cvt_pk_bf16_f32 v128,v128,v129
v_cvt_pk_bf16_f32 v136,v136,v137
v_exp_f32 v130,v130
v_exp_f32 v138,v138
v_add_f32 v228,v228,v130
v_add_f32 v229,v229,v138
v_exp_f32 v131,v131
v_exp_f32 v139,v139
v_add_f32 v228,v228,v131
v_add_f32 v229,v229,v139
v_cvt_pk_bf16_f32 v129,v130,v131
v_cvt_pk_bf16_f32 v137,v138,v139
v_exp_f32 v132,v132
v_exp_f32 v140,v140
v_add_f32 v228,v228,v132
v_add_f32 v229,v229,v140
v_exp_f32 v133,v133
v_exp_f32 v141,v141
v_add_f32 v228,v228,v133
v_add_f32 v229,v229,v141
v_cvt_pk_bf16_f32 v130,v132,v133
v_cvt_pk_bf16_f32 v138,v140,v141
v_exp_f32 v134,v134
v_exp_f32 v142,v142
v_add_f32 v228,v228,v134
v_add_f32 v229,v229,v142
v_exp_f32 v135,v135
v_exp_f32 v143,v143
v_add_f32 v228,v228,v135
v_add_f32 v229,v229,v143
v_cvt_pk_bf16_f32 v131,v134,v135
v_cvt_pk_bf16_f32 v139,v142,v143
L_LOOP:
v_mfma_f32_16x16x32_bf16 v[160:163],v[208:211],v[0:3],v[192:195]
v_exp_f32 v144,v144
v_mfma_f32_16x16x32_bf16 v[160:163],v[212:215],v[16:19],v[160:163]
s_bitcmp1_b32 s46,0
s_cselect_b64 s[42:43],s[84:85],s[38:39]
v_mfma_f32_16x16x32_bf16 v[168:171],v[208:211],v[4:7],v[196:199]
v_exp_f32 v145,v145
v_mfma_f32_16x16x32_bf16 v[168:171],v[212:215],v[20:23],v[168:171]
v_add_f32 v230,v144,v145
v_cvt_pk_bf16_f32 v144,v144,v145
v_mfma_f32_16x16x32_bf16 v[176:179],v[208:211],v[8:11],v[200:203]
v_exp_f32 v146,v146
v_mfma_f32_16x16x32_bf16 v[176:179],v[212:215],v[24:27],v[176:179]
v_add_f32 v230,v230,v146
s_cselect_b64 s[34:35],0,s[86:87]
v_mfma_f32_16x16x32_bf16 v[184:187],v[208:211],v[12:15],v[204:207]
ds_read_b128 v[208:211],v232 offset:256
s_add_u32 s39,s39,s35
v_mfma_f32_16x16x32_bf16 v[184:187],v[212:215],v[28:31],v[184:187]
s_waitcnt lgkmcnt(1)
ds_read_b128 v[212:215],v232 offset:320
v_mfma_f32_16x16x32_bf16 v[160:163],v[216:219],v[32:35],v[160:163]
v_exp_f32 v147,v147
v_mfma_f32_16x16x32_bf16 v[160:163],v[220:223],v[48:51],v[160:163]
v_add_f32 v230,v230,v147
v_cvt_pk_bf16_f32 v145,v146,v147
v_mfma_f32_16x16x32_bf16 v[168:171],v[216:219],v[36:39],v[168:171]
v_exp_f32 v148,v148
v_mfma_f32_16x16x32_bf16 v[168:171],v[220:223],v[52:55],v[168:171]
v_add_f32 v230,v230,v148
s_add_u32 s38,s38,s34
v_mfma_f32_16x16x32_bf16 v[176:179],v[216:219],v[40:43],v[176:179]
v_exp_f32 v149,v149
v_mfma_f32_16x16x32_bf16 v[176:179],v[220:223],v[56:59],v[176:179]
v_add_f32 v230,v230,v149
v_cvt_pk_bf16_f32 v146,v148,v149
v_mfma_f32_16x16x32_bf16 v[184:187],v[216:219],v[44:47],v[184:187]
ds_read_b128 v[216:219],v232 offset:384
s_cmp_eq_u32 s38,s49
v_mfma_f32_16x16x32_bf16 v[184:187],v[220:223],v[60:63],v[184:187]
s_waitcnt lgkmcnt(1)
ds_read_b128 v[220:223],v232 offset:448
v_mfma_f32_16x16x32_bf16 v[160:163],v[208:211],v[64:67],v[160:163]
v_exp_f32 v150,v150
v_mfma_f32_16x16x32_bf16 v[160:163],v[212:215],v[80:83],v[160:163]
v_add_f32 v230,v230,v150
s_cmov_b32 s38,s48
v_mfma_f32_16x16x32_bf16 v[168:171],v[208:211],v[68:71],v[168:171]
s_bitcmp1_b32 s47,0
s_cselect_b64 s[44:45],s[84:85],s[40:41]
v_mfma_f32_16x16x32_bf16 v[168:171],v[212:215],v[84:87],v[168:171]
v_exp_f32 v151,v151
v_mfma_f32_16x16x32_bf16 v[176:179],v[208:211],v[72:75],v[176:179]
s_mov_b32 m0,s42
v_add_f32 v230,v230,v151
v_mfma_f32_16x16x32_bf16 v[176:179],v[212:215],v[88:91],v[176:179]
buffer_load_dwordx4 v236,s[8:11],s43 offen offset:0 sc0 sc1 nt lds
v_mfma_f32_16x16x32_bf16 v[184:187],v[208:211],v[76:79],v[184:187]
ds_read_b128 v[208:211],v232 offset:8704
v_max3_f32 v243,v228,v229,v230
v_mfma_f32_16x16x32_bf16 v[184:187],v[212:215],v[92:95],v[184:187]
s_waitcnt lgkmcnt(1)
ds_read_b128 v[212:215],v232 offset:8768
v_mfma_f32_16x16x32_bf16 v[160:163],v[216:219],v[96:99],v[160:163]
v_exp_f32 v152,v152
v_mfma_f32_16x16x32_bf16 v[160:163],v[220:223],v[112:115],v[160:163]
v_cvt_pk_bf16_f32 v147,v150,v151
s_cselect_b64 s[34:35],0,s[86:87]
v_mfma_f32_16x16x32_bf16 v[168:171],v[216:219],v[100:103],v[168:171]
s_add_u32 s41,s41,s35
s_add_u32 s40,s40,s34
v_mfma_f32_16x16x32_bf16 v[168:171],v[220:223],v[116:119],v[168:171]
v_exp_f32 v153,v153
v_mfma_f32_16x16x32_bf16 v[176:179],v[216:219],v[104:107],v[176:179]
s_add_u32 m0,s42,64
v_add_f32 v231,v152,v153
v_mfma_f32_16x16x32_bf16 v[176:179],v[220:223],v[120:123],v[176:179]
buffer_load_dwordx4 v236,s[8:11],s43 offen offset:1024 sc0 sc1 nt lds
v_mfma_f32_16x16x32_bf16 v[184:187],v[216:219],v[108:111],v[184:187]
ds_read_b128 v[216:219],v232 offset:8832
v_cvt_pk_bf16_f32 v152,v152,v153
v_mfma_f32_16x16x32_bf16 v[184:187],v[220:223],v[124:127],v[184:187]
s_waitcnt lgkmcnt(1)
ds_read_b128 v[220:223],v232 offset:8896
v_mfma_f32_16x16x32_bf16 v[164:167],v[208:211],v[0:3],v[192:195]
v_exp_f32 v154,v154
v_mfma_f32_16x16x32_bf16 v[164:167],v[212:215],v[16:19],v[164:167]
v_add_f32 v231,v231,v154
s_cmp_eq_u32 s40,s48
v_mfma_f32_16x16x32_bf16 v[172:175],v[208:211],v[4:7],v[196:199]
s_cmov_b32 s40,s32
v_mfma_f32_16x16x32_bf16 v[172:175],v[212:215],v[20:23],v[172:175]
v_exp_f32 v155,v155
v_mfma_f32_16x16x32_bf16 v[180:183],v[208:211],v[8:11],v[200:203]
s_add_u32 m0,s42,128
v_add_f32 v231,v231,v155
v_mfma_f32_16x16x32_bf16 v[180:183],v[212:215],v[24:27],v[180:183]
buffer_load_dwordx4 v236,s[8:11],s43 offen offset:2048 sc0 sc1 nt lds
v_mfma_f32_16x16x32_bf16 v[188:191],v[208:211],v[12:15],v[204:207]
ds_read_b128 v[208:211],v232 offset:8960
v_cvt_pk_bf16_f32 v153,v154,v155
v_mfma_f32_16x16x32_bf16 v[188:191],v[212:215],v[28:31],v[188:191]
s_waitcnt lgkmcnt(1)
ds_read_b128 v[212:215],v232 offset:9024
v_mfma_f32_16x16x32_bf16 v[164:167],v[216:219],v[32:35],v[164:167]
v_exp_f32 v156,v156
v_mfma_f32_16x16x32_bf16 v[164:167],v[220:223],v[48:51],v[164:167]
v_add_f32 v231,v231,v156
v_mfma_f32_16x16x32_bf16 v[172:175],v[216:219],v[36:39],v[172:175]
v_mfma_f32_16x16x32_bf16 v[172:175],v[220:223],v[52:55],v[172:175]
v_exp_f32 v157,v157
v_mfma_f32_16x16x32_bf16 v[180:183],v[216:219],v[40:43],v[180:183]
s_add_u32 m0,s42,192
v_add_f32 v231,v231,v157
v_mfma_f32_16x16x32_bf16 v[180:183],v[220:223],v[56:59],v[180:183]
buffer_load_dwordx4 v236,s[8:11],s43 offen offset:3072 sc0 sc1 nt lds
v_mfma_f32_16x16x32_bf16 v[188:191],v[216:219],v[44:47],v[188:191]
ds_read_b128 v[216:219],v232 offset:9088
v_cvt_pk_bf16_f32 v154,v156,v157
v_mfma_f32_16x16x32_bf16 v[188:191],v[220:223],v[60:63],v[188:191]
s_waitcnt lgkmcnt(1)
ds_read_b128 v[220:223],v232 offset:9152
v_mfma_f32_16x16x32_bf16 v[164:167],v[208:211],v[64:67],v[164:167]
v_exp_f32 v158,v158
v_mfma_f32_16x16x32_bf16 v[164:167],v[212:215],v[80:83],v[164:167]
v_add_f32 v231,v231,v158
s_add_u32 s62,s62,s86
v_mfma_f32_16x16x32_bf16 v[172:175],v[208:211],v[68:71],v[172:175]
v_mfma_f32_16x16x32_bf16 v[172:175],v[212:215],v[84:87],v[172:175]
v_exp_f32 v159,v159
v_mfma_f32_16x16x32_bf16 v[180:183],v[208:211],v[72:75],v[180:183]
v_add_f32 v231,v231,v159
v_cvt_pk_bf16_f32 v155,v158,v159
v_mfma_f32_16x16x32_bf16 v[180:183],v[212:215],v[88:91],v[180:183]
v_max_f32 v243,v243,v231
v_cmp_lt_f32 vcc,s54,v243
v_mfma_f32_16x16x32_bf16 v[188:191],v[208:211],v[76:79],v[188:191]
ds_read_b64_tr_b16 v[208:209],v233 offset:0
ds_read_b64_tr_b16 v[210:211],v233 offset:8704
v_mfma_f32_16x16x32_bf16 v[188:191],v[212:215],v[92:95],v[188:191]
s_waitcnt lgkmcnt(2)
ds_read_b64_tr_b16 v[212:213],v234 offset:32
v_mfma_f32_16x16x32_bf16 v[164:167],v[216:219],v[96:99],v[164:167]
ds_read_b64_tr_b16 v[214:215],v234 offset:8736
s_cbranch_vccnz RS_0
RS_0_RET:
v_mfma_f32_16x16x32_bf16 v[164:167],v[220:223],v[112:115],v[164:167]
v_add_f32 v224,v224,v228
v_add_f32 v225,v225,v229
v_mfma_f32_16x16x32_bf16 v[172:175],v[216:219],v[100:103],v[172:175]
v_add_f32 v226,v226,v230
v_add_f32 v227,v227,v231
v_mfma_f32_16x16x32_bf16 v[172:175],v[220:223],v[116:119],v[172:175]
s_cmp_eq_u32 s62,87040
s_cselect_b32 s88,-69632,s86
v_mfma_f32_16x16x32_bf16 v[180:183],v[216:219],v[104:107],v[180:183]
s_cmov_b32 s62,0
v_add_u32 v232,s88,v232
v_mfma_f32_16x16x32_bf16 v[180:183],v[220:223],v[120:123],v[180:183]
s_add_u32 s52,s52,16384
v_mfma_f32_16x16x32_bf16 v[188:191],v[216:219],v[108:111],v[188:191]
ds_read_b64_tr_b16 v[216:217],v233 offset:64
ds_read_b64_tr_b16 v[218:219],v233 offset:8768
v_mfma_f32_16x16x32_bf16 v[188:191],v[220:223],v[124:127],v[188:191]
s_waitcnt lgkmcnt(4)
ds_read_b64_tr_b16 v[220:221],v234 offset:96
ds_read_b64_tr_b16 v[222:223],v234 offset:8800
v_mfma_f32_16x16x32_bf16 a[0:3],v[208:211],v[128:131],a[0:3]
v_exp_f32 v160,v160
v_mfma_f32_16x16x32_bf16 a[4:7],v[208:211],v[136:139],a[4:7]
v_mfma_f32_16x16x32_bf16 a[8:11],v[208:211],v[144:147],a[8:11]
s_waitcnt lgkmcnt(4)
s_mov_b32 m0,s44
v_mfma_f32_16x16x32_bf16 a[12:15],v[208:211],v[152:155],a[12:15]
ds_read_b64_tr_b16 v[208:209],v233 offset:128
ds_read_b64_tr_b16 v[210:211],v233 offset:8832
v_mfma_f32_16x16x32_bf16 a[28:31],v[212:215],v[152:155],a[28:31]
v_exp_f32 v161,v161
v_mfma_f32_16x16x32_bf16 a[24:27],v[212:215],v[144:147],a[24:27]
buffer_load_dwordx4 v237,s[12:15],s45 offen offset:0 sc0 sc1 nt lds
v_mfma_f32_16x16x32_bf16 a[20:23],v[212:215],v[136:139],a[20:23]
s_waitcnt lgkmcnt(4)
v_add_f32 v228,v160,v161
v_mfma_f32_16x16x32_bf16 a[16:19],v[212:215],v[128:131],a[16:19]
ds_read_b64_tr_b16 v[212:213],v234 offset:160
ds_read_b64_tr_b16 v[214:215],v234 offset:8864
v_mfma_f32_16x16x32_bf16 a[32:35],v[216:219],v[128:131],a[32:35]
v_exp_f32 v162,v162
v_mfma_f32_16x16x32_bf16 a[36:39],v[216:219],v[136:139],a[36:39]
v_cvt_pk_bf16_f32 v160,v160,v161
v_add_f32 v228,v228,v162
v_mfma_f32_16x16x32_bf16 a[40:43],v[216:219],v[144:147],a[40:43]
s_waitcnt lgkmcnt(4)
s_add_u32 m0,s44,64
v_mfma_f32_16x16x32_bf16 a[44:47],v[216:219],v[152:155],a[44:47]
ds_read_b64_tr_b16 v[216:217],v233 offset:192
ds_read_b64_tr_b16 v[218:219],v233 offset:8896
v_mfma_f32_16x16x32_bf16 a[60:63],v[220:223],v[152:155],a[60:63]
v_exp_f32 v163,v163
v_mfma_f32_16x16x32_bf16 a[56:59],v[220:223],v[144:147],a[56:59]
buffer_load_dwordx4 v237,s[12:15],s45 offen offset:1024 sc0 sc1 nt lds
v_mfma_f32_16x16x32_bf16 a[52:55],v[220:223],v[136:139],a[52:55]
s_waitcnt lgkmcnt(4)
v_add_f32 v228,v228,v163
v_mfma_f32_16x16x32_bf16 a[48:51],v[220:223],v[128:131],a[48:51]
ds_read_b64_tr_b16 v[220:221],v234 offset:224
ds_read_b64_tr_b16 v[222:223],v234 offset:8928
v_mfma_f32_16x16x32_bf16 a[64:67],v[208:211],v[128:131],a[64:67]
v_exp_f32 v164,v164
v_mfma_f32_16x16x32_bf16 a[68:71],v[208:211],v[136:139],a[68:71]
v_cvt_pk_bf16_f32 v161,v162,v163
v_add_f32 v228,v228,v164
v_mfma_f32_16x16x32_bf16 a[72:75],v[208:211],v[144:147],a[72:75]
s_waitcnt lgkmcnt(4)
s_add_u32 m0,s44,128
v_mfma_f32_16x16x32_bf16 a[76:79],v[208:211],v[152:155],a[76:79]
ds_read_b64_tr_b16 v[208:209],v233 offset:256
ds_read_b64_tr_b16 v[210:211],v233 offset:8960
v_mfma_f32_16x16x32_bf16 a[92:95],v[212:215],v[152:155],a[92:95]
v_exp_f32 v165,v165
v_mfma_f32_16x16x32_bf16 a[88:91],v[212:215],v[144:147],a[88:91]
buffer_load_dwordx4 v237,s[12:15],s45 offen offset:2048 sc0 sc1 nt lds
v_mfma_f32_16x16x32_bf16 a[84:87],v[212:215],v[136:139],a[84:87]
s_waitcnt lgkmcnt(4)
v_add_f32 v228,v228,v165
v_mfma_f32_16x16x32_bf16 a[80:83],v[212:215],v[128:131],a[80:83]
ds_read_b64_tr_b16 v[212:213],v234 offset:288
ds_read_b64_tr_b16 v[214:215],v234 offset:8992
v_mfma_f32_16x16x32_bf16 a[96:99],v[216:219],v[128:131],a[96:99]
v_exp_f32 v166,v166
v_mfma_f32_16x16x32_bf16 a[100:103],v[216:219],v[136:139],a[100:103]
v_cvt_pk_bf16_f32 v162,v164,v165
v_add_f32 v228,v228,v166
v_mfma_f32_16x16x32_bf16 a[104:107],v[216:219],v[144:147],a[104:107]
s_waitcnt lgkmcnt(4)
s_add_u32 m0,s44,192
v_mfma_f32_16x16x32_bf16 a[108:111],v[216:219],v[152:155],a[108:111]
ds_read_b64_tr_b16 v[216:217],v233 offset:320
ds_read_b64_tr_b16 v[218:219],v233 offset:9024
v_mfma_f32_16x16x32_bf16 a[124:127],v[220:223],v[152:155],a[124:127]
v_exp_f32 v167,v167
v_mfma_f32_16x16x32_bf16 a[120:123],v[220:223],v[144:147],a[120:123]
buffer_load_dwordx4 v237,s[12:15],s45 offen offset:3072 sc0 sc1 nt lds
v_mfma_f32_16x16x32_bf16 a[116:119],v[220:223],v[136:139],a[116:119]
s_waitcnt lgkmcnt(4)
v_add_f32 v228,v228,v167
v_mfma_f32_16x16x32_bf16 a[112:115],v[220:223],v[128:131],a[112:115]
ds_read_b64_tr_b16 v[220:221],v234 offset:352
ds_read_b64_tr_b16 v[222:223],v234 offset:9056
v_mfma_f32_16x16x32_bf16 a[128:131],v[208:211],v[128:131],a[128:131]
v_exp_f32 v168,v168
v_mfma_f32_16x16x32_bf16 a[132:135],v[208:211],v[136:139],a[132:135]
v_cvt_pk_bf16_f32 v163,v166,v167
v_mfma_f32_16x16x32_bf16 a[136:139],v[208:211],v[144:147],a[136:139]
s_waitcnt lgkmcnt(4)
v_mfma_f32_16x16x32_bf16 a[140:143],v[208:211],v[152:155],a[140:143]
ds_read_b64_tr_b16 v[208:209],v233 offset:384
ds_read_b64_tr_b16 v[210:211],v233 offset:9088
v_mfma_f32_16x16x32_bf16 a[156:159],v[212:215],v[152:155],a[156:159]
v_exp_f32 v169,v169
v_mfma_f32_16x16x32_bf16 a[152:155],v[212:215],v[144:147],a[152:155]
v_add_f32 v229,v168,v169
v_cvt_pk_bf16_f32 v168,v168,v169
v_mfma_f32_16x16x32_bf16 a[148:151],v[212:215],v[136:139],a[148:151]
s_waitcnt lgkmcnt(4)
v_mfma_f32_16x16x32_bf16 a[144:147],v[212:215],v[128:131],a[144:147]
ds_read_b64_tr_b16 v[212:213],v234 offset:416
ds_read_b64_tr_b16 v[214:215],v234 offset:9120
v_mfma_f32_16x16x32_bf16 a[160:163],v[216:219],v[128:131],a[160:163]
v_exp_f32 v170,v170
v_mfma_f32_16x16x32_bf16 a[164:167],v[216:219],v[136:139],a[164:167]
v_add_f32 v229,v229,v170
v_mfma_f32_16x16x32_bf16 a[168:171],v[216:219],v[144:147],a[168:171]
s_waitcnt lgkmcnt(4)
v_mfma_f32_16x16x32_bf16 a[172:175],v[216:219],v[152:155],a[172:175]
ds_read_b64_tr_b16 v[216:217],v233 offset:448
ds_read_b64_tr_b16 v[218:219],v233 offset:9152
v_mfma_f32_16x16x32_bf16 a[188:191],v[220:223],v[152:155],a[188:191]
v_exp_f32 v171,v171
v_mfma_f32_16x16x32_bf16 a[184:187],v[220:223],v[144:147],a[184:187]
v_add_f32 v229,v229,v171
v_cvt_pk_bf16_f32 v169,v170,v171
v_mfma_f32_16x16x32_bf16 a[180:183],v[220:223],v[136:139],a[180:183]
s_waitcnt lgkmcnt(4)
v_mfma_f32_16x16x32_bf16 a[176:179],v[220:223],v[128:131],a[176:179]
ds_read_b64_tr_b16 v[220:221],v234 offset:480
ds_read_b64_tr_b16 v[222:223],v234 offset:9184
v_mfma_f32_16x16x32_bf16 a[192:195],v[208:211],v[128:131],a[192:195]
v_exp_f32 v172,v172
v_mfma_f32_16x16x32_bf16 a[196:199],v[208:211],v[136:139],a[196:199]
v_add_f32 v229,v229,v172
v_mfma_f32_16x16x32_bf16 a[200:203],v[208:211],v[144:147],a[200:203]
s_waitcnt vmcnt(8) lgkmcnt(4)
s_barrier
v_mfma_f32_16x16x32_bf16 a[204:207],v[208:211],v[152:155],a[204:207]
ds_read_b128 v[208:211],v232 offset:0
v_mfma_f32_16x16x32_bf16 a[220:223],v[212:215],v[152:155],a[220:223]
v_exp_f32 v173,v173
v_mfma_f32_16x16x32_bf16 a[216:219],v[212:215],v[144:147],a[216:219]
v_add_f32 v229,v229,v173
v_cvt_pk_bf16_f32 v170,v172,v173
v_mfma_f32_16x16x32_bf16 a[212:215],v[212:215],v[136:139],a[212:215]
s_waitcnt lgkmcnt(3)
v_mfma_f32_16x16x32_bf16 a[208:211],v[212:215],v[128:131],a[208:211]
ds_read_b128 v[212:215],v232 offset:64
v_mfma_f32_16x16x32_bf16 a[224:227],v[216:219],v[128:131],a[224:227]
v_exp_f32 v174,v174
v_mfma_f32_16x16x32_bf16 a[228:231],v[216:219],v[136:139],a[228:231]
v_add_f32 v229,v229,v174
v_mfma_f32_16x16x32_bf16 a[232:235],v[216:219],v[144:147],a[232:235]
s_waitcnt lgkmcnt(2)
v_mfma_f32_16x16x32_bf16 a[236:239],v[216:219],v[152:155],a[236:239]
ds_read_b128 v[216:219],v232 offset:128
v_mfma_f32_16x16x32_bf16 a[252:255],v[220:223],v[152:155],a[252:255]
v_exp_f32 v175,v175
v_mfma_f32_16x16x32_bf16 a[248:251],v[220:223],v[144:147],a[248:251]
v_add_f32 v229,v229,v175
v_cvt_pk_bf16_f32 v171,v174,v175
v_mfma_f32_16x16x32_bf16 a[244:247],v[220:223],v[136:139],a[244:247]
v_mfma_f32_16x16x32_bf16 a[240:243],v[220:223],v[128:131],a[240:243]
s_waitcnt lgkmcnt(1)
ds_read_b128 v[220:223],v232 offset:192
v_mfma_f32_16x16x32_bf16 v[128:131],v[208:211],v[0:3],v[192:195]
v_exp_f32 v176,v176
v_mfma_f32_16x16x32_bf16 v[128:131],v[212:215],v[16:19],v[128:131]
s_bitcmp1_b32 s46,1
s_cselect_b64 s[42:43],s[84:85],s[38:39]
v_mfma_f32_16x16x32_bf16 v[136:139],v[208:211],v[4:7],v[196:199]
v_exp_f32 v177,v177
v_mfma_f32_16x16x32_bf16 v[136:139],v[212:215],v[20:23],v[136:139]
v_add_f32 v230,v176,v177
v_cvt_pk_bf16_f32 v176,v176,v177
v_mfma_f32_16x16x32_bf16 v[144:147],v[208:211],v[8:11],v[200:203]
v_exp_f32 v178,v178
v_mfma_f32_16x16x32_bf16 v[144:147],v[212:215],v[24:27],v[144:147]
v_add_f32 v230,v230,v178
s_cselect_b64 s[34:35],0,s[86:87]
v_mfma_f32_16x16x32_bf16 v[152:155],v[208:211],v[12:15],v[204:207]
ds_read_b128 v[208:211],v232 offset:256
s_add_u32 s39,s39,s35
v_mfma_f32_16x16x32_bf16 v[152:155],v[212:215],v[28:31],v[152:155]
s_waitcnt lgkmcnt(1)
ds_read_b128 v[212:215],v232 offset:320
v_mfma_f32_16x16x32_bf16 v[128:131],v[216:219],v[32:35],v[128:131]
v_exp_f32 v179,v179
v_mfma_f32_16x16x32_bf16 v[128:131],v[220:223],v[48:51],v[128:131]
v_add_f32 v230,v230,v179
v_cvt_pk_bf16_f32 v177,v178,v179
v_mfma_f32_16x16x32_bf16 v[136:139],v[216:219],v[36:39],v[136:139]
v_exp_f32 v180,v180
v_mfma_f32_16x16x32_bf16 v[136:139],v[220:223],v[52:55],v[136:139]
v_add_f32 v230,v230,v180
s_add_u32 s38,s38,s34
v_mfma_f32_16x16x32_bf16 v[144:147],v[216:219],v[40:43],v[144:147]
v_exp_f32 v181,v181
v_mfma_f32_16x16x32_bf16 v[144:147],v[220:223],v[56:59],v[144:147]
v_add_f32 v230,v230,v181
v_cvt_pk_bf16_f32 v178,v180,v181
v_mfma_f32_16x16x32_bf16 v[152:155],v[216:219],v[44:47],v[152:155]
ds_read_b128 v[216:219],v232 offset:384
s_cmp_eq_u32 s38,s49
v_mfma_f32_16x16x32_bf16 v[152:155],v[220:223],v[60:63],v[152:155]
s_waitcnt lgkmcnt(1)
ds_read_b128 v[220:223],v232 offset:448
v_mfma_f32_16x16x32_bf16 v[128:131],v[208:211],v[64:67],v[128:131]
v_exp_f32 v182,v182
v_mfma_f32_16x16x32_bf16 v[128:131],v[212:215],v[80:83],v[128:131]
v_add_f32 v230,v230,v182
s_cmov_b32 s38,s48
v_mfma_f32_16x16x32_bf16 v[136:139],v[208:211],v[68:71],v[136:139]
s_bitcmp1_b32 s47,1
s_cselect_b64 s[44:45],s[84:85],s[40:41]
v_mfma_f32_16x16x32_bf16 v[136:139],v[212:215],v[84:87],v[136:139]
v_exp_f32 v183,v183
v_mfma_f32_16x16x32_bf16 v[144:147],v[208:211],v[72:75],v[144:147]
s_mov_b32 m0,s42
v_add_f32 v230,v230,v183
v_mfma_f32_16x16x32_bf16 v[144:147],v[212:215],v[88:91],v[144:147]
buffer_load_dwordx4 v236,s[8:11],s43 offen offset:0 sc0 sc1 nt lds
v_mfma_f32_16x16x32_bf16 v[152:155],v[208:211],v[76:79],v[152:155]
ds_read_b128 v[208:211],v232 offset:8704
v_max3_f32 v243,v228,v229,v230
v_mfma_f32_16x16x32_bf16 v[152:155],v[212:215],v[92:95],v[152:155]
s_waitcnt lgkmcnt(1)
ds_read_b128 v[212:215],v232 offset:8768
v_mfma_f32_16x16x32_bf16 v[128:131],v[216:219],v[96:99],v[128:131]
v_exp_f32 v184,v184
v_mfma_f32_16x16x32_bf16 v[128:131],v[220:223],v[112:115],v[128:131]
v_cvt_pk_bf16_f32 v179,v182,v183
s_cselect_b64 s[34:35],0,s[86:87]
v_mfma_f32_16x16x32_bf16 v[136:139],v[216:219],v[100:103],v[136:139]
s_add_u32 s41,s41,s35
s_add_u32 s40,s40,s34
v_mfma_f32_16x16x32_bf16 v[136:139],v[220:223],v[116:119],v[136:139]
v_exp_f32 v185,v185
v_mfma_f32_16x16x32_bf16 v[144:147],v[216:219],v[104:107],v[144:147]
s_add_u32 m0,s42,64
v_add_f32 v231,v184,v185
v_mfma_f32_16x16x32_bf16 v[144:147],v[220:223],v[120:123],v[144:147]
buffer_load_dwordx4 v236,s[8:11],s43 offen offset:1024 sc0 sc1 nt lds
v_mfma_f32_16x16x32_bf16 v[152:155],v[216:219],v[108:111],v[152:155]
ds_read_b128 v[216:219],v232 offset:8832
v_cvt_pk_bf16_f32 v184,v184,v185
v_mfma_f32_16x16x32_bf16 v[152:155],v[220:223],v[124:127],v[152:155]
s_waitcnt lgkmcnt(1)
ds_read_b128 v[220:223],v232 offset:8896
v_mfma_f32_16x16x32_bf16 v[132:135],v[208:211],v[0:3],v[192:195]
v_exp_f32 v186,v186
v_mfma_f32_16x16x32_bf16 v[132:135],v[212:215],v[16:19],v[132:135]
v_add_f32 v231,v231,v186
s_cmp_eq_u32 s40,s48
v_mfma_f32_16x16x32_bf16 v[140:143],v[208:211],v[4:7],v[196:199]
s_cmov_b32 s40,s32
v_mfma_f32_16x16x32_bf16 v[140:143],v[212:215],v[20:23],v[140:143]
v_exp_f32 v187,v187
v_mfma_f32_16x16x32_bf16 v[148:151],v[208:211],v[8:11],v[200:203]
s_add_u32 m0,s42,128
v_add_f32 v231,v231,v187
v_mfma_f32_16x16x32_bf16 v[148:151],v[212:215],v[24:27],v[148:151]
buffer_load_dwordx4 v236,s[8:11],s43 offen offset:2048 sc0 sc1 nt lds
v_mfma_f32_16x16x32_bf16 v[156:159],v[208:211],v[12:15],v[204:207]
ds_read_b128 v[208:211],v232 offset:8960
v_cvt_pk_bf16_f32 v185,v186,v187
v_mfma_f32_16x16x32_bf16 v[156:159],v[212:215],v[28:31],v[156:159]
s_waitcnt lgkmcnt(1)
ds_read_b128 v[212:215],v232 offset:9024
v_mfma_f32_16x16x32_bf16 v[132:135],v[216:219],v[32:35],v[132:135]
v_exp_f32 v188,v188
v_mfma_f32_16x16x32_bf16 v[132:135],v[220:223],v[48:51],v[132:135]
v_add_f32 v231,v231,v188
v_mfma_f32_16x16x32_bf16 v[140:143],v[216:219],v[36:39],v[140:143]
v_mfma_f32_16x16x32_bf16 v[140:143],v[220:223],v[52:55],v[140:143]
v_exp_f32 v189,v189
v_mfma_f32_16x16x32_bf16 v[148:151],v[216:219],v[40:43],v[148:151]
s_add_u32 m0,s42,192
v_add_f32 v231,v231,v189
v_mfma_f32_16x16x32_bf16 v[148:151],v[220:223],v[56:59],v[148:151]
buffer_load_dwordx4 v236,s[8:11],s43 offen offset:3072 sc0 sc1 nt lds
v_mfma_f32_16x16x32_bf16 v[156:159],v[216:219],v[44:47],v[156:159]
ds_read_b128 v[216:219],v232 offset:9088
v_cvt_pk_bf16_f32 v186,v188,v189
v_mfma_f32_16x16x32_bf16 v[156:159],v[220:223],v[60:63],v[156:159]
s_waitcnt lgkmcnt(1)
ds_read_b128 v[220:223],v232 offset:9152
v_mfma_f32_16x16x32_bf16 v[132:135],v[208:211],v[64:67],v[132:135]
v_exp_f32 v190,v190
v_mfma_f32_16x16x32_bf16 v[132:135],v[212:215],v[80:83],v[132:135]
v_add_f32 v231,v231,v190
s_add_u32 s62,s62,s86
v_mfma_f32_16x16x32_bf16 v[140:143],v[208:211],v[68:71],v[140:143]
v_mfma_f32_16x16x32_bf16 v[140:143],v[212:215],v[84:87],v[140:143]
v_exp_f32 v191,v191
v_mfma_f32_16x16x32_bf16 v[148:151],v[208:211],v[72:75],v[148:151]
v_add_f32 v231,v231,v191
v_cvt_pk_bf16_f32 v187,v190,v191
v_mfma_f32_16x16x32_bf16 v[148:151],v[212:215],v[88:91],v[148:151]
v_max_f32 v243,v243,v231
v_cmp_lt_f32 vcc,s54,v243
v_mfma_f32_16x16x32_bf16 v[156:159],v[208:211],v[76:79],v[156:159]
ds_read_b64_tr_b16 v[208:209],v233 offset:17408
ds_read_b64_tr_b16 v[210:211],v233 offset:26112
v_mfma_f32_16x16x32_bf16 v[156:159],v[212:215],v[92:95],v[156:159]
s_waitcnt lgkmcnt(2)
ds_read_b64_tr_b16 v[212:213],v234 offset:17440
v_mfma_f32_16x16x32_bf16 v[132:135],v[216:219],v[96:99],v[132:135]
ds_read_b64_tr_b16 v[214:215],v234 offset:26144
s_cbranch_vccnz RS_1
RS_1_RET:
v_mfma_f32_16x16x32_bf16 v[132:135],v[220:223],v[112:115],v[132:135]
v_add_f32 v224,v224,v228
v_add_f32 v225,v225,v229
v_mfma_f32_16x16x32_bf16 v[140:143],v[216:219],v[100:103],v[140:143]
v_add_f32 v226,v226,v230
v_add_f32 v227,v227,v231
v_mfma_f32_16x16x32_bf16 v[140:143],v[220:223],v[116:119],v[140:143]
s_cmp_eq_u32 s62,87040
s_cselect_b32 s88,-69632,s86
v_mfma_f32_16x16x32_bf16 v[148:151],v[216:219],v[104:107],v[148:151]
s_cmov_b32 s62,0
v_add_u32 v232,s88,v232
v_mfma_f32_16x16x32_bf16 v[148:151],v[220:223],v[120:123],v[148:151]
s_add_u32 s52,s52,16384
v_mfma_f32_16x16x32_bf16 v[156:159],v[216:219],v[108:111],v[156:159]
ds_read_b64_tr_b16 v[216:217],v233 offset:17472
ds_read_b64_tr_b16 v[218:219],v233 offset:26176
v_mfma_f32_16x16x32_bf16 v[156:159],v[220:223],v[124:127],v[156:159]
s_waitcnt lgkmcnt(4)
ds_read_b64_tr_b16 v[220:221],v234 offset:17504
ds_read_b64_tr_b16 v[222:223],v234 offset:26208
v_mfma_f32_16x16x32_bf16 a[0:3],v[208:211],v[160:163],a[0:3]
v_exp_f32 v128,v128
v_mfma_f32_16x16x32_bf16 a[4:7],v[208:211],v[168:171],a[4:7]
v_mfma_f32_16x16x32_bf16 a[8:11],v[208:211],v[176:179],a[8:11]
s_waitcnt lgkmcnt(4)
s_mov_b32 m0,s44
v_mfma_f32_16x16x32_bf16 a[12:15],v[208:211],v[184:187],a[12:15]
ds_read_b64_tr_b16 v[208:209],v233 offset:17536
ds_read_b64_tr_b16 v[210:211],v233 offset:26240
v_mfma_f32_16x16x32_bf16 a[28:31],v[212:215],v[184:187],a[28:31]
v_exp_f32 v129,v129
v_mfma_f32_16x16x32_bf16 a[24:27],v[212:215],v[176:179],a[24:27]
buffer_load_dwordx4 v237,s[12:15],s45 offen offset:0 sc0 sc1 nt lds
v_mfma_f32_16x16x32_bf16 a[20:23],v[212:215],v[168:171],a[20:23]
s_waitcnt lgkmcnt(4)
v_add_f32 v228,v128,v129
v_mfma_f32_16x16x32_bf16 a[16:19],v[212:215],v[160:163],a[16:19]
ds_read_b64_tr_b16 v[212:213],v234 offset:17568
ds_read_b64_tr_b16 v[214:215],v234 offset:26272
v_mfma_f32_16x16x32_bf16 a[32:35],v[216:219],v[160:163],a[32:35]
v_exp_f32 v130,v130
v_mfma_f32_16x16x32_bf16 a[36:39],v[216:219],v[168:171],a[36:39]
v_cvt_pk_bf16_f32 v128,v128,v129
v_add_f32 v228,v228,v130
v_mfma_f32_16x16x32_bf16 a[40:43],v[216:219],v[176:179],a[40:43]
s_waitcnt lgkmcnt(4)
s_add_u32 m0,s44,64
v_mfma_f32_16x16x32_bf16 a[44:47],v[216:219],v[184:187],a[44:47]
ds_read_b64_tr_b16 v[216:217],v233 offset:17600
ds_read_b64_tr_b16 v[218:219],v233 offset:26304
v_mfma_f32_16x16x32_bf16 a[60:63],v[220:223],v[184:187],a[60:63]
v_exp_f32 v131,v131
v_mfma_f32_16x16x32_bf16 a[56:59],v[220:223],v[176:179],a[56:59]
buffer_load_dwordx4 v237,s[12:15],s45 offen offset:1024 sc0 sc1 nt lds
v_mfma_f32_16x16x32_bf16 a[52:55],v[220:223],v[168:171],a[52:55]
s_waitcnt lgkmcnt(4)
v_add_f32 v228,v228,v131
v_mfma_f32_16x16x32_bf16 a[48:51],v[220:223],v[160:163],a[48:51]
ds_read_b64_tr_b16 v[220:221],v234 offset:17632
ds_read_b64_tr_b16 v[222:223],v234 offset:26336
v_mfma_f32_16x16x32_bf16 a[64:67],v[208:211],v[160:163],a[64:67]
v_exp_f32 v132,v132
v_mfma_f32_16x16x32_bf16 a[68:71],v[208:211],v[168:171],a[68:71]
v_cvt_pk_bf16_f32 v129,v130,v131
v_add_f32 v228,v228,v132
v_mfma_f32_16x16x32_bf16 a[72:75],v[208:211],v[176:179],a[72:75]
s_waitcnt lgkmcnt(4)
s_add_u32 m0,s44,128
v_mfma_f32_16x16x32_bf16 a[76:79],v[208:211],v[184:187],a[76:79]
ds_read_b64_tr_b16 v[208:209],v233 offset:17664
ds_read_b64_tr_b16 v[210:211],v233 offset:26368
v_mfma_f32_16x16x32_bf16 a[92:95],v[212:215],v[184:187],a[92:95]
v_exp_f32 v133,v133
v_mfma_f32_16x16x32_bf16 a[88:91],v[212:215],v[176:179],a[88:91]
buffer_load_dwordx4 v237,s[12:15],s45 offen offset:2048 sc0 sc1 nt lds
v_mfma_f32_16x16x32_bf16 a[84:87],v[212:215],v[168:171],a[84:87]
s_waitcnt lgkmcnt(4)
v_add_f32 v228,v228,v133
v_mfma_f32_16x16x32_bf16 a[80:83],v[212:215],v[160:163],a[80:83]
ds_read_b64_tr_b16 v[212:213],v234 offset:17696
ds_read_b64_tr_b16 v[214:215],v234 offset:26400
v_mfma_f32_16x16x32_bf16 a[96:99],v[216:219],v[160:163],a[96:99]
v_exp_f32 v134,v134
v_mfma_f32_16x16x32_bf16 a[100:103],v[216:219],v[168:171],a[100:103]
v_cvt_pk_bf16_f32 v130,v132,v133
v_add_f32 v228,v228,v134
v_mfma_f32_16x16x32_bf16 a[104:107],v[216:219],v[176:179],a[104:107]
s_waitcnt lgkmcnt(4)
s_add_u32 m0,s44,192
v_mfma_f32_16x16x32_bf16 a[108:111],v[216:219],v[184:187],a[108:111]
ds_read_b64_tr_b16 v[216:217],v233 offset:17728
ds_read_b64_tr_b16 v[218:219],v233 offset:26432
v_mfma_f32_16x16x32_bf16 a[124:127],v[220:223],v[184:187],a[124:127]
v_exp_f32 v135,v135
v_mfma_f32_16x16x32_bf16 a[120:123],v[220:223],v[176:179],a[120:123]
buffer_load_dwordx4 v237,s[12:15],s45 offen offset:3072 sc0 sc1 nt lds
v_mfma_f32_16x16x32_bf16 a[116:119],v[220:223],v[168:171],a[116:119]
s_waitcnt lgkmcnt(4)
v_add_f32 v228,v228,v135
v_mfma_f32_16x16x32_bf16 a[112:115],v[220:223],v[160:163],a[112:115]
ds_read_b64_tr_b16 v[220:221],v234 offset:17760
ds_read_b64_tr_b16 v[222:223],v234 offset:26464
v_mfma_f32_16x16x32_bf16 a[128:131],v[208:211],v[160:163],a[128:131]
v_exp_f32 v136,v136
v_mfma_f32_16x16x32_bf16 a[132:135],v[208:211],v[168:171],a[132:135]
v_cvt_pk_bf16_f32 v131,v134,v135
v_mfma_f32_16x16x32_bf16 a[136:139],v[208:211],v[176:179],a[136:139]
s_waitcnt lgkmcnt(4)
v_mfma_f32_16x16x32_bf16 a[140:143],v[208:211],v[184:187],a[140:143]
ds_read_b64_tr_b16 v[208:209],v233 offset:17792
ds_read_b64_tr_b16 v[210:211],v233 offset:26496
v_mfma_f32_16x16x32_bf16 a[156:159],v[212:215],v[184:187],a[156:159]
v_exp_f32 v137,v137
v_mfma_f32_16x16x32_bf16 a[152:155],v[212:215],v[176:179],a[152:155]
v_add_f32 v229,v136,v137
v_cvt_pk_bf16_f32 v136,v136,v137
v_mfma_f32_16x16x32_bf16 a[148:151],v[212:215],v[168:171],a[148:151]
s_waitcnt lgkmcnt(4)
v_mfma_f32_16x16x32_bf16 a[144:147],v[212:215],v[160:163],a[144:147]
ds_read_b64_tr_b16 v[212:213],v234 offset:17824
ds_read_b64_tr_b16 v[214:215],v234 offset:26528
v_mfma_f32_16x16x32_bf16 a[160:163],v[216:219],v[160:163],a[160:163]
v_exp_f32 v138,v138
v_mfma_f32_16x16x32_bf16 a[164:167],v[216:219],v[168:171],a[164:167]
v_add_f32 v229,v229,v138
v_mfma_f32_16x16x32_bf16 a[168:171],v[216:219],v[176:179],a[168:171]
s_waitcnt lgkmcnt(4)
v_mfma_f32_16x16x32_bf16 a[172:175],v[216:219],v[184:187],a[172:175]
ds_read_b64_tr_b16 v[216:217],v233 offset:17856
ds_read_b64_tr_b16 v[218:219],v233 offset:26560
v_mfma_f32_16x16x32_bf16 a[188:191],v[220:223],v[184:187],a[188:191]
v_exp_f32 v139,v139
v_mfma_f32_16x16x32_bf16 a[184:187],v[220:223],v[176:179],a[184:187]
v_add_f32 v229,v229,v139
v_cvt_pk_bf16_f32 v137,v138,v139
v_mfma_f32_16x16x32_bf16 a[180:183],v[220:223],v[168:171],a[180:183]
s_waitcnt lgkmcnt(4)
v_mfma_f32_16x16x32_bf16 a[176:179],v[220:223],v[160:163],a[176:179]
ds_read_b64_tr_b16 v[220:221],v234 offset:17888
ds_read_b64_tr_b16 v[222:223],v234 offset:26592
v_mfma_f32_16x16x32_bf16 a[192:195],v[208:211],v[160:163],a[192:195]
v_exp_f32 v140,v140
v_mfma_f32_16x16x32_bf16 a[196:199],v[208:211],v[168:171],a[196:199]
v_add_f32 v229,v229,v140
v_mfma_f32_16x16x32_bf16 a[200:203],v[208:211],v[176:179],a[200:203]
s_waitcnt vmcnt(8) lgkmcnt(4)
s_barrier
v_mfma_f32_16x16x32_bf16 a[204:207],v[208:211],v[184:187],a[204:207]
ds_read_b128 v[208:211],v232 offset:0
v_mfma_f32_16x16x32_bf16 a[220:223],v[212:215],v[184:187],a[220:223]
v_exp_f32 v141,v141
v_mfma_f32_16x16x32_bf16 a[216:219],v[212:215],v[176:179],a[216:219]
v_add_f32 v229,v229,v141
v_cvt_pk_bf16_f32 v138,v140,v141
v_mfma_f32_16x16x32_bf16 a[212:215],v[212:215],v[168:171],a[212:215]
s_waitcnt lgkmcnt(3)
v_mfma_f32_16x16x32_bf16 a[208:211],v[212:215],v[160:163],a[208:211]
ds_read_b128 v[212:215],v232 offset:64
v_mfma_f32_16x16x32_bf16 a[224:227],v[216:219],v[160:163],a[224:227]
v_exp_f32 v142,v142
v_mfma_f32_16x16x32_bf16 a[228:231],v[216:219],v[168:171],a[228:231]
v_add_f32 v229,v229,v142
v_mfma_f32_16x16x32_bf16 a[232:235],v[216:219],v[176:179],a[232:235]
s_waitcnt lgkmcnt(2)
v_mfma_f32_16x16x32_bf16 a[236:239],v[216:219],v[184:187],a[236:239]
ds_read_b128 v[216:219],v232 offset:128
v_mfma_f32_16x16x32_bf16 a[252:255],v[220:223],v[184:187],a[252:255]
v_exp_f32 v143,v143
v_mfma_f32_16x16x32_bf16 a[248:251],v[220:223],v[176:179],a[248:251]
v_add_f32 v229,v229,v143
v_cvt_pk_bf16_f32 v139,v142,v143
v_mfma_f32_16x16x32_bf16 a[244:247],v[220:223],v[168:171],a[244:247]
v_mfma_f32_16x16x32_bf16 a[240:243],v[220:223],v[160:163],a[240:243]
s_waitcnt lgkmcnt(1)
ds_read_b128 v[220:223],v232 offset:192
v_mfma_f32_16x16x32_bf16 v[160:163],v[208:211],v[0:3],v[192:195]
v_exp_f32 v144,v144
v_mfma_f32_16x16x32_bf16 v[160:163],v[212:215],v[16:19],v[160:163]
s_bitcmp1_b32 s46,2
s_cselect_b64 s[42:43],s[84:85],s[38:39]
v_mfma_f32_16x16x32_bf16 v[168:171],v[208:211],v[4:7],v[196:199]
v_exp_f32 v145,v145
v_mfma_f32_16x16x32_bf16 v[168:171],v[212:215],v[20:23],v[168:171]
v_add_f32 v230,v144,v145
v_cvt_pk_bf16_f32 v144,v144,v145
v_mfma_f32_16x16x32_bf16 v[176:179],v[208:211],v[8:11],v[200:203]
v_exp_f32 v146,v146
v_mfma_f32_16x16x32_bf16 v[176:179],v[212:215],v[24:27],v[176:179]
v_add_f32 v230,v230,v146
s_cselect_b64 s[34:35],0,s[86:87]
v_mfma_f32_16x16x32_bf16 v[184:187],v[208:211],v[12:15],v[204:207]
ds_read_b128 v[208:211],v232 offset:256
s_add_u32 s39,s39,s35
v_mfma_f32_16x16x32_bf16 v[184:187],v[212:215],v[28:31],v[184:187]
s_waitcnt lgkmcnt(1)
ds_read_b128 v[212:215],v232 offset:320
v_mfma_f32_16x16x32_bf16 v[160:163],v[216:219],v[32:35],v[160:163]
v_exp_f32 v147,v147
v_mfma_f32_16x16x32_bf16 v[160:163],v[220:223],v[48:51],v[160:163]
v_add_f32 v230,v230,v147
v_cvt_pk_bf16_f32 v145,v146,v147
v_mfma_f32_16x16x32_bf16 v[168:171],v[216:219],v[36:39],v[168:171]
v_exp_f32 v148,v148
v_mfma_f32_16x16x32_bf16 v[168:171],v[220:223],v[52:55],v[168:171]
v_add_f32 v230,v230,v148
s_add_u32 s38,s38,s34
v_mfma_f32_16x16x32_bf16 v[176:179],v[216:219],v[40:43],v[176:179]
v_exp_f32 v149,v149
v_mfma_f32_16x16x32_bf16 v[176:179],v[220:223],v[56:59],v[176:179]
v_add_f32 v230,v230,v149
v_cvt_pk_bf16_f32 v146,v148,v149
v_mfma_f32_16x16x32_bf16 v[184:187],v[216:219],v[44:47],v[184:187]
ds_read_b128 v[216:219],v232 offset:384
s_cmp_eq_u32 s38,s49
v_mfma_f32_16x16x32_bf16 v[184:187],v[220:223],v[60:63],v[184:187]
s_waitcnt lgkmcnt(1)
ds_read_b128 v[220:223],v232 offset:448
v_mfma_f32_16x16x32_bf16 v[160:163],v[208:211],v[64:67],v[160:163]
v_exp_f32 v150,v150
v_mfma_f32_16x16x32_bf16 v[160:163],v[212:215],v[80:83],v[160:163]
v_add_f32 v230,v230,v150
s_cmov_b32 s38,s48
v_mfma_f32_16x16x32_bf16 v[168:171],v[208:211],v[68:71],v[168:171]
s_bitcmp1_b32 s47,2
s_cselect_b64 s[44:45],s[84:85],s[40:41]
v_mfma_f32_16x16x32_bf16 v[168:171],v[212:215],v[84:87],v[168:171]
v_exp_f32 v151,v151
v_mfma_f32_16x16x32_bf16 v[176:179],v[208:211],v[72:75],v[176:179]
s_mov_b32 m0,s42
v_add_f32 v230,v230,v151
v_mfma_f32_16x16x32_bf16 v[176:179],v[212:215],v[88:91],v[176:179]
buffer_load_dwordx4 v236,s[8:11],s43 offen offset:0 sc0 sc1 nt lds
v_mfma_f32_16x16x32_bf16 v[184:187],v[208:211],v[76:79],v[184:187]
ds_read_b128 v[208:211],v232 offset:8704
v_max3_f32 v243,v228,v229,v230
v_mfma_f32_16x16x32_bf16 v[184:187],v[212:215],v[92:95],v[184:187]
s_waitcnt lgkmcnt(1)
ds_read_b128 v[212:215],v232 offset:8768
v_mfma_f32_16x16x32_bf16 v[160:163],v[216:219],v[96:99],v[160:163]
v_exp_f32 v152,v152
v_mfma_f32_16x16x32_bf16 v[160:163],v[220:223],v[112:115],v[160:163]
v_cvt_pk_bf16_f32 v147,v150,v151
s_cselect_b64 s[34:35],0,s[86:87]
v_mfma_f32_16x16x32_bf16 v[168:171],v[216:219],v[100:103],v[168:171]
s_add_u32 s41,s41,s35
s_add_u32 s40,s40,s34
v_mfma_f32_16x16x32_bf16 v[168:171],v[220:223],v[116:119],v[168:171]
v_exp_f32 v153,v153
v_mfma_f32_16x16x32_bf16 v[176:179],v[216:219],v[104:107],v[176:179]
s_add_u32 m0,s42,64
v_add_f32 v231,v152,v153
v_mfma_f32_16x16x32_bf16 v[176:179],v[220:223],v[120:123],v[176:179]
buffer_load_dwordx4 v236,s[8:11],s43 offen offset:1024 sc0 sc1 nt lds
v_mfma_f32_16x16x32_bf16 v[184:187],v[216:219],v[108:111],v[184:187]
ds_read_b128 v[216:219],v232 offset:8832
v_cvt_pk_bf16_f32 v152,v152,v153
v_mfma_f32_16x16x32_bf16 v[184:187],v[220:223],v[124:127],v[184:187]
s_waitcnt lgkmcnt(1)
ds_read_b128 v[220:223],v232 offset:8896
v_mfma_f32_16x16x32_bf16 v[164:167],v[208:211],v[0:3],v[192:195]
v_exp_f32 v154,v154
v_mfma_f32_16x16x32_bf16 v[164:167],v[212:215],v[16:19],v[164:167]
v_add_f32 v231,v231,v154
s_cmp_eq_u32 s40,s48
v_mfma_f32_16x16x32_bf16 v[172:175],v[208:211],v[4:7],v[196:199]
s_cmov_b32 s40,s32
v_mfma_f32_16x16x32_bf16 v[172:175],v[212:215],v[20:23],v[172:175]
v_exp_f32 v155,v155
v_mfma_f32_16x16x32_bf16 v[180:183],v[208:211],v[8:11],v[200:203]
s_add_u32 m0,s42,128
v_add_f32 v231,v231,v155
v_mfma_f32_16x16x32_bf16 v[180:183],v[212:215],v[24:27],v[180:183]
buffer_load_dwordx4 v236,s[8:11],s43 offen offset:2048 sc0 sc1 nt lds
v_mfma_f32_16x16x32_bf16 v[188:191],v[208:211],v[12:15],v[204:207]
ds_read_b128 v[208:211],v232 offset:8960
v_cvt_pk_bf16_f32 v153,v154,v155
v_mfma_f32_16x16x32_bf16 v[188:191],v[212:215],v[28:31],v[188:191]
s_waitcnt lgkmcnt(1)
ds_read_b128 v[212:215],v232 offset:9024
v_mfma_f32_16x16x32_bf16 v[164:167],v[216:219],v[32:35],v[164:167]
v_exp_f32 v156,v156
v_mfma_f32_16x16x32_bf16 v[164:167],v[220:223],v[48:51],v[164:167]
v_add_f32 v231,v231,v156
v_mfma_f32_16x16x32_bf16 v[172:175],v[216:219],v[36:39],v[172:175]
v_mfma_f32_16x16x32_bf16 v[172:175],v[220:223],v[52:55],v[172:175]
v_exp_f32 v157,v157
v_mfma_f32_16x16x32_bf16 v[180:183],v[216:219],v[40:43],v[180:183]
s_add_u32 m0,s42,192
v_add_f32 v231,v231,v157
v_mfma_f32_16x16x32_bf16 v[180:183],v[220:223],v[56:59],v[180:183]
buffer_load_dwordx4 v236,s[8:11],s43 offen offset:3072 sc0 sc1 nt lds
v_mfma_f32_16x16x32_bf16 v[188:191],v[216:219],v[44:47],v[188:191]
ds_read_b128 v[216:219],v232 offset:9088
v_cvt_pk_bf16_f32 v154,v156,v157
v_mfma_f32_16x16x32_bf16 v[188:191],v[220:223],v[60:63],v[188:191]
s_waitcnt lgkmcnt(1)
ds_read_b128 v[220:223],v232 offset:9152
v_mfma_f32_16x16x32_bf16 v[164:167],v[208:211],v[64:67],v[164:167]
v_exp_f32 v158,v158
v_mfma_f32_16x16x32_bf16 v[164:167],v[212:215],v[80:83],v[164:167]
v_add_f32 v231,v231,v158
s_add_u32 s62,s62,s86
v_mfma_f32_16x16x32_bf16 v[172:175],v[208:211],v[68:71],v[172:175]
v_mfma_f32_16x16x32_bf16 v[172:175],v[212:215],v[84:87],v[172:175]
v_exp_f32 v159,v159
v_mfma_f32_16x16x32_bf16 v[180:183],v[208:211],v[72:75],v[180:183]
v_add_f32 v231,v231,v159
v_cvt_pk_bf16_f32 v155,v158,v159
v_mfma_f32_16x16x32_bf16 v[180:183],v[212:215],v[88:91],v[180:183]
v_max_f32 v243,v243,v231
v_cmp_lt_f32 vcc,s54,v243
v_mfma_f32_16x16x32_bf16 v[188:191],v[208:211],v[76:79],v[188:191]
ds_read_b64_tr_b16 v[208:209],v233 offset:34816
ds_read_b64_tr_b16 v[210:211],v233 offset:43520
v_mfma_f32_16x16x32_bf16 v[188:191],v[212:215],v[92:95],v[188:191]
s_waitcnt lgkmcnt(2)
ds_read_b64_tr_b16 v[212:213],v234 offset:34848
v_mfma_f32_16x16x32_bf16 v[164:167],v[216:219],v[96:99],v[164:167]
ds_read_b64_tr_b16 v[214:215],v234 offset:43552
s_cbranch_vccnz RS_2
RS_2_RET:
v_mfma_f32_16x16x32_bf16 v[164:167],v[220:223],v[112:115],v[164:167]
v_add_f32 v224,v224,v228
v_add_f32 v225,v225,v229
v_mfma_f32_16x16x32_bf16 v[172:175],v[216:219],v[100:103],v[172:175]
v_add_f32 v226,v226,v230
v_add_f32 v227,v227,v231
v_mfma_f32_16x16x32_bf16 v[172:175],v[220:223],v[116:119],v[172:175]
s_cmp_eq_u32 s62,87040
s_cselect_b32 s88,-69632,s86
v_mfma_f32_16x16x32_bf16 v[180:183],v[216:219],v[104:107],v[180:183]
s_cmov_b32 s62,0
v_add_u32 v232,s88,v232
v_mfma_f32_16x16x32_bf16 v[180:183],v[220:223],v[120:123],v[180:183]
s_add_u32 s52,s52,16384
v_mfma_f32_16x16x32_bf16 v[188:191],v[216:219],v[108:111],v[188:191]
ds_read_b64_tr_b16 v[216:217],v233 offset:34880
ds_read_b64_tr_b16 v[218:219],v233 offset:43584
v_mfma_f32_16x16x32_bf16 v[188:191],v[220:223],v[124:127],v[188:191]
s_waitcnt lgkmcnt(4)
ds_read_b64_tr_b16 v[220:221],v234 offset:34912
ds_read_b64_tr_b16 v[222:223],v234 offset:43616
v_mfma_f32_16x16x32_bf16 a[0:3],v[208:211],v[128:131],a[0:3]
v_exp_f32 v160,v160
v_mfma_f32_16x16x32_bf16 a[4:7],v[208:211],v[136:139],a[4:7]
v_mfma_f32_16x16x32_bf16 a[8:11],v[208:211],v[144:147],a[8:11]
s_waitcnt lgkmcnt(4)
s_mov_b32 m0,s44
v_mfma_f32_16x16x32_bf16 a[12:15],v[208:211],v[152:155],a[12:15]
ds_read_b64_tr_b16 v[208:209],v233 offset:34944
ds_read_b64_tr_b16 v[210:211],v233 offset:43648
v_mfma_f32_16x16x32_bf16 a[28:31],v[212:215],v[152:155],a[28:31]
v_exp_f32 v161,v161
v_mfma_f32_16x16x32_bf16 a[24:27],v[212:215],v[144:147],a[24:27]
buffer_load_dwordx4 v237,s[12:15],s45 offen offset:0 sc0 sc1 nt lds
v_mfma_f32_16x16x32_bf16 a[20:23],v[212:215],v[136:139],a[20:23]
s_waitcnt lgkmcnt(4)
v_add_f32 v228,v160,v161
v_mfma_f32_16x16x32_bf16 a[16:19],v[212:215],v[128:131],a[16:19]
ds_read_b64_tr_b16 v[212:213],v234 offset:34976
ds_read_b64_tr_b16 v[214:215],v234 offset:43680
v_mfma_f32_16x16x32_bf16 a[32:35],v[216:219],v[128:131],a[32:35]
v_exp_f32 v162,v162
v_mfma_f32_16x16x32_bf16 a[36:39],v[216:219],v[136:139],a[36:39]
v_cvt_pk_bf16_f32 v160,v160,v161
v_add_f32 v228,v228,v162
v_mfma_f32_16x16x32_bf16 a[40:43],v[216:219],v[144:147],a[40:43]
s_waitcnt lgkmcnt(4)
s_add_u32 m0,s44,64
v_mfma_f32_16x16x32_bf16 a[44:47],v[216:219],v[152:155],a[44:47]
ds_read_b64_tr_b16 v[216:217],v233 offset:35008
ds_read_b64_tr_b16 v[218:219],v233 offset:43712
v_mfma_f32_16x16x32_bf16 a[60:63],v[220:223],v[152:155],a[60:63]
v_exp_f32 v163,v163
v_mfma_f32_16x16x32_bf16 a[56:59],v[220:223],v[144:147],a[56:59]
buffer_load_dwordx4 v237,s[12:15],s45 offen offset:1024 sc0 sc1 nt lds
v_mfma_f32_16x16x32_bf16 a[52:55],v[220:223],v[136:139],a[52:55]
s_waitcnt lgkmcnt(4)
v_add_f32 v228,v228,v163
v_mfma_f32_16x16x32_bf16 a[48:51],v[220:223],v[128:131],a[48:51]
ds_read_b64_tr_b16 v[220:221],v234 offset:35040
ds_read_b64_tr_b16 v[222:223],v234 offset:43744
v_mfma_f32_16x16x32_bf16 a[64:67],v[208:211],v[128:131],a[64:67]
v_exp_f32 v164,v164
v_mfma_f32_16x16x32_bf16 a[68:71],v[208:211],v[136:139],a[68:71]
v_cvt_pk_bf16_f32 v161,v162,v163
v_add_f32 v228,v228,v164
v_mfma_f32_16x16x32_bf16 a[72:75],v[208:211],v[144:147],a[72:75]
s_waitcnt lgkmcnt(4)
s_add_u32 m0,s44,128
v_mfma_f32_16x16x32_bf16 a[76:79],v[208:211],v[152:155],a[76:79]
ds_read_b64_tr_b16 v[208:209],v233 offset:35072
ds_read_b64_tr_b16 v[210:211],v233 offset:43776
v_mfma_f32_16x16x32_bf16 a[92:95],v[212:215],v[152:155],a[92:95]
v_exp_f32 v165,v165
v_mfma_f32_16x16x32_bf16 a[88:91],v[212:215],v[144:147],a[88:91]
buffer_load_dwordx4 v237,s[12:15],s45 offen offset:2048 sc0 sc1 nt lds
v_mfma_f32_16x16x32_bf16 a[84:87],v[212:215],v[136:139],a[84:87]
s_waitcnt lgkmcnt(4)
v_add_f32 v228,v228,v165
v_mfma_f32_16x16x32_bf16 a[80:83],v[212:215],v[128:131],a[80:83]
ds_read_b64_tr_b16 v[212:213],v234 offset:35104
ds_read_b64_tr_b16 v[214:215],v234 offset:43808
v_mfma_f32_16x16x32_bf16 a[96:99],v[216:219],v[128:131],a[96:99]
v_exp_f32 v166,v166
v_mfma_f32_16x16x32_bf16 a[100:103],v[216:219],v[136:139],a[100:103]
v_cvt_pk_bf16_f32 v162,v164,v165
v_add_f32 v228,v228,v166
v_mfma_f32_16x16x32_bf16 a[104:107],v[216:219],v[144:147],a[104:107]
s_waitcnt lgkmcnt(4)
s_add_u32 m0,s44,192
v_mfma_f32_16x16x32_bf16 a[108:111],v[216:219],v[152:155],a[108:111]
ds_read_b64_tr_b16 v[216:217],v233 offset:35136
ds_read_b64_tr_b16 v[218:219],v233 offset:43840
v_mfma_f32_16x16x32_bf16 a[124:127],v[220:223],v[152:155],a[124:127]
v_exp_f32 v167,v167
v_mfma_f32_16x16x32_bf16 a[120:123],v[220:223],v[144:147],a[120:123]
buffer_load_dwordx4 v237,s[12:15],s45 offen offset:3072 sc0 sc1 nt lds
v_mfma_f32_16x16x32_bf16 a[116:119],v[220:223],v[136:139],a[116:119]
s_waitcnt lgkmcnt(4)
v_add_f32 v228,v228,v167
v_mfma_f32_16x16x32_bf16 a[112:115],v[220:223],v[128:131],a[112:115]
ds_read_b64_tr_b16 v[220:221],v234 offset:35168
ds_read_b64_tr_b16 v[222:223],v234 offset:43872
v_mfma_f32_16x16x32_bf16 a[128:131],v[208:211],v[128:131],a[128:131]
v_exp_f32 v168,v168
v_mfma_f32_16x16x32_bf16 a[132:135],v[208:211],v[136:139],a[132:135]
v_cvt_pk_bf16_f32 v163,v166,v167
v_mfma_f32_16x16x32_bf16 a[136:139],v[208:211],v[144:147],a[136:139]
s_waitcnt lgkmcnt(4)
v_mfma_f32_16x16x32_bf16 a[140:143],v[208:211],v[152:155],a[140:143]
ds_read_b64_tr_b16 v[208:209],v233 offset:35200
ds_read_b64_tr_b16 v[210:211],v233 offset:43904
v_mfma_f32_16x16x32_bf16 a[156:159],v[212:215],v[152:155],a[156:159]
v_exp_f32 v169,v169
v_mfma_f32_16x16x32_bf16 a[152:155],v[212:215],v[144:147],a[152:155]
v_add_f32 v229,v168,v169
v_cvt_pk_bf16_f32 v168,v168,v169
v_mfma_f32_16x16x32_bf16 a[148:151],v[212:215],v[136:139],a[148:151]
s_waitcnt lgkmcnt(4)
v_mfma_f32_16x16x32_bf16 a[144:147],v[212:215],v[128:131],a[144:147]
ds_read_b64_tr_b16 v[212:213],v234 offset:35232
ds_read_b64_tr_b16 v[214:215],v234 offset:43936
v_mfma_f32_16x16x32_bf16 a[160:163],v[216:219],v[128:131],a[160:163]
v_exp_f32 v170,v170
v_mfma_f32_16x16x32_bf16 a[164:167],v[216:219],v[136:139],a[164:167]
v_add_f32 v229,v229,v170
v_mfma_f32_16x16x32_bf16 a[168:171],v[216:219],v[144:147],a[168:171]
s_waitcnt lgkmcnt(4)
v_mfma_f32_16x16x32_bf16 a[172:175],v[216:219],v[152:155],a[172:175]
ds_read_b64_tr_b16 v[216:217],v233 offset:35264
ds_read_b64_tr_b16 v[218:219],v233 offset:43968
v_mfma_f32_16x16x32_bf16 a[188:191],v[220:223],v[152:155],a[188:191]
v_exp_f32 v171,v171
v_mfma_f32_16x16x32_bf16 a[184:187],v[220:223],v[144:147],a[184:187]
v_add_f32 v229,v229,v171
v_cvt_pk_bf16_f32 v169,v170,v171
v_mfma_f32_16x16x32_bf16 a[180:183],v[220:223],v[136:139],a[180:183]
s_waitcnt lgkmcnt(4)
v_mfma_f32_16x16x32_bf16 a[176:179],v[220:223],v[128:131],a[176:179]
ds_read_b64_tr_b16 v[220:221],v234 offset:35296
ds_read_b64_tr_b16 v[222:223],v234 offset:44000
v_mfma_f32_16x16x32_bf16 a[192:195],v[208:211],v[128:131],a[192:195]
v_exp_f32 v172,v172
v_mfma_f32_16x16x32_bf16 a[196:199],v[208:211],v[136:139],a[196:199]
v_add_f32 v229,v229,v172
v_mfma_f32_16x16x32_bf16 a[200:203],v[208:211],v[144:147],a[200:203]
s_waitcnt vmcnt(8) lgkmcnt(4)
s_barrier
v_mfma_f32_16x16x32_bf16 a[204:207],v[208:211],v[152:155],a[204:207]
ds_read_b128 v[208:211],v232 offset:0
v_mfma_f32_16x16x32_bf16 a[220:223],v[212:215],v[152:155],a[220:223]
v_exp_f32 v173,v173
v_mfma_f32_16x16x32_bf16 a[216:219],v[212:215],v[144:147],a[216:219]
v_add_f32 v229,v229,v173
v_cvt_pk_bf16_f32 v170,v172,v173
v_mfma_f32_16x16x32_bf16 a[212:215],v[212:215],v[136:139],a[212:215]
s_waitcnt lgkmcnt(3)
v_mfma_f32_16x16x32_bf16 a[208:211],v[212:215],v[128:131],a[208:211]
ds_read_b128 v[212:215],v232 offset:64
v_mfma_f32_16x16x32_bf16 a[224:227],v[216:219],v[128:131],a[224:227]
v_exp_f32 v174,v174
v_mfma_f32_16x16x32_bf16 a[228:231],v[216:219],v[136:139],a[228:231]
v_add_f32 v229,v229,v174
v_mfma_f32_16x16x32_bf16 a[232:235],v[216:219],v[144:147],a[232:235]
s_waitcnt lgkmcnt(2)
v_mfma_f32_16x16x32_bf16 a[236:239],v[216:219],v[152:155],a[236:239]
ds_read_b128 v[216:219],v232 offset:128
v_mfma_f32_16x16x32_bf16 a[252:255],v[220:223],v[152:155],a[252:255]
v_exp_f32 v175,v175
v_mfma_f32_16x16x32_bf16 a[248:251],v[220:223],v[144:147],a[248:251]
v_add_f32 v229,v229,v175
v_cvt_pk_bf16_f32 v171,v174,v175
v_mfma_f32_16x16x32_bf16 a[244:247],v[220:223],v[136:139],a[244:247]
v_mfma_f32_16x16x32_bf16 a[240:243],v[220:223],v[128:131],a[240:243]
s_waitcnt lgkmcnt(1)
ds_read_b128 v[220:223],v232 offset:192
v_mfma_f32_16x16x32_bf16 v[128:131],v[208:211],v[0:3],v[192:195]
v_exp_f32 v176,v176
v_mfma_f32_16x16x32_bf16 v[128:131],v[212:215],v[16:19],v[128:131]
s_bitcmp1_b32 s46,3
s_cselect_b64 s[42:43],s[84:85],s[38:39]
v_mfma_f32_16x16x32_bf16 v[136:139],v[208:211],v[4:7],v[196:199]
v_exp_f32 v177,v177
v_mfma_f32_16x16x32_bf16 v[136:139],v[212:215],v[20:23],v[136:139]
v_add_f32 v230,v176,v177
v_cvt_pk_bf16_f32 v176,v176,v177
v_mfma_f32_16x16x32_bf16 v[144:147],v[208:211],v[8:11],v[200:203]
v_exp_f32 v178,v178
v_mfma_f32_16x16x32_bf16 v[144:147],v[212:215],v[24:27],v[144:147]
v_add_f32 v230,v230,v178
s_cselect_b64 s[34:35],0,s[86:87]
v_mfma_f32_16x16x32_bf16 v[152:155],v[208:211],v[12:15],v[204:207]
ds_read_b128 v[208:211],v232 offset:256
s_add_u32 s39,s39,s35
v_mfma_f32_16x16x32_bf16 v[152:155],v[212:215],v[28:31],v[152:155]
s_waitcnt lgkmcnt(1)
ds_read_b128 v[212:215],v232 offset:320
v_mfma_f32_16x16x32_bf16 v[128:131],v[216:219],v[32:35],v[128:131]
v_exp_f32 v179,v179
v_mfma_f32_16x16x32_bf16 v[128:131],v[220:223],v[48:51],v[128:131]
v_add_f32 v230,v230,v179
v_cvt_pk_bf16_f32 v177,v178,v179
v_mfma_f32_16x16x32_bf16 v[136:139],v[216:219],v[36:39],v[136:139]
v_exp_f32 v180,v180
v_mfma_f32_16x16x32_bf16 v[136:139],v[220:223],v[52:55],v[136:139]
v_add_f32 v230,v230,v180
s_add_u32 s38,s38,s34
v_mfma_f32_16x16x32_bf16 v[144:147],v[216:219],v[40:43],v[144:147]
v_exp_f32 v181,v181
v_mfma_f32_16x16x32_bf16 v[144:147],v[220:223],v[56:59],v[144:147]
v_add_f32 v230,v230,v181
v_cvt_pk_bf16_f32 v178,v180,v181
v_mfma_f32_16x16x32_bf16 v[152:155],v[216:219],v[44:47],v[152:155]
ds_read_b128 v[216:219],v232 offset:384
s_cmp_eq_u32 s38,s49
v_mfma_f32_16x16x32_bf16 v[152:155],v[220:223],v[60:63],v[152:155]
s_waitcnt lgkmcnt(1)
ds_read_b128 v[220:223],v232 offset:448
v_mfma_f32_16x16x32_bf16 v[128:131],v[208:211],v[64:67],v[128:131]
v_exp_f32 v182,v182
v_mfma_f32_16x16x32_bf16 v[128:131],v[212:215],v[80:83],v[128:131]
v_add_f32 v230,v230,v182
s_cmov_b32 s38,s48
v_mfma_f32_16x16x32_bf16 v[136:139],v[208:211],v[68:71],v[136:139]
s_bitcmp1_b32 s47,3
s_cselect_b64 s[44:45],s[84:85],s[40:41]
v_mfma_f32_16x16x32_bf16 v[136:139],v[212:215],v[84:87],v[136:139]
v_exp_f32 v183,v183
v_mfma_f32_16x16x32_bf16 v[144:147],v[208:211],v[72:75],v[144:147]
s_mov_b32 m0,s42
v_add_f32 v230,v230,v183
v_mfma_f32_16x16x32_bf16 v[144:147],v[212:215],v[88:91],v[144:147]
buffer_load_dwordx4 v236,s[8:11],s43 offen offset:0 sc0 sc1 nt lds
v_mfma_f32_16x16x32_bf16 v[152:155],v[208:211],v[76:79],v[152:155]
ds_read_b128 v[208:211],v232 offset:8704
v_max3_f32 v243,v228,v229,v230
v_mfma_f32_16x16x32_bf16 v[152:155],v[212:215],v[92:95],v[152:155]
s_waitcnt lgkmcnt(1)
ds_read_b128 v[212:215],v232 offset:8768
v_mfma_f32_16x16x32_bf16 v[128:131],v[216:219],v[96:99],v[128:131]
v_exp_f32 v184,v184
v_mfma_f32_16x16x32_bf16 v[128:131],v[220:223],v[112:115],v[128:131]
v_cvt_pk_bf16_f32 v179,v182,v183
s_cselect_b64 s[34:35],0,s[86:87]
v_mfma_f32_16x16x32_bf16 v[136:139],v[216:219],v[100:103],v[136:139]
s_add_u32 s41,s41,s35
s_add_u32 s40,s40,s34
v_mfma_f32_16x16x32_bf16 v[136:139],v[220:223],v[116:119],v[136:139]
v_exp_f32 v185,v185
v_mfma_f32_16x16x32_bf16 v[144:147],v[216:219],v[104:107],v[144:147]
s_add_u32 m0,s42,64
v_add_f32 v231,v184,v185
v_mfma_f32_16x16x32_bf16 v[144:147],v[220:223],v[120:123],v[144:147]
buffer_load_dwordx4 v236,s[8:11],s43 offen offset:1024 sc0 sc1 nt lds
v_mfma_f32_16x16x32_bf16 v[152:155],v[216:219],v[108:111],v[152:155]
ds_read_b128 v[216:219],v232 offset:8832
v_cvt_pk_bf16_f32 v184,v184,v185
v_mfma_f32_16x16x32_bf16 v[152:155],v[220:223],v[124:127],v[152:155]
s_waitcnt lgkmcnt(1)
ds_read_b128 v[220:223],v232 offset:8896
v_mfma_f32_16x16x32_bf16 v[132:135],v[208:211],v[0:3],v[192:195]
v_exp_f32 v186,v186
v_mfma_f32_16x16x32_bf16 v[132:135],v[212:215],v[16:19],v[132:135]
v_add_f32 v231,v231,v186
s_cmp_eq_u32 s40,s48
v_mfma_f32_16x16x32_bf16 v[140:143],v[208:211],v[4:7],v[196:199]
s_cmov_b32 s40,s32
s_lshr_b64 s[46:47],s[46:47],4
v_mfma_f32_16x16x32_bf16 v[140:143],v[212:215],v[20:23],v[140:143]
v_exp_f32 v187,v187
v_mfma_f32_16x16x32_bf16 v[148:151],v[208:211],v[8:11],v[200:203]
s_add_u32 m0,s42,128
v_add_f32 v231,v231,v187
v_mfma_f32_16x16x32_bf16 v[148:151],v[212:215],v[24:27],v[148:151]
buffer_load_dwordx4 v236,s[8:11],s43 offen offset:2048 sc0 sc1 nt lds
v_mfma_f32_16x16x32_bf16 v[156:159],v[208:211],v[12:15],v[204:207]
ds_read_b128 v[208:211],v232 offset:8960
v_cvt_pk_bf16_f32 v185,v186,v187
v_mfma_f32_16x16x32_bf16 v[156:159],v[212:215],v[28:31],v[156:159]
s_waitcnt lgkmcnt(1)
ds_read_b128 v[212:215],v232 offset:9024
v_mfma_f32_16x16x32_bf16 v[132:135],v[216:219],v[32:35],v[132:135]
v_exp_f32 v188,v188
v_mfma_f32_16x16x32_bf16 v[132:135],v[220:223],v[48:51],v[132:135]
v_add_f32 v231,v231,v188
v_mfma_f32_16x16x32_bf16 v[140:143],v[216:219],v[36:39],v[140:143]
v_mfma_f32_16x16x32_bf16 v[140:143],v[220:223],v[52:55],v[140:143]
v_exp_f32 v189,v189
v_mfma_f32_16x16x32_bf16 v[148:151],v[216:219],v[40:43],v[148:151]
s_add_u32 m0,s42,192
v_add_f32 v231,v231,v189
v_mfma_f32_16x16x32_bf16 v[148:151],v[220:223],v[56:59],v[148:151]
buffer_load_dwordx4 v236,s[8:11],s43 offen offset:3072 sc0 sc1 nt lds
v_mfma_f32_16x16x32_bf16 v[156:159],v[216:219],v[44:47],v[156:159]
ds_read_b128 v[216:219],v232 offset:9088
v_cvt_pk_bf16_f32 v186,v188,v189
v_mfma_f32_16x16x32_bf16 v[156:159],v[220:223],v[60:63],v[156:159]
s_waitcnt lgkmcnt(1)
ds_read_b128 v[220:223],v232 offset:9152
v_mfma_f32_16x16x32_bf16 v[132:135],v[208:211],v[64:67],v[132:135]
v_exp_f32 v190,v190
v_mfma_f32_16x16x32_bf16 v[132:135],v[212:215],v[80:83],v[132:135]
v_add_f32 v231,v231,v190
s_add_u32 s62,s62,s86
v_mfma_f32_16x16x32_bf16 v[140:143],v[208:211],v[68:71],v[140:143]
v_mfma_f32_16x16x32_bf16 v[140:143],v[212:215],v[84:87],v[140:143]
v_exp_f32 v191,v191
v_mfma_f32_16x16x32_bf16 v[148:151],v[208:211],v[72:75],v[148:151]
v_add_f32 v231,v231,v191
v_cvt_pk_bf16_f32 v187,v190,v191
v_mfma_f32_16x16x32_bf16 v[148:151],v[212:215],v[88:91],v[148:151]
v_max_f32 v243,v243,v231
v_cmp_lt_f32 vcc,s54,v243
v_mfma_f32_16x16x32_bf16 v[156:159],v[208:211],v[76:79],v[156:159]
ds_read_b64_tr_b16 v[208:209],v233 offset:52224
ds_read_b64_tr_b16 v[210:211],v233 offset:60928
v_mfma_f32_16x16x32_bf16 v[156:159],v[212:215],v[92:95],v[156:159]
s_waitcnt lgkmcnt(2)
ds_read_b64_tr_b16 v[212:213],v234 offset:52256
v_mfma_f32_16x16x32_bf16 v[132:135],v[216:219],v[96:99],v[132:135]
ds_read_b64_tr_b16 v[214:215],v234 offset:60960
s_cbranch_vccnz RS_3
RS_3_RET:
v_mfma_f32_16x16x32_bf16 v[132:135],v[220:223],v[112:115],v[132:135]
v_add_f32 v224,v224,v228
v_add_f32 v225,v225,v229
v_mfma_f32_16x16x32_bf16 v[140:143],v[216:219],v[100:103],v[140:143]
v_add_f32 v226,v226,v230
v_add_f32 v227,v227,v231
v_mfma_f32_16x16x32_bf16 v[140:143],v[220:223],v[116:119],v[140:143]
s_cmp_eq_u32 s62,87040
s_cselect_b32 s88,-69632,s86
v_mfma_f32_16x16x32_bf16 v[148:151],v[216:219],v[104:107],v[148:151]
s_cmov_b32 s62,0
v_add_u32 v232,s88,v232
v_mfma_f32_16x16x32_bf16 v[148:151],v[220:223],v[120:123],v[148:151]
s_add_u32 s52,s52,16384
v_mfma_f32_16x16x32_bf16 v[156:159],v[216:219],v[108:111],v[156:159]
ds_read_b64_tr_b16 v[216:217],v233 offset:52288
ds_read_b64_tr_b16 v[218:219],v233 offset:60992
v_mfma_f32_16x16x32_bf16 v[156:159],v[220:223],v[124:127],v[156:159]
s_waitcnt lgkmcnt(4)
ds_read_b64_tr_b16 v[220:221],v234 offset:52320
ds_read_b64_tr_b16 v[222:223],v234 offset:61024
v_mfma_f32_16x16x32_bf16 a[0:3],v[208:211],v[160:163],a[0:3]
v_exp_f32 v128,v128
v_mfma_f32_16x16x32_bf16 a[4:7],v[208:211],v[168:171],a[4:7]
v_mfma_f32_16x16x32_bf16 a[8:11],v[208:211],v[176:179],a[8:11]
s_waitcnt lgkmcnt(4)
s_mov_b32 m0,s44
v_mfma_f32_16x16x32_bf16 a[12:15],v[208:211],v[184:187],a[12:15]
ds_read_b64_tr_b16 v[208:209],v233 offset:52352
ds_read_b64_tr_b16 v[210:211],v233 offset:61056
v_mfma_f32_16x16x32_bf16 a[28:31],v[212:215],v[184:187],a[28:31]
v_exp_f32 v129,v129
v_mfma_f32_16x16x32_bf16 a[24:27],v[212:215],v[176:179],a[24:27]
buffer_load_dwordx4 v237,s[12:15],s45 offen offset:0 sc0 sc1 nt lds
v_mfma_f32_16x16x32_bf16 a[20:23],v[212:215],v[168:171],a[20:23]
s_waitcnt lgkmcnt(4)
v_add_f32 v228,v128,v129
v_mfma_f32_16x16x32_bf16 a[16:19],v[212:215],v[160:163],a[16:19]
ds_read_b64_tr_b16 v[212:213],v234 offset:52384
ds_read_b64_tr_b16 v[214:215],v234 offset:61088
v_mfma_f32_16x16x32_bf16 a[32:35],v[216:219],v[160:163],a[32:35]
v_exp_f32 v130,v130
v_mfma_f32_16x16x32_bf16 a[36:39],v[216:219],v[168:171],a[36:39]
v_cvt_pk_bf16_f32 v128,v128,v129
v_add_f32 v228,v228,v130
v_mfma_f32_16x16x32_bf16 a[40:43],v[216:219],v[176:179],a[40:43]
s_waitcnt lgkmcnt(4)
s_add_u32 m0,s44,64
v_mfma_f32_16x16x32_bf16 a[44:47],v[216:219],v[184:187],a[44:47]
ds_read_b64_tr_b16 v[216:217],v233 offset:52416
ds_read_b64_tr_b16 v[218:219],v233 offset:61120
v_mfma_f32_16x16x32_bf16 a[60:63],v[220:223],v[184:187],a[60:63]
v_exp_f32 v131,v131
v_mfma_f32_16x16x32_bf16 a[56:59],v[220:223],v[176:179],a[56:59]
buffer_load_dwordx4 v237,s[12:15],s45 offen offset:1024 sc0 sc1 nt lds
v_mfma_f32_16x16x32_bf16 a[52:55],v[220:223],v[168:171],a[52:55]
s_waitcnt lgkmcnt(4)
v_add_f32 v228,v228,v131
v_mfma_f32_16x16x32_bf16 a[48:51],v[220:223],v[160:163],a[48:51]
ds_read_b64_tr_b16 v[220:221],v234 offset:52448
ds_read_b64_tr_b16 v[222:223],v234 offset:61152
v_mfma_f32_16x16x32_bf16 a[64:67],v[208:211],v[160:163],a[64:67]
v_exp_f32 v132,v132
v_mfma_f32_16x16x32_bf16 a[68:71],v[208:211],v[168:171],a[68:71]
v_cvt_pk_bf16_f32 v129,v130,v131
v_add_f32 v228,v228,v132
v_mfma_f32_16x16x32_bf16 a[72:75],v[208:211],v[176:179],a[72:75]
s_waitcnt lgkmcnt(4)
s_add_u32 m0,s44,128
v_mfma_f32_16x16x32_bf16 a[76:79],v[208:211],v[184:187],a[76:79]
ds_read_b64_tr_b16 v[208:209],v233 offset:52480
ds_read_b64_tr_b16 v[210:211],v233 offset:61184
v_mfma_f32_16x16x32_bf16 a[92:95],v[212:215],v[184:187],a[92:95]
v_exp_f32 v133,v133
v_mfma_f32_16x16x32_bf16 a[88:91],v[212:215],v[176:179],a[88:91]
buffer_load_dwordx4 v237,s[12:15],s45 offen offset:2048 sc0 sc1 nt lds
v_mfma_f32_16x16x32_bf16 a[84:87],v[212:215],v[168:171],a[84:87]
s_waitcnt lgkmcnt(4)
v_add_f32 v228,v228,v133
v_mfma_f32_16x16x32_bf16 a[80:83],v[212:215],v[160:163],a[80:83]
ds_read_b64_tr_b16 v[212:213],v234 offset:52512
ds_read_b64_tr_b16 v[214:215],v234 offset:61216
v_mfma_f32_16x16x32_bf16 a[96:99],v[216:219],v[160:163],a[96:99]
v_exp_f32 v134,v134
v_mfma_f32_16x16x32_bf16 a[100:103],v[216:219],v[168:171],a[100:103]
v_cvt_pk_bf16_f32 v130,v132,v133
v_add_f32 v228,v228,v134
v_mfma_f32_16x16x32_bf16 a[104:107],v[216:219],v[176:179],a[104:107]
s_waitcnt lgkmcnt(4)
s_add_u32 m0,s44,192
v_mfma_f32_16x16x32_bf16 a[108:111],v[216:219],v[184:187],a[108:111]
ds_read_b64_tr_b16 v[216:217],v233 offset:52544
ds_read_b64_tr_b16 v[218:219],v233 offset:61248
v_mfma_f32_16x16x32_bf16 a[124:127],v[220:223],v[184:187],a[124:127]
v_exp_f32 v135,v135
v_mfma_f32_16x16x32_bf16 a[120:123],v[220:223],v[176:179],a[120:123]
buffer_load_dwordx4 v237,s[12:15],s45 offen offset:3072 sc0 sc1 nt lds
v_mfma_f32_16x16x32_bf16 a[116:119],v[220:223],v[168:171],a[116:119]
s_waitcnt lgkmcnt(4)
v_add_f32 v228,v228,v135
v_mfma_f32_16x16x32_bf16 a[112:115],v[220:223],v[160:163],a[112:115]
ds_read_b64_tr_b16 v[220:221],v234 offset:52576
ds_read_b64_tr_b16 v[222:223],v234 offset:61280
v_mfma_f32_16x16x32_bf16 a[128:131],v[208:211],v[160:163],a[128:131]
v_exp_f32 v136,v136
v_mfma_f32_16x16x32_bf16 a[132:135],v[208:211],v[168:171],a[132:135]
v_cvt_pk_bf16_f32 v131,v134,v135
v_mfma_f32_16x16x32_bf16 a[136:139],v[208:211],v[176:179],a[136:139]
s_waitcnt lgkmcnt(4)
v_mfma_f32_16x16x32_bf16 a[140:143],v[208:211],v[184:187],a[140:143]
ds_read_b64_tr_b16 v[208:209],v233 offset:52608
ds_read_b64_tr_b16 v[210:211],v233 offset:61312
v_mfma_f32_16x16x32_bf16 a[156:159],v[212:215],v[184:187],a[156:159]
v_exp_f32 v137,v137
v_mfma_f32_16x16x32_bf16 a[152:155],v[212:215],v[176:179],a[152:155]
v_add_f32 v229,v136,v137
v_cvt_pk_bf16_f32 v136,v136,v137
v_mfma_f32_16x16x32_bf16 a[148:151],v[212:215],v[168:171],a[148:151]
s_waitcnt lgkmcnt(4)
v_mfma_f32_16x16x32_bf16 a[144:147],v[212:215],v[160:163],a[144:147]
ds_read_b64_tr_b16 v[212:213],v234 offset:52640
ds_read_b64_tr_b16 v[214:215],v234 offset:61344
v_mfma_f32_16x16x32_bf16 a[160:163],v[216:219],v[160:163],a[160:163]
v_exp_f32 v138,v138
v_mfma_f32_16x16x32_bf16 a[164:167],v[216:219],v[168:171],a[164:167]
v_add_f32 v229,v229,v138
v_mfma_f32_16x16x32_bf16 a[168:171],v[216:219],v[176:179],a[168:171]
s_waitcnt lgkmcnt(4)
v_mfma_f32_16x16x32_bf16 a[172:175],v[216:219],v[184:187],a[172:175]
ds_read_b64_tr_b16 v[216:217],v233 offset:52672
ds_read_b64_tr_b16 v[218:219],v233 offset:61376
v_mfma_f32_16x16x32_bf16 a[188:191],v[220:223],v[184:187],a[188:191]
v_exp_f32 v139,v139
v_mfma_f32_16x16x32_bf16 a[184:187],v[220:223],v[176:179],a[184:187]
v_add_f32 v229,v229,v139
v_cvt_pk_bf16_f32 v137,v138,v139
v_mfma_f32_16x16x32_bf16 a[180:183],v[220:223],v[168:171],a[180:183]
s_waitcnt lgkmcnt(4)
s_add_u32 s53,s53,1
v_mfma_f32_16x16x32_bf16 a[176:179],v[220:223],v[160:163],a[176:179]
ds_read_b64_tr_b16 v[220:221],v234 offset:52704
ds_read_b64_tr_b16 v[222:223],v234 offset:61408
v_mfma_f32_16x16x32_bf16 a[192:195],v[208:211],v[160:163],a[192:195]
v_exp_f32 v140,v140
v_mfma_f32_16x16x32_bf16 a[196:199],v[208:211],v[168:171],a[196:199]
v_add_f32 v229,v229,v140
v_mfma_f32_16x16x32_bf16 a[200:203],v[208:211],v[176:179],a[200:203]
s_waitcnt vmcnt(8) lgkmcnt(4)
s_barrier
v_mfma_f32_16x16x32_bf16 a[204:207],v[208:211],v[184:187],a[204:207]
ds_read_b128 v[208:211],v232 offset:0
v_mfma_f32_16x16x32_bf16 a[220:223],v[212:215],v[184:187],a[220:223]
v_exp_f32 v141,v141
v_mfma_f32_16x16x32_bf16 a[216:219],v[212:215],v[176:179],a[216:219]
v_add_f32 v229,v229,v141
v_cvt_pk_bf16_f32 v138,v140,v141
v_mfma_f32_16x16x32_bf16 a[212:215],v[212:215],v[168:171],a[212:215]
s_waitcnt lgkmcnt(3)
s_cmp_lt_u32 s53,7
v_mfma_f32_16x16x32_bf16 a[208:211],v[212:215],v[160:163],a[208:211]
ds_read_b128 v[212:215],v232 offset:64
v_mfma_f32_16x16x32_bf16 a[224:227],v[216:219],v[160:163],a[224:227]
v_exp_f32 v142,v142
v_mfma_f32_16x16x32_bf16 a[228:231],v[216:219],v[168:171],a[228:231]
v_add_f32 v229,v229,v142
v_mfma_f32_16x16x32_bf16 a[232:235],v[216:219],v[176:179],a[232:235]
s_waitcnt lgkmcnt(2)
v_mfma_f32_16x16x32_bf16 a[236:239],v[216:219],v[184:187],a[236:239]
ds_read_b128 v[216:219],v232 offset:128
v_mfma_f32_16x16x32_bf16 a[252:255],v[220:223],v[184:187],a[252:255]
v_exp_f32 v143,v143
v_mfma_f32_16x16x32_bf16 a[248:251],v[220:223],v[176:179],a[248:251]
v_add_f32 v229,v229,v143
v_cvt_pk_bf16_f32 v139,v142,v143
v_mfma_f32_16x16x32_bf16 a[244:247],v[220:223],v[168:171],a[244:247]
v_mfma_f32_16x16x32_bf16 a[240:243],v[220:223],v[160:163],a[240:243]
s_waitcnt lgkmcnt(1)
ds_read_b128 v[220:223],v232 offset:192
s_cbranch_scc1 L_LOOP
L_TAILC:
v_mfma_f32_16x16x32_bf16 v[160:163],v[208:211],v[0:3],v[192:195]
v_exp_f32 v144,v144
v_mfma_f32_16x16x32_bf16 v[160:163],v[212:215],v[16:19],v[160:163]
v_mov_b32 v244,0x3f80
v_mbcnt_lo_u32_b32 v255,-1,0
v_mfma_f32_16x16x32_bf16 v[168:171],v[208:211],v[4:7],v[196:199]
v_exp_f32 v145,v145
v_mfma_f32_16x16x32_bf16 v[168:171],v[212:215],v[20:23],v[168:171]
v_add_f32 v230,v144,v145
v_cvt_pk_bf16_f32 v144,v144,v145
v_mfma_f32_16x16x32_bf16 v[176:179],v[208:211],v[8:11],v[200:203]
v_exp_f32 v146,v146
v_mfma_f32_16x16x32_bf16 v[176:179],v[212:215],v[24:27],v[176:179]
v_add_f32 v230,v230,v146
v_mbcnt_hi_u32_b32 v255,-1,v255
v_mfma_f32_16x16x32_bf16 v[184:187],v[208:211],v[12:15],v[204:207]
ds_read_b128 v[208:211],v232 offset:256
s_mov_b32 s62,229376
v_mfma_f32_16x16x32_bf16 v[184:187],v[212:215],v[28:31],v[184:187]
s_waitcnt lgkmcnt(1)
ds_read_b128 v[212:215],v232 offset:320
v_mfma_f32_16x16x32_bf16 v[160:163],v[216:219],v[32:35],v[160:163]
v_exp_f32 v147,v147
v_mfma_f32_16x16x32_bf16 v[160:163],v[220:223],v[48:51],v[160:163]
v_add_f32 v230,v230,v147
v_cvt_pk_bf16_f32 v145,v146,v147
v_mfma_f32_16x16x32_bf16 v[168:171],v[216:219],v[36:39],v[168:171]
v_exp_f32 v148,v148
v_mfma_f32_16x16x32_bf16 v[168:171],v[220:223],v[52:55],v[168:171]
v_add_f32 v230,v230,v148
v_and_b32 v246,15,v255
v_mfma_f32_16x16x32_bf16 v[176:179],v[216:219],v[40:43],v[176:179]
v_exp_f32 v149,v149
v_mfma_f32_16x16x32_bf16 v[176:179],v[220:223],v[56:59],v[176:179]
v_add_f32 v230,v230,v149
v_cvt_pk_bf16_f32 v146,v148,v149
v_mfma_f32_16x16x32_bf16 v[184:187],v[216:219],v[44:47],v[184:187]
ds_read_b128 v[216:219],v232 offset:384
v_lshrrev_b32 v254,4,v255
v_mfma_f32_16x16x32_bf16 v[184:187],v[220:223],v[60:63],v[184:187]
s_waitcnt lgkmcnt(1)
ds_read_b128 v[220:223],v232 offset:448
v_mfma_f32_16x16x32_bf16 v[160:163],v[208:211],v[64:67],v[160:163]
v_exp_f32 v150,v150
v_mfma_f32_16x16x32_bf16 v[160:163],v[212:215],v[80:83],v[160:163]
v_add_f32 v230,v230,v150
v_lshl_add_u32 v252,v255,9,s98
v_mfma_f32_16x16x32_bf16 v[168:171],v[208:211],v[68:71],v[168:171]
v_lshl_add_u32 v248,v246,4,s100
v_writelane_b32 v252,s33,1
v_mfma_f32_16x16x32_bf16 v[168:171],v[212:215],v[84:87],v[168:171]
v_exp_f32 v151,v151
v_mfma_f32_16x16x32_bf16 v[176:179],v[208:211],v[72:75],v[176:179]
s_add_u32 m0,s32,87040
s_mov_b32 s34,507904
v_mfma_f32_16x16x32_bf16 v[176:179],v[212:215],v[88:91],v[176:179]
buffer_load_dwordx4 v236,s[8:11],s34 offen offset:0 sc0 sc1 nt lds
v_mfma_f32_16x16x32_bf16 v[184:187],v[208:211],v[76:79],v[184:187]
ds_read_b128 v[208:211],v232 offset:8704
v_add_f32 v230,v230,v151
v_mfma_f32_16x16x32_bf16 v[184:187],v[212:215],v[92:95],v[184:187]
s_waitcnt lgkmcnt(1)
ds_read_b128 v[212:215],v232 offset:8768
v_mfma_f32_16x16x32_bf16 v[160:163],v[216:219],v[96:99],v[160:163]
v_exp_f32 v152,v152
v_mfma_f32_16x16x32_bf16 v[160:163],v[220:223],v[112:115],v[160:163]
v_max3_f32 v243,v228,v229,v230
v_cvt_pk_bf16_f32 v147,v150,v151
v_mfma_f32_16x16x32_bf16 v[168:171],v[216:219],v[100:103],v[168:171]
v_mad_u32_u24 v248,v254,s62,v248
v_add_u32 v249,917504,v248
v_mfma_f32_16x16x32_bf16 v[168:171],v[220:223],v[116:119],v[168:171]
v_exp_f32 v153,v153
v_mfma_f32_16x16x32_bf16 v[176:179],v[216:219],v[104:107],v[176:179]
s_add_u32 m0,s32,87104
v_add_f32 v231,v152,v153
v_mfma_f32_16x16x32_bf16 v[176:179],v[220:223],v[120:123],v[176:179]
buffer_load_dwordx4 v236,s[8:11],s34 offen offset:1024 sc0 sc1 nt lds
v_mfma_f32_16x16x32_bf16 v[184:187],v[216:219],v[108:111],v[184:187]
ds_read_b128 v[216:219],v232 offset:8832
v_cvt_pk_bf16_f32 v152,v152,v153
v_mfma_f32_16x16x32_bf16 v[184:187],v[220:223],v[124:127],v[184:187]
s_waitcnt lgkmcnt(1)
ds_read_b128 v[220:223],v232 offset:8896
v_mfma_f32_16x16x32_bf16 v[164:167],v[208:211],v[0:3],v[192:195]
v_exp_f32 v154,v154
v_mfma_f32_16x16x32_bf16 v[164:167],v[212:215],v[16:19],v[164:167]
v_add_f32 v231,v231,v154
v_add_u32 v250,1835008,v248
v_mfma_f32_16x16x32_bf16 v[172:175],v[208:211],v[4:7],v[196:199]
v_add_u32 v251,2752512,v248
v_and_b32 v255,1,v254
v_mfma_f32_16x16x32_bf16 v[172:175],v[212:215],v[20:23],v[172:175]
v_exp_f32 v155,v155
v_mfma_f32_16x16x32_bf16 v[180:183],v[208:211],v[8:11],v[200:203]
s_add_u32 m0,s32,87168
v_add_f32 v231,v231,v155
v_mfma_f32_16x16x32_bf16 v[180:183],v[212:215],v[24:27],v[180:183]
buffer_load_dwordx4 v236,s[8:11],s34 offen offset:2048 sc0 sc1 nt lds
v_mfma_f32_16x16x32_bf16 v[188:191],v[208:211],v[12:15],v[204:207]
ds_read_b128 v[208:211],v232 offset:8960
v_cvt_pk_bf16_f32 v153,v154,v155
v_mfma_f32_16x16x32_bf16 v[188:191],v[212:215],v[28:31],v[188:191]
s_waitcnt lgkmcnt(1)
ds_read_b128 v[212:215],v232 offset:9024
v_mfma_f32_16x16x32_bf16 v[164:167],v[216:219],v[32:35],v[164:167]
v_exp_f32 v156,v156
v_mfma_f32_16x16x32_bf16 v[164:167],v[220:223],v[48:51],v[164:167]
v_add_f32 v231,v231,v156
v_mul_lo_u32 v255,v255,s63
v_mfma_f32_16x16x32_bf16 v[172:175],v[216:219],v[36:39],v[172:175]
v_lshl_add_u32 v253,v246,2,s99
v_add_u32 v253,v255,v253
v_mfma_f32_16x16x32_bf16 v[172:175],v[220:223],v[52:55],v[172:175]
v_exp_f32 v157,v157
v_mfma_f32_16x16x32_bf16 v[180:183],v[216:219],v[40:43],v[180:183]
s_add_u32 m0,s32,87232
v_add_f32 v231,v231,v157
v_mfma_f32_16x16x32_bf16 v[180:183],v[220:223],v[56:59],v[180:183]
buffer_load_dwordx4 v236,s[8:11],s34 offen offset:3072 sc0 sc1 nt lds
v_mfma_f32_16x16x32_bf16 v[188:191],v[216:219],v[44:47],v[188:191]
ds_read_b128 v[216:219],v232 offset:9088
v_cvt_pk_bf16_f32 v154,v156,v157
v_mfma_f32_16x16x32_bf16 v[188:191],v[220:223],v[60:63],v[188:191]
s_waitcnt lgkmcnt(1)
ds_read_b128 v[220:223],v232 offset:9152
v_mfma_f32_16x16x32_bf16 v[164:167],v[208:211],v[64:67],v[164:167]
v_exp_f32 v158,v158
v_mfma_f32_16x16x32_bf16 v[164:167],v[212:215],v[80:83],v[164:167]
v_add_f32 v231,v231,v158
v_subrev_u32 v232,69632,v232
v_mfma_f32_16x16x32_bf16 v[172:175],v[208:211],v[68:71],v[172:175]
v_lshrrev_b32 v255,1,v254
v_lshlrev_b32 v254,5,v254
v_mfma_f32_16x16x32_bf16 v[172:175],v[212:215],v[84:87],v[172:175]
v_exp_f32 v159,v159
v_mfma_f32_16x16x32_bf16 v[180:183],v[208:211],v[72:75],v[180:183]
v_add_f32 v231,v231,v159
v_cvt_pk_bf16_f32 v155,v158,v159
v_mfma_f32_16x16x32_bf16 v[180:183],v[212:215],v[88:91],v[180:183]
v_max_f32 v243,v243,v231
v_cmp_lt_f32 vcc,s54,v243
v_mfma_f32_16x16x32_bf16 v[188:191],v[208:211],v[76:79],v[188:191]
ds_read_b64_tr_b16 v[208:209],v233 offset:0
ds_read_b64_tr_b16 v[210:211],v233 offset:8704
v_mfma_f32_16x16x32_bf16 v[188:191],v[212:215],v[92:95],v[188:191]
s_waitcnt lgkmcnt(2)
ds_read_b64_tr_b16 v[212:213],v234 offset:32
v_mfma_f32_16x16x32_bf16 v[164:167],v[216:219],v[96:99],v[164:167]
ds_read_b64_tr_b16 v[214:215],v234 offset:8736
s_cbranch_vccnz RS_128
RS_128_RET:
v_mfma_f32_16x16x32_bf16 v[164:167],v[220:223],v[112:115],v[164:167]
v_add_f32 v224,v224,v228
v_add_f32 v225,v225,v229
v_mfma_f32_16x16x32_bf16 v[172:175],v[216:219],v[100:103],v[172:175]
v_add_f32 v226,v226,v230
v_add_f32 v227,v227,v231
v_mfma_f32_16x16x32_bf16 v[172:175],v[220:223],v[116:119],v[172:175]
s_add_u32 s52,s52,16384
v_lshl_add_u32 v254,v255,20,v254
v_mfma_f32_16x16x32_bf16 v[180:183],v[216:219],v[104:107],v[180:183]
v_add_u32 v254,s101,v254
v_lshrrev_b32 v255,2,v246
v_mfma_f32_16x16x32_bf16 v[180:183],v[220:223],v[120:123],v[180:183]
v_lshl_add_u32 v254,v255,3,v254
v_and_b32 v255,3,v246
v_mfma_f32_16x16x32_bf16 v[188:191],v[216:219],v[108:111],v[188:191]
ds_read_b64_tr_b16 v[216:217],v233 offset:64
ds_read_b64_tr_b16 v[218:219],v233 offset:8768
v_mfma_f32_16x16x32_bf16 v[188:191],v[220:223],v[124:127],v[188:191]
s_waitcnt lgkmcnt(4)
ds_read_b64_tr_b16 v[220:221],v234 offset:96
ds_read_b64_tr_b16 v[222:223],v234 offset:8800
v_mfma_f32_16x16x32_bf16 a[0:3],v[208:211],v[128:131],a[0:3]
v_exp_f32 v160,v160
v_mfma_f32_16x16x32_bf16 a[4:7],v[208:211],v[136:139],a[4:7]
s_add_u32 m0,s32,34816
v_mfma_f32_16x16x32_bf16 a[8:11],v[208:211],v[144:147],a[8:11]
s_waitcnt lgkmcnt(4)
s_mov_b32 s34,491520
v_mfma_f32_16x16x32_bf16 a[12:15],v[208:211],v[152:155],a[12:15]
ds_read_b64_tr_b16 v[208:209],v233 offset:128
ds_read_b64_tr_b16 v[210:211],v233 offset:8832
v_mfma_f32_16x16x32_bf16 a[28:31],v[212:215],v[152:155],a[28:31]
v_exp_f32 v161,v161
v_mfma_f32_16x16x32_bf16 a[24:27],v[212:215],v[144:147],a[24:27]
buffer_load_dwordx4 v237,s[12:15],s34 offen offset:0 sc0 sc1 nt lds
v_mfma_f32_16x16x32_bf16 a[20:23],v[212:215],v[136:139],a[20:23]
s_waitcnt lgkmcnt(4)
v_add_f32 v228,v160,v161
v_mfma_f32_16x16x32_bf16 a[16:19],v[212:215],v[128:131],a[16:19]
ds_read_b64_tr_b16 v[212:213],v234 offset:160
ds_read_b64_tr_b16 v[214:215],v234 offset:8864
v_mfma_f32_16x16x32_bf16 a[32:35],v[216:219],v[128:131],a[32:35]
v_exp_f32 v162,v162
v_mfma_f32_16x16x32_bf16 a[36:39],v[216:219],v[136:139],a[36:39]
v_cvt_pk_bf16_f32 v160,v160,v161
v_add_f32 v228,v228,v162
v_mfma_f32_16x16x32_bf16 a[40:43],v[216:219],v[144:147],a[40:43]
s_waitcnt lgkmcnt(4)
s_add_u32 m0,s32,34880
v_mfma_f32_16x16x32_bf16 a[44:47],v[216:219],v[152:155],a[44:47]
ds_read_b64_tr_b16 v[216:217],v233 offset:192
ds_read_b64_tr_b16 v[218:219],v233 offset:8896
v_mfma_f32_16x16x32_bf16 a[60:63],v[220:223],v[152:155],a[60:63]
v_exp_f32 v163,v163
v_mfma_f32_16x16x32_bf16 a[56:59],v[220:223],v[144:147],a[56:59]
buffer_load_dwordx4 v237,s[12:15],s34 offen offset:1024 sc0 sc1 nt lds
v_mfma_f32_16x16x32_bf16 a[52:55],v[220:223],v[136:139],a[52:55]
s_waitcnt lgkmcnt(4)
v_add_f32 v228,v228,v163
v_mfma_f32_16x16x32_bf16 a[48:51],v[220:223],v[128:131],a[48:51]
ds_read_b64_tr_b16 v[220:221],v234 offset:224
ds_read_b64_tr_b16 v[222:223],v234 offset:8928
v_mfma_f32_16x16x32_bf16 a[64:67],v[208:211],v[128:131],a[64:67]
v_exp_f32 v164,v164
v_mfma_f32_16x16x32_bf16 a[68:71],v[208:211],v[136:139],a[68:71]
v_cvt_pk_bf16_f32 v161,v162,v163
v_add_f32 v228,v228,v164
v_mfma_f32_16x16x32_bf16 a[72:75],v[208:211],v[144:147],a[72:75]
s_waitcnt lgkmcnt(4)
s_add_u32 m0,s32,34944
v_mfma_f32_16x16x32_bf16 a[76:79],v[208:211],v[152:155],a[76:79]
ds_read_b64_tr_b16 v[208:209],v233 offset:256
ds_read_b64_tr_b16 v[210:211],v233 offset:8960
v_mfma_f32_16x16x32_bf16 a[92:95],v[212:215],v[152:155],a[92:95]
v_exp_f32 v165,v165
v_mfma_f32_16x16x32_bf16 a[88:91],v[212:215],v[144:147],a[88:91]
buffer_load_dwordx4 v237,s[12:15],s34 offen offset:2048 sc0 sc1 nt lds
v_mfma_f32_16x16x32_bf16 a[84:87],v[212:215],v[136:139],a[84:87]
s_waitcnt lgkmcnt(4)
v_add_f32 v228,v228,v165
v_mfma_f32_16x16x32_bf16 a[80:83],v[212:215],v[128:131],a[80:83]
ds_read_b64_tr_b16 v[212:213],v234 offset:288
ds_read_b64_tr_b16 v[214:215],v234 offset:8992
v_mfma_f32_16x16x32_bf16 a[96:99],v[216:219],v[128:131],a[96:99]
v_exp_f32 v166,v166
v_mfma_f32_16x16x32_bf16 a[100:103],v[216:219],v[136:139],a[100:103]
v_cvt_pk_bf16_f32 v162,v164,v165
v_add_f32 v228,v228,v166
v_mfma_f32_16x16x32_bf16 a[104:107],v[216:219],v[144:147],a[104:107]
s_waitcnt lgkmcnt(4)
s_add_u32 m0,s32,35008
v_mfma_f32_16x16x32_bf16 a[108:111],v[216:219],v[152:155],a[108:111]
ds_read_b64_tr_b16 v[216:217],v233 offset:320
ds_read_b64_tr_b16 v[218:219],v233 offset:9024
v_mfma_f32_16x16x32_bf16 a[124:127],v[220:223],v[152:155],a[124:127]
v_exp_f32 v167,v167
v_mfma_f32_16x16x32_bf16 a[120:123],v[220:223],v[144:147],a[120:123]
buffer_load_dwordx4 v237,s[12:15],s34 offen offset:3072 sc0 sc1 nt lds
v_mfma_f32_16x16x32_bf16 a[116:119],v[220:223],v[136:139],a[116:119]
s_waitcnt lgkmcnt(4)
v_add_f32 v228,v228,v167
v_mfma_f32_16x16x32_bf16 a[112:115],v[220:223],v[128:131],a[112:115]
ds_read_b64_tr_b16 v[220:221],v234 offset:352
ds_read_b64_tr_b16 v[222:223],v234 offset:9056
v_mfma_f32_16x16x32_bf16 a[128:131],v[208:211],v[128:131],a[128:131]
v_exp_f32 v168,v168
v_mfma_f32_16x16x32_bf16 a[132:135],v[208:211],v[136:139],a[132:135]
v_cvt_pk_bf16_f32 v163,v166,v167
v_mfma_f32_16x16x32_bf16 a[136:139],v[208:211],v[144:147],a[136:139]
s_waitcnt lgkmcnt(4)
v_mbcnt_lo_u32_b32 v243,-1,0
v_and_b32 v243,3,v243
v_mfma_f32_16x16x32_bf16 a[140:143],v[208:211],v[152:155],a[140:143]
ds_read_b64_tr_b16 v[208:209],v233 offset:384
ds_read_b64_tr_b16 v[210:211],v233 offset:9088
v_lshlrev_b32 v243,2,v243
v_mfma_f32_16x16x32_bf16 a[156:159],v[212:215],v[152:155],a[156:159]
v_exp_f32 v169,v169
buffer_load_dword v236,v243,s[20:23],s60 offen sc1
v_mfma_f32_16x16x32_bf16 a[152:155],v[212:215],v[144:147],a[152:155]
v_mbcnt_lo_u32_b32 v231,-1,0
v_min_u32 v231,31,v231
v_mfma_f32_16x16x32_bf16 a[148:151],v[212:215],v[136:139],a[148:151]
s_waitcnt lgkmcnt(4)
v_lshlrev_b32 v231,7,v231
v_mfma_f32_16x16x32_bf16 a[144:147],v[212:215],v[128:131],a[144:147]
ds_read_b64_tr_b16 v[212:213],v234 offset:416
ds_read_b64_tr_b16 v[214:215],v234 offset:9120
v_mfma_f32_16x16x32_bf16 a[160:163],v[216:219],v[128:131],a[160:163]
v_exp_f32 v170,v170
v_mfma_f32_16x16x32_bf16 a[164:167],v[216:219],v[136:139],a[164:167]
s_lshl_b32 s36,s3,12
s_add_u32 s36,s36,s55
v_mfma_f32_16x16x32_bf16 a[168:171],v[216:219],v[144:147],a[168:171]
s_waitcnt lgkmcnt(4)
s_mov_b32 m0,156672
v_mfma_f32_16x16x32_bf16 a[172:175],v[216:219],v[152:155],a[172:175]
ds_read_b64_tr_b16 v[216:217],v233 offset:448
ds_read_b64_tr_b16 v[218:219],v233 offset:9152
v_mfma_f32_16x16x32_bf16 a[188:191],v[220:223],v[152:155],a[188:191]
v_exp_f32 v171,v171
v_mfma_f32_16x16x32_bf16 a[184:187],v[220:223],v[144:147],a[184:187]
buffer_load_dword v231,s[28:31],s36 offen  lds
v_mfma_f32_16x16x32_bf16 a[180:183],v[220:223],v[136:139],a[180:183]
s_waitcnt lgkmcnt(4)
v_add_f32 v229,v168,v169
v_mfma_f32_16x16x32_bf16 a[176:179],v[220:223],v[128:131],a[176:179]
ds_read_b64_tr_b16 v[220:221],v234 offset:480
ds_read_b64_tr_b16 v[222:223],v234 offset:9184
v_mfma_f32_16x16x32_bf16 a[192:195],v[208:211],v[128:131],a[192:195]
v_exp_f32 v172,v172
v_mfma_f32_16x16x32_bf16 a[196:199],v[208:211],v[136:139],a[196:199]
v_cvt_pk_bf16_f32 v168,v168,v169
v_add_f32 v229,v229,v170
v_mfma_f32_16x16x32_bf16 a[200:203],v[208:211],v[144:147],a[200:203]
s_waitcnt vmcnt(10) lgkmcnt(4)
s_barrier
v_mfma_f32_16x16x32_bf16 a[204:207],v[208:211],v[152:155],a[204:207]
ds_read_b128 v[208:211],v232 offset:0
v_add_f32 v229,v229,v171
v_mfma_f32_16x16x32_bf16 a[220:223],v[212:215],v[152:155],a[220:223]
v_exp_f32 v173,v173
v_mfma_f32_16x16x32_bf16 a[216:219],v[212:215],v[144:147],a[216:219]
v_cvt_pk_bf16_f32 v169,v170,v171
v_add_f32 v229,v229,v172
v_mfma_f32_16x16x32_bf16 a[212:215],v[212:215],v[136:139],a[212:215]
s_waitcnt lgkmcnt(3)
v_add_f32 v229,v229,v173
v_mfma_f32_16x16x32_bf16 a[208:211],v[212:215],v[128:131],a[208:211]
ds_read_b128 v[212:215],v232 offset:64
v_cvt_pk_bf16_f32 v170,v172,v173
v_mfma_f32_16x16x32_bf16 a[224:227],v[216:219],v[128:131],a[224:227]
v_exp_f32 v174,v174
v_mfma_f32_16x16x32_bf16 a[228:231],v[216:219],v[136:139],a[228:231]
v_add_f32 v229,v229,v174
v_mfma_f32_16x16x32_bf16 a[232:235],v[216:219],v[144:147],a[232:235]
s_waitcnt lgkmcnt(2)
v_mfma_f32_16x16x32_bf16 a[236:239],v[216:219],v[152:155],a[236:239]
ds_read_b128 v[216:219],v232 offset:128
v_mfma_f32_16x16x32_bf16 a[252:255],v[220:223],v[152:155],a[252:255]
v_exp_f32 v175,v175
v_mfma_f32_16x16x32_bf16 a[248:251],v[220:223],v[144:147],a[248:251]
v_add_f32 v229,v229,v175
v_cvt_pk_bf16_f32 v171,v174,v175
v_mfma_f32_16x16x32_bf16 a[244:247],v[220:223],v[136:139],a[244:247]
v_mfma_f32_16x16x32_bf16 a[240:243],v[220:223],v[128:131],a[240:243]
s_waitcnt lgkmcnt(1)
ds_read_b128 v[220:223],v232 offset:192
v_mfma_f32_16x16x32_bf16 v[128:131],v[208:211],v[0:3],v[192:195]
v_exp_f32 v176,v176
v_mfma_f32_16x16x32_bf16 v[128:131],v[212:215],v[16:19],v[128:131]
v_mul_u32_u24 v255,896,v255
v_add_u32 v254,v255,v254
v_mfma_f32_16x16x32_bf16 v[136:139],v[208:211],v[4:7],v[196:199]
v_exp_f32 v177,v177
v_mfma_f32_16x16x32_bf16 v[136:139],v[212:215],v[20:23],v[136:139]
v_add_f32 v230,v176,v177
v_cvt_pk_bf16_f32 v176,v176,v177
v_mfma_f32_16x16x32_bf16 v[144:147],v[208:211],v[8:11],v[200:203]
v_exp_f32 v178,v178
v_mfma_f32_16x16x32_bf16 v[144:147],v[212:215],v[24:27],v[144:147]
v_add_f32 v230,v230,v178
v_and_b32 v255,1,v246
v_mfma_f32_16x16x32_bf16 v[152:155],v[208:211],v[12:15],v[204:207]
ds_read_b128 v[208:211],v232 offset:256
v_lshlrev_b32 v255,4,v255
v_mfma_f32_16x16x32_bf16 v[152:155],v[212:215],v[28:31],v[152:155]
s_waitcnt lgkmcnt(1)
ds_read_b128 v[212:215],v232 offset:320
v_mfma_f32_16x16x32_bf16 v[128:131],v[216:219],v[32:35],v[128:131]
v_exp_f32 v179,v179
v_mfma_f32_16x16x32_bf16 v[128:131],v[220:223],v[48:51],v[128:131]
v_add_f32 v230,v230,v179
v_cvt_pk_bf16_f32 v177,v178,v179
v_mfma_f32_16x16x32_bf16 v[136:139],v[216:219],v[36:39],v[136:139]
v_exp_f32 v180,v180
v_mfma_f32_16x16x32_bf16 v[136:139],v[220:223],v[52:55],v[136:139]
v_add_f32 v230,v230,v180
v_lshlrev_b32 v255,v255,v244
v_mfma_f32_16x16x32_bf16 v[144:147],v[216:219],v[40:43],v[144:147]
v_exp_f32 v181,v181
v_mfma_f32_16x16x32_bf16 v[144:147],v[220:223],v[56:59],v[144:147]
v_add_f32 v230,v230,v181
v_cvt_pk_bf16_f32 v178,v180,v181
v_mfma_f32_16x16x32_bf16 v[152:155],v[216:219],v[44:47],v[152:155]
ds_read_b128 v[216:219],v232 offset:384
v_lshrrev_b32 v247,1,v246
v_mfma_f32_16x16x32_bf16 v[152:155],v[220:223],v[60:63],v[152:155]
s_waitcnt lgkmcnt(1)
ds_read_b128 v[220:223],v232 offset:448
v_mfma_f32_16x16x32_bf16 v[128:131],v[208:211],v[64:67],v[128:131]
v_exp_f32 v182,v182
v_mfma_f32_16x16x32_bf16 v[128:131],v[212:215],v[80:83],v[128:131]
v_add_f32 v230,v230,v182
v_lshlrev_b32 v247,v247,1
v_mfma_f32_16x16x32_bf16 v[136:139],v[208:211],v[68:71],v[136:139]
v_bfe_i32 v244,v247,0,1
v_and_b32 v244,v255,v244
v_mfma_f32_16x16x32_bf16 v[136:139],v[212:215],v[84:87],v[136:139]
v_exp_f32 v183,v183
v_mfma_f32_16x16x32_bf16 v[144:147],v[208:211],v[72:75],v[144:147]
s_add_u32 m0,s32,121856
s_mov_b32 s34,0
v_mfma_f32_16x16x32_bf16 v[144:147],v[212:215],v[88:91],v[144:147]
buffer_load_dwordx4 v235,s[24:27],s34 offen  lds
v_mfma_f32_16x16x32_bf16 v[152:155],v[208:211],v[76:79],v[152:155]
ds_read_b128 v[208:211],v232 offset:8704
v_add_f32 v230,v230,v183
v_mfma_f32_16x16x32_bf16 v[152:155],v[212:215],v[92:95],v[152:155]
s_waitcnt lgkmcnt(1)
ds_read_b128 v[212:215],v232 offset:8768
v_mfma_f32_16x16x32_bf16 v[128:131],v[216:219],v[96:99],v[128:131]
v_exp_f32 v184,v184
v_mfma_f32_16x16x32_bf16 v[128:131],v[220:223],v[112:115],v[128:131]
v_max3_f32 v243,v228,v229,v230
v_cvt_pk_bf16_f32 v179,v182,v183
v_mfma_f32_16x16x32_bf16 v[136:139],v[216:219],v[100:103],v[136:139]
v_bfe_i32 v245,v247,1,1
v_and_b32 v245,v255,v245
v_mfma_f32_16x16x32_bf16 v[136:139],v[220:223],v[116:119],v[136:139]
v_exp_f32 v185,v185
v_mfma_f32_16x16x32_bf16 v[144:147],v[216:219],v[104:107],v[144:147]
s_add_u32 m0,s32,122944
s_mov_b32 s34,7168
v_mfma_f32_16x16x32_bf16 v[144:147],v[220:223],v[120:123],v[144:147]
buffer_load_dwordx4 v235,s[24:27],s34 offen  lds
v_mfma_f32_16x16x32_bf16 v[152:155],v[216:219],v[108:111],v[152:155]
ds_read_b128 v[216:219],v232 offset:8832
v_add_f32 v231,v184,v185
v_mfma_f32_16x16x32_bf16 v[152:155],v[220:223],v[124:127],v[152:155]
s_waitcnt lgkmcnt(1)
ds_read_b128 v[220:223],v232 offset:8896
v_mfma_f32_16x16x32_bf16 v[132:135],v[208:211],v[0:3],v[192:195]
v_exp_f32 v186,v186
v_mfma_f32_16x16x32_bf16 v[132:135],v[212:215],v[16:19],v[132:135]
v_cvt_pk_bf16_f32 v184,v184,v185
v_add_f32 v231,v231,v186
v_mfma_f32_16x16x32_bf16 v[140:143],v[208:211],v[4:7],v[196:199]
v_bfe_i32 v246,v247,2,1
v_and_b32 v246,v255,v246
v_mfma_f32_16x16x32_bf16 v[140:143],v[212:215],v[20:23],v[140:143]
v_exp_f32 v187,v187
v_mfma_f32_16x16x32_bf16 v[148:151],v[208:211],v[8:11],v[200:203]
s_add_u32 m0,s32,124032
s_mov_b32 s34,14336
v_mfma_f32_16x16x32_bf16 v[148:151],v[212:215],v[24:27],v[148:151]
buffer_load_dwordx4 v235,s[24:27],s34 offen  lds
v_mfma_f32_16x16x32_bf16 v[156:159],v[208:211],v[12:15],v[204:207]
ds_read_b128 v[208:211],v232 offset:8960
v_add_f32 v231,v231,v187
v_mfma_f32_16x16x32_bf16 v[156:159],v[212:215],v[28:31],v[156:159]
s_waitcnt lgkmcnt(1)
ds_read_b128 v[212:215],v232 offset:9024
v_mfma_f32_16x16x32_bf16 v[132:135],v[216:219],v[32:35],v[132:135]
v_exp_f32 v188,v188
v_mfma_f32_16x16x32_bf16 v[132:135],v[220:223],v[48:51],v[132:135]
v_cvt_pk_bf16_f32 v185,v186,v187
v_add_f32 v231,v231,v188
v_mfma_f32_16x16x32_bf16 v[140:143],v[216:219],v[36:39],v[140:143]
v_bfe_i32 v247,v247,3,1
v_and_b32 v247,v255,v247
v_mfma_f32_16x16x32_bf16 v[140:143],v[220:223],v[52:55],v[140:143]
v_exp_f32 v189,v189
v_mfma_f32_16x16x32_bf16 v[148:151],v[216:219],v[40:43],v[148:151]
s_add_u32 m0,s32,125120
s_mov_b32 s34,21504
v_mfma_f32_16x16x32_bf16 v[148:151],v[220:223],v[56:59],v[148:151]
buffer_load_dwordx4 v235,s[24:27],s34 offen  lds
v_mfma_f32_16x16x32_bf16 v[156:159],v[216:219],v[44:47],v[156:159]
ds_read_b128 v[216:219],v232 offset:9088
v_add_f32 v231,v231,v189
v_mfma_f32_16x16x32_bf16 v[156:159],v[220:223],v[60:63],v[156:159]
s_waitcnt lgkmcnt(1)
ds_read_b128 v[220:223],v232 offset:9152
v_mfma_f32_16x16x32_bf16 v[132:135],v[208:211],v[64:67],v[132:135]
v_exp_f32 v190,v190
v_mfma_f32_16x16x32_bf16 v[132:135],v[212:215],v[80:83],v[132:135]
v_cvt_pk_bf16_f32 v186,v188,v189
v_add_f32 v231,v231,v190
v_mfma_f32_16x16x32_bf16 v[140:143],v[208:211],v[68:71],v[140:143]
v_add_u32 v232,17408,v232
v_mfma_f32_16x16x32_bf16 v[140:143],v[212:215],v[84:87],v[140:143]
v_exp_f32 v191,v191
v_mfma_f32_16x16x32_bf16 v[148:151],v[208:211],v[72:75],v[148:151]
v_add_f32 v231,v231,v191
v_cvt_pk_bf16_f32 v187,v190,v191
v_mfma_f32_16x16x32_bf16 v[148:151],v[212:215],v[88:91],v[148:151]
v_max_f32 v243,v243,v231
v_cmp_lt_f32 vcc,s54,v243
v_mfma_f32_16x16x32_bf16 v[156:159],v[208:211],v[76:79],v[156:159]
ds_read_b64_tr_b16 v[208:209],v233 offset:17408
ds_read_b64_tr_b16 v[210:211],v233 offset:26112
v_mfma_f32_16x16x32_bf16 v[156:159],v[212:215],v[92:95],v[156:159]
s_waitcnt lgkmcnt(2)
ds_read_b64_tr_b16 v[212:213],v234 offset:17440
v_mfma_f32_16x16x32_bf16 v[132:135],v[216:219],v[96:99],v[132:135]
ds_read_b64_tr_b16 v[214:215],v234 offset:26144
s_cbranch_vccnz RS_129
RS_129_RET:
v_mfma_f32_16x16x32_bf16 v[132:135],v[220:223],v[112:115],v[132:135]
v_add_f32 v224,v224,v228
v_add_f32 v225,v225,v229
v_mfma_f32_16x16x32_bf16 v[140:143],v[216:219],v[100:103],v[140:143]
v_add_f32 v226,v226,v230
v_add_f32 v227,v227,v231
v_mfma_f32_16x16x32_bf16 v[140:143],v[220:223],v[116:119],v[140:143]
s_add_u32 s52,s52,16384
v_mfma_f32_16x16x32_bf16 v[148:151],v[216:219],v[104:107],v[148:151]
v_mfma_f32_16x16x32_bf16 v[148:151],v[220:223],v[120:123],v[148:151]
v_mfma_f32_16x16x32_bf16 v[156:159],v[216:219],v[108:111],v[156:159]
ds_read_b64_tr_b16 v[216:217],v233 offset:17472
ds_read_b64_tr_b16 v[218:219],v233 offset:26176
v_mfma_f32_16x16x32_bf16 v[156:159],v[220:223],v[124:127],v[156:159]
s_waitcnt lgkmcnt(4)
ds_read_b64_tr_b16 v[220:221],v234 offset:17504
ds_read_b64_tr_b16 v[222:223],v234 offset:26208
v_mfma_f32_16x16x32_bf16 a[0:3],v[208:211],v[160:163],a[0:3]
v_exp_f32 v128,v128
v_mfma_f32_16x16x32_bf16 a[4:7],v[208:211],v[168:171],a[4:7]
s_add_u32 m0,s32,52224
v_mfma_f32_16x16x32_bf16 a[8:11],v[208:211],v[176:179],a[8:11]
s_waitcnt lgkmcnt(4)
s_mov_b32 s34,507904
v_mfma_f32_16x16x32_bf16 a[12:15],v[208:211],v[184:187],a[12:15]
ds_read_b64_tr_b16 v[208:209],v233 offset:17536
ds_read_b64_tr_b16 v[210:211],v233 offset:26240
v_mfma_f32_16x16x32_bf16 a[28:31],v[212:215],v[184:187],a[28:31]
v_exp_f32 v129,v129
v_mfma_f32_16x16x32_bf16 a[24:27],v[212:215],v[176:179],a[24:27]
buffer_load_dwordx4 v237,s[12:15],s34 offen offset:0 sc0 sc1 nt lds
v_mfma_f32_16x16x32_bf16 a[20:23],v[212:215],v[168:171],a[20:23]
s_waitcnt lgkmcnt(4)
v_add_f32 v228,v128,v129
v_mfma_f32_16x16x32_bf16 a[16:19],v[212:215],v[160:163],a[16:19]
ds_read_b64_tr_b16 v[212:213],v234 offset:17568
ds_read_b64_tr_b16 v[214:215],v234 offset:26272
v_mfma_f32_16x16x32_bf16 a[32:35],v[216:219],v[160:163],a[32:35]
v_exp_f32 v130,v130
v_mfma_f32_16x16x32_bf16 a[36:39],v[216:219],v[168:171],a[36:39]
v_cvt_pk_bf16_f32 v128,v128,v129
v_add_f32 v228,v228,v130
v_mfma_f32_16x16x32_bf16 a[40:43],v[216:219],v[176:179],a[40:43]
s_waitcnt lgkmcnt(4)
s_add_u32 m0,s32,52288
v_mfma_f32_16x16x32_bf16 a[44:47],v[216:219],v[184:187],a[44:47]
ds_read_b64_tr_b16 v[216:217],v233 offset:17600
ds_read_b64_tr_b16 v[218:219],v233 offset:26304
v_mfma_f32_16x16x32_bf16 a[60:63],v[220:223],v[184:187],a[60:63]
v_exp_f32 v131,v131
v_mfma_f32_16x16x32_bf16 a[56:59],v[220:223],v[176:179],a[56:59]
buffer_load_dwordx4 v237,s[12:15],s34 offen offset:1024 sc0 sc1 nt lds
v_mfma_f32_16x16x32_bf16 a[52:55],v[220:223],v[168:171],a[52:55]
s_waitcnt lgkmcnt(4)
v_add_f32 v228,v228,v131
v_mfma_f32_16x16x32_bf16 a[48:51],v[220:223],v[160:163],a[48:51]
ds_read_b64_tr_b16 v[220:221],v234 offset:17632
ds_read_b64_tr_b16 v[222:223],v234 offset:26336
v_mfma_f32_16x16x32_bf16 a[64:67],v[208:211],v[160:163],a[64:67]
v_exp_f32 v132,v132
v_mfma_f32_16x16x32_bf16 a[68:71],v[208:211],v[168:171],a[68:71]
v_cvt_pk_bf16_f32 v129,v130,v131
v_add_f32 v228,v228,v132
v_mfma_f32_16x16x32_bf16 a[72:75],v[208:211],v[176:179],a[72:75]
s_waitcnt lgkmcnt(4)
s_add_u32 m0,s32,52352
v_mfma_f32_16x16x32_bf16 a[76:79],v[208:211],v[184:187],a[76:79]
ds_read_b64_tr_b16 v[208:209],v233 offset:17664
ds_read_b64_tr_b16 v[210:211],v233 offset:26368
v_mfma_f32_16x16x32_bf16 a[92:95],v[212:215],v[184:187],a[92:95]
v_exp_f32 v133,v133
v_mfma_f32_16x16x32_bf16 a[88:91],v[212:215],v[176:179],a[88:91]
buffer_load_dwordx4 v237,s[12:15],s34 offen offset:2048 sc0 sc1 nt lds
v_mfma_f32_16x16x32_bf16 a[84:87],v[212:215],v[168:171],a[84:87]
s_waitcnt lgkmcnt(4)
v_add_f32 v228,v228,v133
v_mfma_f32_16x16x32_bf16 a[80:83],v[212:215],v[160:163],a[80:83]
ds_read_b64_tr_b16 v[212:213],v234 offset:17696
ds_read_b64_tr_b16 v[214:215],v234 offset:26400
v_mfma_f32_16x16x32_bf16 a[96:99],v[216:219],v[160:163],a[96:99]
v_exp_f32 v134,v134
v_mfma_f32_16x16x32_bf16 a[100:103],v[216:219],v[168:171],a[100:103]
v_cvt_pk_bf16_f32 v130,v132,v133
v_add_f32 v228,v228,v134
v_mfma_f32_16x16x32_bf16 a[104:107],v[216:219],v[176:179],a[104:107]
s_waitcnt lgkmcnt(4)
s_add_u32 m0,s32,52416
v_mfma_f32_16x16x32_bf16 a[108:111],v[216:219],v[184:187],a[108:111]
ds_read_b64_tr_b16 v[216:217],v233 offset:17728
ds_read_b64_tr_b16 v[218:219],v233 offset:26432
v_mfma_f32_16x16x32_bf16 a[124:127],v[220:223],v[184:187],a[124:127]
v_exp_f32 v135,v135
v_mfma_f32_16x16x32_bf16 a[120:123],v[220:223],v[176:179],a[120:123]
buffer_load_dwordx4 v237,s[12:15],s34 offen offset:3072 sc0 sc1 nt lds
v_mfma_f32_16x16x32_bf16 a[116:119],v[220:223],v[168:171],a[116:119]
s_waitcnt lgkmcnt(4)
v_add_f32 v228,v228,v135
v_mfma_f32_16x16x32_bf16 a[112:115],v[220:223],v[160:163],a[112:115]
ds_read_b64_tr_b16 v[220:221],v234 offset:17760
ds_read_b64_tr_b16 v[222:223],v234 offset:26464
v_mfma_f32_16x16x32_bf16 a[128:131],v[208:211],v[160:163],a[128:131]
v_exp_f32 v136,v136
v_mfma_f32_16x16x32_bf16 a[132:135],v[208:211],v[168:171],a[132:135]
v_cvt_pk_bf16_f32 v131,v134,v135
v_mfma_f32_16x16x32_bf16 a[136:139],v[208:211],v[176:179],a[136:139]
s_waitcnt lgkmcnt(4)
v_mfma_f32_16x16x32_bf16 a[140:143],v[208:211],v[184:187],a[140:143]
ds_read_b64_tr_b16 v[208:209],v233 offset:17792
ds_read_b64_tr_b16 v[210:211],v233 offset:26496
v_mfma_f32_16x16x32_bf16 a[156:159],v[212:215],v[184:187],a[156:159]
v_exp_f32 v137,v137
v_mfma_f32_16x16x32_bf16 a[152:155],v[212:215],v[176:179],a[152:155]
v_mbcnt_lo_u32_b32 v231,-1,0
v_add_f32 v229,v136,v137
v_mfma_f32_16x16x32_bf16 a[148:151],v[212:215],v[168:171],a[148:151]
s_waitcnt lgkmcnt(4)
v_min_u32 v231,31,v231
v_mfma_f32_16x16x32_bf16 a[144:147],v[212:215],v[160:163],a[144:147]
ds_read_b64_tr_b16 v[212:213],v234 offset:17824
ds_read_b64_tr_b16 v[214:215],v234 offset:26528
v_mfma_f32_16x16x32_bf16 a[160:163],v[216:219],v[160:163],a[160:163]
v_exp_f32 v138,v138
v_mfma_f32_16x16x32_bf16 a[164:167],v[216:219],v[168:171],a[164:167]
v_lshlrev_b32 v231,7,v231
s_add_u32 s36,s36,16384
v_mfma_f32_16x16x32_bf16 a[168:171],v[216:219],v[176:179],a[168:171]
s_waitcnt lgkmcnt(4)
s_mov_b32 m0,156672
v_mfma_f32_16x16x32_bf16 a[172:175],v[216:219],v[184:187],a[172:175]
ds_read_b64_tr_b16 v[216:217],v233 offset:17856
ds_read_b64_tr_b16 v[218:219],v233 offset:26560
v_mfma_f32_16x16x32_bf16 a[188:191],v[220:223],v[184:187],a[188:191]
v_exp_f32 v139,v139
v_mfma_f32_16x16x32_bf16 a[184:187],v[220:223],v[176:179],a[184:187]
buffer_load_dword v231,s[28:31],s36 offen  lds
v_mfma_f32_16x16x32_bf16 a[180:183],v[220:223],v[168:171],a[180:183]
s_waitcnt lgkmcnt(4)
v_cvt_pk_bf16_f32 v136,v136,v137
v_mfma_f32_16x16x32_bf16 a[176:179],v[220:223],v[160:163],a[176:179]
ds_read_b64_tr_b16 v[220:221],v234 offset:17888
ds_read_b64_tr_b16 v[222:223],v234 offset:26592
v_mfma_f32_16x16x32_bf16 a[192:195],v[208:211],v[160:163],a[192:195]
v_exp_f32 v140,v140
v_mfma_f32_16x16x32_bf16 a[196:199],v[208:211],v[168:171],a[196:199]
v_add_f32 v229,v229,v138
v_add_f32 v229,v229,v139
v_mfma_f32_16x16x32_bf16 a[200:203],v[208:211],v[176:179],a[200:203]
s_waitcnt vmcnt(10) lgkmcnt(4)
s_barrier
v_mfma_f32_16x16x32_bf16 a[204:207],v[208:211],v[184:187],a[204:207]
ds_read_b128 v[208:211],v232 offset:0
v_cvt_pk_bf16_f32 v137,v138,v139
v_mfma_f32_16x16x32_bf16 a[220:223],v[212:215],v[184:187],a[220:223]
v_exp_f32 v141,v141
v_cmp_ne_u32 vcc,s7,v236
v_mfma_f32_16x16x32_bf16 a[216:219],v[212:215],v[176:179],a[216:219]
v_add_f32 v229,v229,v140
v_add_f32 v229,v229,v141
v_mbcnt_lo_u32_b32 v243,-1,0
v_mfma_f32_16x16x32_bf16 a[212:215],v[212:215],v[168:171],a[212:215]
s_waitcnt lgkmcnt(3)
v_cvt_pk_bf16_f32 v138,v140,v141
v_mfma_f32_16x16x32_bf16 a[208:211],v[212:215],v[160:163],a[208:211]
ds_read_b128 v[212:215],v232 offset:64
s_or_b32 s62,s6,s3
v_mfma_f32_16x16x32_bf16 a[224:227],v[216:219],v[160:163],a[224:227]
v_exp_f32 v142,v142
v_mfma_f32_16x16x32_bf16 a[228:231],v[216:219],v[168:171],a[228:231]
v_add_f32 v229,v229,v142
v_or_b32 v243,s62,v243
v_mfma_f32_16x16x32_bf16 a[232:235],v[216:219],v[176:179],a[232:235]
s_waitcnt lgkmcnt(2)
s_cmp_eq_u64 vcc,0
v_mfma_f32_16x16x32_bf16 a[236:239],v[216:219],v[184:187],a[236:239]
ds_read_b128 v[216:219],v232 offset:128
s_cselect_b32 s62,32,64
v_lshlrev_b32 v243,8,v243
v_mfma_f32_16x16x32_bf16 a[252:255],v[220:223],v[184:187],a[252:255]
v_exp_f32 v143,v143
s_or_b32 s62,s62,s5
v_mfma_f32_16x16x32_bf16 a[248:251],v[220:223],v[176:179],a[248:251]
v_add_f32 v229,v229,v143
v_cvt_pk_bf16_f32 v139,v142,v143
v_mfma_f32_16x16x32_bf16 a[244:247],v[220:223],v[168:171],a[244:247]
v_mov_b32 v236,s62
v_mfma_f32_16x16x32_bf16 a[240:243],v[220:223],v[160:163],a[240:243]
s_waitcnt lgkmcnt(1)
ds_read_b128 v[220:223],v232 offset:192
buffer_store_byte v236,v243,s[20:23],s60 offen
v_mfma_f32_16x16x32_bf16 v[160:163],v[208:211],v[0:3],v[192:195]
v_exp_f32 v144,v144
v_mfma_f32_16x16x32_bf16 v[160:163],v[212:215],v[16:19],v[160:163]
v_mfma_f32_16x16x32_bf16 v[168:171],v[208:211],v[4:7],v[196:199]
v_exp_f32 v145,v145
v_mfma_f32_16x16x32_bf16 v[168:171],v[212:215],v[20:23],v[168:171]
v_add_f32 v230,v144,v145
v_cvt_pk_bf16_f32 v144,v144,v145
v_mfma_f32_16x16x32_bf16 v[176:179],v[208:211],v[8:11],v[200:203]
v_exp_f32 v146,v146
v_mfma_f32_16x16x32_bf16 v[176:179],v[212:215],v[24:27],v[176:179]
v_add_f32 v230,v230,v146
v_mfma_f32_16x16x32_bf16 v[184:187],v[208:211],v[12:15],v[204:207]
ds_read_b128 v[208:211],v232 offset:256
v_mfma_f32_16x16x32_bf16 v[184:187],v[212:215],v[28:31],v[184:187]
s_waitcnt lgkmcnt(1)
ds_read_b128 v[212:215],v232 offset:320
v_mfma_f32_16x16x32_bf16 v[160:163],v[216:219],v[32:35],v[160:163]
v_exp_f32 v147,v147
v_mfma_f32_16x16x32_bf16 v[160:163],v[220:223],v[48:51],v[160:163]
v_add_f32 v230,v230,v147
v_cvt_pk_bf16_f32 v145,v146,v147
v_mfma_f32_16x16x32_bf16 v[168:171],v[216:219],v[36:39],v[168:171]
v_exp_f32 v148,v148
v_mfma_f32_16x16x32_bf16 v[168:171],v[220:223],v[52:55],v[168:171]
v_add_f32 v230,v230,v148
v_mfma_f32_16x16x32_bf16 v[176:179],v[216:219],v[40:43],v[176:179]
v_exp_f32 v149,v149
v_mfma_f32_16x16x32_bf16 v[176:179],v[220:223],v[56:59],v[176:179]
v_add_f32 v230,v230,v149
v_cvt_pk_bf16_f32 v146,v148,v149
v_mfma_f32_16x16x32_bf16 v[184:187],v[216:219],v[44:47],v[184:187]
ds_read_b128 v[216:219],v232 offset:384
v_mfma_f32_16x16x32_bf16 v[184:187],v[220:223],v[60:63],v[184:187]
s_waitcnt lgkmcnt(1)
ds_read_b128 v[220:223],v232 offset:448
v_mfma_f32_16x16x32_bf16 v[160:163],v[208:211],v[64:67],v[160:163]
v_exp_f32 v150,v150
v_mfma_f32_16x16x32_bf16 v[160:163],v[212:215],v[80:83],v[160:163]
v_add_f32 v230,v230,v150
v_mfma_f32_16x16x32_bf16 v[168:171],v[208:211],v[68:71],v[168:171]
v_mfma_f32_16x16x32_bf16 v[168:171],v[212:215],v[84:87],v[168:171]
v_exp_f32 v151,v151
v_mfma_f32_16x16x32_bf16 v[176:179],v[208:211],v[72:75],v[176:179]
s_add_u32 m0,s32,139264
s_mov_b32 s34,114688
v_mfma_f32_16x16x32_bf16 v[176:179],v[212:215],v[88:91],v[176:179]
buffer_load_dwordx4 v235,s[24:27],s34 offen  lds
v_mfma_f32_16x16x32_bf16 v[184:187],v[208:211],v[76:79],v[184:187]
ds_read_b128 v[208:211],v232 offset:8704
v_add_f32 v230,v230,v151
v_mfma_f32_16x16x32_bf16 v[184:187],v[212:215],v[92:95],v[184:187]
s_waitcnt lgkmcnt(1)
ds_read_b128 v[212:215],v232 offset:8768
v_mfma_f32_16x16x32_bf16 v[160:163],v[216:219],v[96:99],v[160:163]
v_exp_f32 v152,v152
v_mfma_f32_16x16x32_bf16 v[160:163],v[220:223],v[112:115],v[160:163]
v_max3_f32 v243,v228,v229,v230
v_cvt_pk_bf16_f32 v147,v150,v151
v_mfma_f32_16x16x32_bf16 v[168:171],v[216:219],v[100:103],v[168:171]
v_mfma_f32_16x16x32_bf16 v[168:171],v[220:223],v[116:119],v[168:171]
v_exp_f32 v153,v153
v_mfma_f32_16x16x32_bf16 v[176:179],v[216:219],v[104:107],v[176:179]
s_add_u32 m0,s32,140352
s_mov_b32 s34,121856
v_mfma_f32_16x16x32_bf16 v[176:179],v[220:223],v[120:123],v[176:179]
buffer_load_dwordx4 v235,s[24:27],s34 offen  lds
v_mfma_f32_16x16x32_bf16 v[184:187],v[216:219],v[108:111],v[184:187]
ds_read_b128 v[216:219],v232 offset:8832
v_add_f32 v231,v152,v153
v_mfma_f32_16x16x32_bf16 v[184:187],v[220:223],v[124:127],v[184:187]
s_waitcnt lgkmcnt(1)
ds_read_b128 v[220:223],v232 offset:8896
v_mfma_f32_16x16x32_bf16 v[164:167],v[208:211],v[0:3],v[192:195]
v_exp_f32 v154,v154
v_mfma_f32_16x16x32_bf16 v[164:167],v[212:215],v[16:19],v[164:167]
v_cvt_pk_bf16_f32 v152,v152,v153
v_add_f32 v231,v231,v154
v_mfma_f32_16x16x32_bf16 v[172:175],v[208:211],v[4:7],v[196:199]
v_mfma_f32_16x16x32_bf16 v[172:175],v[212:215],v[20:23],v[172:175]
v_exp_f32 v155,v155
v_mfma_f32_16x16x32_bf16 v[180:183],v[208:211],v[8:11],v[200:203]
s_add_u32 m0,s32,141440
s_mov_b32 s34,129024
v_mfma_f32_16x16x32_bf16 v[180:183],v[212:215],v[24:27],v[180:183]
buffer_load_dwordx4 v235,s[24:27],s34 offen  lds
v_mfma_f32_16x16x32_bf16 v[188:191],v[208:211],v[12:15],v[204:207]
ds_read_b128 v[208:211],v232 offset:8960
v_add_f32 v231,v231,v155
v_mfma_f32_16x16x32_bf16 v[188:191],v[212:215],v[28:31],v[188:191]
s_waitcnt lgkmcnt(1)
ds_read_b128 v[212:215],v232 offset:9024
v_mfma_f32_16x16x32_bf16 v[164:167],v[216:219],v[32:35],v[164:167]
v_exp_f32 v156,v156
v_mfma_f32_16x16x32_bf16 v[164:167],v[220:223],v[48:51],v[164:167]
v_cvt_pk_bf16_f32 v153,v154,v155
v_add_f32 v231,v231,v156
v_mfma_f32_16x16x32_bf16 v[172:175],v[216:219],v[36:39],v[172:175]
v_mfma_f32_16x16x32_bf16 v[172:175],v[220:223],v[52:55],v[172:175]
v_exp_f32 v157,v157
v_mfma_f32_16x16x32_bf16 v[180:183],v[216:219],v[40:43],v[180:183]
s_add_u32 m0,s32,142528
s_mov_b32 s34,136192
v_mfma_f32_16x16x32_bf16 v[180:183],v[220:223],v[56:59],v[180:183]
buffer_load_dwordx4 v235,s[24:27],s34 offen  lds
v_mfma_f32_16x16x32_bf16 v[188:191],v[216:219],v[44:47],v[188:191]
ds_read_b128 v[216:219],v232 offset:9088
v_add_f32 v231,v231,v157
v_mfma_f32_16x16x32_bf16 v[188:191],v[220:223],v[60:63],v[188:191]
s_waitcnt lgkmcnt(1)
ds_read_b128 v[220:223],v232 offset:9152
v_mfma_f32_16x16x32_bf16 v[164:167],v[208:211],v[64:67],v[164:167]
v_exp_f32 v158,v158
v_mfma_f32_16x16x32_bf16 v[164:167],v[212:215],v[80:83],v[164:167]
v_cvt_pk_bf16_f32 v154,v156,v157
v_add_f32 v231,v231,v158
v_mfma_f32_16x16x32_bf16 v[172:175],v[208:211],v[68:71],v[172:175]
v_mfma_f32_16x16x32_bf16 v[172:175],v[212:215],v[84:87],v[172:175]
v_exp_f32 v159,v159
v_mfma_f32_16x16x32_bf16 v[180:183],v[208:211],v[72:75],v[180:183]
v_add_f32 v231,v231,v159
v_cvt_pk_bf16_f32 v155,v158,v159
v_mfma_f32_16x16x32_bf16 v[180:183],v[212:215],v[88:91],v[180:183]
v_max_f32 v243,v243,v231
v_cmp_lt_f32 vcc,s54,v243
v_mfma_f32_16x16x32_bf16 v[188:191],v[208:211],v[76:79],v[188:191]
ds_read_b64_tr_b16 v[208:209],v233 offset:34816
ds_read_b64_tr_b16 v[210:211],v233 offset:43520
v_mfma_f32_16x16x32_bf16 v[188:191],v[212:215],v[92:95],v[188:191]
s_waitcnt lgkmcnt(2)
ds_read_b64_tr_b16 v[212:213],v234 offset:34848
v_mfma_f32_16x16x32_bf16 v[164:167],v[216:219],v[96:99],v[164:167]
ds_read_b64_tr_b16 v[214:215],v234 offset:43552
s_cbranch_vccnz RS_130
RS_130_RET:
v_mfma_f32_16x16x32_bf16 v[164:167],v[220:223],v[112:115],v[164:167]
v_add_f32 v224,v224,v228
v_add_f32 v225,v225,v229
v_mfma_f32_16x16x32_bf16 v[172:175],v[216:219],v[100:103],v[172:175]
v_add_f32 v226,v226,v230
v_add_f32 v227,v227,v231
v_mfma_f32_16x16x32_bf16 v[172:175],v[220:223],v[116:119],v[172:175]
s_add_u32 s52,s52,16384
v_mfma_f32_16x16x32_bf16 v[180:183],v[216:219],v[104:107],v[180:183]
v_mfma_f32_16x16x32_bf16 v[180:183],v[220:223],v[120:123],v[180:183]
v_mfma_f32_16x16x32_bf16 v[188:191],v[216:219],v[108:111],v[188:191]
ds_read_b64_tr_b16 v[216:217],v233 offset:34880
ds_read_b64_tr_b16 v[218:219],v233 offset:43584
v_mfma_f32_16x16x32_bf16 v[188:191],v[220:223],v[124:127],v[188:191]
s_waitcnt lgkmcnt(4)
ds_read_b64_tr_b16 v[220:221],v234 offset:34912
ds_read_b64_tr_b16 v[222:223],v234 offset:43616
v_mfma_f32_16x16x32_bf16 a[0:3],v[208:211],v[128:131],a[0:3]
v_exp_f32 v160,v160
v_mfma_f32_16x16x32_bf16 a[4:7],v[208:211],v[136:139],a[4:7]
s_add_u32 m0,s32,0
v_mfma_f32_16x16x32_bf16 a[8:11],v[208:211],v[144:147],a[8:11]
s_waitcnt lgkmcnt(4)
s_mov_b32 s34,128
v_mfma_f32_16x16x32_bf16 a[12:15],v[208:211],v[152:155],a[12:15]
ds_read_b64_tr_b16 v[208:209],v233 offset:34944
ds_read_b64_tr_b16 v[210:211],v233 offset:43648
v_mfma_f32_16x16x32_bf16 a[28:31],v[212:215],v[152:155],a[28:31]
v_exp_f32 v161,v161
v_mfma_f32_16x16x32_bf16 a[24:27],v[212:215],v[144:147],a[24:27]
buffer_load_dwordx4 v235,s[24:27],s34 offen  lds
v_mfma_f32_16x16x32_bf16 a[20:23],v[212:215],v[136:139],a[20:23]
s_waitcnt lgkmcnt(4)
v_add_f32 v228,v160,v161
v_mfma_f32_16x16x32_bf16 a[16:19],v[212:215],v[128:131],a[16:19]
ds_read_b64_tr_b16 v[212:213],v234 offset:34976
ds_read_b64_tr_b16 v[214:215],v234 offset:43680
v_mfma_f32_16x16x32_bf16 a[32:35],v[216:219],v[128:131],a[32:35]
v_exp_f32 v162,v162
v_mfma_f32_16x16x32_bf16 a[36:39],v[216:219],v[136:139],a[36:39]
s_add_u32 m0,s32,1088
v_cvt_pk_bf16_f32 v160,v160,v161
v_mfma_f32_16x16x32_bf16 a[40:43],v[216:219],v[144:147],a[40:43]
s_waitcnt lgkmcnt(4)
s_mov_b32 s34,7296
v_mfma_f32_16x16x32_bf16 a[44:47],v[216:219],v[152:155],a[44:47]
ds_read_b64_tr_b16 v[216:217],v233 offset:35008
ds_read_b64_tr_b16 v[218:219],v233 offset:43712
v_mfma_f32_16x16x32_bf16 a[60:63],v[220:223],v[152:155],a[60:63]
v_exp_f32 v163,v163
v_mfma_f32_16x16x32_bf16 a[56:59],v[220:223],v[144:147],a[56:59]
buffer_load_dwordx4 v235,s[24:27],s34 offen  lds
v_mfma_f32_16x16x32_bf16 a[52:55],v[220:223],v[136:139],a[52:55]
s_waitcnt lgkmcnt(4)
v_add_f32 v228,v228,v162
v_mfma_f32_16x16x32_bf16 a[48:51],v[220:223],v[128:131],a[48:51]
ds_read_b64_tr_b16 v[220:221],v234 offset:35040
ds_read_b64_tr_b16 v[222:223],v234 offset:43744
v_mfma_f32_16x16x32_bf16 a[64:67],v[208:211],v[128:131],a[64:67]
v_exp_f32 v164,v164
v_mfma_f32_16x16x32_bf16 a[68:71],v[208:211],v[136:139],a[68:71]
s_add_u32 m0,s32,2176
v_add_f32 v228,v228,v163
v_mfma_f32_16x16x32_bf16 a[72:75],v[208:211],v[144:147],a[72:75]
s_waitcnt lgkmcnt(4)
s_mov_b32 s34,14464
v_mfma_f32_16x16x32_bf16 a[76:79],v[208:211],v[152:155],a[76:79]
ds_read_b64_tr_b16 v[208:209],v233 offset:35072
ds_read_b64_tr_b16 v[210:211],v233 offset:43776
v_mfma_f32_16x16x32_bf16 a[92:95],v[212:215],v[152:155],a[92:95]
v_exp_f32 v165,v165
v_mfma_f32_16x16x32_bf16 a[88:91],v[212:215],v[144:147],a[88:91]
buffer_load_dwordx4 v235,s[24:27],s34 offen  lds
v_mfma_f32_16x16x32_bf16 a[84:87],v[212:215],v[136:139],a[84:87]
s_waitcnt lgkmcnt(4)
v_cvt_pk_bf16_f32 v161,v162,v163
v_mfma_f32_16x16x32_bf16 a[80:83],v[212:215],v[128:131],a[80:83]
ds_read_b64_tr_b16 v[212:213],v234 offset:35104
ds_read_b64_tr_b16 v[214:215],v234 offset:43808
v_mfma_f32_16x16x32_bf16 a[96:99],v[216:219],v[128:131],a[96:99]
v_exp_f32 v166,v166
v_mfma_f32_16x16x32_bf16 a[100:103],v[216:219],v[136:139],a[100:103]
s_add_u32 m0,s32,3264
v_add_f32 v228,v228,v164
v_mfma_f32_16x16x32_bf16 a[104:107],v[216:219],v[144:147],a[104:107]
s_waitcnt lgkmcnt(4)
s_mov_b32 s34,21632
v_mfma_f32_16x16x32_bf16 a[108:111],v[216:219],v[152:155],a[108:111]
ds_read_b64_tr_b16 v[216:217],v233 offset:35136
ds_read_b64_tr_b16 v[218:219],v233 offset:43840
v_mfma_f32_16x16x32_bf16 a[124:127],v[220:223],v[152:155],a[124:127]
v_exp_f32 v167,v167
v_mfma_f32_16x16x32_bf16 a[120:123],v[220:223],v[144:147],a[120:123]
buffer_load_dwordx4 v235,s[24:27],s34 offen  lds
v_mfma_f32_16x16x32_bf16 a[116:119],v[220:223],v[136:139],a[116:119]
s_waitcnt lgkmcnt(4)
v_add_f32 v228,v228,v165
v_mfma_f32_16x16x32_bf16 a[112:115],v[220:223],v[128:131],a[112:115]
ds_read_b64_tr_b16 v[220:221],v234 offset:35168
ds_read_b64_tr_b16 v[222:223],v234 offset:43872
v_mfma_f32_16x16x32_bf16 a[128:131],v[208:211],v[128:131],a[128:131]
v_exp_f32 v168,v168
v_mfma_f32_16x16x32_bf16 a[132:135],v[208:211],v[136:139],a[132:135]
v_cvt_pk_bf16_f32 v162,v164,v165
v_add_f32 v228,v228,v166
v_mfma_f32_16x16x32_bf16 a[136:139],v[208:211],v[144:147],a[136:139]
s_waitcnt lgkmcnt(4)
v_add_f32 v228,v228,v167
v_mfma_f32_16x16x32_bf16 a[140:143],v[208:211],v[152:155],a[140:143]
ds_read_b64_tr_b16 v[208:209],v233 offset:35200
ds_read_b64_tr_b16 v[210:211],v233 offset:43904
v_mfma_f32_16x16x32_bf16 a[156:159],v[212:215],v[152:155],a[156:159]
v_exp_f32 v169,v169
v_mfma_f32_16x16x32_bf16 a[152:155],v[212:215],v[144:147],a[152:155]
v_mbcnt_lo_u32_b32 v231,-1,0
v_cvt_pk_bf16_f32 v163,v166,v167
v_mfma_f32_16x16x32_bf16 a[148:151],v[212:215],v[136:139],a[148:151]
s_waitcnt lgkmcnt(4)
v_min_u32 v231,31,v231
v_mfma_f32_16x16x32_bf16 a[144:147],v[212:215],v[128:131],a[144:147]
ds_read_b64_tr_b16 v[212:213],v234 offset:35232
ds_read_b64_tr_b16 v[214:215],v234 offset:43936
v_mfma_f32_16x16x32_bf16 a[160:163],v[216:219],v[128:131],a[160:163]
v_exp_f32 v170,v170
v_mfma_f32_16x16x32_bf16 a[164:167],v[216:219],v[136:139],a[164:167]
v_lshlrev_b32 v231,7,v231
s_add_u32 s36,s36,16384
v_mfma_f32_16x16x32_bf16 a[168:171],v[216:219],v[144:147],a[168:171]
s_waitcnt lgkmcnt(4)
s_mov_b32 m0,156672
v_mfma_f32_16x16x32_bf16 a[172:175],v[216:219],v[152:155],a[172:175]
ds_read_b64_tr_b16 v[216:217],v233 offset:35264
ds_read_b64_tr_b16 v[218:219],v233 offset:43968
v_mfma_f32_16x16x32_bf16 a[188:191],v[220:223],v[152:155],a[188:191]
v_exp_f32 v171,v171
v_mfma_f32_16x16x32_bf16 a[184:187],v[220:223],v[144:147],a[184:187]
buffer_load_dword v231,s[28:31],s36 offen  lds
v_mfma_f32_16x16x32_bf16 a[180:183],v[220:223],v[136:139],a[180:183]
s_waitcnt lgkmcnt(4)
v_add_f32 v229,v168,v169
v_mfma_f32_16x16x32_bf16 a[176:179],v[220:223],v[128:131],a[176:179]
ds_read_b64_tr_b16 v[220:221],v234 offset:35296
ds_read_b64_tr_b16 v[222:223],v234 offset:44000
v_mfma_f32_16x16x32_bf16 a[192:195],v[208:211],v[128:131],a[192:195]
v_exp_f32 v172,v172
v_mfma_f32_16x16x32_bf16 a[196:199],v[208:211],v[136:139],a[196:199]
v_cvt_pk_bf16_f32 v168,v168,v169
v_add_f32 v229,v229,v170
v_mfma_f32_16x16x32_bf16 a[200:203],v[208:211],v[144:147],a[200:203]
s_waitcnt vmcnt(11) lgkmcnt(4)
s_barrier
v_mfma_f32_16x16x32_bf16 a[204:207],v[208:211],v[152:155],a[204:207]
ds_read_b64_tr_b16 v[208:209],v233 offset:52224
ds_read_b64_tr_b16 v[210:211],v233 offset:60928
v_mfma_f32_16x16x32_bf16 a[220:223],v[212:215],v[152:155],a[220:223]
v_exp_f32 v173,v173
v_mfma_f32_16x16x32_bf16 a[216:219],v[212:215],v[144:147],a[216:219]
v_add_f32 v229,v229,v171
v_cvt_pk_bf16_f32 v169,v170,v171
v_mfma_f32_16x16x32_bf16 a[212:215],v[212:215],v[136:139],a[212:215]
s_waitcnt lgkmcnt(4)
v_add_f32 v229,v229,v172
v_mfma_f32_16x16x32_bf16 a[208:211],v[212:215],v[128:131],a[208:211]
ds_read_b64_tr_b16 v[212:213],v234 offset:52256
ds_read_b64_tr_b16 v[214:215],v234 offset:60960
v_mfma_f32_16x16x32_bf16 a[224:227],v[216:219],v[128:131],a[224:227]
v_exp_f32 v174,v174
v_mfma_f32_16x16x32_bf16 a[228:231],v[216:219],v[136:139],a[228:231]
v_add_f32 v229,v229,v173
v_cvt_pk_bf16_f32 v170,v172,v173
v_mfma_f32_16x16x32_bf16 a[232:235],v[216:219],v[144:147],a[232:235]
s_waitcnt lgkmcnt(4)
v_add_f32 v229,v229,v174
v_mfma_f32_16x16x32_bf16 a[236:239],v[216:219],v[152:155],a[236:239]
ds_read_b64_tr_b16 v[216:217],v233 offset:52288
ds_read_b64_tr_b16 v[218:219],v233 offset:60992
v_mfma_f32_16x16x32_bf16 a[252:255],v[220:223],v[152:155],a[252:255]
v_exp_f32 v175,v175
v_mfma_f32_16x16x32_bf16 a[248:251],v[220:223],v[144:147],a[248:251]
v_add_f32 v229,v229,v175
v_cvt_pk_bf16_f32 v171,v174,v175
v_mfma_f32_16x16x32_bf16 a[244:247],v[220:223],v[136:139],a[244:247]
s_waitcnt lgkmcnt(4)
v_mfma_f32_16x16x32_bf16 a[240:243],v[220:223],v[128:131],a[240:243]
ds_read_b64_tr_b16 v[220:221],v234 offset:52320
ds_read_b64_tr_b16 v[222:223],v234 offset:61024
s_add_u32 m0,s32,17408
s_mov_b32 s34,114816
s_nop 0
buffer_load_dwordx4 v235,s[24:27],s34 offen  lds
s_add_u32 m0,s32,18496
s_mov_b32 s34,121984
s_nop 0
buffer_load_dwordx4 v235,s[24:27],s34 offen  lds
s_add_u32 m0,s32,19584
s_mov_b32 s34,129152
s_nop 0
buffer_load_dwordx4 v235,s[24:27],s34 offen  lds
s_add_u32 m0,s32,20672
s_mov_b32 s34,136320
s_nop 0
buffer_load_dwordx4 v235,s[24:27],s34 offen  lds
v_exp_f32 v176,v176
v_exp_f32 v184,v184
v_exp_f32 v177,v177
v_exp_f32 v185,v185
v_add_f32 v230,v176,v177
v_add_f32 v231,v184,v185
v_cvt_pk_bf16_f32 v176,v176,v177
v_cvt_pk_bf16_f32 v184,v184,v185
v_exp_f32 v178,v178
v_exp_f32 v186,v186
v_add_f32 v230,v230,v178
v_add_f32 v231,v231,v186
v_exp_f32 v179,v179
v_exp_f32 v187,v187
v_add_f32 v230,v230,v179
v_add_f32 v231,v231,v187
v_cvt_pk_bf16_f32 v177,v178,v179
v_cvt_pk_bf16_f32 v185,v186,v187
v_exp_f32 v180,v180
v_exp_f32 v188,v188
v_add_f32 v230,v230,v180
v_add_f32 v231,v231,v188
v_exp_f32 v181,v181
v_exp_f32 v189,v189
v_add_f32 v230,v230,v181
v_add_f32 v231,v231,v189
v_cvt_pk_bf16_f32 v178,v180,v181
v_cvt_pk_bf16_f32 v186,v188,v189
v_exp_f32 v182,v182
v_exp_f32 v190,v190
v_add_f32 v230,v230,v182
v_add_f32 v231,v231,v190
v_exp_f32 v183,v183
v_exp_f32 v191,v191
v_add_f32 v230,v230,v183
v_add_f32 v231,v231,v191
v_cvt_pk_bf16_f32 v179,v182,v183
v_cvt_pk_bf16_f32 v187,v190,v191
v_max3_f32 v243,v228,v229,v230
v_max_f32 v243,v243,v231
v_cmp_lt_f32 vcc,s54,v243
s_cbranch_vccnz RS_131
RS_131_RET:
v_add_f32 v224,v224,v228
v_add_f32 v225,v225,v229
v_add_f32 v226,v226,v230
v_add_f32 v227,v227,v231
v_mfma_f32_16x16x32_bf16 a[0:3],v[208:211],v[160:163],a[0:3]
v_mov_b32 v228,v224
v_mov_b32 v229,v225
v_mov_b32 v230,v226
v_mfma_f32_16x16x32_bf16 a[4:7],v[208:211],v[168:171],a[4:7]
v_mov_b32 v231,v227
v_permlane32_swap_b32 v224,v228
v_permlane32_swap_b32 v225,v229
v_mfma_f32_16x16x32_bf16 a[8:11],v[208:211],v[176:179],a[8:11]
s_waitcnt lgkmcnt(4)
buffer_load_dword v236,off,s[20:23],s60 sc1
v_mfma_f32_16x16x32_bf16 a[12:15],v[208:211],v[184:187],a[12:15]
ds_read_b64_tr_b16 v[208:209],v233 offset:52352
ds_read_b64_tr_b16 v[210:211],v233 offset:61056
v_permlane32_swap_b32 v226,v230
v_mfma_f32_16x16x32_bf16 a[28:31],v[212:215],v[184:187],a[28:31]
s_add_u32 m0,s32,69632
s_mov_b32 s34,256
v_permlane32_swap_b32 v227,v231
v_mfma_f32_16x16x32_bf16 a[24:27],v[212:215],v[176:179],a[24:27]
buffer_load_dwordx4 v235,s[24:27],s34 offen  lds
v_add_f32 v224,v224,v228
v_mfma_f32_16x16x32_bf16 a[20:23],v[212:215],v[168:171],a[20:23]
s_waitcnt lgkmcnt(4)
v_add_f32 v225,v225,v229
v_add_f32 v226,v226,v230
v_mfma_f32_16x16x32_bf16 a[16:19],v[212:215],v[160:163],a[16:19]
ds_read_b64_tr_b16 v[212:213],v234 offset:52384
ds_read_b64_tr_b16 v[214:215],v234 offset:61088
v_add_f32 v227,v227,v231
v_mfma_f32_16x16x32_bf16 a[32:35],v[216:219],v[160:163],a[32:35]
v_mov_b32 v228,v224
v_mov_b32 v229,v225
v_mov_b32 v230,v226
v_mfma_f32_16x16x32_bf16 a[36:39],v[216:219],v[168:171],a[36:39]
v_mov_b32 v231,v227
v_permlane16_swap_b32 v224,v228
v_permlane16_swap_b32 v225,v229
v_mfma_f32_16x16x32_bf16 a[40:43],v[216:219],v[176:179],a[40:43]
s_waitcnt lgkmcnt(4)
v_permlane16_swap_b32 v226,v230
v_permlane16_swap_b32 v227,v231
v_accvgpr_read_b32 v128,a0
v_accvgpr_read_b32 v129,a1
v_mfma_f32_16x16x32_bf16 a[44:47],v[216:219],v[184:187],a[44:47]
ds_read_b64_tr_b16 v[216:217],v233 offset:52416
ds_read_b64_tr_b16 v[218:219],v233 offset:61120
v_add_f32 v224,v224,v228
v_accvgpr_read_b32 v130,a2
v_accvgpr_read_b32 v131,a3
v_mfma_f32_16x16x32_bf16 a[60:63],v[220:223],v[184:187],a[60:63]
s_add_u32 m0,s32,70720
s_mov_b32 s34,7424
v_add_f32 v225,v225,v229
v_accvgpr_read_b32 v132,a16
v_accvgpr_read_b32 v133,a17
v_mfma_f32_16x16x32_bf16 a[56:59],v[220:223],v[176:179],a[56:59]
buffer_load_dwordx4 v235,s[24:27],s34 offen  lds
v_add_f32 v226,v226,v230
v_accvgpr_read_b32 v134,a18
v_accvgpr_read_b32 v135,a19
v_mfma_f32_16x16x32_bf16 a[52:55],v[220:223],v[168:171],a[52:55]
s_waitcnt lgkmcnt(4)
v_add_f32 v227,v227,v231
v_mbcnt_lo_u32_b32 v243,-1,0
v_cvt_pk_bf16_f32 v0,v128,v129
v_cvt_pk_bf16_f32 v1,v130,v131
v_mfma_f32_16x16x32_bf16 a[48:51],v[220:223],v[160:163],a[48:51]
ds_read_b64_tr_b16 v[220:221],v234 offset:52448
ds_read_b64_tr_b16 v[222:223],v234 offset:61152
v_mbcnt_hi_u32_b32 v243,-1,v243
v_cvt_pk_bf16_f32 v2,v132,v133
v_cvt_pk_bf16_f32 v3,v134,v135
v_mfma_f32_16x16x32_bf16 a[64:67],v[208:211],v[160:163],a[64:67]
v_rcp_f32 v224,v224
v_and_b32 v243,15,v243
v_accvgpr_read_b32 v136,a4
v_accvgpr_read_b32 v137,a5
v_mfma_f32_16x16x32_bf16 a[68:71],v[208:211],v[168:171],a[68:71]
v_rcp_f32 v225,v225
v_lshl_add_u32 v255,v243,2,s99
v_accvgpr_read_b32 v138,a6
v_accvgpr_read_b32 v139,a7
v_mfma_f32_16x16x32_bf16 a[72:75],v[208:211],v[176:179],a[72:75]
s_waitcnt lgkmcnt(4)
v_rcp_f32 v226,v226
v_accvgpr_read_b32 v140,a20
v_accvgpr_read_b32 v141,a21
v_mfma_f32_16x16x32_bf16 a[76:79],v[208:211],v[184:187],a[76:79]
ds_read_b64_tr_b16 v[208:209],v233 offset:52480
ds_read_b64_tr_b16 v[210:211],v233 offset:61184
v_mul_i32_i24 v243,0,v243
v_accvgpr_read_b32 v142,a22
v_accvgpr_read_b32 v143,a23
v_mfma_f32_16x16x32_bf16 a[92:95],v[212:215],v[184:187],a[92:95]
s_add_u32 m0,s32,71808
s_mov_b32 s34,14592
v_cvt_pk_bf16_f32 v4,v136,v137
v_cvt_pk_bf16_f32 v5,v138,v139
v_cvt_pk_bf16_f32 v6,v140,v141
v_mfma_f32_16x16x32_bf16 a[88:91],v[212:215],v[176:179],a[88:91]
buffer_load_dwordx4 v235,s[24:27],s34 offen  lds
v_cvt_pk_bf16_f32 v7,v142,v143
v_accvgpr_read_b32 v144,a8
v_accvgpr_read_b32 v145,a9
v_mfma_f32_16x16x32_bf16 a[84:87],v[212:215],v[168:171],a[84:87]
s_waitcnt lgkmcnt(4)
v_rcp_f32 v227,v227
v_accvgpr_read_b32 v146,a10
v_accvgpr_read_b32 v147,a11
v_mfma_f32_16x16x32_bf16 a[80:83],v[212:215],v[160:163],a[80:83]
ds_read_b64_tr_b16 v[212:213],v234 offset:52512
ds_read_b64_tr_b16 v[214:215],v234 offset:61216
v_accvgpr_read_b32 v148,a24
v_accvgpr_read_b32 v149,a25
v_accvgpr_read_b32 v150,a26
v_mfma_f32_16x16x32_bf16 a[96:99],v[216:219],v[160:163],a[96:99]
v_accvgpr_read_b32 v151,a27
v_cvt_pk_bf16_f32 v8,v144,v145
v_cvt_pk_bf16_f32 v9,v146,v147
v_cvt_pk_bf16_f32 v10,v148,v149
v_cvt_pk_bf16_f32 v11,v150,v151
v_mfma_f32_16x16x32_bf16 a[100:103],v[216:219],v[168:171],a[100:103]
v_accvgpr_read_b32 v152,a12
v_accvgpr_read_b32 v153,a13
v_accvgpr_read_b32 v154,a14
v_accvgpr_read_b32 v155,a15
v_accvgpr_read_b32 v156,a28
v_mfma_f32_16x16x32_bf16 a[104:107],v[216:219],v[176:179],a[104:107]
s_waitcnt lgkmcnt(4)
v_accvgpr_read_b32 v157,a29
v_accvgpr_read_b32 v158,a30
v_accvgpr_read_b32 v159,a31
v_cvt_pk_bf16_f32 v12,v152,v153
v_mfma_f32_16x16x32_bf16 a[108:111],v[216:219],v[184:187],a[108:111]
ds_read_b64_tr_b16 v[216:217],v233 offset:52544
ds_read_b64_tr_b16 v[218:219],v233 offset:61248
v_cvt_pk_bf16_f32 v13,v154,v155
v_cvt_pk_bf16_f32 v14,v156,v157
v_cvt_pk_bf16_f32 v15,v158,v159
v_mfma_f32_16x16x32_bf16 a[124:127],v[220:223],v[184:187],a[124:127]
s_add_u32 m0,s32,72896
s_mov_b32 s34,21760
v_accvgpr_read_b32 v128,a32
v_accvgpr_read_b32 v129,a33
v_accvgpr_read_b32 v130,a34
v_mfma_f32_16x16x32_bf16 a[120:123],v[220:223],v[176:179],a[120:123]
buffer_load_dwordx4 v235,s[24:27],s34 offen  lds
v_accvgpr_read_b32 v131,a35
v_accvgpr_read_b32 v132,a48
v_accvgpr_read_b32 v133,a49
v_mfma_f32_16x16x32_bf16 a[116:119],v[220:223],v[168:171],a[116:119]
s_waitcnt lgkmcnt(4)
v_accvgpr_read_b32 v134,a50
v_accvgpr_read_b32 v135,a51
v_cvt_pk_bf16_f32 v16,v128,v129
v_cvt_pk_bf16_f32 v17,v130,v131
v_mfma_f32_16x16x32_bf16 a[112:115],v[220:223],v[160:163],a[112:115]
ds_read_b64_tr_b16 v[220:221],v234 offset:52576
ds_read_b64_tr_b16 v[222:223],v234 offset:61280
v_cvt_pk_bf16_f32 v18,v132,v133
v_cvt_pk_bf16_f32 v19,v134,v135
v_accvgpr_read_b32 v136,a36
v_mfma_f32_16x16x32_bf16 a[128:131],v[208:211],v[160:163],a[128:131]
v_accvgpr_read_b32 v137,a37
v_accvgpr_read_b32 v138,a38
v_accvgpr_read_b32 v139,a39
v_accvgpr_read_b32 v140,a52
v_accvgpr_read_b32 v141,a53
v_mfma_f32_16x16x32_bf16 a[132:135],v[208:211],v[168:171],a[132:135]
v_accvgpr_read_b32 v142,a54
v_accvgpr_read_b32 v143,a55
v_cvt_pk_bf16_f32 v20,v136,v137
v_cvt_pk_bf16_f32 v21,v138,v139
v_cvt_pk_bf16_f32 v22,v140,v141
v_mfma_f32_16x16x32_bf16 a[136:139],v[208:211],v[176:179],a[136:139]
s_waitcnt lgkmcnt(4)
v_cvt_pk_bf16_f32 v23,v142,v143
v_accvgpr_read_b32 v144,a40
v_accvgpr_read_b32 v145,a41
v_accvgpr_read_b32 v146,a42
v_mfma_f32_16x16x32_bf16 a[140:143],v[208:211],v[184:187],a[140:143]
ds_read_b64_tr_b16 v[208:209],v233 offset:52608
ds_read_b64_tr_b16 v[210:211],v233 offset:61312
v_accvgpr_read_b32 v147,a43
v_accvgpr_read_b32 v148,a56
v_accvgpr_read_b32 v149,a57
v_mfma_f32_16x16x32_bf16 a[156:159],v[212:215],v[184:187],a[156:159]
v_accvgpr_read_b32 v150,a58
v_accvgpr_read_b32 v151,a59
v_cvt_pk_bf16_f32 v24,v144,v145
v_cvt_pk_bf16_f32 v25,v146,v147
v_cvt_pk_bf16_f32 v26,v148,v149
v_mfma_f32_16x16x32_bf16 a[152:155],v[212:215],v[176:179],a[152:155]
v_cvt_pk_bf16_f32 v27,v150,v151
v_accvgpr_read_b32 v152,a44
v_accvgpr_read_b32 v153,a45
v_accvgpr_read_b32 v154,a46
v_accvgpr_read_b32 v155,a47
v_mfma_f32_16x16x32_bf16 a[148:151],v[212:215],v[168:171],a[148:151]
s_waitcnt lgkmcnt(4)
v_accvgpr_read_b32 v156,a60
v_accvgpr_read_b32 v157,a61
v_accvgpr_read_b32 v158,a62
v_accvgpr_read_b32 v159,a63
v_mfma_f32_16x16x32_bf16 a[144:147],v[212:215],v[160:163],a[144:147]
ds_read_b64_tr_b16 v[212:213],v234 offset:52640
ds_read_b64_tr_b16 v[214:215],v234 offset:61344
v_cvt_pk_bf16_f32 v28,v152,v153
v_cvt_pk_bf16_f32 v29,v154,v155
v_cvt_pk_bf16_f32 v30,v156,v157
v_mfma_f32_16x16x32_bf16 a[160:163],v[216:219],v[160:163],a[160:163]
v_cvt_pk_bf16_f32 v31,v158,v159
v_accvgpr_read_b32 v128,a64
v_accvgpr_read_b32 v129,a65
v_accvgpr_read_b32 v130,a66
v_accvgpr_read_b32 v131,a67
v_mfma_f32_16x16x32_bf16 a[164:167],v[216:219],v[168:171],a[164:167]
v_accvgpr_read_b32 v132,a80
v_accvgpr_read_b32 v133,a81
v_accvgpr_read_b32 v134,a82
v_accvgpr_read_b32 v135,a83
v_cvt_pk_bf16_f32 v32,v128,v129
v_mfma_f32_16x16x32_bf16 a[168:171],v[216:219],v[176:179],a[168:171]
s_waitcnt lgkmcnt(4)
v_cvt_pk_bf16_f32 v33,v130,v131
v_cvt_pk_bf16_f32 v34,v132,v133
v_cvt_pk_bf16_f32 v35,v134,v135
v_accvgpr_read_b32 v136,a68
v_mfma_f32_16x16x32_bf16 a[172:175],v[216:219],v[184:187],a[172:175]
ds_read_b64_tr_b16 v[216:217],v233 offset:52672
ds_read_b64_tr_b16 v[218:219],v233 offset:61376
v_accvgpr_read_b32 v137,a69
v_accvgpr_read_b32 v138,a70
v_accvgpr_read_b32 v139,a71
v_mfma_f32_16x16x32_bf16 a[188:191],v[220:223],v[184:187],a[188:191]
v_accvgpr_read_b32 v140,a84
v_accvgpr_read_b32 v141,a85
v_accvgpr_read_b32 v142,a86
v_accvgpr_read_b32 v143,a87
v_cvt_pk_bf16_f32 v36,v136,v137
v_mfma_f32_16x16x32_bf16 a[184:187],v[220:223],v[176:179],a[184:187]
v_cvt_pk_bf16_f32 v37,v138,v139
v_cvt_pk_bf16_f32 v38,v140,v141
v_cvt_pk_bf16_f32 v39,v142,v143
v_accvgpr_read_b32 v144,a72
v_accvgpr_read_b32 v145,a73
v_mfma_f32_16x16x32_bf16 a[180:183],v[220:223],v[168:171],a[180:183]
s_waitcnt lgkmcnt(4)
v_accvgpr_read_b32 v146,a74
v_accvgpr_read_b32 v147,a75
v_accvgpr_read_b32 v148,a88
v_accvgpr_read_b32 v149,a89
v_mfma_f32_16x16x32_bf16 a[176:179],v[220:223],v[160:163],a[176:179]
ds_read_b64_tr_b16 v[220:221],v234 offset:52704
ds_read_b64_tr_b16 v[222:223],v234 offset:61408
v_accvgpr_read_b32 v150,a90
v_accvgpr_read_b32 v151,a91
v_cvt_pk_bf16_f32 v40,v144,v145
v_mfma_f32_16x16x32_bf16 a[192:195],v[208:211],v[160:163],a[192:195]
v_cvt_pk_bf16_f32 v41,v146,v147
v_cvt_pk_bf16_f32 v42,v148,v149
v_cvt_pk_bf16_f32 v43,v150,v151
v_accvgpr_read_b32 v152,a76
v_accvgpr_read_b32 v153,a77
v_mfma_f32_16x16x32_bf16 a[196:199],v[208:211],v[168:171],a[196:199]
v_accvgpr_read_b32 v154,a78
v_accvgpr_read_b32 v155,a79
v_accvgpr_read_b32 v156,a92
v_accvgpr_read_b32 v157,a93
v_accvgpr_read_b32 v158,a94
v_mfma_f32_16x16x32_bf16 a[200:203],v[208:211],v[176:179],a[200:203]
s_waitcnt vmcnt(14) lgkmcnt(4)
s_barrier
v_accvgpr_read_b32 v159,a95
v_cvt_pk_bf16_f32 v44,v152,v153
v_cvt_pk_bf16_f32 v45,v154,v155
v_mfma_f32_16x16x32_bf16 a[204:207],v[208:211],v[184:187],a[204:207]
ds_read_b64_tr_b16 v[208:209],v238 offset:0
ds_read_b64_tr_b16 v[210:211],v238 offset:2176
v_cvt_pk_bf16_f32 v46,v156,v157
v_cvt_pk_bf16_f32 v47,v158,v159
v_accvgpr_read_b32 v128,a96
v_mfma_f32_16x16x32_bf16 a[220:223],v[212:215],v[184:187],a[220:223]
v_accvgpr_read_b32 v129,a97
v_accvgpr_read_b32 v130,a98
v_accvgpr_read_b32 v131,a99
v_accvgpr_read_b32 v132,a112
v_accvgpr_read_b32 v133,a113
v_mfma_f32_16x16x32_bf16 a[216:219],v[212:215],v[176:179],a[216:219]
v_mbcnt_lo_u32_b32 v231,-1,0
v_min_u32 v231,31,v231
v_accvgpr_read_b32 v134,a114
v_accvgpr_read_b32 v135,a115
v_cvt_pk_bf16_f32 v48,v128,v129
v_mfma_f32_16x16x32_bf16 a[212:215],v[212:215],v[168:171],a[212:215]
s_waitcnt lgkmcnt(4)
v_lshlrev_b32 v231,7,v231
v_cvt_pk_bf16_f32 v49,v130,v131
v_cvt_pk_bf16_f32 v50,v132,v133
v_cvt_pk_bf16_f32 v51,v134,v135
v_mfma_f32_16x16x32_bf16 a[208:211],v[212:215],v[160:163],a[208:211]
ds_read_b64_tr_b16 v[212:213],v239 offset:0
ds_read_b64_tr_b16 v[214:215],v239 offset:2176
v_accvgpr_read_b32 v136,a100
v_accvgpr_read_b32 v137,a101
v_accvgpr_read_b32 v138,a102
v_mfma_f32_16x16x32_bf16 a[224:227],v[216:219],v[160:163],a[224:227]
s_add_u32 s36,s36,16384
s_mov_b32 m0,156672
v_accvgpr_read_b32 v139,a103
v_accvgpr_read_b32 v140,a116
v_accvgpr_read_b32 v141,a117
v_mfma_f32_16x16x32_bf16 a[228:231],v[216:219],v[168:171],a[228:231]
buffer_load_dword v231,s[28:31],s36 offen  lds
v_accvgpr_read_b32 v142,a118
v_accvgpr_read_b32 v143,a119
v_cvt_pk_bf16_f32 v52,v136,v137
v_mfma_f32_16x16x32_bf16 a[232:235],v[216:219],v[176:179],a[232:235]
s_waitcnt lgkmcnt(4)
v_cvt_pk_bf16_f32 v53,v138,v139
v_cvt_pk_bf16_f32 v54,v140,v141
v_cvt_pk_bf16_f32 v55,v142,v143
v_accvgpr_read_b32 v144,a104
v_mfma_f32_16x16x32_bf16 a[236:239],v[216:219],v[184:187],a[236:239]
ds_read_b64_tr_b16 v[216:217],v238 offset:4352
ds_read_b64_tr_b16 v[218:219],v238 offset:6528
v_accvgpr_read_b32 v145,a105
v_accvgpr_read_b32 v146,a106
v_accvgpr_read_b32 v147,a107
v_mfma_f32_16x16x32_bf16 a[252:255],v[220:223],v[184:187],a[252:255]
v_accvgpr_read_b32 v148,a120
v_accvgpr_read_b32 v149,a121
v_accvgpr_read_b32 v150,a122
v_accvgpr_read_b32 v151,a123
v_cvt_pk_bf16_f32 v56,v144,v145
v_mfma_f32_16x16x32_bf16 a[248:251],v[220:223],v[176:179],a[248:251]
v_cvt_pk_bf16_f32 v57,v146,v147
v_cvt_pk_bf16_f32 v58,v148,v149
v_cvt_pk_bf16_f32 v59,v150,v151
v_mfma_f32_16x16x32_bf16 a[244:247],v[220:223],v[168:171],a[244:247]
s_waitcnt lgkmcnt(4)
v_mfma_f32_16x16x32_bf16 a[240:243],v[220:223],v[160:163],a[240:243]
ds_read_b64_tr_b16 v[220:221],v239 offset:4352
ds_read_b64_tr_b16 v[222:223],v239 offset:6528
ds_read_b64_tr_b16 v[192:193],v238 offset:8704
ds_read_b64_tr_b16 v[194:195],v238 offset:10880
ds_read_b64_tr_b16 v[196:197],v239 offset:8704
ds_read_b64_tr_b16 v[198:199],v239 offset:10880
ds_read_b64_tr_b16 v[200:201],v238 offset:13056
ds_read_b64_tr_b16 v[202:203],v238 offset:15232
v_accvgpr_read_b32 v128,a108
v_accvgpr_read_b32 v129,a109
v_accvgpr_read_b32 v130,a110
v_accvgpr_read_b32 v131,a111
v_accvgpr_read_b32 v132,a124
v_accvgpr_read_b32 v133,a125
v_accvgpr_read_b32 v134,a126
v_accvgpr_read_b32 v135,a127
v_cvt_pk_bf16_f32 v60,v128,v129
v_cvt_pk_bf16_f32 v61,v130,v131
v_cvt_pk_bf16_f32 v62,v132,v133
v_cvt_pk_bf16_f32 v63,v134,v135
s_waitcnt lgkmcnt(10)
s_waitcnt vmcnt(5)
v_readfirstlane_b32 s34,v236
s_bitcmp1_b32 s34,5
s_cbranch_scc0 L_DECIDE
L_FAST:
s_mov_b32 s60,0
v_mfma_f32_16x16x32_bf16 v[128:131],v[208:211],v[0:3],0
v_accvgpr_read_b32 v160,a128
v_accvgpr_read_b32 v161,a129
v_accvgpr_read_b32 v162,a130
v_accvgpr_read_b32 v163,a131
v_accvgpr_read_b32 v164,a144
v_mfma_f32_16x16x32_bf16 v[136:139],v[208:211],v[4:7],0
v_accvgpr_read_b32 v165,a145
v_accvgpr_read_b32 v166,a146
v_accvgpr_read_b32 v167,a147
v_cvt_pk_bf16_f32 v64,v160,v161
v_cvt_pk_bf16_f32 v65,v162,v163
v_mfma_f32_16x16x32_bf16 v[144:147],v[208:211],v[8:11],0
v_cvt_pk_bf16_f32 v66,v164,v165
v_cvt_pk_bf16_f32 v67,v166,v167
v_accvgpr_read_b32 v168,a132
v_accvgpr_read_b32 v169,a133
v_accvgpr_read_b32 v170,a134
v_mfma_f32_16x16x32_bf16 v[152:155],v[208:211],v[12:15],0
ds_read_b64_tr_b16 v[204:205],v239 offset:13056
ds_read_b64_tr_b16 v[206:207],v239 offset:15232
v_accvgpr_read_b32 v171,a135
v_accvgpr_read_b32 v172,a148
v_accvgpr_read_b32 v173,a149
v_mfma_f32_16x16x32_bf16 v[132:135],v[212:215],v[0:3],0
v_accvgpr_read_b32 v174,a150
v_accvgpr_read_b32 v175,a151
v_cvt_pk_bf16_f32 v68,v168,v169
v_cvt_pk_bf16_f32 v69,v170,v171
v_cvt_pk_bf16_f32 v70,v172,v173
v_mfma_f32_16x16x32_bf16 v[140:143],v[212:215],v[4:7],0
v_cvt_pk_bf16_f32 v71,v174,v175
v_accvgpr_read_b32 v176,a136
v_accvgpr_read_b32 v177,a137
v_accvgpr_read_b32 v178,a138
v_accvgpr_read_b32 v179,a139
v_mfma_f32_16x16x32_bf16 v[148:151],v[212:215],v[8:11],0
s_waitcnt lgkmcnt(8)
v_accvgpr_read_b32 v180,a152
v_accvgpr_read_b32 v181,a153
v_accvgpr_read_b32 v182,a154
v_accvgpr_read_b32 v183,a155
v_mfma_f32_16x16x32_bf16 v[156:159],v[212:215],v[12:15],0
ds_read_b64_tr_b16 v[208:209],v238 offset:17408
ds_read_b64_tr_b16 v[210:211],v238 offset:19584
v_cvt_pk_bf16_f32 v72,v176,v177
v_cvt_pk_bf16_f32 v73,v178,v179
v_cvt_pk_bf16_f32 v74,v180,v181
v_mfma_f32_16x16x32_bf16 v[128:131],v[216:219],v[16:19],v[128:131]
v_cvt_pk_bf16_f32 v75,v182,v183
v_accvgpr_read_b32 v184,a140
v_accvgpr_read_b32 v185,a141
v_accvgpr_read_b32 v186,a142
v_accvgpr_read_b32 v187,a143
v_mfma_f32_16x16x32_bf16 v[136:139],v[216:219],v[20:23],v[136:139]
v_accvgpr_read_b32 v188,a156
v_accvgpr_read_b32 v189,a157
v_accvgpr_read_b32 v190,a158
v_accvgpr_read_b32 v191,a159
v_cvt_pk_bf16_f32 v76,v184,v185
v_mfma_f32_16x16x32_bf16 v[144:147],v[216:219],v[24:27],v[144:147]
v_cvt_pk_bf16_f32 v77,v186,v187
v_cvt_pk_bf16_f32 v78,v188,v189
v_cvt_pk_bf16_f32 v79,v190,v191
v_accvgpr_read_b32 v160,a160
v_accvgpr_read_b32 v161,a161
v_mfma_f32_16x16x32_bf16 v[152:155],v[216:219],v[28:31],v[152:155]
ds_read_b64_tr_b16 v[212:213],v239 offset:17408
ds_read_b64_tr_b16 v[214:215],v239 offset:19584
v_accvgpr_read_b32 v162,a162
v_accvgpr_read_b32 v163,a163
v_accvgpr_read_b32 v164,a176
v_mfma_f32_16x16x32_bf16 v[132:135],v[220:223],v[16:19],v[132:135]
v_accvgpr_read_b32 v165,a177
v_accvgpr_read_b32 v166,a178
v_accvgpr_read_b32 v167,a179
v_cvt_pk_bf16_f32 v80,v160,v161
v_cvt_pk_bf16_f32 v81,v162,v163
v_mfma_f32_16x16x32_bf16 v[140:143],v[220:223],v[20:23],v[140:143]
v_cvt_pk_bf16_f32 v82,v164,v165
v_cvt_pk_bf16_f32 v83,v166,v167
v_accvgpr_read_b32 v168,a164
v_accvgpr_read_b32 v169,a165
v_accvgpr_read_b32 v170,a166
v_mfma_f32_16x16x32_bf16 v[148:151],v[220:223],v[24:27],v[148:151]
s_waitcnt lgkmcnt(8)
v_accvgpr_read_b32 v171,a167
v_accvgpr_read_b32 v172,a180
v_accvgpr_read_b32 v173,a181
v_accvgpr_read_b32 v174,a182
v_mfma_f32_16x16x32_bf16 v[156:159],v[220:223],v[28:31],v[156:159]
ds_read_b64_tr_b16 v[216:217],v238 offset:21760
ds_read_b64_tr_b16 v[218:219],v238 offset:23936
v_accvgpr_read_b32 v175,a183
v_cvt_pk_bf16_f32 v84,v168,v169
v_cvt_pk_bf16_f32 v85,v170,v171
v_mfma_f32_16x16x32_bf16 v[128:131],v[192:195],v[32:35],v[128:131]
s_add_u32 m0,s32,87040
s_mov_b32 s34,114944
v_cvt_pk_bf16_f32 v86,v172,v173
v_cvt_pk_bf16_f32 v87,v174,v175
v_accvgpr_read_b32 v176,a168
v_mfma_f32_16x16x32_bf16 v[136:139],v[192:195],v[36:39],v[136:139]
buffer_load_dwordx4 v235,s[24:27],s34 offen  lds
v_accvgpr_read_b32 v177,a169
v_accvgpr_read_b32 v178,a170
v_accvgpr_read_b32 v179,a171
v_mfma_f32_16x16x32_bf16 v[144:147],v[192:195],v[40:43],v[144:147]
v_accvgpr_read_b32 v180,a184
v_accvgpr_read_b32 v181,a185
v_accvgpr_read_b32 v182,a186
v_accvgpr_read_b32 v183,a187
v_cvt_pk_bf16_f32 v88,v176,v177
v_mfma_f32_16x16x32_bf16 v[152:155],v[192:195],v[44:47],v[152:155]
ds_read_b64_tr_b16 v[220:221],v239 offset:21760
ds_read_b64_tr_b16 v[222:223],v239 offset:23936
v_cvt_pk_bf16_f32 v89,v178,v179
v_cvt_pk_bf16_f32 v90,v180,v181
v_cvt_pk_bf16_f32 v91,v182,v183
v_mfma_f32_16x16x32_bf16 v[132:135],v[196:199],v[32:35],v[132:135]
s_add_u32 m0,s32,88128
s_mov_b32 s34,122112
v_accvgpr_read_b32 v184,a172
v_accvgpr_read_b32 v185,a173
v_accvgpr_read_b32 v186,a174
v_mfma_f32_16x16x32_bf16 v[140:143],v[196:199],v[36:39],v[140:143]
buffer_load_dwordx4 v235,s[24:27],s34 offen  lds
v_accvgpr_read_b32 v187,a175
v_accvgpr_read_b32 v188,a188
v_accvgpr_read_b32 v189,a189
v_mfma_f32_16x16x32_bf16 v[148:151],v[196:199],v[40:43],v[148:151]
s_waitcnt lgkmcnt(8)
v_accvgpr_read_b32 v190,a190
v_accvgpr_read_b32 v191,a191
v_cvt_pk_bf16_f32 v92,v184,v185
v_cvt_pk_bf16_f32 v93,v186,v187
v_mfma_f32_16x16x32_bf16 v[156:159],v[196:199],v[44:47],v[156:159]
ds_read_b64_tr_b16 v[192:193],v238 offset:26112
ds_read_b64_tr_b16 v[194:195],v238 offset:28288
v_cvt_pk_bf16_f32 v94,v188,v189
v_cvt_pk_bf16_f32 v95,v190,v191
v_accvgpr_read_b32 v160,a192
v_mfma_f32_16x16x32_bf16 v[128:131],v[200:203],v[48:51],v[128:131]
v_accvgpr_read_b32 v161,a193
v_accvgpr_read_b32 v162,a194
v_accvgpr_read_b32 v163,a195
v_accvgpr_read_b32 v164,a208
v_accvgpr_read_b32 v165,a209
v_mfma_f32_16x16x32_bf16 v[136:139],v[200:203],v[52:55],v[136:139]
v_accvgpr_read_b32 v166,a210
v_accvgpr_read_b32 v167,a211
v_cvt_pk_bf16_f32 v96,v160,v161
v_cvt_pk_bf16_f32 v97,v162,v163
v_cvt_pk_bf16_f32 v98,v164,v165
v_mfma_f32_16x16x32_bf16 v[144:147],v[200:203],v[56:59],v[144:147]
v_cvt_pk_bf16_f32 v99,v166,v167
v_accvgpr_read_b32 v168,a196
v_accvgpr_read_b32 v169,a197
v_accvgpr_read_b32 v170,a198
v_accvgpr_read_b32 v171,a199
v_mfma_f32_16x16x32_bf16 v[152:155],v[200:203],v[60:63],v[152:155]
ds_read_b64_tr_b16 v[196:197],v239 offset:26112
ds_read_b64_tr_b16 v[198:199],v239 offset:28288
v_accvgpr_read_b32 v172,a212
v_accvgpr_read_b32 v173,a213
v_accvgpr_read_b32 v174,a214
v_mfma_f32_16x16x32_bf16 v[132:135],v[204:207],v[48:51],v[132:135]
s_add_u32 m0,s32,89216
s_mov_b32 s34,129280
v_accvgpr_read_b32 v175,a215
v_cvt_pk_bf16_f32 v100,v168,v169
v_cvt_pk_bf16_f32 v101,v170,v171
v_mfma_f32_16x16x32_bf16 v[140:143],v[204:207],v[52:55],v[140:143]
buffer_load_dwordx4 v235,s[24:27],s34 offen  lds
v_cvt_pk_bf16_f32 v102,v172,v173
v_cvt_pk_bf16_f32 v103,v174,v175
v_accvgpr_read_b32 v176,a200
v_mfma_f32_16x16x32_bf16 v[148:151],v[204:207],v[56:59],v[148:151]
s_waitcnt lgkmcnt(8)
v_accvgpr_read_b32 v177,a201
v_accvgpr_read_b32 v178,a202
v_accvgpr_read_b32 v179,a203
v_accvgpr_read_b32 v180,a216
v_mfma_f32_16x16x32_bf16 v[156:159],v[204:207],v[60:63],v[156:159]
ds_read_b64_tr_b16 v[200:201],v238 offset:30464
ds_read_b64_tr_b16 v[202:203],v238 offset:32640
v_accvgpr_read_b32 v181,a217
v_accvgpr_read_b32 v182,a218
v_accvgpr_read_b32 v183,a219
v_mfma_f32_16x16x32_bf16 v[128:131],v[208:211],v[64:67],v[128:131]
s_add_u32 m0,s32,90304
s_mov_b32 s34,136448
v_cvt_pk_bf16_f32 v104,v176,v177
v_cvt_pk_bf16_f32 v105,v178,v179
v_cvt_pk_bf16_f32 v106,v180,v181
v_mfma_f32_16x16x32_bf16 v[136:139],v[208:211],v[68:71],v[136:139]
buffer_load_dwordx4 v235,s[24:27],s34 offen  lds
v_cvt_pk_bf16_f32 v107,v182,v183
v_accvgpr_read_b32 v184,a204
v_accvgpr_read_b32 v185,a205
v_mfma_f32_16x16x32_bf16 v[144:147],v[208:211],v[72:75],v[144:147]
v_accvgpr_read_b32 v186,a206
v_accvgpr_read_b32 v187,a207
v_accvgpr_read_b32 v188,a220
v_accvgpr_read_b32 v189,a221
v_accvgpr_read_b32 v190,a222
v_mfma_f32_16x16x32_bf16 v[152:155],v[208:211],v[76:79],v[152:155]
ds_read_b64_tr_b16 v[204:205],v239 offset:30464
ds_read_b64_tr_b16 v[206:207],v239 offset:32640
v_accvgpr_read_b32 v191,a223
v_cvt_pk_bf16_f32 v108,v184,v185
v_cvt_pk_bf16_f32 v109,v186,v187
v_mfma_f32_16x16x32_bf16 v[132:135],v[212:215],v[64:67],v[132:135]
v_subrev_u32 v238,121856,v238
v_subrev_u32 v239,121856,v239
v_cvt_pk_bf16_f32 v110,v188,v189
v_cvt_pk_bf16_f32 v111,v190,v191
v_accvgpr_read_b32 v160,a224
v_mfma_f32_16x16x32_bf16 v[140:143],v[212:215],v[68:71],v[140:143]
v_accvgpr_read_b32 v161,a225
v_accvgpr_read_b32 v162,a226
v_accvgpr_read_b32 v163,a227
v_accvgpr_read_b32 v164,a240
v_accvgpr_read_b32 v165,a241
v_mfma_f32_16x16x32_bf16 v[148:151],v[212:215],v[72:75],v[148:151]
s_waitcnt lgkmcnt(8)
v_accvgpr_read_b32 v166,a242
v_accvgpr_read_b32 v167,a243
v_cvt_pk_bf16_f32 v112,v160,v161
v_cvt_pk_bf16_f32 v113,v162,v163
v_mfma_f32_16x16x32_bf16 v[156:159],v[212:215],v[76:79],v[156:159]
ds_read_b64_tr_b16 v[208:209],v240 offset:0
ds_read_b64_tr_b16 v[210:211],v240 offset:2176
v_cvt_pk_bf16_f32 v114,v164,v165
v_cvt_pk_bf16_f32 v115,v166,v167
v_accvgpr_read_b32 v168,a228
v_mfma_f32_16x16x32_bf16 v[128:131],v[216:219],v[80:83],v[128:131]
v_accvgpr_read_b32 v169,a229
v_accvgpr_read_b32 v170,a230
v_accvgpr_read_b32 v171,a231
v_accvgpr_read_b32 v172,a244
v_accvgpr_read_b32 v173,a245
v_mfma_f32_16x16x32_bf16 v[136:139],v[216:219],v[84:87],v[136:139]
v_accvgpr_read_b32 v174,a246
v_accvgpr_read_b32 v175,a247
v_cvt_pk_bf16_f32 v116,v168,v169
v_cvt_pk_bf16_f32 v117,v170,v171
v_cvt_pk_bf16_f32 v118,v172,v173
v_mfma_f32_16x16x32_bf16 v[144:147],v[216:219],v[88:91],v[144:147]
v_cvt_pk_bf16_f32 v119,v174,v175
v_accvgpr_read_b32 v176,a232
v_accvgpr_read_b32 v177,a233
v_accvgpr_read_b32 v178,a234
v_accvgpr_read_b32 v179,a235
v_mfma_f32_16x16x32_bf16 v[152:155],v[216:219],v[92:95],v[152:155]
ds_read_b64_tr_b16 v[212:213],v240 offset:4352
ds_read_b64_tr_b16 v[214:215],v240 offset:6528
v_accvgpr_read_b32 v180,a248
v_accvgpr_read_b32 v181,a249
v_accvgpr_read_b32 v182,a250
v_mfma_f32_16x16x32_bf16 v[132:135],v[220:223],v[80:83],v[132:135]
v_accvgpr_read_b32 v183,a251
v_cvt_pk_bf16_f32 v120,v176,v177
v_cvt_pk_bf16_f32 v121,v178,v179
v_cvt_pk_bf16_f32 v122,v180,v181
v_cvt_pk_bf16_f32 v123,v182,v183
v_mfma_f32_16x16x32_bf16 v[140:143],v[220:223],v[84:87],v[140:143]
v_accvgpr_read_b32 v184,a236
v_accvgpr_read_b32 v185,a237
v_accvgpr_read_b32 v186,a238
v_accvgpr_read_b32 v187,a239
v_accvgpr_read_b32 v188,a252
v_mfma_f32_16x16x32_bf16 v[148:151],v[220:223],v[88:91],v[148:151]
s_waitcnt lgkmcnt(8)
v_accvgpr_read_b32 v189,a253
v_accvgpr_read_b32 v190,a254
v_accvgpr_read_b32 v191,a255
v_cvt_pk_bf16_f32 v124,v184,v185
v_mfma_f32_16x16x32_bf16 v[156:159],v[220:223],v[92:95],v[156:159]
ds_read_b64_tr_b16 v[216:217],v241 offset:0
ds_read_b64_tr_b16 v[218:219],v241 offset:2176
v_cvt_pk_bf16_f32 v125,v186,v187
v_cvt_pk_bf16_f32 v126,v188,v189
v_cvt_pk_bf16_f32 v127,v190,v191
v_mfma_f32_16x16x32_bf16 v[128:131],v[192:195],v[96:99],v[128:131]
v_mfma_f32_16x16x32_bf16 v[136:139],v[192:195],v[100:103],v[136:139]
v_mfma_f32_16x16x32_bf16 v[144:147],v[192:195],v[104:107],v[144:147]
v_mfma_f32_16x16x32_bf16 v[152:155],v[192:195],v[108:111],v[152:155]
ds_read_b64_tr_b16 v[220:221],v241 offset:4352
ds_read_b64_tr_b16 v[222:223],v241 offset:6528
v_mfma_f32_16x16x32_bf16 v[132:135],v[196:199],v[96:99],v[132:135]
v_mfma_f32_16x16x32_bf16 v[140:143],v[196:199],v[100:103],v[140:143]
v_mfma_f32_16x16x32_bf16 v[148:151],v[196:199],v[104:107],v[148:151]
s_waitcnt lgkmcnt(8)
v_mfma_f32_16x16x32_bf16 v[156:159],v[196:199],v[108:111],v[156:159]
ds_read_b64_tr_b16 v[192:193],v240 offset:8704
ds_read_b64_tr_b16 v[194:195],v240 offset:10880
v_mfma_f32_16x16x32_bf16 v[128:131],v[200:203],v[112:115],v[128:131]
v_mfma_f32_16x16x32_bf16 v[136:139],v[200:203],v[116:119],v[136:139]
v_mfma_f32_16x16x32_bf16 v[144:147],v[200:203],v[120:123],v[144:147]
v_mfma_f32_16x16x32_bf16 v[152:155],v[200:203],v[124:127],v[152:155]
ds_read_b64_tr_b16 v[196:197],v240 offset:13056
ds_read_b64_tr_b16 v[198:199],v240 offset:15232
v_mfma_f32_16x16x32_bf16 v[132:135],v[204:207],v[112:115],v[132:135]
v_mfma_f32_16x16x32_bf16 v[140:143],v[204:207],v[116:119],v[140:143]
v_mfma_f32_16x16x32_bf16 v[148:151],v[204:207],v[120:123],v[148:151]
s_waitcnt lgkmcnt(8)
v_mfma_f32_16x16x32_bf16 v[156:159],v[204:207],v[124:127],v[156:159]
ds_read_b64_tr_b16 v[200:201],v241 offset:8704
ds_read_b64_tr_b16 v[202:203],v241 offset:10880
v_mfma_f32_16x16x32_bf16 v[160:163],v[208:211],v[0:3],0
v_mul_f32 v128,v128,v224
v_mul_f32 v129,v129,v224
v_mfma_f32_16x16x32_bf16 v[160:163],v[212:215],v[16:19],v[160:163]
v_cvt_pk_bf16_f32 v128,v128,v129
v_mul_f32 v130,v130,v224
v_mfma_f32_16x16x32_bf16 v[168:171],v[208:211],v[4:7],0
v_mul_f32 v131,v131,v224
v_cvt_pk_bf16_f32 v129,v130,v131
v_mfma_f32_16x16x32_bf16 v[168:171],v[212:215],v[20:23],v[168:171]
ds_read_b64_tr_b16 v[204:205],v241 offset:13056
ds_read_b64_tr_b16 v[206:207],v241 offset:15232
v_mfma_f32_16x16x32_bf16 v[176:179],v[208:211],v[8:11],0
v_mul_f32 v132,v132,v224
v_mul_f32 v133,v133,v224
v_mfma_f32_16x16x32_bf16 v[176:179],v[212:215],v[24:27],v[176:179]
v_cvt_pk_bf16_f32 v130,v132,v133
v_mul_f32 v134,v134,v224
v_mfma_f32_16x16x32_bf16 v[184:187],v[208:211],v[12:15],0
s_waitcnt lgkmcnt(8)
v_mul_f32 v135,v135,v224
v_mfma_f32_16x16x32_bf16 v[184:187],v[212:215],v[28:31],v[184:187]
ds_read_b64_tr_b16 v[208:209],v240 offset:17408
ds_read_b64_tr_b16 v[210:211],v240 offset:19584
v_mfma_f32_16x16x32_bf16 v[164:167],v[216:219],v[0:3],0
v_cvt_pk_bf16_f32 v131,v134,v135
v_mul_f32 v136,v136,v225
v_mfma_f32_16x16x32_bf16 v[164:167],v[220:223],v[16:19],v[164:167]
buffer_store_dwordx4 v[128:131],v242,s[28:31],s55 offen offset:0
v_mfma_f32_16x16x32_bf16 v[172:175],v[216:219],v[4:7],0
v_mul_f32 v137,v137,v225
v_cvt_pk_bf16_f32 v136,v136,v137
v_mfma_f32_16x16x32_bf16 v[172:175],v[220:223],v[20:23],v[172:175]
ds_read_b64_tr_b16 v[212:213],v240 offset:21760
ds_read_b64_tr_b16 v[214:215],v240 offset:23936
v_mfma_f32_16x16x32_bf16 v[180:183],v[216:219],v[8:11],0
v_mul_f32 v138,v138,v225
v_mul_f32 v139,v139,v225
v_mfma_f32_16x16x32_bf16 v[180:183],v[220:223],v[24:27],v[180:183]
v_cvt_pk_bf16_f32 v137,v138,v139
v_mul_f32 v140,v140,v225
v_mfma_f32_16x16x32_bf16 v[188:191],v[216:219],v[12:15],0
s_waitcnt lgkmcnt(8)
v_mul_f32 v141,v141,v225
v_mfma_f32_16x16x32_bf16 v[188:191],v[220:223],v[28:31],v[188:191]
ds_read_b64_tr_b16 v[216:217],v241 offset:17408
ds_read_b64_tr_b16 v[218:219],v241 offset:19584
v_mfma_f32_16x16x32_bf16 v[160:163],v[192:195],v[32:35],v[160:163]
s_add_u32 m0,s32,34816
s_mov_b32 s34,384
v_mfma_f32_16x16x32_bf16 v[160:163],v[196:199],v[48:51],v[160:163]
buffer_load_dwordx4 v235,s[24:27],s34 offen  lds
v_mfma_f32_16x16x32_bf16 v[168:171],v[192:195],v[36:39],v[168:171]
v_cvt_pk_bf16_f32 v138,v140,v141
v_mul_f32 v142,v142,v225
v_mfma_f32_16x16x32_bf16 v[168:171],v[196:199],v[52:55],v[168:171]
ds_read_b64_tr_b16 v[220:221],v241 offset:21760
ds_read_b64_tr_b16 v[222:223],v241 offset:23936
v_mfma_f32_16x16x32_bf16 v[176:179],v[192:195],v[40:43],v[176:179]
s_add_u32 m0,s32,35904
s_mov_b32 s34,7552
v_mfma_f32_16x16x32_bf16 v[176:179],v[196:199],v[56:59],v[176:179]
buffer_load_dwordx4 v235,s[24:27],s34 offen  lds
v_mfma_f32_16x16x32_bf16 v[184:187],v[192:195],v[44:47],v[184:187]
s_waitcnt lgkmcnt(8)
v_mul_f32 v143,v143,v225
v_mfma_f32_16x16x32_bf16 v[184:187],v[196:199],v[60:63],v[184:187]
ds_read_b64_tr_b16 v[192:193],v240 offset:26112
ds_read_b64_tr_b16 v[194:195],v240 offset:28288
v_mfma_f32_16x16x32_bf16 v[164:167],v[200:203],v[32:35],v[164:167]
v_cvt_pk_bf16_f32 v139,v142,v143
v_mul_f32 v144,v144,v226
v_mfma_f32_16x16x32_bf16 v[164:167],v[204:207],v[48:51],v[164:167]
buffer_store_dwordx4 v[136:139],v242,s[28:31],s55 offen offset:1024
v_mfma_f32_16x16x32_bf16 v[172:175],v[200:203],v[36:39],v[172:175]
v_mul_f32 v145,v145,v226
v_cvt_pk_bf16_f32 v144,v144,v145
v_mfma_f32_16x16x32_bf16 v[172:175],v[204:207],v[52:55],v[172:175]
ds_read_b64_tr_b16 v[196:197],v240 offset:30464
ds_read_b64_tr_b16 v[198:199],v240 offset:32640
v_mfma_f32_16x16x32_bf16 v[180:183],v[200:203],v[40:43],v[180:183]
s_add_u32 m0,s32,36992
s_mov_b32 s34,14720
v_mfma_f32_16x16x32_bf16 v[180:183],v[204:207],v[56:59],v[180:183]
buffer_load_dwordx4 v235,s[24:27],s34 offen  lds
v_mfma_f32_16x16x32_bf16 v[188:191],v[200:203],v[44:47],v[188:191]
s_waitcnt lgkmcnt(8)
v_mul_f32 v146,v146,v226
v_mfma_f32_16x16x32_bf16 v[188:191],v[204:207],v[60:63],v[188:191]
ds_read_b64_tr_b16 v[200:201],v241 offset:26112
ds_read_b64_tr_b16 v[202:203],v241 offset:28288
v_mfma_f32_16x16x32_bf16 v[160:163],v[208:211],v[64:67],v[160:163]
s_add_u32 m0,s32,38080
s_mov_b32 s34,21888
v_mfma_f32_16x16x32_bf16 v[160:163],v[212:215],v[80:83],v[160:163]
buffer_load_dwordx4 v235,s[24:27],s34 offen  lds
v_mfma_f32_16x16x32_bf16 v[168:171],v[208:211],v[68:71],v[168:171]
v_mul_f32 v147,v147,v226
v_cvt_pk_bf16_f32 v145,v146,v147
v_mfma_f32_16x16x32_bf16 v[168:171],v[212:215],v[84:87],v[168:171]
ds_read_b64_tr_b16 v[204:205],v241 offset:30464
ds_read_b64_tr_b16 v[206:207],v241 offset:32640
v_mfma_f32_16x16x32_bf16 v[176:179],v[208:211],v[72:75],v[176:179]
v_subrev_u32 v240,121856,v240
v_subrev_u32 v241,121856,v241
v_mfma_f32_16x16x32_bf16 v[176:179],v[212:215],v[88:91],v[176:179]
v_mul_f32 v148,v148,v226
v_mul_f32 v149,v149,v226
v_mfma_f32_16x16x32_bf16 v[184:187],v[208:211],v[76:79],v[184:187]
s_waitcnt vmcnt(16) lgkmcnt(8)
s_barrier
v_mfma_f32_16x16x32_bf16 v[184:187],v[212:215],v[92:95],v[184:187]
ds_read_b64_tr_b16 v[208:209],v238 offset:0
ds_read_b64_tr_b16 v[210:211],v238 offset:2176
v_mfma_f32_16x16x32_bf16 v[164:167],v[216:219],v[64:67],v[164:167]
v_cvt_pk_bf16_f32 v146,v148,v149
v_mul_f32 v150,v150,v226
v_mfma_f32_16x16x32_bf16 v[164:167],v[220:223],v[80:83],v[164:167]
v_mul_f32 v151,v151,v226
v_cvt_pk_bf16_f32 v147,v150,v151
v_mfma_f32_16x16x32_bf16 v[172:175],v[216:219],v[68:71],v[172:175]
buffer_store_dwordx4 v[144:147],v242,s[28:31],s55 offen offset:2048
v_mfma_f32_16x16x32_bf16 v[172:175],v[220:223],v[84:87],v[172:175]
ds_read_b64_tr_b16 v[212:213],v238 offset:4352
ds_read_b64_tr_b16 v[214:215],v238 offset:6528
v_mfma_f32_16x16x32_bf16 v[180:183],v[216:219],v[72:75],v[180:183]
v_mul_f32 v152,v152,v227
v_mul_f32 v153,v153,v227
v_mfma_f32_16x16x32_bf16 v[180:183],v[220:223],v[88:91],v[180:183]
v_cvt_pk_bf16_f32 v152,v152,v153
v_mul_f32 v154,v154,v227
v_mfma_f32_16x16x32_bf16 v[188:191],v[216:219],v[76:79],v[188:191]
s_waitcnt lgkmcnt(8)
v_mul_f32 v155,v155,v227
v_mfma_f32_16x16x32_bf16 v[188:191],v[220:223],v[92:95],v[188:191]
ds_read_b64_tr_b16 v[216:217],v239 offset:0
ds_read_b64_tr_b16 v[218:219],v239 offset:2176
v_mfma_f32_16x16x32_bf16 v[160:163],v[192:195],v[96:99],v[160:163]
v_cvt_pk_bf16_f32 v153,v154,v155
v_mul_f32 v156,v156,v227
v_mfma_f32_16x16x32_bf16 v[160:163],v[196:199],v[112:115],v[160:163]
v_mul_f32 v157,v157,v227
v_cvt_pk_bf16_f32 v154,v156,v157
v_mfma_f32_16x16x32_bf16 v[168:171],v[192:195],v[100:103],v[168:171]
v_mul_f32 v158,v158,v227
v_mul_f32 v159,v159,v227
v_mfma_f32_16x16x32_bf16 v[168:171],v[196:199],v[116:119],v[168:171]
ds_read_b64_tr_b16 v[220:221],v239 offset:4352
ds_read_b64_tr_b16 v[222:223],v239 offset:6528
v_mfma_f32_16x16x32_bf16 v[176:179],v[192:195],v[104:107],v[176:179]
v_cvt_pk_bf16_f32 v155,v158,v159
v_mfma_f32_16x16x32_bf16 v[176:179],v[196:199],v[120:123],v[176:179]
buffer_store_dwordx4 v[152:155],v242,s[28:31],s55 offen offset:3072
v_mfma_f32_16x16x32_bf16 v[184:187],v[192:195],v[108:111],v[184:187]
s_waitcnt lgkmcnt(8)
s_add_u32 s55,s55,16384
v_mfma_f32_16x16x32_bf16 v[184:187],v[196:199],v[124:127],v[184:187]
ds_read_b64_tr_b16 v[192:193],v238 offset:8704
ds_read_b64_tr_b16 v[194:195],v238 offset:10880
v_mfma_f32_16x16x32_bf16 v[164:167],v[200:203],v[96:99],v[164:167]
v_mfma_f32_16x16x32_bf16 v[164:167],v[204:207],v[112:115],v[164:167]
v_mfma_f32_16x16x32_bf16 v[172:175],v[200:203],v[100:103],v[172:175]
v_mfma_f32_16x16x32_bf16 v[172:175],v[204:207],v[116:119],v[172:175]
ds_read_b64_tr_b16 v[196:197],v238 offset:13056
ds_read_b64_tr_b16 v[198:199],v238 offset:15232
v_mfma_f32_16x16x32_bf16 v[180:183],v[200:203],v[104:107],v[180:183]
v_mfma_f32_16x16x32_bf16 v[180:183],v[204:207],v[120:123],v[180:183]
v_mfma_f32_16x16x32_bf16 v[188:191],v[200:203],v[108:111],v[188:191]
s_waitcnt lgkmcnt(8)
v_mfma_f32_16x16x32_bf16 v[188:191],v[204:207],v[124:127],v[188:191]
ds_read_b64_tr_b16 v[200:201],v239 offset:8704
ds_read_b64_tr_b16 v[202:203],v239 offset:10880
v_mfma_f32_16x16x32_bf16 v[128:131],v[208:211],v[0:3],0
v_mul_f32 v160,v160,v224
v_mul_f32 v161,v161,v224
v_mfma_f32_16x16x32_bf16 v[128:131],v[212:215],v[16:19],v[128:131]
v_cvt_pk_bf16_f32 v160,v160,v161
v_mul_f32 v162,v162,v224
v_mfma_f32_16x16x32_bf16 v[136:139],v[208:211],v[4:7],0
v_mul_f32 v163,v163,v224
v_cvt_pk_bf16_f32 v161,v162,v163
v_mfma_f32_16x16x32_bf16 v[136:139],v[212:215],v[20:23],v[136:139]
ds_read_b64_tr_b16 v[204:205],v239 offset:13056
ds_read_b64_tr_b16 v[206:207],v239 offset:15232
v_mfma_f32_16x16x32_bf16 v[144:147],v[208:211],v[8:11],0
v_mul_f32 v164,v164,v224
v_mul_f32 v165,v165,v224
v_mfma_f32_16x16x32_bf16 v[144:147],v[212:215],v[24:27],v[144:147]
v_cvt_pk_bf16_f32 v162,v164,v165
v_mul_f32 v166,v166,v224
v_mfma_f32_16x16x32_bf16 v[152:155],v[208:211],v[12:15],0
s_waitcnt lgkmcnt(8)
v_mul_f32 v167,v167,v224
v_mfma_f32_16x16x32_bf16 v[152:155],v[212:215],v[28:31],v[152:155]
ds_read_b64_tr_b16 v[208:209],v238 offset:17408
ds_read_b64_tr_b16 v[210:211],v238 offset:19584
v_mfma_f32_16x16x32_bf16 v[132:135],v[216:219],v[0:3],0
v_cvt_pk_bf16_f32 v163,v166,v167
v_mul_f32 v168,v168,v225
v_mfma_f32_16x16x32_bf16 v[132:135],v[220:223],v[16:19],v[132:135]
buffer_store_dwordx4 v[160:163],v242,s[28:31],s55 offen offset:0
v_mfma_f32_16x16x32_bf16 v[140:143],v[216:219],v[4:7],0
v_mul_f32 v169,v169,v225
v_cvt_pk_bf16_f32 v168,v168,v169
v_mfma_f32_16x16x32_bf16 v[140:143],v[220:223],v[20:23],v[140:143]
ds_read_b64_tr_b16 v[212:213],v238 offset:21760
ds_read_b64_tr_b16 v[214:215],v238 offset:23936
v_mfma_f32_16x16x32_bf16 v[148:151],v[216:219],v[8:11],0
v_mul_f32 v170,v170,v225
v_mul_f32 v171,v171,v225
v_mfma_f32_16x16x32_bf16 v[148:151],v[220:223],v[24:27],v[148:151]
v_cvt_pk_bf16_f32 v169,v170,v171
v_mul_f32 v172,v172,v225
v_mfma_f32_16x16x32_bf16 v[156:159],v[216:219],v[12:15],0
s_waitcnt lgkmcnt(8)
v_mul_f32 v173,v173,v225
v_mfma_f32_16x16x32_bf16 v[156:159],v[220:223],v[28:31],v[156:159]
ds_read_b64_tr_b16 v[216:217],v239 offset:17408
ds_read_b64_tr_b16 v[218:219],v239 offset:19584
v_mfma_f32_16x16x32_bf16 v[128:131],v[192:195],v[32:35],v[128:131]
s_add_u32 m0,s32,52224
s_mov_b32 s34,115072
v_mfma_f32_16x16x32_bf16 v[128:131],v[196:199],v[48:51],v[128:131]
buffer_load_dwordx4 v235,s[24:27],s34 offen  lds
v_mfma_f32_16x16x32_bf16 v[136:139],v[192:195],v[36:39],v[136:139]
v_cvt_pk_bf16_f32 v170,v172,v173
v_mul_f32 v174,v174,v225
v_mfma_f32_16x16x32_bf16 v[136:139],v[196:199],v[52:55],v[136:139]
ds_read_b64_tr_b16 v[220:221],v239 offset:21760
ds_read_b64_tr_b16 v[222:223],v239 offset:23936
v_mfma_f32_16x16x32_bf16 v[144:147],v[192:195],v[40:43],v[144:147]
s_add_u32 m0,s32,53312
s_mov_b32 s34,122240
v_mfma_f32_16x16x32_bf16 v[144:147],v[196:199],v[56:59],v[144:147]
buffer_load_dwordx4 v235,s[24:27],s34 offen  lds
v_mfma_f32_16x16x32_bf16 v[152:155],v[192:195],v[44:47],v[152:155]
s_waitcnt lgkmcnt(8)
v_mul_f32 v175,v175,v225
v_mfma_f32_16x16x32_bf16 v[152:155],v[196:199],v[60:63],v[152:155]
ds_read_b64_tr_b16 v[192:193],v238 offset:26112
ds_read_b64_tr_b16 v[194:195],v238 offset:28288
v_mfma_f32_16x16x32_bf16 v[132:135],v[200:203],v[32:35],v[132:135]
v_cvt_pk_bf16_f32 v171,v174,v175
v_mul_f32 v176,v176,v226
v_mfma_f32_16x16x32_bf16 v[132:135],v[204:207],v[48:51],v[132:135]
buffer_store_dwordx4 v[168:171],v242,s[28:31],s55 offen offset:1024
v_mfma_f32_16x16x32_bf16 v[140:143],v[200:203],v[36:39],v[140:143]
v_mul_f32 v177,v177,v226
v_cvt_pk_bf16_f32 v176,v176,v177
v_mfma_f32_16x16x32_bf16 v[140:143],v[204:207],v[52:55],v[140:143]
ds_read_b64_tr_b16 v[196:197],v238 offset:30464
ds_read_b64_tr_b16 v[198:199],v238 offset:32640
v_mfma_f32_16x16x32_bf16 v[148:151],v[200:203],v[40:43],v[148:151]
s_add_u32 m0,s32,54400
s_mov_b32 s34,129408
v_mfma_f32_16x16x32_bf16 v[148:151],v[204:207],v[56:59],v[148:151]
buffer_load_dwordx4 v235,s[24:27],s34 offen  lds
v_mfma_f32_16x16x32_bf16 v[156:159],v[200:203],v[44:47],v[156:159]
s_waitcnt lgkmcnt(8)
v_mov_b32 v237,2
v_mfma_f32_16x16x32_bf16 v[156:159],v[204:207],v[60:63],v[156:159]
ds_read_b64_tr_b16 v[200:201],v239 offset:26112
ds_read_b64_tr_b16 v[202:203],v239 offset:28288
v_mfma_f32_16x16x32_bf16 v[128:131],v[208:211],v[64:67],v[128:131]
s_add_u32 m0,s32,55488
s_mov_b32 s34,136576
v_mfma_f32_16x16x32_bf16 v[128:131],v[212:215],v[80:83],v[128:131]
buffer_load_dwordx4 v235,s[24:27],s34 offen  lds
v_mfma_f32_16x16x32_bf16 v[136:139],v[208:211],v[68:71],v[136:139]
v_writelane_b32 v237,1,0
v_mul_f32 v178,v178,v226
v_mfma_f32_16x16x32_bf16 v[136:139],v[212:215],v[84:87],v[136:139]
ds_read_b64_tr_b16 v[204:205],v239 offset:30464
ds_read_b64_tr_b16 v[206:207],v239 offset:32640
v_mfma_f32_16x16x32_bf16 v[144:147],v[208:211],v[72:75],v[144:147]
v_add_u32 v238,69632,v238
v_add_u32 v239,69632,v239
v_mfma_f32_16x16x32_bf16 v[144:147],v[212:215],v[88:91],v[144:147]
v_mul_f32 v179,v179,v226
v_cvt_pk_bf16_f32 v177,v178,v179
v_mfma_f32_16x16x32_bf16 v[152:155],v[208:211],v[76:79],v[152:155]
s_waitcnt vmcnt(6) lgkmcnt(8)
v_mul_f32 v180,v180,v226
v_mfma_f32_16x16x32_bf16 v[152:155],v[212:215],v[92:95],v[152:155]
ds_read_b64_tr_b16 v[208:209],v240 offset:0
ds_read_b64_tr_b16 v[210:211],v240 offset:2176
v_mfma_f32_16x16x32_bf16 v[132:135],v[216:219],v[64:67],v[132:135]
buffer_store_dword v237,v252,s[28:31],0 offen
v_mfma_f32_16x16x32_bf16 v[132:135],v[220:223],v[80:83],v[132:135]
v_mul_f32 v181,v181,v226
v_cvt_pk_bf16_f32 v178,v180,v181
v_mfma_f32_16x16x32_bf16 v[140:143],v[216:219],v[68:71],v[140:143]
v_mul_f32 v182,v182,v226
v_mul_f32 v183,v183,v226
v_mfma_f32_16x16x32_bf16 v[140:143],v[220:223],v[84:87],v[140:143]
ds_read_b64_tr_b16 v[212:213],v240 offset:4352
ds_read_b64_tr_b16 v[214:215],v240 offset:6528
v_mfma_f32_16x16x32_bf16 v[148:151],v[216:219],v[72:75],v[148:151]
v_cvt_pk_bf16_f32 v179,v182,v183
v_mul_f32 v184,v184,v227
v_mfma_f32_16x16x32_bf16 v[148:151],v[220:223],v[88:91],v[148:151]
buffer_store_dwordx4 v[176:179],v242,s[28:31],s55 offen offset:2048
v_mfma_f32_16x16x32_bf16 v[156:159],v[216:219],v[76:79],v[156:159]
s_waitcnt lgkmcnt(8)
v_mul_f32 v185,v185,v227
v_mfma_f32_16x16x32_bf16 v[156:159],v[220:223],v[92:95],v[156:159]
ds_read_b64_tr_b16 v[216:217],v241 offset:0
ds_read_b64_tr_b16 v[218:219],v241 offset:2176
v_mfma_f32_16x16x32_bf16 v[128:131],v[192:195],v[96:99],v[128:131]
v_cvt_pk_bf16_f32 v184,v184,v185
v_mul_f32 v186,v186,v227
v_mfma_f32_16x16x32_bf16 v[128:131],v[196:199],v[112:115],v[128:131]
v_mul_f32 v187,v187,v227
v_cvt_pk_bf16_f32 v185,v186,v187
v_mfma_f32_16x16x32_bf16 v[136:139],v[192:195],v[100:103],v[136:139]
v_mul_f32 v188,v188,v227
v_mul_f32 v189,v189,v227
v_mfma_f32_16x16x32_bf16 v[136:139],v[196:199],v[116:119],v[136:139]
ds_read_b64_tr_b16 v[220:221],v241 offset:4352
ds_read_b64_tr_b16 v[222:223],v241 offset:6528
v_mfma_f32_16x16x32_bf16 v[144:147],v[192:195],v[104:107],v[144:147]
v_cvt_pk_bf16_f32 v186,v188,v189
v_mul_f32 v190,v190,v227
v_mfma_f32_16x16x32_bf16 v[144:147],v[196:199],v[120:123],v[144:147]
v_mul_f32 v191,v191,v227
v_cvt_pk_bf16_f32 v187,v190,v191
v_mfma_f32_16x16x32_bf16 v[152:155],v[192:195],v[108:111],v[152:155]
s_waitcnt lgkmcnt(8)
v_mfma_f32_16x16x32_bf16 v[152:155],v[196:199],v[124:127],v[152:155]
ds_read_b64_tr_b16 v[192:193],v240 offset:8704
ds_read_b64_tr_b16 v[194:195],v240 offset:10880
v_mfma_f32_16x16x32_bf16 v[132:135],v[200:203],v[96:99],v[132:135]
buffer_store_dwordx4 v[184:187],v242,s[28:31],s55 offen offset:3072
v_mfma_f32_16x16x32_bf16 v[132:135],v[204:207],v[112:115],v[132:135]
s_add_u32 s55,s55,16384
v_mfma_f32_16x16x32_bf16 v[140:143],v[200:203],v[100:103],v[140:143]
v_mfma_f32_16x16x32_bf16 v[140:143],v[204:207],v[116:119],v[140:143]
ds_read_b64_tr_b16 v[196:197],v240 offset:13056
ds_read_b64_tr_b16 v[198:199],v240 offset:15232
v_mfma_f32_16x16x32_bf16 v[148:151],v[200:203],v[104:107],v[148:151]
v_mfma_f32_16x16x32_bf16 v[148:151],v[204:207],v[120:123],v[148:151]
v_mfma_f32_16x16x32_bf16 v[156:159],v[200:203],v[108:111],v[156:159]
s_waitcnt lgkmcnt(8)
v_mfma_f32_16x16x32_bf16 v[156:159],v[204:207],v[124:127],v[156:159]
ds_read_b64_tr_b16 v[200:201],v241 offset:8704
ds_read_b64_tr_b16 v[202:203],v241 offset:10880
v_mfma_f32_16x16x32_bf16 v[160:163],v[208:211],v[0:3],0
v_mul_f32 v128,v128,v224
v_mul_f32 v129,v129,v224
v_mfma_f32_16x16x32_bf16 v[160:163],v[212:215],v[16:19],v[160:163]
v_cvt_pk_bf16_f32 v128,v128,v129
v_mul_f32 v130,v130,v224
v_mfma_f32_16x16x32_bf16 v[168:171],v[208:211],v[4:7],0
v_mul_f32 v131,v131,v224
v_cvt_pk_bf16_f32 v129,v130,v131
v_mfma_f32_16x16x32_bf16 v[168:171],v[212:215],v[20:23],v[168:171]
ds_read_b64_tr_b16 v[204:205],v241 offset:13056
ds_read_b64_tr_b16 v[206:207],v241 offset:15232
v_mfma_f32_16x16x32_bf16 v[176:179],v[208:211],v[8:11],0
v_mul_f32 v132,v132,v224
v_mul_f32 v133,v133,v224
v_mfma_f32_16x16x32_bf16 v[176:179],v[212:215],v[24:27],v[176:179]
v_cvt_pk_bf16_f32 v130,v132,v133
v_mul_f32 v134,v134,v224
v_mfma_f32_16x16x32_bf16 v[184:187],v[208:211],v[12:15],0
s_waitcnt lgkmcnt(8)
v_mul_f32 v135,v135,v224
v_mfma_f32_16x16x32_bf16 v[184:187],v[212:215],v[28:31],v[184:187]
ds_read_b64_tr_b16 v[208:209],v240 offset:17408
ds_read_b64_tr_b16 v[210:211],v240 offset:19584
v_mfma_f32_16x16x32_bf16 v[164:167],v[216:219],v[0:3],0
v_cvt_pk_bf16_f32 v131,v134,v135
v_mul_f32 v136,v136,v225
v_mfma_f32_16x16x32_bf16 v[164:167],v[220:223],v[16:19],v[164:167]
v_mul_f32 v137,v137,v225
v_cvt_pk_bf16_f32 v136,v136,v137
v_mfma_f32_16x16x32_bf16 v[172:175],v[216:219],v[4:7],0
v_mul_f32 v138,v138,v225
v_mul_f32 v139,v139,v225
v_mfma_f32_16x16x32_bf16 v[172:175],v[220:223],v[20:23],v[172:175]
ds_read_b64_tr_b16 v[212:213],v240 offset:21760
ds_read_b64_tr_b16 v[214:215],v240 offset:23936
v_mfma_f32_16x16x32_bf16 v[180:183],v[216:219],v[8:11],0
buffer_load_dword v234,v253,s[28:31],0 offen sc1
v_mfma_f32_16x16x32_bf16 v[180:183],v[220:223],v[24:27],v[180:183]
v_cvt_pk_bf16_f32 v137,v138,v139
v_mul_f32 v140,v140,v225
v_mfma_f32_16x16x32_bf16 v[188:191],v[216:219],v[12:15],0
s_waitcnt lgkmcnt(8)
v_mul_f32 v141,v141,v225
v_mfma_f32_16x16x32_bf16 v[188:191],v[220:223],v[28:31],v[188:191]
ds_read_b64_tr_b16 v[216:217],v241 offset:17408
ds_read_b64_tr_b16 v[218:219],v241 offset:19584
v_mfma_f32_16x16x32_bf16 v[160:163],v[192:195],v[32:35],v[160:163]
s_add_u32 m0,s32,121856
s_mov_b32 s34,512
v_mfma_f32_16x16x32_bf16 v[160:163],v[196:199],v[48:51],v[160:163]
buffer_load_dwordx4 v235,s[24:27],s34 offen  lds
v_mfma_f32_16x16x32_bf16 v[168:171],v[192:195],v[36:39],v[168:171]
v_cvt_pk_bf16_f32 v138,v140,v141
v_mul_f32 v142,v142,v225
v_mfma_f32_16x16x32_bf16 v[168:171],v[196:199],v[52:55],v[168:171]
ds_read_b64_tr_b16 v[220:221],v241 offset:21760
ds_read_b64_tr_b16 v[222:223],v241 offset:23936
v_mfma_f32_16x16x32_bf16 v[176:179],v[192:195],v[40:43],v[176:179]
s_add_u32 m0,s32,122944
s_mov_b32 s34,7680
v_mfma_f32_16x16x32_bf16 v[176:179],v[196:199],v[56:59],v[176:179]
buffer_load_dwordx4 v235,s[24:27],s34 offen  lds
v_mfma_f32_16x16x32_bf16 v[184:187],v[192:195],v[44:47],v[184:187]
s_waitcnt lgkmcnt(8)
v_mul_f32 v143,v143,v225
v_mfma_f32_16x16x32_bf16 v[184:187],v[196:199],v[60:63],v[184:187]
ds_read_b64_tr_b16 v[192:193],v240 offset:26112
ds_read_b64_tr_b16 v[194:195],v240 offset:28288
v_mfma_f32_16x16x32_bf16 v[164:167],v[200:203],v[32:35],v[164:167]
v_cvt_pk_bf16_f32 v139,v142,v143
v_mul_f32 v144,v144,v226
v_mfma_f32_16x16x32_bf16 v[164:167],v[204:207],v[48:51],v[164:167]
v_mul_f32 v145,v145,v226
v_cvt_pk_bf16_f32 v144,v144,v145
v_mfma_f32_16x16x32_bf16 v[172:175],v[200:203],v[36:39],v[172:175]
v_mul_f32 v146,v146,v226
v_mul_f32 v147,v147,v226
v_mfma_f32_16x16x32_bf16 v[172:175],v[204:207],v[52:55],v[172:175]
ds_read_b64_tr_b16 v[196:197],v240 offset:30464
ds_read_b64_tr_b16 v[198:199],v240 offset:32640
v_mfma_f32_16x16x32_bf16 v[180:183],v[200:203],v[40:43],v[180:183]
s_add_u32 m0,s32,124032
s_mov_b32 s34,14848
v_mfma_f32_16x16x32_bf16 v[180:183],v[204:207],v[56:59],v[180:183]
buffer_load_dwordx4 v235,s[24:27],s34 offen  lds
v_mfma_f32_16x16x32_bf16 v[188:191],v[200:203],v[44:47],v[188:191]
s_waitcnt lgkmcnt(8)
v_add_u32 v237,2,v243
v_mfma_f32_16x16x32_bf16 v[188:191],v[204:207],v[60:63],v[188:191]
ds_read_b64_tr_b16 v[200:201],v241 offset:26112
ds_read_b64_tr_b16 v[202:203],v241 offset:28288
v_mfma_f32_16x16x32_bf16 v[160:163],v[208:211],v[64:67],v[160:163]
s_add_u32 m0,s32,125120
s_mov_b32 s34,22016
v_mfma_f32_16x16x32_bf16 v[160:163],v[212:215],v[80:83],v[160:163]
buffer_load_dwordx4 v235,s[24:27],s34 offen  lds
v_mfma_f32_16x16x32_bf16 v[168:171],v[208:211],v[68:71],v[168:171]
v_cvt_pk_bf16_f32 v145,v146,v147
v_mul_f32 v148,v148,v226
v_mfma_f32_16x16x32_bf16 v[168:171],v[212:215],v[84:87],v[168:171]
ds_read_b64_tr_b16 v[204:205],v241 offset:30464
ds_read_b64_tr_b16 v[206:207],v241 offset:32640
v_mfma_f32_16x16x32_bf16 v[176:179],v[208:211],v[72:75],v[176:179]
v_add_u32 v240,69632,v240
v_add_u32 v241,69632,v241
v_mfma_f32_16x16x32_bf16 v[176:179],v[212:215],v[88:91],v[176:179]
v_mul_f32 v149,v149,v226
v_cvt_pk_bf16_f32 v146,v148,v149
v_mfma_f32_16x16x32_bf16 v[184:187],v[208:211],v[76:79],v[184:187]
s_waitcnt vmcnt(4) lgkmcnt(8)
s_barrier
v_mfma_f32_16x16x32_bf16 v[184:187],v[212:215],v[92:95],v[184:187]
ds_read_b64_tr_b16 v[208:209],v238 offset:0
ds_read_b64_tr_b16 v[210:211],v238 offset:2176
v_mfma_f32_16x16x32_bf16 v[164:167],v[216:219],v[64:67],v[164:167]
buffer_store_dword v237,v252,s[28:31],0 offen
v_mfma_f32_16x16x32_bf16 v[164:167],v[220:223],v[80:83],v[164:167]
v_cmp_gt_u32 vcc,1,v234
v_mul_f32 v150,v150,v226
v_mfma_f32_16x16x32_bf16 v[172:175],v[216:219],v[68:71],v[172:175]
s_cbranch_vccnz SP_3
SP_3_RET:
v_mul_f32 v151,v151,v226
v_mfma_f32_16x16x32_bf16 v[172:175],v[220:223],v[84:87],v[172:175]
ds_read_b64_tr_b16 v[212:213],v238 offset:4352
ds_read_b64_tr_b16 v[214:215],v238 offset:6528
v_mfma_f32_16x16x32_bf16 v[180:183],v[216:219],v[72:75],v[180:183]
buffer_store_dwordx4 v[128:131],v242,s[28:31],s55 offen offset:0
v_mfma_f32_16x16x32_bf16 v[180:183],v[220:223],v[88:91],v[180:183]
v_cvt_pk_bf16_f32 v147,v150,v151
v_mul_f32 v152,v152,v227
v_mfma_f32_16x16x32_bf16 v[188:191],v[216:219],v[76:79],v[188:191]
s_waitcnt lgkmcnt(8)
v_mul_f32 v153,v153,v227
v_mfma_f32_16x16x32_bf16 v[188:191],v[220:223],v[92:95],v[188:191]
ds_read_b64_tr_b16 v[216:217],v239 offset:0
ds_read_b64_tr_b16 v[218:219],v239 offset:2176
v_mfma_f32_16x16x32_bf16 v[160:163],v[192:195],v[96:99],v[160:163]
buffer_store_dwordx4 v[136:139],v242,s[28:31],s55 offen offset:1024
v_mfma_f32_16x16x32_bf16 v[160:163],v[196:199],v[112:115],v[160:163]
v_cvt_pk_bf16_f32 v152,v152,v153
v_mul_f32 v154,v154,v227
v_mfma_f32_16x16x32_bf16 v[168:171],v[192:195],v[100:103],v[168:171]
buffer_store_dwordx4 v[144:147],v242,s[28:31],s55 offen offset:2048
v_mfma_f32_16x16x32_bf16 v[168:171],v[196:199],v[116:119],v[168:171]
ds_read_b64_tr_b16 v[220:221],v239 offset:4352
ds_read_b64_tr_b16 v[222:223],v239 offset:6528
v_mfma_f32_16x16x32_bf16 v[176:179],v[192:195],v[104:107],v[176:179]
v_mul_f32 v155,v155,v227
v_cvt_pk_bf16_f32 v153,v154,v155
v_mfma_f32_16x16x32_bf16 v[176:179],v[196:199],v[120:123],v[176:179]
buffer_load_dwordx4 a[0:3],v248,s[28:31],s60 offen sc1
v_mfma_f32_16x16x32_bf16 v[184:187],v[192:195],v[108:111],v[184:187]
s_waitcnt lgkmcnt(8)
v_mul_f32 v156,v156,v227
v_mfma_f32_16x16x32_bf16 v[184:187],v[196:199],v[124:127],v[184:187]
ds_read_b64_tr_b16 v[192:193],v238 offset:8704
ds_read_b64_tr_b16 v[194:195],v238 offset:10880
v_mfma_f32_16x16x32_bf16 v[164:167],v[200:203],v[96:99],v[164:167]
v_mul_f32 v157,v157,v227
v_cvt_pk_bf16_f32 v154,v156,v157
v_mfma_f32_16x16x32_bf16 v[164:167],v[204:207],v[112:115],v[164:167]
v_mul_f32 v158,v158,v227
v_mul_f32 v159,v159,v227
v_mfma_f32_16x16x32_bf16 v[172:175],v[200:203],v[100:103],v[172:175]
v_cvt_pk_bf16_f32 v155,v158,v159
v_mfma_f32_16x16x32_bf16 v[172:175],v[204:207],v[116:119],v[172:175]
ds_read_b64_tr_b16 v[196:197],v238 offset:13056
ds_read_b64_tr_b16 v[198:199],v238 offset:15232
v_mfma_f32_16x16x32_bf16 v[180:183],v[200:203],v[104:107],v[180:183]
buffer_store_dwordx4 v[152:155],v242,s[28:31],s55 offen offset:3072
v_mfma_f32_16x16x32_bf16 v[180:183],v[204:207],v[120:123],v[180:183]
buffer_load_dwordx4 a[4:7],v249,s[28:31],s60 offen sc1
v_mfma_f32_16x16x32_bf16 v[188:191],v[200:203],v[108:111],v[188:191]
s_waitcnt lgkmcnt(8)
s_add_u32 s55,s55,16384
v_mfma_f32_16x16x32_bf16 v[188:191],v[204:207],v[124:127],v[188:191]
ds_read_b64_tr_b16 v[200:201],v239 offset:8704
ds_read_b64_tr_b16 v[202:203],v239 offset:10880
v_mfma_f32_16x16x32_bf16 v[128:131],v[208:211],v[0:3],0
buffer_load_dwordx4 a[8:11],v250,s[28:31],s60 offen sc1
v_mfma_f32_16x16x32_bf16 v[128:131],v[212:215],v[16:19],v[128:131]
v_mul_f32 v160,v160,v224
v_mul_f32 v161,v161,v224
v_mfma_f32_16x16x32_bf16 v[136:139],v[208:211],v[4:7],0
v_cvt_pk_bf16_f32 v160,v160,v161
v_mul_f32 v162,v162,v224
v_mfma_f32_16x16x32_bf16 v[136:139],v[212:215],v[20:23],v[136:139]
ds_read_b64_tr_b16 v[204:205],v239 offset:13056
ds_read_b64_tr_b16 v[206:207],v239 offset:15232
v_mfma_f32_16x16x32_bf16 v[144:147],v[208:211],v[8:11],0
v_mul_f32 v163,v163,v224
v_cvt_pk_bf16_f32 v161,v162,v163
v_mfma_f32_16x16x32_bf16 v[144:147],v[212:215],v[24:27],v[144:147]
buffer_load_dwordx4 a[12:15],v251,s[28:31],s60 offen sc1
v_mfma_f32_16x16x32_bf16 v[152:155],v[208:211],v[12:15],0
s_add_u32 s60,s60,16384
s_waitcnt lgkmcnt(8)
v_mfma_f32_16x16x32_bf16 v[152:155],v[212:215],v[28:31],v[152:155]
ds_read_b64_tr_b16 v[208:209],v238 offset:17408
ds_read_b64_tr_b16 v[210:211],v238 offset:19584
v_mfma_f32_16x16x32_bf16 v[132:135],v[216:219],v[0:3],0
v_mul_f32 v164,v164,v224
v_mul_f32 v165,v165,v224
v_mfma_f32_16x16x32_bf16 v[132:135],v[220:223],v[16:19],v[132:135]
v_cvt_pk_bf16_f32 v162,v164,v165
v_mul_f32 v166,v166,v224
v_mfma_f32_16x16x32_bf16 v[140:143],v[216:219],v[4:7],0
v_mul_f32 v167,v167,v224
v_cvt_pk_bf16_f32 v163,v166,v167
v_mfma_f32_16x16x32_bf16 v[140:143],v[220:223],v[20:23],v[140:143]
ds_read_b64_tr_b16 v[212:213],v238 offset:21760
ds_read_b64_tr_b16 v[214:215],v238 offset:23936
v_mfma_f32_16x16x32_bf16 v[148:151],v[216:219],v[8:11],0
buffer_load_dword v234,v253,s[28:31],0 offen sc1
v_mfma_f32_16x16x32_bf16 v[148:151],v[220:223],v[24:27],v[148:151]
v_mul_f32 v168,v168,v225
v_mul_f32 v169,v169,v225
v_mfma_f32_16x16x32_bf16 v[156:159],v[216:219],v[12:15],0
s_waitcnt lgkmcnt(8)
v_cvt_pk_bf16_f32 v168,v168,v169
v_mfma_f32_16x16x32_bf16 v[156:159],v[220:223],v[28:31],v[156:159]
ds_read_b64_tr_b16 v[216:217],v239 offset:17408
ds_read_b64_tr_b16 v[218:219],v239 offset:19584
v_mfma_f32_16x16x32_bf16 v[128:131],v[192:195],v[32:35],v[128:131]
s_add_u32 m0,s32,139264
s_mov_b32 s34,115200
v_mfma_f32_16x16x32_bf16 v[128:131],v[196:199],v[48:51],v[128:131]
buffer_load_dwordx4 v235,s[24:27],s34 offen  lds
v_mfma_f32_16x16x32_bf16 v[136:139],v[192:195],v[36:39],v[136:139]
v_mul_f32 v170,v170,v225
v_mul_f32 v171,v171,v225
v_mfma_f32_16x16x32_bf16 v[136:139],v[196:199],v[52:55],v[136:139]
ds_read_b64_tr_b16 v[220:221],v239 offset:21760
ds_read_b64_tr_b16 v[222:223],v239 offset:23936
v_mfma_f32_16x16x32_bf16 v[144:147],v[192:195],v[40:43],v[144:147]
s_add_u32 m0,s32,140352
s_mov_b32 s34,122368
v_mfma_f32_16x16x32_bf16 v[144:147],v[196:199],v[56:59],v[144:147]
buffer_load_dwordx4 v235,s[24:27],s34 offen  lds
v_mfma_f32_16x16x32_bf16 v[152:155],v[192:195],v[44:47],v[152:155]
s_waitcnt lgkmcnt(8)
v_cvt_pk_bf16_f32 v169,v170,v171
v_mfma_f32_16x16x32_bf16 v[152:155],v[196:199],v[60:63],v[152:155]
ds_read_b64_tr_b16 v[192:193],v238 offset:26112
ds_read_b64_tr_b16 v[194:195],v238 offset:28288
v_mfma_f32_16x16x32_bf16 v[132:135],v[200:203],v[32:35],v[132:135]
v_mul_f32 v172,v172,v225
v_mul_f32 v173,v173,v225
v_mfma_f32_16x16x32_bf16 v[132:135],v[204:207],v[48:51],v[132:135]
v_cvt_pk_bf16_f32 v170,v172,v173
v_mul_f32 v174,v174,v225
v_mfma_f32_16x16x32_bf16 v[140:143],v[200:203],v[36:39],v[140:143]
v_mul_f32 v175,v175,v225
v_cvt_pk_bf16_f32 v171,v174,v175
v_mfma_f32_16x16x32_bf16 v[140:143],v[204:207],v[52:55],v[140:143]
ds_read_b64_tr_b16 v[196:197],v238 offset:30464
ds_read_b64_tr_b16 v[198:199],v238 offset:32640
v_mfma_f32_16x16x32_bf16 v[148:151],v[200:203],v[40:43],v[148:151]
s_add_u32 m0,s32,141440
s_mov_b32 s34,129536
v_mfma_f32_16x16x32_bf16 v[148:151],v[204:207],v[56:59],v[148:151]
buffer_load_dwordx4 v235,s[24:27],s34 offen  lds
v_mfma_f32_16x16x32_bf16 v[156:159],v[200:203],v[44:47],v[156:159]
s_waitcnt lgkmcnt(8)
v_add_u32 v237,3,v243
v_mfma_f32_16x16x32_bf16 v[156:159],v[204:207],v[60:63],v[156:159]
ds_read_b64_tr_b16 v[200:201],v239 offset:26112
ds_read_b64_tr_b16 v[202:203],v239 offset:28288
v_mfma_f32_16x16x32_bf16 v[128:131],v[208:211],v[64:67],v[128:131]
s_add_u32 m0,s32,142528
s_mov_b32 s34,136704
v_mfma_f32_16x16x32_bf16 v[128:131],v[212:215],v[80:83],v[128:131]
buffer_load_dwordx4 v235,s[24:27],s34 offen  lds
v_mfma_f32_16x16x32_bf16 v[136:139],v[208:211],v[68:71],v[136:139]
v_mul_f32 v176,v176,v226
v_mul_f32 v177,v177,v226
v_mfma_f32_16x16x32_bf16 v[136:139],v[212:215],v[84:87],v[136:139]
ds_read_b64_tr_b16 v[204:205],v239 offset:30464
ds_read_b64_tr_b16 v[206:207],v239 offset:32640
v_mfma_f32_16x16x32_bf16 v[144:147],v[208:211],v[72:75],v[144:147]
v_subrev_u32 v238,34816,v238
v_subrev_u32 v239,34816,v239
v_mfma_f32_16x16x32_bf16 v[144:147],v[212:215],v[88:91],v[144:147]
v_cvt_pk_bf16_f32 v176,v176,v177
v_mul_f32 v178,v178,v226
v_mfma_f32_16x16x32_bf16 v[152:155],v[208:211],v[76:79],v[152:155]
s_waitcnt vmcnt(4) lgkmcnt(8)
v_mul_f32 v179,v179,v226
v_mfma_f32_16x16x32_bf16 v[152:155],v[212:215],v[92:95],v[152:155]
ds_read_b64_tr_b16 v[208:209],v240 offset:0
ds_read_b64_tr_b16 v[210:211],v240 offset:2176
v_mfma_f32_16x16x32_bf16 v[228:231],v[244:247],a[0:3],0
buffer_store_dword v237,v252,s[28:31],0 offen
v_mfma_f32_16x16x32_bf16 v[132:135],v[216:219],v[64:67],v[132:135]
v_cmp_gt_u32 vcc,2,v234
v_cvt_pk_bf16_f32 v177,v178,v179
v_mfma_f32_16x16x32_bf16 v[132:135],v[220:223],v[80:83],v[132:135]
s_cbranch_vccnz SP_4
SP_4_RET:
v_mul_f32 v180,v180,v226
v_mfma_f32_16x16x32_bf16 v[228:231],v[244:247],a[4:7],v[228:231]
buffer_store_dwordx4 v[160:163],v242,s[28:31],s55 offen offset:0
v_mfma_f32_16x16x32_bf16 v[140:143],v[216:219],v[68:71],v[140:143]
v_mul_f32 v181,v181,v226
v_cvt_pk_bf16_f32 v178,v180,v181
v_mfma_f32_16x16x32_bf16 v[140:143],v[220:223],v[84:87],v[140:143]
ds_read_b64_tr_b16 v[212:213],v240 offset:4352
ds_read_b64_tr_b16 v[214:215],v240 offset:6528
v_mfma_f32_16x16x32_bf16 v[228:231],v[244:247],a[8:11],v[228:231]
v_mul_f32 v182,v182,v226
v_mul_f32 v183,v183,v226
v_mfma_f32_16x16x32_bf16 v[148:151],v[216:219],v[72:75],v[148:151]
v_cvt_pk_bf16_f32 v179,v182,v183
v_mul_f32 v184,v184,v227
v_mfma_f32_16x16x32_bf16 v[148:151],v[220:223],v[88:91],v[148:151]
v_mul_f32 v185,v185,v227
v_cvt_pk_bf16_f32 v184,v184,v185
v_mfma_f32_16x16x32_bf16 v[228:231],v[244:247],a[12:15],v[228:231]
v_mul_f32 v186,v186,v227
v_mul_f32 v187,v187,v227
v_mfma_f32_16x16x32_bf16 v[156:159],v[216:219],v[76:79],v[156:159]
s_waitcnt lgkmcnt(8)
v_cvt_pk_bf16_f32 v185,v186,v187
v_mfma_f32_16x16x32_bf16 v[156:159],v[220:223],v[92:95],v[156:159]
ds_read_b64_tr_b16 v[216:217],v241 offset:0
ds_read_b64_tr_b16 v[218:219],v241 offset:2176
v_mfma_f32_16x16x32_bf16 v[128:131],v[192:195],v[96:99],v[128:131]
buffer_store_dwordx4 v[168:171],v242,s[28:31],s55 offen offset:1024
v_mfma_f32_16x16x32_bf16 v[128:131],v[196:199],v[112:115],v[128:131]
v_mul_f32 v188,v188,v227
v_mul_f32 v189,v189,v227
v_mfma_f32_16x16x32_bf16 v[136:139],v[192:195],v[100:103],v[136:139]
buffer_store_dwordx4 v[176:179],v242,s[28:31],s55 offen offset:2048
v_mfma_f32_16x16x32_bf16 v[136:139],v[196:199],v[116:119],v[136:139]
ds_read_b64_tr_b16 v[220:221],v241 offset:4352
ds_read_b64_tr_b16 v[222:223],v241 offset:6528
v_mfma_f32_16x16x32_bf16 v[144:147],v[192:195],v[104:107],v[144:147]
v_cvt_pk_bf16_f32 v232,v228,v229
v_cvt_pk_bf16_f32 v233,v230,v231
v_mfma_f32_16x16x32_bf16 v[144:147],v[196:199],v[120:123],v[144:147]
buffer_load_dwordx4 a[0:3],v248,s[28:31],s60 offen sc1
v_mfma_f32_16x16x32_bf16 v[152:155],v[192:195],v[108:111],v[152:155]
s_waitcnt lgkmcnt(8)
v_cvt_pk_bf16_f32 v186,v188,v189
v_mfma_f32_16x16x32_bf16 v[152:155],v[196:199],v[124:127],v[152:155]
ds_read_b64_tr_b16 v[192:193],v240 offset:8704
ds_read_b64_tr_b16 v[194:195],v240 offset:10880
v_mfma_f32_16x16x32_bf16 v[132:135],v[200:203],v[96:99],v[132:135]
v_mul_f32 v190,v190,v227
v_mul_f32 v191,v191,v227
v_mfma_f32_16x16x32_bf16 v[132:135],v[204:207],v[112:115],v[132:135]
v_cvt_pk_bf16_f32 v187,v190,v191
v_mfma_f32_16x16x32_bf16 v[140:143],v[200:203],v[100:103],v[140:143]
buffer_store_dwordx4 v[184:187],v242,s[28:31],s55 offen offset:3072
v_mfma_f32_16x16x32_bf16 v[140:143],v[204:207],v[116:119],v[140:143]
ds_read_b64_tr_b16 v[196:197],v240 offset:13056
ds_read_b64_tr_b16 v[198:199],v240 offset:15232
v_mfma_f32_16x16x32_bf16 v[148:151],v[200:203],v[104:107],v[148:151]
s_sub_u32 s55,s55,49152
v_mfma_f32_16x16x32_bf16 v[148:151],v[204:207],v[120:123],v[148:151]
buffer_load_dwordx4 a[4:7],v249,s[28:31],s60 offen sc1
v_mfma_f32_16x16x32_bf16 v[156:159],v[200:203],v[108:111],v[156:159]
s_waitcnt lgkmcnt(8)
v_mfma_f32_16x16x32_bf16 v[156:159],v[204:207],v[124:127],v[156:159]
ds_read_b64_tr_b16 v[200:201],v241 offset:8704
ds_read_b64_tr_b16 v[202:203],v241 offset:10880
v_mfma_f32_16x16x32_bf16 v[160:163],v[208:211],v[0:3],0
buffer_load_dwordx4 a[8:11],v250,s[28:31],s60 offen sc1
v_mfma_f32_16x16x32_bf16 v[160:163],v[212:215],v[16:19],v[160:163]
v_mul_f32 v128,v128,v224
v_mul_f32 v129,v129,v224
v_mfma_f32_16x16x32_bf16 v[168:171],v[208:211],v[4:7],0
v_cvt_pk_bf16_f32 v128,v128,v129
v_mul_f32 v130,v130,v224
v_mfma_f32_16x16x32_bf16 v[168:171],v[212:215],v[20:23],v[168:171]
ds_read_b64_tr_b16 v[204:205],v241 offset:13056
ds_read_b64_tr_b16 v[206:207],v241 offset:15232
v_mfma_f32_16x16x32_bf16 v[176:179],v[208:211],v[8:11],0
v_mul_f32 v131,v131,v224
v_cvt_pk_bf16_f32 v129,v130,v131
v_mfma_f32_16x16x32_bf16 v[176:179],v[212:215],v[24:27],v[176:179]
buffer_load_dwordx4 a[12:15],v251,s[28:31],s60 offen sc1
v_mfma_f32_16x16x32_bf16 v[184:187],v[208:211],v[12:15],0
s_add_u32 s60,s60,16384
s_waitcnt lgkmcnt(8)
v_mfma_f32_16x16x32_bf16 v[184:187],v[212:215],v[28:31],v[184:187]
ds_read_b64_tr_b16 v[208:209],v240 offset:17408
ds_read_b64_tr_b16 v[210:211],v240 offset:19584
v_mfma_f32_16x16x32_bf16 v[164:167],v[216:219],v[0:3],0
v_mul_f32 v132,v132,v224
v_mul_f32 v133,v133,v224
v_mfma_f32_16x16x32_bf16 v[164:167],v[220:223],v[16:19],v[164:167]
v_cvt_pk_bf16_f32 v130,v132,v133
v_mul_f32 v134,v134,v224
v_mfma_f32_16x16x32_bf16 v[172:175],v[216:219],v[4:7],0
v_mul_f32 v135,v135,v224
v_cvt_pk_bf16_f32 v131,v134,v135
v_mfma_f32_16x16x32_bf16 v[172:175],v[220:223],v[20:23],v[172:175]
ds_read_b64_tr_b16 v[212:213],v240 offset:21760
ds_read_b64_tr_b16 v[214:215],v240 offset:23936
v_mfma_f32_16x16x32_bf16 v[180:183],v[216:219],v[8:11],0
buffer_load_dword v234,v253,s[28:31],0 offen sc1
v_mfma_f32_16x16x32_bf16 v[180:183],v[220:223],v[24:27],v[180:183]
v_mul_f32 v136,v136,v225
v_mul_f32 v137,v137,v225
v_mfma_f32_16x16x32_bf16 v[188:191],v[216:219],v[12:15],0
s_waitcnt lgkmcnt(8)
v_cvt_pk_bf16_f32 v136,v136,v137
v_mfma_f32_16x16x32_bf16 v[188:191],v[220:223],v[28:31],v[188:191]
ds_read_b64_tr_b16 v[216:217],v241 offset:17408
ds_read_b64_tr_b16 v[218:219],v241 offset:19584
v_mfma_f32_16x16x32_bf16 v[160:163],v[192:195],v[32:35],v[160:163]
s_add_u32 m0,s32,0
s_mov_b32 s34,640
v_mfma_f32_16x16x32_bf16 v[160:163],v[196:199],v[48:51],v[160:163]
buffer_load_dwordx4 v235,s[24:27],s34 offen  lds
v_mfma_f32_16x16x32_bf16 v[168:171],v[192:195],v[36:39],v[168:171]
v_mul_f32 v138,v138,v225
v_mul_f32 v139,v139,v225
v_mfma_f32_16x16x32_bf16 v[168:171],v[196:199],v[52:55],v[168:171]
ds_read_b64_tr_b16 v[220:221],v241 offset:21760
ds_read_b64_tr_b16 v[222:223],v241 offset:23936
v_mfma_f32_16x16x32_bf16 v[176:179],v[192:195],v[40:43],v[176:179]
s_add_u32 m0,s32,1088
s_mov_b32 s34,7808
v_mfma_f32_16x16x32_bf16 v[176:179],v[196:199],v[56:59],v[176:179]
buffer_load_dwordx4 v235,s[24:27],s34 offen  lds
v_mfma_f32_16x16x32_bf16 v[184:187],v[192:195],v[44:47],v[184:187]
s_waitcnt lgkmcnt(8)
v_cvt_pk_bf16_f32 v137,v138,v139
v_mfma_f32_16x16x32_bf16 v[184:187],v[196:199],v[60:63],v[184:187]
ds_read_b64_tr_b16 v[192:193],v240 offset:26112
ds_read_b64_tr_b16 v[194:195],v240 offset:28288
v_mfma_f32_16x16x32_bf16 v[164:167],v[200:203],v[32:35],v[164:167]
v_mul_f32 v140,v140,v225
v_mul_f32 v141,v141,v225
v_mfma_f32_16x16x32_bf16 v[164:167],v[204:207],v[48:51],v[164:167]
v_cvt_pk_bf16_f32 v138,v140,v141
v_mul_f32 v142,v142,v225
v_mfma_f32_16x16x32_bf16 v[172:175],v[200:203],v[36:39],v[172:175]
v_mul_f32 v143,v143,v225
v_cvt_pk_bf16_f32 v139,v142,v143
v_mfma_f32_16x16x32_bf16 v[172:175],v[204:207],v[52:55],v[172:175]
ds_read_b64_tr_b16 v[196:197],v240 offset:30464
ds_read_b64_tr_b16 v[198:199],v240 offset:32640
v_mfma_f32_16x16x32_bf16 v[180:183],v[200:203],v[40:43],v[180:183]
s_add_u32 m0,s32,2176
s_mov_b32 s34,14976
v_mfma_f32_16x16x32_bf16 v[180:183],v[204:207],v[56:59],v[180:183]
buffer_load_dwordx4 v235,s[24:27],s34 offen  lds
v_mfma_f32_16x16x32_bf16 v[188:191],v[200:203],v[44:47],v[188:191]
s_waitcnt lgkmcnt(8)
v_add_u32 v237,4,v243
v_mfma_f32_16x16x32_bf16 v[188:191],v[204:207],v[60:63],v[188:191]
ds_read_b64_tr_b16 v[200:201],v241 offset:26112
ds_read_b64_tr_b16 v[202:203],v241 offset:28288
v_mfma_f32_16x16x32_bf16 v[160:163],v[208:211],v[64:67],v[160:163]
s_add_u32 m0,s32,3264
s_mov_b32 s34,22144
v_mfma_f32_16x16x32_bf16 v[160:163],v[212:215],v[80:83],v[160:163]
buffer_load_dwordx4 v235,s[24:27],s34 offen  lds
v_mfma_f32_16x16x32_bf16 v[168:171],v[208:211],v[68:71],v[168:171]
v_mul_f32 v144,v144,v226
v_mul_f32 v145,v145,v226
v_mfma_f32_16x16x32_bf16 v[168:171],v[212:215],v[84:87],v[168:171]
ds_read_b64_tr_b16 v[204:205],v241 offset:30464
ds_read_b64_tr_b16 v[206:207],v241 offset:32640
v_mfma_f32_16x16x32_bf16 v[176:179],v[208:211],v[72:75],v[176:179]
v_subrev_u32 v240,34816,v240
v_subrev_u32 v241,34816,v241
v_mfma_f32_16x16x32_bf16 v[176:179],v[212:215],v[88:91],v[176:179]
v_cvt_pk_bf16_f32 v144,v144,v145
v_mul_f32 v146,v146,v226
v_mfma_f32_16x16x32_bf16 v[184:187],v[208:211],v[76:79],v[184:187]
s_waitcnt vmcnt(4) lgkmcnt(8)
s_barrier
v_mfma_f32_16x16x32_bf16 v[184:187],v[212:215],v[92:95],v[184:187]
ds_read_b64_tr_b16 v[208:209],v238 offset:0
ds_read_b64_tr_b16 v[210:211],v238 offset:2176
v_mfma_f32_16x16x32_bf16 v[228:231],v[244:247],a[0:3],0
buffer_store_dword v237,v252,s[28:31],0 offen
v_mfma_f32_16x16x32_bf16 v[164:167],v[216:219],v[64:67],v[164:167]
v_cmp_gt_u32 vcc,3,v234
v_mul_f32 v147,v147,v226
v_mfma_f32_16x16x32_bf16 v[164:167],v[220:223],v[80:83],v[164:167]
s_cbranch_vccnz SP_5
SP_5_RET:
v_cvt_pk_bf16_f32 v145,v146,v147
v_mfma_f32_16x16x32_bf16 v[228:231],v[244:247],a[4:7],v[228:231]
buffer_store_dwordx4 v[128:131],v242,s[28:31],s55 offen offset:0
v_mfma_f32_16x16x32_bf16 v[172:175],v[216:219],v[68:71],v[172:175]
v_mul_f32 v148,v148,v226
v_mul_f32 v149,v149,v226
v_mfma_f32_16x16x32_bf16 v[172:175],v[220:223],v[84:87],v[172:175]
ds_read_b64_tr_b16 v[212:213],v238 offset:4352
ds_read_b64_tr_b16 v[214:215],v238 offset:6528
v_mfma_f32_16x16x32_bf16 v[228:231],v[244:247],a[8:11],v[228:231]
v_cvt_pk_bf16_f32 v146,v148,v149
v_mul_f32 v150,v150,v226
v_mfma_f32_16x16x32_bf16 v[180:183],v[216:219],v[72:75],v[180:183]
buffer_store_dwordx2 v[232:233],v254,s[16:19],0 offen offset:0
v_mfma_f32_16x16x32_bf16 v[180:183],v[220:223],v[88:91],v[180:183]
v_mul_f32 v151,v151,v226
v_cvt_pk_bf16_f32 v147,v150,v151
v_mfma_f32_16x16x32_bf16 v[228:231],v[244:247],a[12:15],v[228:231]
v_mul_f32 v152,v152,v227
v_mul_f32 v153,v153,v227
v_mfma_f32_16x16x32_bf16 v[188:191],v[216:219],v[76:79],v[188:191]
s_waitcnt lgkmcnt(8)
v_cvt_pk_bf16_f32 v152,v152,v153
v_mfma_f32_16x16x32_bf16 v[188:191],v[220:223],v[92:95],v[188:191]
ds_read_b64_tr_b16 v[216:217],v239 offset:0
ds_read_b64_tr_b16 v[218:219],v239 offset:2176
v_mfma_f32_16x16x32_bf16 v[160:163],v[192:195],v[96:99],v[160:163]
buffer_store_dwordx4 v[136:139],v242,s[28:31],s55 offen offset:1024
v_mfma_f32_16x16x32_bf16 v[160:163],v[196:199],v[112:115],v[160:163]
v_mul_f32 v154,v154,v227
v_mul_f32 v155,v155,v227
v_mfma_f32_16x16x32_bf16 v[168:171],v[192:195],v[100:103],v[168:171]
buffer_store_dwordx4 v[144:147],v242,s[28:31],s55 offen offset:2048
v_mfma_f32_16x16x32_bf16 v[168:171],v[196:199],v[116:119],v[168:171]
ds_read_b64_tr_b16 v[220:221],v239 offset:4352
ds_read_b64_tr_b16 v[222:223],v239 offset:6528
v_mfma_f32_16x16x32_bf16 v[176:179],v[192:195],v[104:107],v[176:179]
v_cvt_pk_bf16_f32 v232,v228,v229
v_cvt_pk_bf16_f32 v233,v230,v231
v_mfma_f32_16x16x32_bf16 v[176:179],v[196:199],v[120:123],v[176:179]
buffer_load_dwordx4 a[0:3],v248,s[28:31],s60 offen sc1
v_mfma_f32_16x16x32_bf16 v[184:187],v[192:195],v[108:111],v[184:187]
s_waitcnt lgkmcnt(8)
v_cvt_pk_bf16_f32 v153,v154,v155
v_mfma_f32_16x16x32_bf16 v[184:187],v[196:199],v[124:127],v[184:187]
ds_read_b64_tr_b16 v[192:193],v238 offset:8704
ds_read_b64_tr_b16 v[194:195],v238 offset:10880
v_mfma_f32_16x16x32_bf16 v[164:167],v[200:203],v[96:99],v[164:167]
v_mul_f32 v156,v156,v227
v_mul_f32 v157,v157,v227
v_mfma_f32_16x16x32_bf16 v[164:167],v[204:207],v[112:115],v[164:167]
v_cvt_pk_bf16_f32 v154,v156,v157
v_mul_f32 v158,v158,v227
v_mfma_f32_16x16x32_bf16 v[172:175],v[200:203],v[100:103],v[172:175]
v_mul_f32 v159,v159,v227
v_cvt_pk_bf16_f32 v155,v158,v159
v_mfma_f32_16x16x32_bf16 v[172:175],v[204:207],v[116:119],v[172:175]
ds_read_b64_tr_b16 v[196:197],v238 offset:13056
ds_read_b64_tr_b16 v[198:199],v238 offset:15232
v_mfma_f32_16x16x32_bf16 v[180:183],v[200:203],v[104:107],v[180:183]
buffer_store_dwordx4 v[152:155],v242,s[28:31],s55 offen offset:3072
v_mfma_f32_16x16x32_bf16 v[180:183],v[204:207],v[120:123],v[180:183]
buffer_load_dwordx4 a[4:7],v249,s[28:31],s60 offen sc1
v_mfma_f32_16x16x32_bf16 v[188:191],v[200:203],v[108:111],v[188:191]
s_waitcnt lgkmcnt(8)
s_add_u32 s55,s55,16384
v_mfma_f32_16x16x32_bf16 v[188:191],v[204:207],v[124:127],v[188:191]
ds_read_b64_tr_b16 v[200:201],v239 offset:8704
ds_read_b64_tr_b16 v[202:203],v239 offset:10880
v_mfma_f32_16x16x32_bf16 v[128:131],v[208:211],v[0:3],0
buffer_load_dwordx4 a[8:11],v250,s[28:31],s60 offen sc1
v_mfma_f32_16x16x32_bf16 v[128:131],v[212:215],v[16:19],v[128:131]
v_mul_f32 v160,v160,v224
v_mul_f32 v161,v161,v224
v_mfma_f32_16x16x32_bf16 v[136:139],v[208:211],v[4:7],0
v_cvt_pk_bf16_f32 v160,v160,v161
v_mul_f32 v162,v162,v224
v_mfma_f32_16x16x32_bf16 v[136:139],v[212:215],v[20:23],v[136:139]
ds_read_b64_tr_b16 v[204:205],v239 offset:13056
ds_read_b64_tr_b16 v[206:207],v239 offset:15232
v_mfma_f32_16x16x32_bf16 v[144:147],v[208:211],v[8:11],0
v_mul_f32 v163,v163,v224
v_cvt_pk_bf16_f32 v161,v162,v163
v_mfma_f32_16x16x32_bf16 v[144:147],v[212:215],v[24:27],v[144:147]
buffer_load_dwordx4 a[12:15],v251,s[28:31],s60 offen sc1
v_mfma_f32_16x16x32_bf16 v[152:155],v[208:211],v[12:15],0
s_add_u32 s60,s60,16384
s_waitcnt lgkmcnt(8)
v_mfma_f32_16x16x32_bf16 v[152:155],v[212:215],v[28:31],v[152:155]
ds_read_b64_tr_b16 v[208:209],v238 offset:17408
ds_read_b64_tr_b16 v[210:211],v238 offset:19584
v_mfma_f32_16x16x32_bf16 v[132:135],v[216:219],v[0:3],0
v_mul_f32 v164,v164,v224
v_mul_f32 v165,v165,v224
v_mfma_f32_16x16x32_bf16 v[132:135],v[220:223],v[16:19],v[132:135]
v_cvt_pk_bf16_f32 v162,v164,v165
v_mul_f32 v166,v166,v224
v_mfma_f32_16x16x32_bf16 v[140:143],v[216:219],v[4:7],0
v_mul_f32 v167,v167,v224
v_cvt_pk_bf16_f32 v163,v166,v167
v_mfma_f32_16x16x32_bf16 v[140:143],v[220:223],v[20:23],v[140:143]
ds_read_b64_tr_b16 v[212:213],v238 offset:21760
ds_read_b64_tr_b16 v[214:215],v238 offset:23936
v_mfma_f32_16x16x32_bf16 v[148:151],v[216:219],v[8:11],0
buffer_load_dword v234,v253,s[28:31],0 offen sc1
v_mfma_f32_16x16x32_bf16 v[148:151],v[220:223],v[24:27],v[148:151]
v_mul_f32 v168,v168,v225
v_mul_f32 v169,v169,v225
v_mfma_f32_16x16x32_bf16 v[156:159],v[216:219],v[12:15],0
s_waitcnt lgkmcnt(8)
v_cvt_pk_bf16_f32 v168,v168,v169
v_mfma_f32_16x16x32_bf16 v[156:159],v[220:223],v[28:31],v[156:159]
ds_read_b64_tr_b16 v[216:217],v239 offset:17408
ds_read_b64_tr_b16 v[218:219],v239 offset:19584
v_mfma_f32_16x16x32_bf16 v[128:131],v[192:195],v[32:35],v[128:131]
s_add_u32 m0,s32,17408
s_mov_b32 s34,115328
v_mfma_f32_16x16x32_bf16 v[128:131],v[196:199],v[48:51],v[128:131]
buffer_load_dwordx4 v235,s[24:27],s34 offen  lds
v_mfma_f32_16x16x32_bf16 v[136:139],v[192:195],v[36:39],v[136:139]
v_mul_f32 v170,v170,v225
v_mul_f32 v171,v171,v225
v_mfma_f32_16x16x32_bf16 v[136:139],v[196:199],v[52:55],v[136:139]
ds_read_b64_tr_b16 v[220:221],v239 offset:21760
ds_read_b64_tr_b16 v[222:223],v239 offset:23936
v_mfma_f32_16x16x32_bf16 v[144:147],v[192:195],v[40:43],v[144:147]
s_add_u32 m0,s32,18496
s_mov_b32 s34,122496
v_mfma_f32_16x16x32_bf16 v[144:147],v[196:199],v[56:59],v[144:147]
buffer_load_dwordx4 v235,s[24:27],s34 offen  lds
v_mfma_f32_16x16x32_bf16 v[152:155],v[192:195],v[44:47],v[152:155]
s_waitcnt lgkmcnt(8)
v_cvt_pk_bf16_f32 v169,v170,v171
v_mfma_f32_16x16x32_bf16 v[152:155],v[196:199],v[60:63],v[152:155]
ds_read_b64_tr_b16 v[192:193],v238 offset:26112
ds_read_b64_tr_b16 v[194:195],v238 offset:28288
v_mfma_f32_16x16x32_bf16 v[132:135],v[200:203],v[32:35],v[132:135]
v_mul_f32 v172,v172,v225
v_mul_f32 v173,v173,v225
v_mfma_f32_16x16x32_bf16 v[132:135],v[204:207],v[48:51],v[132:135]
v_cvt_pk_bf16_f32 v170,v172,v173
v_mul_f32 v174,v174,v225
v_mfma_f32_16x16x32_bf16 v[140:143],v[200:203],v[36:39],v[140:143]
v_mul_f32 v175,v175,v225
v_cvt_pk_bf16_f32 v171,v174,v175
v_mfma_f32_16x16x32_bf16 v[140:143],v[204:207],v[52:55],v[140:143]
ds_read_b64_tr_b16 v[196:197],v238 offset:30464
ds_read_b64_tr_b16 v[198:199],v238 offset:32640
v_mfma_f32_16x16x32_bf16 v[148:151],v[200:203],v[40:43],v[148:151]
s_add_u32 m0,s32,19584
s_mov_b32 s34,129664
v_mfma_f32_16x16x32_bf16 v[148:151],v[204:207],v[56:59],v[148:151]
buffer_load_dwordx4 v235,s[24:27],s34 offen  lds
v_mfma_f32_16x16x32_bf16 v[156:159],v[200:203],v[44:47],v[156:159]
s_waitcnt lgkmcnt(8)
v_add_u32 v237,5,v243
v_mfma_f32_16x16x32_bf16 v[156:159],v[204:207],v[60:63],v[156:159]
ds_read_b64_tr_b16 v[200:201],v239 offset:26112
ds_read_b64_tr_b16 v[202:203],v239 offset:28288
v_mfma_f32_16x16x32_bf16 v[128:131],v[208:211],v[64:67],v[128:131]
s_add_u32 m0,s32,20672
s_mov_b32 s34,136832
v_mfma_f32_16x16x32_bf16 v[128:131],v[212:215],v[80:83],v[128:131]
buffer_load_dwordx4 v235,s[24:27],s34 offen  lds
v_mfma_f32_16x16x32_bf16 v[136:139],v[208:211],v[68:71],v[136:139]
v_mul_f32 v176,v176,v226
v_mul_f32 v177,v177,v226
v_mfma_f32_16x16x32_bf16 v[136:139],v[212:215],v[84:87],v[136:139]
ds_read_b64_tr_b16 v[204:205],v239 offset:30464
ds_read_b64_tr_b16 v[206:207],v239 offset:32640
v_mfma_f32_16x16x32_bf16 v[144:147],v[208:211],v[72:75],v[144:147]
v_add_u32 v238,87040,v238
v_add_u32 v239,87040,v239
v_mfma_f32_16x16x32_bf16 v[144:147],v[212:215],v[88:91],v[144:147]
v_cvt_pk_bf16_f32 v176,v176,v177
v_mul_f32 v178,v178,v226
v_mfma_f32_16x16x32_bf16 v[152:155],v[208:211],v[76:79],v[152:155]
s_waitcnt vmcnt(4) lgkmcnt(8)
v_mul_f32 v179,v179,v226
v_mfma_f32_16x16x32_bf16 v[152:155],v[212:215],v[92:95],v[152:155]
ds_read_b64_tr_b16 v[208:209],v240 offset:0
ds_read_b64_tr_b16 v[210:211],v240 offset:2176
v_mfma_f32_16x16x32_bf16 v[228:231],v[244:247],a[0:3],0
buffer_store_dword v237,v252,s[28:31],0 offen
v_mfma_f32_16x16x32_bf16 v[132:135],v[216:219],v[64:67],v[132:135]
v_cmp_gt_u32 vcc,4,v234
v_cvt_pk_bf16_f32 v177,v178,v179
v_mfma_f32_16x16x32_bf16 v[132:135],v[220:223],v[80:83],v[132:135]
s_cbranch_vccnz SP_6
SP_6_RET:
v_mul_f32 v180,v180,v226
v_mfma_f32_16x16x32_bf16 v[228:231],v[244:247],a[4:7],v[228:231]
buffer_store_dwordx4 v[160:163],v242,s[28:31],s55 offen offset:0
v_mfma_f32_16x16x32_bf16 v[140:143],v[216:219],v[68:71],v[140:143]
v_mul_f32 v181,v181,v226
v_cvt_pk_bf16_f32 v178,v180,v181
v_mfma_f32_16x16x32_bf16 v[140:143],v[220:223],v[84:87],v[140:143]
ds_read_b64_tr_b16 v[212:213],v240 offset:4352
ds_read_b64_tr_b16 v[214:215],v240 offset:6528
v_mfma_f32_16x16x32_bf16 v[228:231],v[244:247],a[8:11],v[228:231]
v_mul_f32 v182,v182,v226
v_mul_f32 v183,v183,v226
v_mfma_f32_16x16x32_bf16 v[148:151],v[216:219],v[72:75],v[148:151]
buffer_store_dwordx2 v[232:233],v254,s[16:19],0 offen offset:64
v_mfma_f32_16x16x32_bf16 v[148:151],v[220:223],v[88:91],v[148:151]
v_cvt_pk_bf16_f32 v179,v182,v183
v_mul_f32 v184,v184,v227
v_mfma_f32_16x16x32_bf16 v[228:231],v[244:247],a[12:15],v[228:231]
v_mul_f32 v185,v185,v227
v_cvt_pk_bf16_f32 v184,v184,v185
v_mfma_f32_16x16x32_bf16 v[156:159],v[216:219],v[76:79],v[156:159]
s_waitcnt lgkmcnt(8)
v_mul_f32 v186,v186,v227
v_mfma_f32_16x16x32_bf16 v[156:159],v[220:223],v[92:95],v[156:159]
ds_read_b64_tr_b16 v[216:217],v241 offset:0
ds_read_b64_tr_b16 v[218:219],v241 offset:2176
v_mfma_f32_16x16x32_bf16 v[128:131],v[192:195],v[96:99],v[128:131]
buffer_store_dwordx4 v[168:171],v242,s[28:31],s55 offen offset:1024
v_mfma_f32_16x16x32_bf16 v[128:131],v[196:199],v[112:115],v[128:131]
v_mul_f32 v187,v187,v227
v_cvt_pk_bf16_f32 v185,v186,v187
v_mfma_f32_16x16x32_bf16 v[136:139],v[192:195],v[100:103],v[136:139]
buffer_store_dwordx4 v[176:179],v242,s[28:31],s55 offen offset:2048
v_mfma_f32_16x16x32_bf16 v[136:139],v[196:199],v[116:119],v[136:139]
ds_read_b64_tr_b16 v[220:221],v241 offset:4352
ds_read_b64_tr_b16 v[222:223],v241 offset:6528
v_mfma_f32_16x16x32_bf16 v[144:147],v[192:195],v[104:107],v[144:147]
v_cvt_pk_bf16_f32 v232,v228,v229
v_cvt_pk_bf16_f32 v233,v230,v231
v_mfma_f32_16x16x32_bf16 v[144:147],v[196:199],v[120:123],v[144:147]
buffer_load_dwordx4 a[0:3],v248,s[28:31],s60 offen sc1
v_mfma_f32_16x16x32_bf16 v[152:155],v[192:195],v[108:111],v[152:155]
s_waitcnt lgkmcnt(8)
v_mul_f32 v188,v188,v227
v_mfma_f32_16x16x32_bf16 v[152:155],v[196:199],v[124:127],v[152:155]
ds_read_b64_tr_b16 v[192:193],v240 offset:8704
ds_read_b64_tr_b16 v[194:195],v240 offset:10880
v_mfma_f32_16x16x32_bf16 v[132:135],v[200:203],v[96:99],v[132:135]
v_mul_f32 v189,v189,v227
v_cvt_pk_bf16_f32 v186,v188,v189
v_mfma_f32_16x16x32_bf16 v[132:135],v[204:207],v[112:115],v[132:135]
v_mul_f32 v190,v190,v227
v_mul_f32 v191,v191,v227
v_mfma_f32_16x16x32_bf16 v[140:143],v[200:203],v[100:103],v[140:143]
v_cvt_pk_bf16_f32 v187,v190,v191
v_mfma_f32_16x16x32_bf16 v[140:143],v[204:207],v[116:119],v[140:143]
ds_read_b64_tr_b16 v[196:197],v240 offset:13056
ds_read_b64_tr_b16 v[198:199],v240 offset:15232
v_mfma_f32_16x16x32_bf16 v[148:151],v[200:203],v[104:107],v[148:151]
buffer_store_dwordx4 v[184:187],v242,s[28:31],s55 offen offset:3072
v_mfma_f32_16x16x32_bf16 v[148:151],v[204:207],v[120:123],v[148:151]
buffer_load_dwordx4 a[4:7],v249,s[28:31],s60 offen sc1
v_mfma_f32_16x16x32_bf16 v[156:159],v[200:203],v[108:111],v[156:159]
s_waitcnt lgkmcnt(8)
s_add_u32 s55,s55,16384
v_mfma_f32_16x16x32_bf16 v[156:159],v[204:207],v[124:127],v[156:159]
ds_read_b64_tr_b16 v[200:201],v241 offset:8704
ds_read_b64_tr_b16 v[202:203],v241 offset:10880
v_mfma_f32_16x16x32_bf16 v[160:163],v[208:211],v[0:3],0
buffer_load_dwordx4 a[8:11],v250,s[28:31],s60 offen sc1
v_mfma_f32_16x16x32_bf16 v[160:163],v[212:215],v[16:19],v[160:163]
v_mul_f32 v128,v128,v224
v_mul_f32 v129,v129,v224
v_mfma_f32_16x16x32_bf16 v[168:171],v[208:211],v[4:7],0
v_cvt_pk_bf16_f32 v128,v128,v129
v_mul_f32 v130,v130,v224
v_mfma_f32_16x16x32_bf16 v[168:171],v[212:215],v[20:23],v[168:171]
ds_read_b64_tr_b16 v[204:205],v241 offset:13056
ds_read_b64_tr_b16 v[206:207],v241 offset:15232
v_mfma_f32_16x16x32_bf16 v[176:179],v[208:211],v[8:11],0
v_mul_f32 v131,v131,v224
v_cvt_pk_bf16_f32 v129,v130,v131
v_mfma_f32_16x16x32_bf16 v[176:179],v[212:215],v[24:27],v[176:179]
buffer_load_dwordx4 a[12:15],v251,s[28:31],s60 offen sc1
v_mfma_f32_16x16x32_bf16 v[184:187],v[208:211],v[12:15],0
s_sub_u32 s60,s60,49152
s_waitcnt lgkmcnt(8)
v_mfma_f32_16x16x32_bf16 v[184:187],v[212:215],v[28:31],v[184:187]
ds_read_b64_tr_b16 v[208:209],v240 offset:17408
ds_read_b64_tr_b16 v[210:211],v240 offset:19584
v_mfma_f32_16x16x32_bf16 v[164:167],v[216:219],v[0:3],0
v_mul_f32 v132,v132,v224
v_mul_f32 v133,v133,v224
v_mfma_f32_16x16x32_bf16 v[164:167],v[220:223],v[16:19],v[164:167]
v_cvt_pk_bf16_f32 v130,v132,v133
v_mul_f32 v134,v134,v224
v_mfma_f32_16x16x32_bf16 v[172:175],v[216:219],v[4:7],0
v_mul_f32 v135,v135,v224
v_cvt_pk_bf16_f32 v131,v134,v135
v_mfma_f32_16x16x32_bf16 v[172:175],v[220:223],v[20:23],v[172:175]
ds_read_b64_tr_b16 v[212:213],v240 offset:21760
ds_read_b64_tr_b16 v[214:215],v240 offset:23936
v_mfma_f32_16x16x32_bf16 v[180:183],v[216:219],v[8:11],0
buffer_load_dword v234,v253,s[28:31],0 offen sc1
v_mfma_f32_16x16x32_bf16 v[180:183],v[220:223],v[24:27],v[180:183]
v_mul_f32 v136,v136,v225
v_mul_f32 v137,v137,v225
v_mfma_f32_16x16x32_bf16 v[188:191],v[216:219],v[12:15],0
s_waitcnt lgkmcnt(8)
v_cvt_pk_bf16_f32 v136,v136,v137
v_mfma_f32_16x16x32_bf16 v[188:191],v[220:223],v[28:31],v[188:191]
ds_read_b64_tr_b16 v[216:217],v241 offset:17408
ds_read_b64_tr_b16 v[218:219],v241 offset:19584
v_mfma_f32_16x16x32_bf16 v[160:163],v[192:195],v[32:35],v[160:163]
s_add_u32 m0,s32,69632
s_mov_b32 s34,768
v_mfma_f32_16x16x32_bf16 v[160:163],v[196:199],v[48:51],v[160:163]
buffer_load_dwordx4 v235,s[24:27],s34 offen  lds
v_mfma_f32_16x16x32_bf16 v[168:171],v[192:195],v[36:39],v[168:171]
v_mul_f32 v138,v138,v225
v_mul_f32 v139,v139,v225
v_mfma_f32_16x16x32_bf16 v[168:171],v[196:199],v[52:55],v[168:171]
ds_read_b64_tr_b16 v[220:221],v241 offset:21760
ds_read_b64_tr_b16 v[222:223],v241 offset:23936
v_mfma_f32_16x16x32_bf16 v[176:179],v[192:195],v[40:43],v[176:179]
s_add_u32 m0,s32,70720
s_mov_b32 s34,7936
v_mfma_f32_16x16x32_bf16 v[176:179],v[196:199],v[56:59],v[176:179]
buffer_load_dwordx4 v235,s[24:27],s34 offen  lds
v_mfma_f32_16x16x32_bf16 v[184:187],v[192:195],v[44:47],v[184:187]
s_waitcnt lgkmcnt(8)
v_cvt_pk_bf16_f32 v137,v138,v139
v_mfma_f32_16x16x32_bf16 v[184:187],v[196:199],v[60:63],v[184:187]
ds_read_b64_tr_b16 v[192:193],v240 offset:26112
ds_read_b64_tr_b16 v[194:195],v240 offset:28288
v_mfma_f32_16x16x32_bf16 v[164:167],v[200:203],v[32:35],v[164:167]
v_mul_f32 v140,v140,v225
v_mul_f32 v141,v141,v225
v_mfma_f32_16x16x32_bf16 v[164:167],v[204:207],v[48:51],v[164:167]
v_cvt_pk_bf16_f32 v138,v140,v141
v_mul_f32 v142,v142,v225
v_mfma_f32_16x16x32_bf16 v[172:175],v[200:203],v[36:39],v[172:175]
v_mul_f32 v143,v143,v225
v_cvt_pk_bf16_f32 v139,v142,v143
v_mfma_f32_16x16x32_bf16 v[172:175],v[204:207],v[52:55],v[172:175]
ds_read_b64_tr_b16 v[196:197],v240 offset:30464
ds_read_b64_tr_b16 v[198:199],v240 offset:32640
v_mfma_f32_16x16x32_bf16 v[180:183],v[200:203],v[40:43],v[180:183]
s_add_u32 m0,s32,71808
s_mov_b32 s34,15104
v_mfma_f32_16x16x32_bf16 v[180:183],v[204:207],v[56:59],v[180:183]
buffer_load_dwordx4 v235,s[24:27],s34 offen  lds
v_mfma_f32_16x16x32_bf16 v[188:191],v[200:203],v[44:47],v[188:191]
s_waitcnt lgkmcnt(8)
v_add_u32 v237,6,v243
v_mfma_f32_16x16x32_bf16 v[188:191],v[204:207],v[60:63],v[188:191]
ds_read_b64_tr_b16 v[200:201],v241 offset:26112
ds_read_b64_tr_b16 v[202:203],v241 offset:28288
v_mfma_f32_16x16x32_bf16 v[160:163],v[208:211],v[64:67],v[160:163]
s_add_u32 m0,s32,72896
s_mov_b32 s34,22272
v_mfma_f32_16x16x32_bf16 v[160:163],v[212:215],v[80:83],v[160:163]
buffer_load_dwordx4 v235,s[24:27],s34 offen  lds
v_mfma_f32_16x16x32_bf16 v[168:171],v[208:211],v[68:71],v[168:171]
v_mul_f32 v144,v144,v226
v_mul_f32 v145,v145,v226
v_mfma_f32_16x16x32_bf16 v[168:171],v[212:215],v[84:87],v[168:171]
ds_read_b64_tr_b16 v[204:205],v241 offset:30464
ds_read_b64_tr_b16 v[206:207],v241 offset:32640
v_mfma_f32_16x16x32_bf16 v[176:179],v[208:211],v[72:75],v[176:179]
v_add_u32 v240,87040,v240
v_add_u32 v241,87040,v241
v_mfma_f32_16x16x32_bf16 v[176:179],v[212:215],v[88:91],v[176:179]
v_cvt_pk_bf16_f32 v144,v144,v145
v_mul_f32 v146,v146,v226
v_mfma_f32_16x16x32_bf16 v[184:187],v[208:211],v[76:79],v[184:187]
s_waitcnt vmcnt(4) lgkmcnt(8)
s_barrier
v_mfma_f32_16x16x32_bf16 v[184:187],v[212:215],v[92:95],v[184:187]
ds_read_b64_tr_b16 v[208:209],v238 offset:0
ds_read_b64_tr_b16 v[210:211],v238 offset:2176
v_mfma_f32_16x16x32_bf16 v[228:231],v[244:247],a[0:3],0
buffer_store_dword v237,v252,s[28:31],0 offen
v_mfma_f32_16x16x32_bf16 v[164:167],v[216:219],v[64:67],v[164:167]
v_cmp_gt_u32 vcc,5,v234
v_mul_f32 v147,v147,v226
v_mfma_f32_16x16x32_bf16 v[164:167],v[220:223],v[80:83],v[164:167]
s_cbranch_vccnz SP_7
SP_7_RET:
v_cvt_pk_bf16_f32 v145,v146,v147
v_mfma_f32_16x16x32_bf16 v[228:231],v[244:247],a[4:7],v[228:231]
buffer_store_dwordx4 v[128:131],v242,s[28:31],s55 offen offset:0
v_mfma_f32_16x16x32_bf16 v[172:175],v[216:219],v[68:71],v[172:175]
v_mul_f32 v148,v148,v226
v_mul_f32 v149,v149,v226
v_mfma_f32_16x16x32_bf16 v[172:175],v[220:223],v[84:87],v[172:175]
ds_read_b64_tr_b16 v[212:213],v238 offset:4352
ds_read_b64_tr_b16 v[214:215],v238 offset:6528
v_mfma_f32_16x16x32_bf16 v[228:231],v[244:247],a[8:11],v[228:231]
v_cvt_pk_bf16_f32 v146,v148,v149
v_mul_f32 v150,v150,v226
v_mfma_f32_16x16x32_bf16 v[180:183],v[216:219],v[72:75],v[180:183]
buffer_store_dwordx2 v[232:233],v254,s[16:19],0 offen offset:128
v_mfma_f32_16x16x32_bf16 v[180:183],v[220:223],v[88:91],v[180:183]
v_mul_f32 v151,v151,v226
v_cvt_pk_bf16_f32 v147,v150,v151
v_mfma_f32_16x16x32_bf16 v[228:231],v[244:247],a[12:15],v[228:231]
v_mul_f32 v152,v152,v227
v_mul_f32 v153,v153,v227
v_mfma_f32_16x16x32_bf16 v[188:191],v[216:219],v[76:79],v[188:191]
s_waitcnt lgkmcnt(8)
v_cvt_pk_bf16_f32 v152,v152,v153
v_mfma_f32_16x16x32_bf16 v[188:191],v[220:223],v[92:95],v[188:191]
ds_read_b64_tr_b16 v[216:217],v239 offset:0
ds_read_b64_tr_b16 v[218:219],v239 offset:2176
v_mfma_f32_16x16x32_bf16 v[160:163],v[192:195],v[96:99],v[160:163]
buffer_store_dwordx4 v[136:139],v242,s[28:31],s55 offen offset:1024
v_mfma_f32_16x16x32_bf16 v[160:163],v[196:199],v[112:115],v[160:163]
v_mul_f32 v154,v154,v227
v_mul_f32 v155,v155,v227
v_mfma_f32_16x16x32_bf16 v[168:171],v[192:195],v[100:103],v[168:171]
buffer_store_dwordx4 v[144:147],v242,s[28:31],s55 offen offset:2048
v_mfma_f32_16x16x32_bf16 v[168:171],v[196:199],v[116:119],v[168:171]
ds_read_b64_tr_b16 v[220:221],v239 offset:4352
ds_read_b64_tr_b16 v[222:223],v239 offset:6528
v_mfma_f32_16x16x32_bf16 v[176:179],v[192:195],v[104:107],v[176:179]
v_cvt_pk_bf16_f32 v232,v228,v229
v_cvt_pk_bf16_f32 v233,v230,v231
v_mfma_f32_16x16x32_bf16 v[176:179],v[196:199],v[120:123],v[176:179]
buffer_load_dwordx4 a[0:3],v248,s[28:31],s60 offen sc1
v_mfma_f32_16x16x32_bf16 v[184:187],v[192:195],v[108:111],v[184:187]
s_waitcnt lgkmcnt(8)
v_cvt_pk_bf16_f32 v153,v154,v155
v_mfma_f32_16x16x32_bf16 v[184:187],v[196:199],v[124:127],v[184:187]
ds_read_b64_tr_b16 v[192:193],v238 offset:8704
ds_read_b64_tr_b16 v[194:195],v238 offset:10880
v_mfma_f32_16x16x32_bf16 v[164:167],v[200:203],v[96:99],v[164:167]
v_mul_f32 v156,v156,v227
v_mul_f32 v157,v157,v227
v_mfma_f32_16x16x32_bf16 v[164:167],v[204:207],v[112:115],v[164:167]
v_cvt_pk_bf16_f32 v154,v156,v157
v_mul_f32 v158,v158,v227
v_mfma_f32_16x16x32_bf16 v[172:175],v[200:203],v[100:103],v[172:175]
v_mul_f32 v159,v159,v227
v_cvt_pk_bf16_f32 v155,v158,v159
v_mfma_f32_16x16x32_bf16 v[172:175],v[204:207],v[116:119],v[172:175]
ds_read_b64_tr_b16 v[196:197],v238 offset:13056
ds_read_b64_tr_b16 v[198:199],v238 offset:15232
v_mfma_f32_16x16x32_bf16 v[180:183],v[200:203],v[104:107],v[180:183]
buffer_store_dwordx4 v[152:155],v242,s[28:31],s55 offen offset:3072
v_mfma_f32_16x16x32_bf16 v[180:183],v[204:207],v[120:123],v[180:183]
buffer_load_dwordx4 a[4:7],v249,s[28:31],s60 offen sc1
v_mfma_f32_16x16x32_bf16 v[188:191],v[200:203],v[108:111],v[188:191]
s_waitcnt lgkmcnt(8)
s_add_u32 s55,s55,16384
v_mfma_f32_16x16x32_bf16 v[188:191],v[204:207],v[124:127],v[188:191]
ds_read_b64_tr_b16 v[200:201],v239 offset:8704
ds_read_b64_tr_b16 v[202:203],v239 offset:10880
v_mfma_f32_16x16x32_bf16 v[128:131],v[208:211],v[0:3],0
buffer_load_dwordx4 a[8:11],v250,s[28:31],s60 offen sc1
v_mfma_f32_16x16x32_bf16 v[128:131],v[212:215],v[16:19],v[128:131]
v_mul_f32 v160,v160,v224
v_mul_f32 v161,v161,v224
v_mfma_f32_16x16x32_bf16 v[136:139],v[208:211],v[4:7],0
v_cvt_pk_bf16_f32 v160,v160,v161
v_mul_f32 v162,v162,v224
v_mfma_f32_16x16x32_bf16 v[136:139],v[212:215],v[20:23],v[136:139]
ds_read_b64_tr_b16 v[204:205],v239 offset:13056
ds_read_b64_tr_b16 v[206:207],v239 offset:15232
v_mfma_f32_16x16x32_bf16 v[144:147],v[208:211],v[8:11],0
v_mul_f32 v163,v163,v224
v_cvt_pk_bf16_f32 v161,v162,v163
v_mfma_f32_16x16x32_bf16 v[144:147],v[212:215],v[24:27],v[144:147]
buffer_load_dwordx4 a[12:15],v251,s[28:31],s60 offen sc1
v_mfma_f32_16x16x32_bf16 v[152:155],v[208:211],v[12:15],0
s_add_u32 s60,s60,16384
s_waitcnt lgkmcnt(8)
v_mfma_f32_16x16x32_bf16 v[152:155],v[212:215],v[28:31],v[152:155]
ds_read_b64_tr_b16 v[208:209],v238 offset:17408
ds_read_b64_tr_b16 v[210:211],v238 offset:19584
v_mfma_f32_16x16x32_bf16 v[132:135],v[216:219],v[0:3],0
v_mul_f32 v164,v164,v224
v_mul_f32 v165,v165,v224
v_mfma_f32_16x16x32_bf16 v[132:135],v[220:223],v[16:19],v[132:135]
v_cvt_pk_bf16_f32 v162,v164,v165
v_mul_f32 v166,v166,v224
v_mfma_f32_16x16x32_bf16 v[140:143],v[216:219],v[4:7],0
v_mul_f32 v167,v167,v224
v_cvt_pk_bf16_f32 v163,v166,v167
v_mfma_f32_16x16x32_bf16 v[140:143],v[220:223],v[20:23],v[140:143]
ds_read_b64_tr_b16 v[212:213],v238 offset:21760
ds_read_b64_tr_b16 v[214:215],v238 offset:23936
v_mfma_f32_16x16x32_bf16 v[148:151],v[216:219],v[8:11],0
buffer_load_dword v234,v253,s[28:31],0 offen sc1
v_mfma_f32_16x16x32_bf16 v[148:151],v[220:223],v[24:27],v[148:151]
v_mul_f32 v168,v168,v225
v_mul_f32 v169,v169,v225
v_mfma_f32_16x16x32_bf16 v[156:159],v[216:219],v[12:15],0
s_waitcnt lgkmcnt(8)
v_cvt_pk_bf16_f32 v168,v168,v169
v_mfma_f32_16x16x32_bf16 v[156:159],v[220:223],v[28:31],v[156:159]
ds_read_b64_tr_b16 v[216:217],v239 offset:17408
ds_read_b64_tr_b16 v[218:219],v239 offset:19584
v_mfma_f32_16x16x32_bf16 v[128:131],v[192:195],v[32:35],v[128:131]
s_add_u32 m0,s32,87040
s_mov_b32 s34,115456
v_mfma_f32_16x16x32_bf16 v[128:131],v[196:199],v[48:51],v[128:131]
buffer_load_dwordx4 v235,s[24:27],s34 offen  lds
v_mfma_f32_16x16x32_bf16 v[136:139],v[192:195],v[36:39],v[136:139]
v_mul_f32 v170,v170,v225
v_mul_f32 v171,v171,v225
v_mfma_f32_16x16x32_bf16 v[136:139],v[196:199],v[52:55],v[136:139]
ds_read_b64_tr_b16 v[220:221],v239 offset:21760
ds_read_b64_tr_b16 v[222:223],v239 offset:23936
v_mfma_f32_16x16x32_bf16 v[144:147],v[192:195],v[40:43],v[144:147]
s_add_u32 m0,s32,88128
s_mov_b32 s34,122624
v_mfma_f32_16x16x32_bf16 v[144:147],v[196:199],v[56:59],v[144:147]
buffer_load_dwordx4 v235,s[24:27],s34 offen  lds
v_mfma_f32_16x16x32_bf16 v[152:155],v[192:195],v[44:47],v[152:155]
s_waitcnt lgkmcnt(8)
v_cvt_pk_bf16_f32 v169,v170,v171
v_mfma_f32_16x16x32_bf16 v[152:155],v[196:199],v[60:63],v[152:155]
ds_read_b64_tr_b16 v[192:193],v238 offset:26112
ds_read_b64_tr_b16 v[194:195],v238 offset:28288
v_mfma_f32_16x16x32_bf16 v[132:135],v[200:203],v[32:35],v[132:135]
v_mul_f32 v172,v172,v225
v_mul_f32 v173,v173,v225
v_mfma_f32_16x16x32_bf16 v[132:135],v[204:207],v[48:51],v[132:135]
v_cvt_pk_bf16_f32 v170,v172,v173
v_mul_f32 v174,v174,v225
v_mfma_f32_16x16x32_bf16 v[140:143],v[200:203],v[36:39],v[140:143]
v_mul_f32 v175,v175,v225
v_cvt_pk_bf16_f32 v171,v174,v175
v_mfma_f32_16x16x32_bf16 v[140:143],v[204:207],v[52:55],v[140:143]
ds_read_b64_tr_b16 v[196:197],v238 offset:30464
ds_read_b64_tr_b16 v[198:199],v238 offset:32640
v_mfma_f32_16x16x32_bf16 v[148:151],v[200:203],v[40:43],v[148:151]
s_add_u32 m0,s32,89216
s_mov_b32 s34,129792
v_mfma_f32_16x16x32_bf16 v[148:151],v[204:207],v[56:59],v[148:151]
buffer_load_dwordx4 v235,s[24:27],s34 offen  lds
v_mfma_f32_16x16x32_bf16 v[156:159],v[200:203],v[44:47],v[156:159]
s_waitcnt lgkmcnt(8)
v_add_u32 v237,7,v243
v_mfma_f32_16x16x32_bf16 v[156:159],v[204:207],v[60:63],v[156:159]
ds_read_b64_tr_b16 v[200:201],v239 offset:26112
ds_read_b64_tr_b16 v[202:203],v239 offset:28288
v_mfma_f32_16x16x32_bf16 v[128:131],v[208:211],v[64:67],v[128:131]
s_add_u32 m0,s32,90304
s_mov_b32 s34,136960
v_mfma_f32_16x16x32_bf16 v[128:131],v[212:215],v[80:83],v[128:131]
buffer_load_dwordx4 v235,s[24:27],s34 offen  lds
v_mfma_f32_16x16x32_bf16 v[136:139],v[208:211],v[68:71],v[136:139]
v_mul_f32 v176,v176,v226
v_mul_f32 v177,v177,v226
v_mfma_f32_16x16x32_bf16 v[136:139],v[212:215],v[84:87],v[136:139]
ds_read_b64_tr_b16 v[204:205],v239 offset:30464
ds_read_b64_tr_b16 v[206:207],v239 offset:32640
v_mfma_f32_16x16x32_bf16 v[144:147],v[208:211],v[72:75],v[144:147]
v_subrev_u32 v238,121856,v238
v_subrev_u32 v239,121856,v239
v_mfma_f32_16x16x32_bf16 v[144:147],v[212:215],v[88:91],v[144:147]
v_cvt_pk_bf16_f32 v176,v176,v177
v_mul_f32 v178,v178,v226
v_mfma_f32_16x16x32_bf16 v[152:155],v[208:211],v[76:79],v[152:155]
s_waitcnt vmcnt(4) lgkmcnt(8)
v_mul_f32 v179,v179,v226
v_mfma_f32_16x16x32_bf16 v[152:155],v[212:215],v[92:95],v[152:155]
ds_read_b64_tr_b16 v[208:209],v240 offset:0
ds_read_b64_tr_b16 v[210:211],v240 offset:2176
v_mfma_f32_16x16x32_bf16 v[228:231],v[244:247],a[0:3],0
buffer_store_dword v237,v252,s[28:31],0 offen
v_mfma_f32_16x16x32_bf16 v[132:135],v[216:219],v[64:67],v[132:135]
v_cmp_gt_u32 vcc,6,v234
v_cvt_pk_bf16_f32 v177,v178,v179
v_mfma_f32_16x16x32_bf16 v[132:135],v[220:223],v[80:83],v[132:135]
s_cbranch_vccnz SP_8
SP_8_RET:
v_mul_f32 v180,v180,v226
v_mfma_f32_16x16x32_bf16 v[228:231],v[244:247],a[4:7],v[228:231]
buffer_store_dwordx4 v[160:163],v242,s[28:31],s55 offen offset:0
v_mfma_f32_16x16x32_bf16 v[140:143],v[216:219],v[68:71],v[140:143]
v_mul_f32 v181,v181,v226
v_cvt_pk_bf16_f32 v178,v180,v181
v_mfma_f32_16x16x32_bf16 v[140:143],v[220:223],v[84:87],v[140:143]
ds_read_b64_tr_b16 v[212:213],v240 offset:4352
ds_read_b64_tr_b16 v[214:215],v240 offset:6528
v_mfma_f32_16x16x32_bf16 v[228:231],v[244:247],a[8:11],v[228:231]
v_mul_f32 v182,v182,v226
v_mul_f32 v183,v183,v226
v_mfma_f32_16x16x32_bf16 v[148:151],v[216:219],v[72:75],v[148:151]
buffer_store_dwordx2 v[232:233],v254,s[16:19],0 offen offset:192
v_mfma_f32_16x16x32_bf16 v[148:151],v[220:223],v[88:91],v[148:151]
v_cvt_pk_bf16_f32 v179,v182,v183
v_mul_f32 v184,v184,v227
v_mfma_f32_16x16x32_bf16 v[228:231],v[244:247],a[12:15],v[228:231]
v_mul_f32 v185,v185,v227
v_cvt_pk_bf16_f32 v184,v184,v185
v_mfma_f32_16x16x32_bf16 v[156:159],v[216:219],v[76:79],v[156:159]
s_waitcnt lgkmcnt(8)
v_mul_f32 v186,v186,v227
v_mfma_f32_16x16x32_bf16 v[156:159],v[220:223],v[92:95],v[156:159]
ds_read_b64_tr_b16 v[216:217],v241 offset:0
ds_read_b64_tr_b16 v[218:219],v241 offset:2176
v_mfma_f32_16x16x32_bf16 v[128:131],v[192:195],v[96:99],v[128:131]
buffer_store_dwordx4 v[168:171],v242,s[28:31],s55 offen offset:1024
v_mfma_f32_16x16x32_bf16 v[128:131],v[196:199],v[112:115],v[128:131]
v_mul_f32 v187,v187,v227
v_cvt_pk_bf16_f32 v185,v186,v187
v_mfma_f32_16x16x32_bf16 v[136:139],v[192:195],v[100:103],v[136:139]
buffer_store_dwordx4 v[176:179],v242,s[28:31],s55 offen offset:2048
v_mfma_f32_16x16x32_bf16 v[136:139],v[196:199],v[116:119],v[136:139]
ds_read_b64_tr_b16 v[220:221],v241 offset:4352
ds_read_b64_tr_b16 v[222:223],v241 offset:6528
v_mfma_f32_16x16x32_bf16 v[144:147],v[192:195],v[104:107],v[144:147]
v_cvt_pk_bf16_f32 v232,v228,v229
v_cvt_pk_bf16_f32 v233,v230,v231
v_mfma_f32_16x16x32_bf16 v[144:147],v[196:199],v[120:123],v[144:147]
buffer_load_dwordx4 a[0:3],v248,s[28:31],s60 offen sc1
v_mfma_f32_16x16x32_bf16 v[152:155],v[192:195],v[108:111],v[152:155]
s_waitcnt lgkmcnt(8)
v_mul_f32 v188,v188,v227
v_mfma_f32_16x16x32_bf16 v[152:155],v[196:199],v[124:127],v[152:155]
ds_read_b64_tr_b16 v[192:193],v240 offset:8704
ds_read_b64_tr_b16 v[194:195],v240 offset:10880
v_mfma_f32_16x16x32_bf16 v[132:135],v[200:203],v[96:99],v[132:135]
v_mul_f32 v189,v189,v227
v_cvt_pk_bf16_f32 v186,v188,v189
v_mfma_f32_16x16x32_bf16 v[132:135],v[204:207],v[112:115],v[132:135]
v_mul_f32 v190,v190,v227
v_mul_f32 v191,v191,v227
v_mfma_f32_16x16x32_bf16 v[140:143],v[200:203],v[100:103],v[140:143]
v_cvt_pk_bf16_f32 v187,v190,v191
v_mfma_f32_16x16x32_bf16 v[140:143],v[204:207],v[116:119],v[140:143]
ds_read_b64_tr_b16 v[196:197],v240 offset:13056
ds_read_b64_tr_b16 v[198:199],v240 offset:15232
v_mfma_f32_16x16x32_bf16 v[148:151],v[200:203],v[104:107],v[148:151]
buffer_store_dwordx4 v[184:187],v242,s[28:31],s55 offen offset:3072
v_mfma_f32_16x16x32_bf16 v[148:151],v[204:207],v[120:123],v[148:151]
buffer_load_dwordx4 a[4:7],v249,s[28:31],s60 offen sc1
v_mfma_f32_16x16x32_bf16 v[156:159],v[200:203],v[108:111],v[156:159]
s_waitcnt lgkmcnt(8)
s_sub_u32 s55,s55,49152
v_mfma_f32_16x16x32_bf16 v[156:159],v[204:207],v[124:127],v[156:159]
ds_read_b64_tr_b16 v[200:201],v241 offset:8704
ds_read_b64_tr_b16 v[202:203],v241 offset:10880
v_mfma_f32_16x16x32_bf16 v[160:163],v[208:211],v[0:3],0
buffer_load_dwordx4 a[8:11],v250,s[28:31],s60 offen sc1
v_mfma_f32_16x16x32_bf16 v[160:163],v[212:215],v[16:19],v[160:163]
v_mul_f32 v128,v128,v224
v_mul_f32 v129,v129,v224
v_mfma_f32_16x16x32_bf16 v[168:171],v[208:211],v[4:7],0
v_cvt_pk_bf16_f32 v128,v128,v129
v_mul_f32 v130,v130,v224
v_mfma_f32_16x16x32_bf16 v[168:171],v[212:215],v[20:23],v[168:171]
ds_read_b64_tr_b16 v[204:205],v241 offset:13056
ds_read_b64_tr_b16 v[206:207],v241 offset:15232
v_mfma_f32_16x16x32_bf16 v[176:179],v[208:211],v[8:11],0
v_mul_f32 v131,v131,v224
v_cvt_pk_bf16_f32 v129,v130,v131
v_mfma_f32_16x16x32_bf16 v[176:179],v[212:215],v[24:27],v[176:179]
buffer_load_dwordx4 a[12:15],v251,s[28:31],s60 offen sc1
v_mfma_f32_16x16x32_bf16 v[184:187],v[208:211],v[12:15],0
s_add_u32 s60,s60,16384
s_waitcnt lgkmcnt(8)
v_mfma_f32_16x16x32_bf16 v[184:187],v[212:215],v[28:31],v[184:187]
ds_read_b64_tr_b16 v[208:209],v240 offset:17408
ds_read_b64_tr_b16 v[210:211],v240 offset:19584
v_mfma_f32_16x16x32_bf16 v[164:167],v[216:219],v[0:3],0
v_mul_f32 v132,v132,v224
v_mul_f32 v133,v133,v224
v_mfma_f32_16x16x32_bf16 v[164:167],v[220:223],v[16:19],v[164:167]
v_cvt_pk_bf16_f32 v130,v132,v133
v_mul_f32 v134,v134,v224
v_mfma_f32_16x16x32_bf16 v[172:175],v[216:219],v[4:7],0
v_mul_f32 v135,v135,v224
v_cvt_pk_bf16_f32 v131,v134,v135
v_mfma_f32_16x16x32_bf16 v[172:175],v[220:223],v[20:23],v[172:175]
ds_read_b64_tr_b16 v[212:213],v240 offset:21760
ds_read_b64_tr_b16 v[214:215],v240 offset:23936
v_mfma_f32_16x16x32_bf16 v[180:183],v[216:219],v[8:11],0
buffer_load_dword v234,v253,s[28:31],0 offen sc1
v_mfma_f32_16x16x32_bf16 v[180:183],v[220:223],v[24:27],v[180:183]
v_mul_f32 v136,v136,v225
v_mul_f32 v137,v137,v225
v_mfma_f32_16x16x32_bf16 v[188:191],v[216:219],v[12:15],0
s_waitcnt lgkmcnt(8)
v_cvt_pk_bf16_f32 v136,v136,v137
v_mfma_f32_16x16x32_bf16 v[188:191],v[220:223],v[28:31],v[188:191]
ds_read_b64_tr_b16 v[216:217],v241 offset:17408
ds_read_b64_tr_b16 v[218:219],v241 offset:19584
v_mfma_f32_16x16x32_bf16 v[160:163],v[192:195],v[32:35],v[160:163]
v_mul_f32 v138,v138,v225
v_mul_f32 v139,v139,v225
v_mfma_f32_16x16x32_bf16 v[160:163],v[196:199],v[48:51],v[160:163]
v_cvt_pk_bf16_f32 v137,v138,v139
v_mul_f32 v140,v140,v225
v_mfma_f32_16x16x32_bf16 v[168:171],v[192:195],v[36:39],v[168:171]
v_mul_f32 v141,v141,v225
v_cvt_pk_bf16_f32 v138,v140,v141
v_mfma_f32_16x16x32_bf16 v[168:171],v[196:199],v[52:55],v[168:171]
ds_read_b64_tr_b16 v[220:221],v241 offset:21760
ds_read_b64_tr_b16 v[222:223],v241 offset:23936
v_mfma_f32_16x16x32_bf16 v[176:179],v[192:195],v[40:43],v[176:179]
v_mul_f32 v142,v142,v225
v_mul_f32 v143,v143,v225
v_mfma_f32_16x16x32_bf16 v[176:179],v[196:199],v[56:59],v[176:179]
v_cvt_pk_bf16_f32 v139,v142,v143
v_mul_f32 v144,v144,v226
v_mfma_f32_16x16x32_bf16 v[184:187],v[192:195],v[44:47],v[184:187]
s_waitcnt lgkmcnt(8)
v_mul_f32 v145,v145,v226
v_mfma_f32_16x16x32_bf16 v[184:187],v[196:199],v[60:63],v[184:187]
ds_read_b64_tr_b16 v[192:193],v240 offset:26112
ds_read_b64_tr_b16 v[194:195],v240 offset:28288
v_mfma_f32_16x16x32_bf16 v[164:167],v[200:203],v[32:35],v[164:167]
v_cvt_pk_bf16_f32 v144,v144,v145
v_mul_f32 v146,v146,v226
v_mfma_f32_16x16x32_bf16 v[164:167],v[204:207],v[48:51],v[164:167]
v_mul_f32 v147,v147,v226
v_cvt_pk_bf16_f32 v145,v146,v147
v_mfma_f32_16x16x32_bf16 v[172:175],v[200:203],v[36:39],v[172:175]
v_mul_f32 v148,v148,v226
v_mul_f32 v149,v149,v226
v_mfma_f32_16x16x32_bf16 v[172:175],v[204:207],v[52:55],v[172:175]
ds_read_b64_tr_b16 v[196:197],v240 offset:30464
ds_read_b64_tr_b16 v[198:199],v240 offset:32640
v_mfma_f32_16x16x32_bf16 v[180:183],v[200:203],v[40:43],v[180:183]
v_cvt_pk_bf16_f32 v146,v148,v149
v_mul_f32 v150,v150,v226
v_mfma_f32_16x16x32_bf16 v[180:183],v[204:207],v[56:59],v[180:183]
v_mul_f32 v151,v151,v226
v_cvt_pk_bf16_f32 v147,v150,v151
v_mfma_f32_16x16x32_bf16 v[188:191],v[200:203],v[44:47],v[188:191]
s_waitcnt lgkmcnt(8)
v_add_u32 v237,8,v243
v_mfma_f32_16x16x32_bf16 v[188:191],v[204:207],v[60:63],v[188:191]
ds_read_b64_tr_b16 v[200:201],v241 offset:26112
ds_read_b64_tr_b16 v[202:203],v241 offset:28288
v_mfma_f32_16x16x32_bf16 v[160:163],v[208:211],v[64:67],v[160:163]
v_mul_f32 v152,v152,v227
v_mul_f32 v153,v153,v227
v_mfma_f32_16x16x32_bf16 v[160:163],v[212:215],v[80:83],v[160:163]
v_cvt_pk_bf16_f32 v152,v152,v153
v_mul_f32 v154,v154,v227
v_mfma_f32_16x16x32_bf16 v[168:171],v[208:211],v[68:71],v[168:171]
v_mul_f32 v155,v155,v227
v_cvt_pk_bf16_f32 v153,v154,v155
v_mfma_f32_16x16x32_bf16 v[168:171],v[212:215],v[84:87],v[168:171]
ds_read_b64_tr_b16 v[204:205],v241 offset:30464
ds_read_b64_tr_b16 v[206:207],v241 offset:32640
v_mfma_f32_16x16x32_bf16 v[176:179],v[208:211],v[72:75],v[176:179]
v_subrev_u32 v240,121856,v240
v_subrev_u32 v241,121856,v241
v_mfma_f32_16x16x32_bf16 v[176:179],v[212:215],v[88:91],v[176:179]
v_mul_f32 v156,v156,v227
v_mul_f32 v157,v157,v227
v_mfma_f32_16x16x32_bf16 v[184:187],v[208:211],v[76:79],v[184:187]
s_waitcnt vmcnt(0) lgkmcnt(8)
s_barrier
v_mfma_f32_16x16x32_bf16 v[184:187],v[212:215],v[92:95],v[184:187]
ds_read_b64_tr_b16 v[208:209],v238 offset:0
ds_read_b64_tr_b16 v[210:211],v238 offset:2176
v_mfma_f32_16x16x32_bf16 v[228:231],v[244:247],a[0:3],0
buffer_store_dword v237,v252,s[28:31],0 offen
v_mfma_f32_16x16x32_bf16 v[164:167],v[216:219],v[64:67],v[164:167]
v_cmp_gt_u32 vcc,7,v234
v_cvt_pk_bf16_f32 v154,v156,v157
v_mfma_f32_16x16x32_bf16 v[164:167],v[220:223],v[80:83],v[164:167]
s_cbranch_vccnz SP_9
SP_9_RET:
v_mul_f32 v158,v158,v227
v_mfma_f32_16x16x32_bf16 v[228:231],v[244:247],a[4:7],v[228:231]
buffer_store_dwordx4 v[128:131],v242,s[28:31],s55 offen offset:0
v_mfma_f32_16x16x32_bf16 v[172:175],v[216:219],v[68:71],v[172:175]
v_mul_f32 v159,v159,v227
v_cvt_pk_bf16_f32 v155,v158,v159
v_mfma_f32_16x16x32_bf16 v[172:175],v[220:223],v[84:87],v[172:175]
ds_read_b64_tr_b16 v[212:213],v238 offset:4352
ds_read_b64_tr_b16 v[214:215],v238 offset:6528
v_mfma_f32_16x16x32_bf16 v[228:231],v[244:247],a[8:11],v[228:231]
v_mfma_f32_16x16x32_bf16 v[180:183],v[216:219],v[72:75],v[180:183]
buffer_store_dwordx2 v[232:233],v254,s[16:19],0 offen offset:256
v_mfma_f32_16x16x32_bf16 v[180:183],v[220:223],v[88:91],v[180:183]
v_mfma_f32_16x16x32_bf16 v[228:231],v[244:247],a[12:15],v[228:231]
v_mfma_f32_16x16x32_bf16 v[188:191],v[216:219],v[76:79],v[188:191]
s_waitcnt lgkmcnt(8)
v_mfma_f32_16x16x32_bf16 v[188:191],v[220:223],v[92:95],v[188:191]
ds_read_b64_tr_b16 v[216:217],v239 offset:0
ds_read_b64_tr_b16 v[218:219],v239 offset:2176
v_mfma_f32_16x16x32_bf16 v[160:163],v[192:195],v[96:99],v[160:163]
buffer_store_dwordx4 v[136:139],v242,s[28:31],s55 offen offset:1024
v_mfma_f32_16x16x32_bf16 v[160:163],v[196:199],v[112:115],v[160:163]
v_mfma_f32_16x16x32_bf16 v[168:171],v[192:195],v[100:103],v[168:171]
buffer_store_dwordx4 v[144:147],v242,s[28:31],s55 offen offset:2048
v_mfma_f32_16x16x32_bf16 v[168:171],v[196:199],v[116:119],v[168:171]
ds_read_b64_tr_b16 v[220:221],v239 offset:4352
ds_read_b64_tr_b16 v[222:223],v239 offset:6528
v_mfma_f32_16x16x32_bf16 v[176:179],v[192:195],v[104:107],v[176:179]
v_cvt_pk_bf16_f32 v232,v228,v229
v_cvt_pk_bf16_f32 v233,v230,v231
v_mfma_f32_16x16x32_bf16 v[176:179],v[196:199],v[120:123],v[176:179]
buffer_load_dwordx4 a[0:3],v248,s[28:31],s60 offen sc1
v_mfma_f32_16x16x32_bf16 v[184:187],v[192:195],v[108:111],v[184:187]
s_waitcnt lgkmcnt(8)
v_mfma_f32_16x16x32_bf16 v[184:187],v[196:199],v[124:127],v[184:187]
ds_read_b64_tr_b16 v[192:193],v238 offset:8704
ds_read_b64_tr_b16 v[194:195],v238 offset:10880
v_mfma_f32_16x16x32_bf16 v[164:167],v[200:203],v[96:99],v[164:167]
buffer_store_dwordx4 v[152:155],v242,s[28:31],s55 offen offset:3072
v_mfma_f32_16x16x32_bf16 v[164:167],v[204:207],v[112:115],v[164:167]
s_add_u32 s55,s55,16384
v_mfma_f32_16x16x32_bf16 v[172:175],v[200:203],v[100:103],v[172:175]
v_mfma_f32_16x16x32_bf16 v[172:175],v[204:207],v[116:119],v[172:175]
ds_read_b64_tr_b16 v[196:197],v238 offset:13056
ds_read_b64_tr_b16 v[198:199],v238 offset:15232
v_mfma_f32_16x16x32_bf16 v[180:183],v[200:203],v[104:107],v[180:183]
v_mfma_f32_16x16x32_bf16 v[180:183],v[204:207],v[120:123],v[180:183]
buffer_load_dwordx4 a[4:7],v249,s[28:31],s60 offen sc1
v_mfma_f32_16x16x32_bf16 v[188:191],v[200:203],v[108:111],v[188:191]
s_waitcnt lgkmcnt(8)
v_mfma_f32_16x16x32_bf16 v[188:191],v[204:207],v[124:127],v[188:191]
ds_read_b64_tr_b16 v[200:201],v239 offset:8704
ds_read_b64_tr_b16 v[202:203],v239 offset:10880
v_mfma_f32_16x16x32_bf16 v[128:131],v[208:211],v[0:3],0
buffer_load_dwordx4 a[8:11],v250,s[28:31],s60 offen sc1
v_mfma_f32_16x16x32_bf16 v[128:131],v[212:215],v[16:19],v[128:131]
v_mul_f32 v160,v160,v224
v_mul_f32 v161,v161,v224
v_mfma_f32_16x16x32_bf16 v[136:139],v[208:211],v[4:7],0
v_cvt_pk_bf16_f32 v160,v160,v161
v_mul_f32 v162,v162,v224
v_mfma_f32_16x16x32_bf16 v[136:139],v[212:215],v[20:23],v[136:139]
ds_read_b64_tr_b16 v[204:205],v239 offset:13056
ds_read_b64_tr_b16 v[206:207],v239 offset:15232
v_mfma_f32_16x16x32_bf16 v[144:147],v[208:211],v[8:11],0
v_mul_f32 v163,v163,v224
v_cvt_pk_bf16_f32 v161,v162,v163
v_mfma_f32_16x16x32_bf16 v[144:147],v[212:215],v[24:27],v[144:147]
buffer_load_dwordx4 a[12:15],v251,s[28:31],s60 offen sc1
v_mfma_f32_16x16x32_bf16 v[152:155],v[208:211],v[12:15],0
s_add_u32 s60,s60,16384
s_waitcnt lgkmcnt(8)
v_mfma_f32_16x16x32_bf16 v[152:155],v[212:215],v[28:31],v[152:155]
ds_read_b64_tr_b16 v[208:209],v238 offset:17408
ds_read_b64_tr_b16 v[210:211],v238 offset:19584
v_mfma_f32_16x16x32_bf16 v[132:135],v[216:219],v[0:3],0
v_mul_f32 v164,v164,v224
v_mul_f32 v165,v165,v224
v_mfma_f32_16x16x32_bf16 v[132:135],v[220:223],v[16:19],v[132:135]
v_cvt_pk_bf16_f32 v162,v164,v165
v_mul_f32 v166,v166,v224
v_mfma_f32_16x16x32_bf16 v[140:143],v[216:219],v[4:7],0
v_mul_f32 v167,v167,v224
v_cvt_pk_bf16_f32 v163,v166,v167
v_mfma_f32_16x16x32_bf16 v[140:143],v[220:223],v[20:23],v[140:143]
ds_read_b64_tr_b16 v[212:213],v238 offset:21760
ds_read_b64_tr_b16 v[214:215],v238 offset:23936
v_mfma_f32_16x16x32_bf16 v[148:151],v[216:219],v[8:11],0
buffer_load_dword v234,v253,s[28:31],0 offen sc1
v_mfma_f32_16x16x32_bf16 v[148:151],v[220:223],v[24:27],v[148:151]
v_mul_f32 v168,v168,v225
v_mul_f32 v169,v169,v225
v_mfma_f32_16x16x32_bf16 v[156:159],v[216:219],v[12:15],0
s_waitcnt lgkmcnt(8)
v_cvt_pk_bf16_f32 v168,v168,v169
v_mfma_f32_16x16x32_bf16 v[156:159],v[220:223],v[28:31],v[156:159]
ds_read_b64_tr_b16 v[216:217],v239 offset:17408
ds_read_b64_tr_b16 v[218:219],v239 offset:19584
v_mfma_f32_16x16x32_bf16 v[128:131],v[192:195],v[32:35],v[128:131]
v_mul_f32 v170,v170,v225
v_mul_f32 v171,v171,v225
v_mfma_f32_16x16x32_bf16 v[128:131],v[196:199],v[48:51],v[128:131]
v_cvt_pk_bf16_f32 v169,v170,v171
v_mul_f32 v172,v172,v225
v_mfma_f32_16x16x32_bf16 v[136:139],v[192:195],v[36:39],v[136:139]
v_mul_f32 v173,v173,v225
v_cvt_pk_bf16_f32 v170,v172,v173
v_mfma_f32_16x16x32_bf16 v[136:139],v[196:199],v[52:55],v[136:139]
ds_read_b64_tr_b16 v[220:221],v239 offset:21760
ds_read_b64_tr_b16 v[222:223],v239 offset:23936
v_mfma_f32_16x16x32_bf16 v[144:147],v[192:195],v[40:43],v[144:147]
v_mul_f32 v174,v174,v225
v_mul_f32 v175,v175,v225
v_mfma_f32_16x16x32_bf16 v[144:147],v[196:199],v[56:59],v[144:147]
v_cvt_pk_bf16_f32 v171,v174,v175
v_mul_f32 v176,v176,v226
v_mfma_f32_16x16x32_bf16 v[152:155],v[192:195],v[44:47],v[152:155]
s_waitcnt lgkmcnt(8)
v_mul_f32 v177,v177,v226
v_mfma_f32_16x16x32_bf16 v[152:155],v[196:199],v[60:63],v[152:155]
ds_read_b64_tr_b16 v[192:193],v238 offset:26112
ds_read_b64_tr_b16 v[194:195],v238 offset:28288
v_mfma_f32_16x16x32_bf16 v[132:135],v[200:203],v[32:35],v[132:135]
v_cvt_pk_bf16_f32 v176,v176,v177
v_mul_f32 v178,v178,v226
v_mfma_f32_16x16x32_bf16 v[132:135],v[204:207],v[48:51],v[132:135]
v_mul_f32 v179,v179,v226
v_cvt_pk_bf16_f32 v177,v178,v179
v_mfma_f32_16x16x32_bf16 v[140:143],v[200:203],v[36:39],v[140:143]
v_mul_f32 v180,v180,v226
v_mul_f32 v181,v181,v226
v_mfma_f32_16x16x32_bf16 v[140:143],v[204:207],v[52:55],v[140:143]
ds_read_b64_tr_b16 v[196:197],v238 offset:30464
ds_read_b64_tr_b16 v[198:199],v238 offset:32640
v_mfma_f32_16x16x32_bf16 v[148:151],v[200:203],v[40:43],v[148:151]
v_cvt_pk_bf16_f32 v178,v180,v181
v_mul_f32 v182,v182,v226
v_mfma_f32_16x16x32_bf16 v[148:151],v[204:207],v[56:59],v[148:151]
v_mul_f32 v183,v183,v226
v_cvt_pk_bf16_f32 v179,v182,v183
v_mfma_f32_16x16x32_bf16 v[156:159],v[200:203],v[44:47],v[156:159]
s_waitcnt lgkmcnt(8)
v_add_u32 v237,9,v243
v_mfma_f32_16x16x32_bf16 v[156:159],v[204:207],v[60:63],v[156:159]
ds_read_b64_tr_b16 v[200:201],v239 offset:26112
ds_read_b64_tr_b16 v[202:203],v239 offset:28288
v_mfma_f32_16x16x32_bf16 v[128:131],v[208:211],v[64:67],v[128:131]
v_mul_f32 v184,v184,v227
v_mul_f32 v185,v185,v227
v_mfma_f32_16x16x32_bf16 v[128:131],v[212:215],v[80:83],v[128:131]
v_cvt_pk_bf16_f32 v184,v184,v185
v_mul_f32 v186,v186,v227
v_mfma_f32_16x16x32_bf16 v[136:139],v[208:211],v[68:71],v[136:139]
v_mul_f32 v187,v187,v227
v_cvt_pk_bf16_f32 v185,v186,v187
v_mfma_f32_16x16x32_bf16 v[136:139],v[212:215],v[84:87],v[136:139]
ds_read_b64_tr_b16 v[204:205],v239 offset:30464
ds_read_b64_tr_b16 v[206:207],v239 offset:32640
v_mfma_f32_16x16x32_bf16 v[144:147],v[208:211],v[72:75],v[144:147]
v_add_u32 v238,69632,v238
v_add_u32 v239,69632,v239
v_mfma_f32_16x16x32_bf16 v[144:147],v[212:215],v[88:91],v[144:147]
v_mul_f32 v188,v188,v227
v_mul_f32 v189,v189,v227
v_mfma_f32_16x16x32_bf16 v[152:155],v[208:211],v[76:79],v[152:155]
s_waitcnt vmcnt(0) lgkmcnt(8)
v_cvt_pk_bf16_f32 v186,v188,v189
v_mfma_f32_16x16x32_bf16 v[152:155],v[212:215],v[92:95],v[152:155]
ds_read_b64_tr_b16 v[208:209],v240 offset:0
ds_read_b64_tr_b16 v[210:211],v240 offset:2176
v_mfma_f32_16x16x32_bf16 v[228:231],v[244:247],a[0:3],0
buffer_store_dword v237,v252,s[28:31],0 offen
v_mfma_f32_16x16x32_bf16 v[132:135],v[216:219],v[64:67],v[132:135]
v_cmp_gt_u32 vcc,8,v234
v_mul_f32 v190,v190,v227
v_mfma_f32_16x16x32_bf16 v[132:135],v[220:223],v[80:83],v[132:135]
s_cbranch_vccnz SP_10
SP_10_RET:
v_mul_f32 v191,v191,v227
v_mfma_f32_16x16x32_bf16 v[228:231],v[244:247],a[4:7],v[228:231]
buffer_store_dwordx4 v[160:163],v242,s[28:31],s55 offen offset:0
v_mfma_f32_16x16x32_bf16 v[140:143],v[216:219],v[68:71],v[140:143]
v_cvt_pk_bf16_f32 v187,v190,v191
v_mfma_f32_16x16x32_bf16 v[140:143],v[220:223],v[84:87],v[140:143]
ds_read_b64_tr_b16 v[212:213],v240 offset:4352
ds_read_b64_tr_b16 v[214:215],v240 offset:6528
v_mfma_f32_16x16x32_bf16 v[228:231],v[244:247],a[8:11],v[228:231]
v_mfma_f32_16x16x32_bf16 v[148:151],v[216:219],v[72:75],v[148:151]
buffer_store_dwordx2 v[232:233],v254,s[16:19],0 offen offset:320
v_mfma_f32_16x16x32_bf16 v[148:151],v[220:223],v[88:91],v[148:151]
v_mfma_f32_16x16x32_bf16 v[228:231],v[244:247],a[12:15],v[228:231]
v_mfma_f32_16x16x32_bf16 v[156:159],v[216:219],v[76:79],v[156:159]
s_waitcnt lgkmcnt(8)
v_mfma_f32_16x16x32_bf16 v[156:159],v[220:223],v[92:95],v[156:159]
ds_read_b64_tr_b16 v[216:217],v241 offset:0
ds_read_b64_tr_b16 v[218:219],v241 offset:2176
v_mfma_f32_16x16x32_bf16 v[128:131],v[192:195],v[96:99],v[128:131]
buffer_store_dwordx4 v[168:171],v242,s[28:31],s55 offen offset:1024
v_mfma_f32_16x16x32_bf16 v[128:131],v[196:199],v[112:115],v[128:131]
v_mfma_f32_16x16x32_bf16 v[136:139],v[192:195],v[100:103],v[136:139]
buffer_store_dwordx4 v[176:179],v242,s[28:31],s55 offen offset:2048
v_mfma_f32_16x16x32_bf16 v[136:139],v[196:199],v[116:119],v[136:139]
ds_read_b64_tr_b16 v[220:221],v241 offset:4352
ds_read_b64_tr_b16 v[222:223],v241 offset:6528
v_mfma_f32_16x16x32_bf16 v[144:147],v[192:195],v[104:107],v[144:147]
v_cvt_pk_bf16_f32 v232,v228,v229
v_cvt_pk_bf16_f32 v233,v230,v231
v_mfma_f32_16x16x32_bf16 v[144:147],v[196:199],v[120:123],v[144:147]
buffer_load_dwordx4 a[0:3],v248,s[28:31],s60 offen sc1
v_mfma_f32_16x16x32_bf16 v[152:155],v[192:195],v[108:111],v[152:155]
s_waitcnt lgkmcnt(8)
v_mfma_f32_16x16x32_bf16 v[152:155],v[196:199],v[124:127],v[152:155]
ds_read_b64_tr_b16 v[192:193],v240 offset:8704
ds_read_b64_tr_b16 v[194:195],v240 offset:10880
v_mfma_f32_16x16x32_bf16 v[132:135],v[200:203],v[96:99],v[132:135]
buffer_store_dwordx4 v[184:187],v242,s[28:31],s55 offen offset:3072
v_mfma_f32_16x16x32_bf16 v[132:135],v[204:207],v[112:115],v[132:135]
s_add_u32 s55,s55,16384
v_mfma_f32_16x16x32_bf16 v[140:143],v[200:203],v[100:103],v[140:143]
v_mfma_f32_16x16x32_bf16 v[140:143],v[204:207],v[116:119],v[140:143]
ds_read_b64_tr_b16 v[196:197],v240 offset:13056
ds_read_b64_tr_b16 v[198:199],v240 offset:15232
v_mfma_f32_16x16x32_bf16 v[148:151],v[200:203],v[104:107],v[148:151]
v_mfma_f32_16x16x32_bf16 v[148:151],v[204:207],v[120:123],v[148:151]
buffer_load_dwordx4 a[4:7],v249,s[28:31],s60 offen sc1
v_mfma_f32_16x16x32_bf16 v[156:159],v[200:203],v[108:111],v[156:159]
s_waitcnt lgkmcnt(8)
v_mfma_f32_16x16x32_bf16 v[156:159],v[204:207],v[124:127],v[156:159]
ds_read_b64_tr_b16 v[200:201],v241 offset:8704
ds_read_b64_tr_b16 v[202:203],v241 offset:10880
v_mfma_f32_16x16x32_bf16 v[160:163],v[208:211],v[0:3],0
buffer_load_dwordx4 a[8:11],v250,s[28:31],s60 offen sc1
v_mfma_f32_16x16x32_bf16 v[160:163],v[212:215],v[16:19],v[160:163]
v_mul_f32 v128,v128,v224
v_mul_f32 v129,v129,v224
v_mfma_f32_16x16x32_bf16 v[168:171],v[208:211],v[4:7],0
v_cvt_pk_bf16_f32 v128,v128,v129
v_mul_f32 v130,v130,v224
v_mfma_f32_16x16x32_bf16 v[168:171],v[212:215],v[20:23],v[168:171]
ds_read_b64_tr_b16 v[204:205],v241 offset:13056
ds_read_b64_tr_b16 v[206:207],v241 offset:15232
v_mfma_f32_16x16x32_bf16 v[176:179],v[208:211],v[8:11],0
v_mul_f32 v131,v131,v224
v_cvt_pk_bf16_f32 v129,v130,v131
v_mfma_f32_16x16x32_bf16 v[176:179],v[212:215],v[24:27],v[176:179]
buffer_load_dwordx4 a[12:15],v251,s[28:31],s60 offen sc1
v_mfma_f32_16x16x32_bf16 v[184:187],v[208:211],v[12:15],0
s_sub_u32 s60,s60,49152
s_waitcnt lgkmcnt(8)
v_mfma_f32_16x16x32_bf16 v[184:187],v[212:215],v[28:31],v[184:187]
ds_read_b64_tr_b16 v[208:209],v240 offset:17408
ds_read_b64_tr_b16 v[210:211],v240 offset:19584
v_mfma_f32_16x16x32_bf16 v[164:167],v[216:219],v[0:3],0
v_mul_f32 v132,v132,v224
v_mul_f32 v133,v133,v224
v_mfma_f32_16x16x32_bf16 v[164:167],v[220:223],v[16:19],v[164:167]
v_cvt_pk_bf16_f32 v130,v132,v133
v_mul_f32 v134,v134,v224
v_mfma_f32_16x16x32_bf16 v[172:175],v[216:219],v[4:7],0
v_mul_f32 v135,v135,v224
v_cvt_pk_bf16_f32 v131,v134,v135
v_mfma_f32_16x16x32_bf16 v[172:175],v[220:223],v[20:23],v[172:175]
ds_read_b64_tr_b16 v[212:213],v240 offset:21760
ds_read_b64_tr_b16 v[214:215],v240 offset:23936
v_mfma_f32_16x16x32_bf16 v[180:183],v[216:219],v[8:11],0
buffer_load_dword v234,v253,s[28:31],0 offen sc1
v_mfma_f32_16x16x32_bf16 v[180:183],v[220:223],v[24:27],v[180:183]
v_mul_f32 v136,v136,v225
v_mul_f32 v137,v137,v225
v_mfma_f32_16x16x32_bf16 v[188:191],v[216:219],v[12:15],0
s_waitcnt lgkmcnt(8)
v_cvt_pk_bf16_f32 v136,v136,v137
v_mfma_f32_16x16x32_bf16 v[188:191],v[220:223],v[28:31],v[188:191]
ds_read_b64_tr_b16 v[216:217],v241 offset:17408
ds_read_b64_tr_b16 v[218:219],v241 offset:19584
v_mfma_f32_16x16x32_bf16 v[160:163],v[192:195],v[32:35],v[160:163]
v_mul_f32 v138,v138,v225
v_mul_f32 v139,v139,v225
v_mfma_f32_16x16x32_bf16 v[160:163],v[196:199],v[48:51],v[160:163]
v_cvt_pk_bf16_f32 v137,v138,v139
v_mul_f32 v140,v140,v225
v_mfma_f32_16x16x32_bf16 v[168:171],v[192:195],v[36:39],v[168:171]
v_mul_f32 v141,v141,v225
v_cvt_pk_bf16_f32 v138,v140,v141
v_mfma_f32_16x16x32_bf16 v[168:171],v[196:199],v[52:55],v[168:171]
ds_read_b64_tr_b16 v[220:221],v241 offset:21760
ds_read_b64_tr_b16 v[222:223],v241 offset:23936
v_mfma_f32_16x16x32_bf16 v[176:179],v[192:195],v[40:43],v[176:179]
v_mul_f32 v142,v142,v225
v_mul_f32 v143,v143,v225
v_mfma_f32_16x16x32_bf16 v[176:179],v[196:199],v[56:59],v[176:179]
v_cvt_pk_bf16_f32 v139,v142,v143
v_mul_f32 v144,v144,v226
v_mfma_f32_16x16x32_bf16 v[184:187],v[192:195],v[44:47],v[184:187]
s_waitcnt lgkmcnt(8)
v_mul_f32 v145,v145,v226
v_mfma_f32_16x16x32_bf16 v[184:187],v[196:199],v[60:63],v[184:187]
ds_read_b64_tr_b16 v[192:193],v240 offset:26112
ds_read_b64_tr_b16 v[194:195],v240 offset:28288
v_mfma_f32_16x16x32_bf16 v[164:167],v[200:203],v[32:35],v[164:167]
v_cvt_pk_bf16_f32 v144,v144,v145
v_mul_f32 v146,v146,v226
v_mfma_f32_16x16x32_bf16 v[164:167],v[204:207],v[48:51],v[164:167]
v_mul_f32 v147,v147,v226
v_cvt_pk_bf16_f32 v145,v146,v147
v_mfma_f32_16x16x32_bf16 v[172:175],v[200:203],v[36:39],v[172:175]
v_mul_f32 v148,v148,v226
v_mul_f32 v149,v149,v226
v_mfma_f32_16x16x32_bf16 v[172:175],v[204:207],v[52:55],v[172:175]
ds_read_b64_tr_b16 v[196:197],v240 offset:30464
ds_read_b64_tr_b16 v[198:199],v240 offset:32640
v_mfma_f32_16x16x32_bf16 v[180:183],v[200:203],v[40:43],v[180:183]
v_cvt_pk_bf16_f32 v146,v148,v149
v_mul_f32 v150,v150,v226
v_mfma_f32_16x16x32_bf16 v[180:183],v[204:207],v[56:59],v[180:183]
v_mul_f32 v151,v151,v226
v_cvt_pk_bf16_f32 v147,v150,v151
v_mfma_f32_16x16x32_bf16 v[188:191],v[200:203],v[44:47],v[188:191]
s_waitcnt lgkmcnt(8)
v_add_u32 v237,10,v243
v_mfma_f32_16x16x32_bf16 v[188:191],v[204:207],v[60:63],v[188:191]
ds_read_b64_tr_b16 v[200:201],v241 offset:26112
ds_read_b64_tr_b16 v[202:203],v241 offset:28288
v_mfma_f32_16x16x32_bf16 v[160:163],v[208:211],v[64:67],v[160:163]
v_mul_f32 v152,v152,v227
v_mul_f32 v153,v153,v227
v_mfma_f32_16x16x32_bf16 v[160:163],v[212:215],v[80:83],v[160:163]
v_cvt_pk_bf16_f32 v152,v152,v153
v_mul_f32 v154,v154,v227
v_mfma_f32_16x16x32_bf16 v[168:171],v[208:211],v[68:71],v[168:171]
v_mul_f32 v155,v155,v227
v_cvt_pk_bf16_f32 v153,v154,v155
v_mfma_f32_16x16x32_bf16 v[168:171],v[212:215],v[84:87],v[168:171]
ds_read_b64_tr_b16 v[204:205],v241 offset:30464
ds_read_b64_tr_b16 v[206:207],v241 offset:32640
v_mfma_f32_16x16x32_bf16 v[176:179],v[208:211],v[72:75],v[176:179]
v_add_u32 v240,69632,v240
v_add_u32 v241,69632,v241
v_mfma_f32_16x16x32_bf16 v[176:179],v[212:215],v[88:91],v[176:179]
v_mul_f32 v156,v156,v227
v_mul_f32 v157,v157,v227
v_mfma_f32_16x16x32_bf16 v[184:187],v[208:211],v[76:79],v[184:187]
s_waitcnt vmcnt(0) lgkmcnt(8)
s_barrier
v_mfma_f32_16x16x32_bf16 v[184:187],v[212:215],v[92:95],v[184:187]
ds_read_b64_tr_b16 v[208:209],v238 offset:0
ds_read_b64_tr_b16 v[210:211],v238 offset:2176
v_mfma_f32_16x16x32_bf16 v[228:231],v[244:247],a[0:3],0
buffer_store_dword v237,v252,s[28:31],0 offen
v_mfma_f32_16x16x32_bf16 v[164:167],v[216:219],v[64:67],v[164:167]
v_cmp_gt_u32 vcc,9,v234
v_cvt_pk_bf16_f32 v154,v156,v157
v_mfma_f32_16x16x32_bf16 v[164:167],v[220:223],v[80:83],v[164:167]
s_cbranch_vccnz SP_11
SP_11_RET:
v_mul_f32 v158,v158,v227
v_mfma_f32_16x16x32_bf16 v[228:231],v[244:247],a[4:7],v[228:231]
buffer_store_dwordx4 v[128:131],v242,s[28:31],s55 offen offset:0
v_mfma_f32_16x16x32_bf16 v[172:175],v[216:219],v[68:71],v[172:175]
v_mul_f32 v159,v159,v227
v_cvt_pk_bf16_f32 v155,v158,v159
v_mfma_f32_16x16x32_bf16 v[172:175],v[220:223],v[84:87],v[172:175]
ds_read_b64_tr_b16 v[212:213],v238 offset:4352
ds_read_b64_tr_b16 v[214:215],v238 offset:6528
v_mfma_f32_16x16x32_bf16 v[228:231],v[244:247],a[8:11],v[228:231]
v_mfma_f32_16x16x32_bf16 v[180:183],v[216:219],v[72:75],v[180:183]
buffer_store_dwordx2 v[232:233],v254,s[16:19],0 offen offset:384
v_mfma_f32_16x16x32_bf16 v[180:183],v[220:223],v[88:91],v[180:183]
v_mfma_f32_16x16x32_bf16 v[228:231],v[244:247],a[12:15],v[228:231]
v_mfma_f32_16x16x32_bf16 v[188:191],v[216:219],v[76:79],v[188:191]
s_waitcnt lgkmcnt(8)
v_mfma_f32_16x16x32_bf16 v[188:191],v[220:223],v[92:95],v[188:191]
ds_read_b64_tr_b16 v[216:217],v239 offset:0
ds_read_b64_tr_b16 v[218:219],v239 offset:2176
v_mfma_f32_16x16x32_bf16 v[160:163],v[192:195],v[96:99],v[160:163]
buffer_store_dwordx4 v[136:139],v242,s[28:31],s55 offen offset:1024
v_mfma_f32_16x16x32_bf16 v[160:163],v[196:199],v[112:115],v[160:163]
v_mfma_f32_16x16x32_bf16 v[168:171],v[192:195],v[100:103],v[168:171]
buffer_store_dwordx4 v[144:147],v242,s[28:31],s55 offen offset:2048
v_mfma_f32_16x16x32_bf16 v[168:171],v[196:199],v[116:119],v[168:171]
ds_read_b64_tr_b16 v[220:221],v239 offset:4352
ds_read_b64_tr_b16 v[222:223],v239 offset:6528
v_mfma_f32_16x16x32_bf16 v[176:179],v[192:195],v[104:107],v[176:179]
v_cvt_pk_bf16_f32 v232,v228,v229
v_cvt_pk_bf16_f32 v233,v230,v231
v_mfma_f32_16x16x32_bf16 v[176:179],v[196:199],v[120:123],v[176:179]
buffer_load_dwordx4 a[0:3],v248,s[28:31],s60 offen sc1
v_mfma_f32_16x16x32_bf16 v[184:187],v[192:195],v[108:111],v[184:187]
s_waitcnt lgkmcnt(8)
v_mfma_f32_16x16x32_bf16 v[184:187],v[196:199],v[124:127],v[184:187]
ds_read_b64_tr_b16 v[192:193],v238 offset:8704
ds_read_b64_tr_b16 v[194:195],v238 offset:10880
v_mfma_f32_16x16x32_bf16 v[164:167],v[200:203],v[96:99],v[164:167]
buffer_store_dwordx4 v[152:155],v242,s[28:31],s55 offen offset:3072
v_mfma_f32_16x16x32_bf16 v[164:167],v[204:207],v[112:115],v[164:167]
s_add_u32 s55,s55,16384
v_mfma_f32_16x16x32_bf16 v[172:175],v[200:203],v[100:103],v[172:175]
v_mfma_f32_16x16x32_bf16 v[172:175],v[204:207],v[116:119],v[172:175]
ds_read_b64_tr_b16 v[196:197],v238 offset:13056
ds_read_b64_tr_b16 v[198:199],v238 offset:15232
v_mfma_f32_16x16x32_bf16 v[180:183],v[200:203],v[104:107],v[180:183]
v_mfma_f32_16x16x32_bf16 v[180:183],v[204:207],v[120:123],v[180:183]
buffer_load_dwordx4 a[4:7],v249,s[28:31],s60 offen sc1
v_mfma_f32_16x16x32_bf16 v[188:191],v[200:203],v[108:111],v[188:191]
s_waitcnt lgkmcnt(8)
v_mfma_f32_16x16x32_bf16 v[188:191],v[204:207],v[124:127],v[188:191]
ds_read_b64_tr_b16 v[200:201],v239 offset:8704
ds_read_b64_tr_b16 v[202:203],v239 offset:10880
v_mfma_f32_16x16x32_bf16 v[128:131],v[208:211],v[0:3],0
buffer_load_dwordx4 a[8:11],v250,s[28:31],s60 offen sc1
v_mfma_f32_16x16x32_bf16 v[128:131],v[212:215],v[16:19],v[128:131]
v_mul_f32 v160,v160,v224
v_mul_f32 v161,v161,v224
v_mfma_f32_16x16x32_bf16 v[136:139],v[208:211],v[4:7],0
v_cvt_pk_bf16_f32 v160,v160,v161
v_mul_f32 v162,v162,v224
v_mfma_f32_16x16x32_bf16 v[136:139],v[212:215],v[20:23],v[136:139]
ds_read_b64_tr_b16 v[204:205],v239 offset:13056
ds_read_b64_tr_b16 v[206:207],v239 offset:15232
v_mfma_f32_16x16x32_bf16 v[144:147],v[208:211],v[8:11],0
v_mul_f32 v163,v163,v224
v_cvt_pk_bf16_f32 v161,v162,v163
v_mfma_f32_16x16x32_bf16 v[144:147],v[212:215],v[24:27],v[144:147]
buffer_load_dwordx4 a[12:15],v251,s[28:31],s60 offen sc1
v_mfma_f32_16x16x32_bf16 v[152:155],v[208:211],v[12:15],0
s_add_u32 s60,s60,16384
s_waitcnt lgkmcnt(8)
v_mfma_f32_16x16x32_bf16 v[152:155],v[212:215],v[28:31],v[152:155]
ds_read_b64_tr_b16 v[208:209],v238 offset:17408
ds_read_b64_tr_b16 v[210:211],v238 offset:19584
v_mfma_f32_16x16x32_bf16 v[132:135],v[216:219],v[0:3],0
v_mul_f32 v164,v164,v224
v_mul_f32 v165,v165,v224
v_mfma_f32_16x16x32_bf16 v[132:135],v[220:223],v[16:19],v[132:135]
v_cvt_pk_bf16_f32 v162,v164,v165
v_mul_f32 v166,v166,v224
v_mfma_f32_16x16x32_bf16 v[140:143],v[216:219],v[4:7],0
v_mul_f32 v167,v167,v224
v_cvt_pk_bf16_f32 v163,v166,v167
v_mfma_f32_16x16x32_bf16 v[140:143],v[220:223],v[20:23],v[140:143]
ds_read_b64_tr_b16 v[212:213],v238 offset:21760
ds_read_b64_tr_b16 v[214:215],v238 offset:23936
v_mfma_f32_16x16x32_bf16 v[148:151],v[216:219],v[8:11],0
buffer_load_dword v234,v253,s[28:31],0 offen sc1
v_mfma_f32_16x16x32_bf16 v[148:151],v[220:223],v[24:27],v[148:151]
v_mul_f32 v168,v168,v225
v_mul_f32 v169,v169,v225
v_mfma_f32_16x16x32_bf16 v[156:159],v[216:219],v[12:15],0
s_waitcnt lgkmcnt(8)
v_cvt_pk_bf16_f32 v168,v168,v169
v_mfma_f32_16x16x32_bf16 v[156:159],v[220:223],v[28:31],v[156:159]
ds_read_b64_tr_b16 v[216:217],v239 offset:17408
ds_read_b64_tr_b16 v[218:219],v239 offset:19584
v_mfma_f32_16x16x32_bf16 v[128:131],v[192:195],v[32:35],v[128:131]
v_mul_f32 v170,v170,v225
v_mul_f32 v171,v171,v225
v_mfma_f32_16x16x32_bf16 v[128:131],v[196:199],v[48:51],v[128:131]
v_cvt_pk_bf16_f32 v169,v170,v171
v_mul_f32 v172,v172,v225
v_mfma_f32_16x16x32_bf16 v[136:139],v[192:195],v[36:39],v[136:139]
v_mul_f32 v173,v173,v225
v_cvt_pk_bf16_f32 v170,v172,v173
v_mfma_f32_16x16x32_bf16 v[136:139],v[196:199],v[52:55],v[136:139]
ds_read_b64_tr_b16 v[220:221],v239 offset:21760
ds_read_b64_tr_b16 v[222:223],v239 offset:23936
v_mfma_f32_16x16x32_bf16 v[144:147],v[192:195],v[40:43],v[144:147]
v_mul_f32 v174,v174,v225
v_mul_f32 v175,v175,v225
v_mfma_f32_16x16x32_bf16 v[144:147],v[196:199],v[56:59],v[144:147]
v_cvt_pk_bf16_f32 v171,v174,v175
v_mul_f32 v176,v176,v226
v_mfma_f32_16x16x32_bf16 v[152:155],v[192:195],v[44:47],v[152:155]
s_waitcnt lgkmcnt(8)
v_mul_f32 v177,v177,v226
v_mfma_f32_16x16x32_bf16 v[152:155],v[196:199],v[60:63],v[152:155]
ds_read_b64_tr_b16 v[192:193],v238 offset:26112
ds_read_b64_tr_b16 v[194:195],v238 offset:28288
v_mfma_f32_16x16x32_bf16 v[132:135],v[200:203],v[32:35],v[132:135]
v_cvt_pk_bf16_f32 v176,v176,v177
v_mul_f32 v178,v178,v226
v_mfma_f32_16x16x32_bf16 v[132:135],v[204:207],v[48:51],v[132:135]
v_mul_f32 v179,v179,v226
v_cvt_pk_bf16_f32 v177,v178,v179
v_mfma_f32_16x16x32_bf16 v[140:143],v[200:203],v[36:39],v[140:143]
v_mul_f32 v180,v180,v226
v_mul_f32 v181,v181,v226
v_mfma_f32_16x16x32_bf16 v[140:143],v[204:207],v[52:55],v[140:143]
ds_read_b64_tr_b16 v[196:197],v238 offset:30464
ds_read_b64_tr_b16 v[198:199],v238 offset:32640
v_mfma_f32_16x16x32_bf16 v[148:151],v[200:203],v[40:43],v[148:151]
v_cvt_pk_bf16_f32 v178,v180,v181
v_mul_f32 v182,v182,v226
v_mfma_f32_16x16x32_bf16 v[148:151],v[204:207],v[56:59],v[148:151]
v_mul_f32 v183,v183,v226
v_cvt_pk_bf16_f32 v179,v182,v183
v_mfma_f32_16x16x32_bf16 v[156:159],v[200:203],v[44:47],v[156:159]
s_waitcnt lgkmcnt(8)
v_add_u32 v237,11,v243
v_mfma_f32_16x16x32_bf16 v[156:159],v[204:207],v[60:63],v[156:159]
ds_read_b64_tr_b16 v[200:201],v239 offset:26112
ds_read_b64_tr_b16 v[202:203],v239 offset:28288
v_mfma_f32_16x16x32_bf16 v[128:131],v[208:211],v[64:67],v[128:131]
v_mul_f32 v184,v184,v227
v_mul_f32 v185,v185,v227
v_mfma_f32_16x16x32_bf16 v[128:131],v[212:215],v[80:83],v[128:131]
v_cvt_pk_bf16_f32 v184,v184,v185
v_mul_f32 v186,v186,v227
v_mfma_f32_16x16x32_bf16 v[136:139],v[208:211],v[68:71],v[136:139]
v_mul_f32 v187,v187,v227
v_cvt_pk_bf16_f32 v185,v186,v187
v_mfma_f32_16x16x32_bf16 v[136:139],v[212:215],v[84:87],v[136:139]
ds_read_b64_tr_b16 v[204:205],v239 offset:30464
ds_read_b64_tr_b16 v[206:207],v239 offset:32640
v_mfma_f32_16x16x32_bf16 v[144:147],v[208:211],v[72:75],v[144:147]
v_mul_f32 v188,v188,v227
v_mul_f32 v189,v189,v227
v_mfma_f32_16x16x32_bf16 v[144:147],v[212:215],v[88:91],v[144:147]
v_cvt_pk_bf16_f32 v186,v188,v189
v_mul_f32 v190,v190,v227
v_mfma_f32_16x16x32_bf16 v[152:155],v[208:211],v[76:79],v[152:155]
s_waitcnt vmcnt(0) lgkmcnt(8)
v_mul_f32 v191,v191,v227
v_mfma_f32_16x16x32_bf16 v[152:155],v[212:215],v[92:95],v[152:155]
ds_read_b64_tr_b16 v[208:209],v240 offset:0
ds_read_b64_tr_b16 v[210:211],v240 offset:2176
v_mfma_f32_16x16x32_bf16 v[228:231],v[244:247],a[0:3],0
buffer_store_dword v237,v252,s[28:31],0 offen
v_mfma_f32_16x16x32_bf16 v[132:135],v[216:219],v[64:67],v[132:135]
v_cmp_gt_u32 vcc,10,v234
v_cvt_pk_bf16_f32 v187,v190,v191
v_mfma_f32_16x16x32_bf16 v[132:135],v[220:223],v[80:83],v[132:135]
s_cbranch_vccnz SP_12
SP_12_RET:
v_mfma_f32_16x16x32_bf16 v[228:231],v[244:247],a[4:7],v[228:231]
buffer_store_dwordx4 v[160:163],v242,s[28:31],s55 offen offset:0
v_mfma_f32_16x16x32_bf16 v[140:143],v[216:219],v[68:71],v[140:143]
v_mfma_f32_16x16x32_bf16 v[140:143],v[220:223],v[84:87],v[140:143]
ds_read_b64_tr_b16 v[212:213],v240 offset:4352
ds_read_b64_tr_b16 v[214:215],v240 offset:6528
v_mfma_f32_16x16x32_bf16 v[228:231],v[244:247],a[8:11],v[228:231]
v_mfma_f32_16x16x32_bf16 v[148:151],v[216:219],v[72:75],v[148:151]
buffer_store_dwordx2 v[232:233],v254,s[16:19],0 offen offset:448
v_mfma_f32_16x16x32_bf16 v[148:151],v[220:223],v[88:91],v[148:151]
v_mfma_f32_16x16x32_bf16 v[228:231],v[244:247],a[12:15],v[228:231]
v_mfma_f32_16x16x32_bf16 v[156:159],v[216:219],v[76:79],v[156:159]
s_waitcnt lgkmcnt(8)
v_mfma_f32_16x16x32_bf16 v[156:159],v[220:223],v[92:95],v[156:159]
ds_read_b64_tr_b16 v[216:217],v241 offset:0
ds_read_b64_tr_b16 v[218:219],v241 offset:2176
v_mfma_f32_16x16x32_bf16 v[128:131],v[192:195],v[96:99],v[128:131]
buffer_store_dwordx4 v[168:171],v242,s[28:31],s55 offen offset:1024
v_mfma_f32_16x16x32_bf16 v[128:131],v[196:199],v[112:115],v[128:131]
v_mfma_f32_16x16x32_bf16 v[136:139],v[192:195],v[100:103],v[136:139]
buffer_store_dwordx4 v[176:179],v242,s[28:31],s55 offen offset:2048
v_mfma_f32_16x16x32_bf16 v[136:139],v[196:199],v[116:119],v[136:139]
ds_read_b64_tr_b16 v[220:221],v241 offset:4352
ds_read_b64_tr_b16 v[222:223],v241 offset:6528
v_mfma_f32_16x16x32_bf16 v[144:147],v[192:195],v[104:107],v[144:147]
v_cvt_pk_bf16_f32 v232,v228,v229
v_cvt_pk_bf16_f32 v233,v230,v231
v_mfma_f32_16x16x32_bf16 v[144:147],v[196:199],v[120:123],v[144:147]
buffer_load_dwordx4 a[0:3],v248,s[28:31],s60 offen sc1
v_mfma_f32_16x16x32_bf16 v[152:155],v[192:195],v[108:111],v[152:155]
s_waitcnt lgkmcnt(8)
v_mfma_f32_16x16x32_bf16 v[152:155],v[196:199],v[124:127],v[152:155]
ds_read_b64_tr_b16 v[192:193],v240 offset:8704
ds_read_b64_tr_b16 v[194:195],v240 offset:10880
v_mfma_f32_16x16x32_bf16 v[132:135],v[200:203],v[96:99],v[132:135]
buffer_store_dwordx4 v[184:187],v242,s[28:31],s55 offen offset:3072
v_mfma_f32_16x16x32_bf16 v[132:135],v[204:207],v[112:115],v[132:135]
s_sub_u32 s55,s55,49152
v_mfma_f32_16x16x32_bf16 v[140:143],v[200:203],v[100:103],v[140:143]
v_mfma_f32_16x16x32_bf16 v[140:143],v[204:207],v[116:119],v[140:143]
ds_read_b64_tr_b16 v[196:197],v240 offset:13056
ds_read_b64_tr_b16 v[198:199],v240 offset:15232
v_mfma_f32_16x16x32_bf16 v[148:151],v[200:203],v[104:107],v[148:151]
v_mfma_f32_16x16x32_bf16 v[148:151],v[204:207],v[120:123],v[148:151]
buffer_load_dwordx4 a[4:7],v249,s[28:31],s60 offen sc1
v_mfma_f32_16x16x32_bf16 v[156:159],v[200:203],v[108:111],v[156:159]
s_waitcnt lgkmcnt(8)
v_mfma_f32_16x16x32_bf16 v[156:159],v[204:207],v[124:127],v[156:159]
ds_read_b64_tr_b16 v[200:201],v241 offset:8704
ds_read_b64_tr_b16 v[202:203],v241 offset:10880
v_mfma_f32_16x16x32_bf16 v[160:163],v[208:211],v[0:3],0
buffer_load_dwordx4 a[8:11],v250,s[28:31],s60 offen sc1
v_mfma_f32_16x16x32_bf16 v[160:163],v[212:215],v[16:19],v[160:163]
v_mul_f32 v128,v128,v224
v_mul_f32 v129,v129,v224
v_mfma_f32_16x16x32_bf16 v[168:171],v[208:211],v[4:7],0
v_cvt_pk_bf16_f32 v128,v128,v129
v_mul_f32 v130,v130,v224
v_mfma_f32_16x16x32_bf16 v[168:171],v[212:215],v[20:23],v[168:171]
ds_read_b64_tr_b16 v[204:205],v241 offset:13056
ds_read_b64_tr_b16 v[206:207],v241 offset:15232
v_mfma_f32_16x16x32_bf16 v[176:179],v[208:211],v[8:11],0
v_mul_f32 v131,v131,v224
v_cvt_pk_bf16_f32 v129,v130,v131
v_mfma_f32_16x16x32_bf16 v[176:179],v[212:215],v[24:27],v[176:179]
buffer_load_dwordx4 a[12:15],v251,s[28:31],s60 offen sc1
v_mfma_f32_16x16x32_bf16 v[184:187],v[208:211],v[12:15],0
s_add_u32 s60,s60,16384
s_waitcnt lgkmcnt(8)
v_mfma_f32_16x16x32_bf16 v[184:187],v[212:215],v[28:31],v[184:187]
ds_read_b64_tr_b16 v[208:209],v240 offset:17408
ds_read_b64_tr_b16 v[210:211],v240 offset:19584
v_mfma_f32_16x16x32_bf16 v[164:167],v[216:219],v[0:3],0
v_mul_f32 v132,v132,v224
v_mul_f32 v133,v133,v224
v_mfma_f32_16x16x32_bf16 v[164:167],v[220:223],v[16:19],v[164:167]
v_cvt_pk_bf16_f32 v130,v132,v133
v_mul_f32 v134,v134,v224
v_mfma_f32_16x16x32_bf16 v[172:175],v[216:219],v[4:7],0
v_mul_f32 v135,v135,v224
v_cvt_pk_bf16_f32 v131,v134,v135
v_mfma_f32_16x16x32_bf16 v[172:175],v[220:223],v[20:23],v[172:175]
ds_read_b64_tr_b16 v[212:213],v240 offset:21760
ds_read_b64_tr_b16 v[214:215],v240 offset:23936
v_mfma_f32_16x16x32_bf16 v[180:183],v[216:219],v[8:11],0
buffer_load_dword v234,v253,s[28:31],0 offen sc1
v_mfma_f32_16x16x32_bf16 v[180:183],v[220:223],v[24:27],v[180:183]
v_mul_f32 v136,v136,v225
v_mul_f32 v137,v137,v225
v_mfma_f32_16x16x32_bf16 v[188:191],v[216:219],v[12:15],0
s_waitcnt lgkmcnt(8)
v_cvt_pk_bf16_f32 v136,v136,v137
v_mfma_f32_16x16x32_bf16 v[188:191],v[220:223],v[28:31],v[188:191]
ds_read_b64_tr_b16 v[216:217],v241 offset:17408
ds_read_b64_tr_b16 v[218:219],v241 offset:19584
v_mfma_f32_16x16x32_bf16 v[160:163],v[192:195],v[32:35],v[160:163]
v_mul_f32 v138,v138,v225
v_mul_f32 v139,v139,v225
v_mfma_f32_16x16x32_bf16 v[160:163],v[196:199],v[48:51],v[160:163]
v_cvt_pk_bf16_f32 v137,v138,v139
v_mul_f32 v140,v140,v225
v_mfma_f32_16x16x32_bf16 v[168:171],v[192:195],v[36:39],v[168:171]
v_mul_f32 v141,v141,v225
v_cvt_pk_bf16_f32 v138,v140,v141
v_mfma_f32_16x16x32_bf16 v[168:171],v[196:199],v[52:55],v[168:171]
ds_read_b64_tr_b16 v[220:221],v241 offset:21760
ds_read_b64_tr_b16 v[222:223],v241 offset:23936
v_mfma_f32_16x16x32_bf16 v[176:179],v[192:195],v[40:43],v[176:179]
v_mul_f32 v142,v142,v225
v_mul_f32 v143,v143,v225
v_mfma_f32_16x16x32_bf16 v[176:179],v[196:199],v[56:59],v[176:179]
v_cvt_pk_bf16_f32 v139,v142,v143
v_mul_f32 v144,v144,v226
v_mfma_f32_16x16x32_bf16 v[184:187],v[192:195],v[44:47],v[184:187]
s_waitcnt lgkmcnt(8)
v_mul_f32 v145,v145,v226
v_mfma_f32_16x16x32_bf16 v[184:187],v[196:199],v[60:63],v[184:187]
ds_read_b64_tr_b16 v[192:193],v240 offset:26112
ds_read_b64_tr_b16 v[194:195],v240 offset:28288
v_mfma_f32_16x16x32_bf16 v[164:167],v[200:203],v[32:35],v[164:167]
v_cvt_pk_bf16_f32 v144,v144,v145
v_mul_f32 v146,v146,v226
v_mfma_f32_16x16x32_bf16 v[164:167],v[204:207],v[48:51],v[164:167]
v_mul_f32 v147,v147,v226
v_cvt_pk_bf16_f32 v145,v146,v147
v_mfma_f32_16x16x32_bf16 v[172:175],v[200:203],v[36:39],v[172:175]
v_mul_f32 v148,v148,v226
v_mul_f32 v149,v149,v226
v_mfma_f32_16x16x32_bf16 v[172:175],v[204:207],v[52:55],v[172:175]
ds_read_b64_tr_b16 v[196:197],v240 offset:30464
ds_read_b64_tr_b16 v[198:199],v240 offset:32640
v_mfma_f32_16x16x32_bf16 v[180:183],v[200:203],v[40:43],v[180:183]
v_cvt_pk_bf16_f32 v146,v148,v149
v_mul_f32 v150,v150,v226
v_mfma_f32_16x16x32_bf16 v[180:183],v[204:207],v[56:59],v[180:183]
v_mul_f32 v151,v151,v226
v_cvt_pk_bf16_f32 v147,v150,v151
v_mfma_f32_16x16x32_bf16 v[188:191],v[200:203],v[44:47],v[188:191]
s_waitcnt lgkmcnt(8)
v_add_u32 v237,12,v243
v_mfma_f32_16x16x32_bf16 v[188:191],v[204:207],v[60:63],v[188:191]
ds_read_b64_tr_b16 v[200:201],v241 offset:26112
ds_read_b64_tr_b16 v[202:203],v241 offset:28288
v_mfma_f32_16x16x32_bf16 v[160:163],v[208:211],v[64:67],v[160:163]
v_mul_f32 v152,v152,v227
v_mul_f32 v153,v153,v227
v_mfma_f32_16x16x32_bf16 v[160:163],v[212:215],v[80:83],v[160:163]
v_cvt_pk_bf16_f32 v152,v152,v153
v_mul_f32 v154,v154,v227
v_mfma_f32_16x16x32_bf16 v[168:171],v[208:211],v[68:71],v[168:171]
v_mul_f32 v155,v155,v227
v_cvt_pk_bf16_f32 v153,v154,v155
v_mfma_f32_16x16x32_bf16 v[168:171],v[212:215],v[84:87],v[168:171]
ds_read_b64_tr_b16 v[204:205],v241 offset:30464
ds_read_b64_tr_b16 v[206:207],v241 offset:32640
v_mfma_f32_16x16x32_bf16 v[176:179],v[208:211],v[72:75],v[176:179]
v_mul_f32 v156,v156,v227
v_mul_f32 v157,v157,v227
v_mfma_f32_16x16x32_bf16 v[176:179],v[212:215],v[88:91],v[176:179]
v_cvt_pk_bf16_f32 v154,v156,v157
v_mul_f32 v158,v158,v227
v_mfma_f32_16x16x32_bf16 v[184:187],v[208:211],v[76:79],v[184:187]
s_waitcnt vmcnt(0) lgkmcnt(8)
v_mul_f32 v159,v159,v227
v_mfma_f32_16x16x32_bf16 v[184:187],v[212:215],v[92:95],v[184:187]
buffer_store_dword v237,v252,s[28:31],0 offen
v_mfma_f32_16x16x32_bf16 v[228:231],v[244:247],a[0:3],0
v_cmp_gt_u32 vcc,11,v234
v_cvt_pk_bf16_f32 v155,v158,v159
v_mfma_f32_16x16x32_bf16 v[164:167],v[216:219],v[64:67],v[164:167]
s_cbranch_vccnz SP_13
SP_13_RET:
v_mfma_f32_16x16x32_bf16 v[164:167],v[220:223],v[80:83],v[164:167]
buffer_store_dwordx4 v[128:131],v242,s[28:31],s55 offen offset:0
v_mfma_f32_16x16x32_bf16 v[228:231],v[244:247],a[4:7],v[228:231]
v_mfma_f32_16x16x32_bf16 v[172:175],v[216:219],v[68:71],v[172:175]
v_mfma_f32_16x16x32_bf16 v[172:175],v[220:223],v[84:87],v[172:175]
v_mfma_f32_16x16x32_bf16 v[228:231],v[244:247],a[8:11],v[228:231]
v_mfma_f32_16x16x32_bf16 v[180:183],v[216:219],v[72:75],v[180:183]
buffer_store_dwordx2 v[232:233],v254,s[16:19],0 offen offset:512
v_mfma_f32_16x16x32_bf16 v[180:183],v[220:223],v[88:91],v[180:183]
v_mfma_f32_16x16x32_bf16 v[228:231],v[244:247],a[12:15],v[228:231]
v_mfma_f32_16x16x32_bf16 v[188:191],v[216:219],v[76:79],v[188:191]
s_waitcnt lgkmcnt(4)
v_mfma_f32_16x16x32_bf16 v[188:191],v[220:223],v[92:95],v[188:191]
buffer_store_dwordx4 v[136:139],v242,s[28:31],s55 offen offset:1024
v_mfma_f32_16x16x32_bf16 v[160:163],v[192:195],v[96:99],v[160:163]
v_mfma_f32_16x16x32_bf16 v[160:163],v[196:199],v[112:115],v[160:163]
v_mfma_f32_16x16x32_bf16 v[168:171],v[192:195],v[100:103],v[168:171]
buffer_store_dwordx4 v[144:147],v242,s[28:31],s55 offen offset:2048
v_mfma_f32_16x16x32_bf16 v[168:171],v[196:199],v[116:119],v[168:171]
buffer_store_dwordx4 v[152:155],v242,s[28:31],s55 offen offset:3072
v_mfma_f32_16x16x32_bf16 v[176:179],v[192:195],v[104:107],v[176:179]
v_cvt_pk_bf16_f32 v232,v228,v229
v_cvt_pk_bf16_f32 v233,v230,v231
v_mfma_f32_16x16x32_bf16 v[176:179],v[196:199],v[120:123],v[176:179]
buffer_load_dwordx4 a[0:3],v248,s[28:31],s60 offen sc1
v_mfma_f32_16x16x32_bf16 v[184:187],v[192:195],v[108:111],v[184:187]
s_waitcnt lgkmcnt(0)
s_add_u32 s55,s55,16384
v_mfma_f32_16x16x32_bf16 v[184:187],v[196:199],v[124:127],v[184:187]
v_mfma_f32_16x16x32_bf16 v[164:167],v[200:203],v[96:99],v[164:167]
v_mfma_f32_16x16x32_bf16 v[164:167],v[204:207],v[112:115],v[164:167]
v_mfma_f32_16x16x32_bf16 v[172:175],v[200:203],v[100:103],v[172:175]
v_mfma_f32_16x16x32_bf16 v[172:175],v[204:207],v[116:119],v[172:175]
v_mfma_f32_16x16x32_bf16 v[180:183],v[200:203],v[104:107],v[180:183]
v_mfma_f32_16x16x32_bf16 v[180:183],v[204:207],v[120:123],v[180:183]
buffer_load_dwordx4 a[4:7],v249,s[28:31],s60 offen sc1
v_mfma_f32_16x16x32_bf16 v[188:191],v[200:203],v[108:111],v[188:191]
v_mfma_f32_16x16x32_bf16 v[188:191],v[204:207],v[124:127],v[188:191]
buffer_load_dwordx4 a[8:11],v250,s[28:31],s60 offen sc1
buffer_load_dwordx4 a[12:15],v251,s[28:31],s60 offen sc1
s_add_u32 s60,s60,16384
buffer_load_dword v234,v253,s[28:31],0 offen sc1
v_add_u32 v237,13,v243
s_nop 2
v_mul_f32 v160,v160,v224
v_mul_f32 v161,v161,v224
v_cvt_pk_bf16_f32 v160,v160,v161
v_mul_f32 v162,v162,v224
v_mul_f32 v163,v163,v224
v_cvt_pk_bf16_f32 v161,v162,v163
v_mul_f32 v164,v164,v224
v_mul_f32 v165,v165,v224
v_cvt_pk_bf16_f32 v162,v164,v165
v_mul_f32 v166,v166,v224
v_mul_f32 v167,v167,v224
v_cvt_pk_bf16_f32 v163,v166,v167
s_waitcnt vmcnt(0)
buffer_store_dword v237,v252,s[28:31],0 offen
v_cmp_gt_u32 vcc,12,v234
v_mul_f32 v168,v168,v225
v_mul_f32 v169,v169,v225
s_cbranch_vccnz SP_14
SP_14_RET:
buffer_store_dwordx4 v[160:163],v242,s[28:31],s55 offen offset:0
v_cvt_pk_bf16_f32 v168,v168,v169
v_mul_f32 v170,v170,v225
v_mul_f32 v171,v171,v225
v_cvt_pk_bf16_f32 v169,v170,v171
v_mul_f32 v172,v172,v225
v_mul_f32 v173,v173,v225
v_cvt_pk_bf16_f32 v170,v172,v173
v_mul_f32 v174,v174,v225
v_mul_f32 v175,v175,v225
v_cvt_pk_bf16_f32 v171,v174,v175
buffer_store_dwordx4 v[168:171],v242,s[28:31],s55 offen offset:1024
v_mul_f32 v176,v176,v226
v_mul_f32 v177,v177,v226
v_cvt_pk_bf16_f32 v176,v176,v177
v_mul_f32 v178,v178,v226
v_mul_f32 v179,v179,v226
v_cvt_pk_bf16_f32 v177,v178,v179
v_mul_f32 v180,v180,v226
v_mul_f32 v181,v181,v226
v_cvt_pk_bf16_f32 v178,v180,v181
v_mul_f32 v182,v182,v226
v_mul_f32 v183,v183,v226
v_cvt_pk_bf16_f32 v179,v182,v183
buffer_store_dwordx4 v[176:179],v242,s[28:31],s55 offen offset:2048
v_mul_f32 v184,v184,v227
v_mul_f32 v185,v185,v227
v_cvt_pk_bf16_f32 v184,v184,v185
v_mul_f32 v186,v186,v227
v_mul_f32 v187,v187,v227
v_cvt_pk_bf16_f32 v185,v186,v187
v_mul_f32 v188,v188,v227
v_mul_f32 v189,v189,v227
v_cvt_pk_bf16_f32 v186,v188,v189
v_mul_f32 v190,v190,v227
v_mul_f32 v191,v191,v227
v_cvt_pk_bf16_f32 v187,v190,v191
buffer_store_dwordx4 v[184:187],v242,s[28:31],s55 offen offset:3072
buffer_load_dwordx4 a[16:19],v248,s[28:31],s60 offen sc1
buffer_load_dwordx4 a[20:23],v249,s[28:31],s60 offen sc1
buffer_load_dwordx4 a[24:27],v250,s[28:31],s60 offen sc1
buffer_load_dwordx4 a[28:31],v251,s[28:31],s60 offen sc1
s_sub_u32 s60,s60,49152
buffer_store_dwordx2 v[232:233],v254,s[16:19],0 offen offset:576
v_mfma_f32_16x16x32_bf16 v[228:231],v[244:247],a[0:3],0
v_mfma_f32_16x16x32_bf16 v[228:231],v[244:247],a[4:7],v[228:231]
v_mfma_f32_16x16x32_bf16 v[228:231],v[244:247],a[8:11],v[228:231]
v_mfma_f32_16x16x32_bf16 v[228:231],v[244:247],a[12:15],v[228:231]
v_mov_b32 v237,14
s_waitcnt vmcnt(5)
buffer_store_dword v237,v252,s[28:31],0 offen
buffer_load_dword v234,v255,s[28:31],0 offen sc1
s_waitcnt vmcnt(3)
v_mfma_f32_16x16x32_bf16 v[128:131],v[244:247],a[16:19],0
v_mfma_f32_16x16x32_bf16 v[128:131],v[244:247],a[20:23],v[128:131]
v_mfma_f32_16x16x32_bf16 v[128:131],v[244:247],a[24:27],v[128:131]
v_mfma_f32_16x16x32_bf16 v[128:131],v[244:247],a[28:31],v[128:131]
v_cvt_pk_bf16_f32 v232,v228,v229
v_cvt_pk_bf16_f32 v233,v230,v231
s_waitcnt vmcnt(0)
v_cmp_gt_u32 vcc,14,v234
s_nop 0
s_cbranch_vccnz SP_15
SP_15_RET:
buffer_load_dwordx4 a[32:35],v248,s[28:31],s60 offen sc1
buffer_load_dwordx4 a[36:39],v249,s[28:31],s60 offen sc1
buffer_load_dwordx4 a[40:43],v250,s[28:31],s60 offen sc1
buffer_load_dwordx4 a[44:47],v251,s[28:31],s60 offen sc1
s_add_u32 s60,s60,16384
buffer_load_dwordx4 a[48:51],v248,s[28:31],s60 offen sc1
buffer_load_dwordx4 a[52:55],v249,s[28:31],s60 offen sc1
buffer_load_dwordx4 a[56:59],v250,s[28:31],s60 offen sc1
buffer_load_dwordx4 a[60:63],v251,s[28:31],s60 offen sc1
s_add_u32 s60,s60,16384
buffer_store_dwordx2 v[232:233],v254,s[16:19],0 offen offset:640
v_cvt_pk_bf16_f32 v132,v128,v129
v_cvt_pk_bf16_f32 v133,v130,v131
buffer_store_dwordx2 v[132:133],v254,s[16:19],0 offen offset:704
s_waitcnt vmcnt(2)
v_mfma_f32_16x16x32_bf16 v[136:139],v[244:247],a[32:35],0
v_mfma_f32_16x16x32_bf16 v[144:147],v[244:247],a[48:51],0
v_mfma_f32_16x16x32_bf16 v[136:139],v[244:247],a[36:39],v[136:139]
v_mfma_f32_16x16x32_bf16 v[144:147],v[244:247],a[52:55],v[144:147]
v_mfma_f32_16x16x32_bf16 v[136:139],v[244:247],a[40:43],v[136:139]
v_mfma_f32_16x16x32_bf16 v[144:147],v[244:247],a[56:59],v[144:147]
v_mfma_f32_16x16x32_bf16 v[136:139],v[244:247],a[44:47],v[136:139]
v_mfma_f32_16x16x32_bf16 v[144:147],v[244:247],a[60:63],v[144:147]
s_nop 7
v_cvt_pk_bf16_f32 v140,v136,v137
v_cvt_pk_bf16_f32 v141,v138,v139
buffer_store_dwordx2 v[140:141],v254,s[16:19],0 offen offset:768
v_cvt_pk_bf16_f32 v148,v144,v145
v_cvt_pk_bf16_f32 v149,v146,v147
buffer_store_dwordx2 v[148:149],v254,s[16:19],0 offen offset:832
s_waitcnt vmcnt(0)
L_END:
s_endpgm
RS_0:
s_call_b64 s[58:59],RARE_0
s_nop 1
s_branch RS_0_RET
RS_1:
s_call_b64 s[58:59],RARE_1
s_nop 1
s_branch RS_1_RET
RS_2:
s_call_b64 s[58:59],RARE_0
s_nop 1
s_branch RS_2_RET
RS_3:
s_call_b64 s[58:59],RARE_1
s_nop 1
s_branch RS_3_RET
RS_128:
s_call_b64 s[58:59],RARE_0
v_mov_b32 v244,0x3f80
v_mbcnt_lo_u32_b32 v255,-1,0
v_mbcnt_hi_u32_b32 v255,-1,v255
s_mov_b32 s62,229376
v_and_b32 v246,15,v255
v_lshrrev_b32 v254,4,v255
v_lshl_add_u32 v252,v255,9,s98
v_lshl_add_u32 v248,v246,4,s100
v_writelane_b32 v252,s33,1
v_mad_u32_u24 v248,v254,s62,v248
v_add_u32 v249,917504,v248
v_add_u32 v250,1835008,v248
v_add_u32 v251,2752512,v248
v_and_b32 v255,1,v254
v_mul_lo_u32 v255,v255,s63
v_lshl_add_u32 v253,v246,2,s99
v_add_u32 v253,v255,v253
v_lshrrev_b32 v255,1,v254
v_lshlrev_b32 v254,5,v254
s_nop 1
s_branch RS_128_RET
RS_129:
s_call_b64 s[58:59],RARE_1
v_mov_b32 v244,0x3f80
v_mbcnt_lo_u32_b32 v255,-1,0
v_mbcnt_hi_u32_b32 v255,-1,v255
s_mov_b32 s62,229376
v_and_b32 v246,15,v255
v_lshrrev_b32 v254,4,v255
v_lshl_add_u32 v252,v255,9,s98
v_lshl_add_u32 v248,v246,4,s100
v_writelane_b32 v252,s33,1
v_mad_u32_u24 v248,v254,s62,v248
v_add_u32 v249,917504,v248
v_add_u32 v250,1835008,v248
v_add_u32 v251,2752512,v248
v_and_b32 v255,1,v254
v_mul_lo_u32 v255,v255,s63
v_lshl_add_u32 v253,v246,2,s99
v_add_u32 v253,v255,v253
v_lshrrev_b32 v255,1,v254
v_lshlrev_b32 v254,5,v254
v_lshl_add_u32 v254,v255,20,v254
v_add_u32 v254,s101,v254
v_lshrrev_b32 v255,2,v246
v_lshl_add_u32 v254,v255,3,v254
v_and_b32 v255,3,v246
v_mul_u32_u24 v255,896,v255
v_add_u32 v254,v255,v254
v_and_b32 v255,1,v246
v_lshlrev_b32 v255,4,v255
v_lshlrev_b32 v255,v255,v244
v_lshrrev_b32 v247,1,v246
v_lshlrev_b32 v247,v247,1
v_bfe_i32 v244,v247,0,1
v_and_b32 v244,v255,v244
v_bfe_i32 v245,v247,1,1
v_and_b32 v245,v255,v245
v_bfe_i32 v246,v247,2,1
v_and_b32 v246,v255,v246
v_bfe_i32 v247,v247,3,1
v_and_b32 v247,v255,v247
s_nop 1
s_branch RS_129_RET
RS_130:
s_call_b64 s[58:59],RARE_0
v_mov_b32 v244,0x3f80
v_mbcnt_lo_u32_b32 v255,-1,0
v_mbcnt_hi_u32_b32 v255,-1,v255
s_mov_b32 s62,229376
v_and_b32 v246,15,v255
v_lshrrev_b32 v254,4,v255
v_lshl_add_u32 v252,v255,9,s98
v_lshl_add_u32 v248,v246,4,s100
v_writelane_b32 v252,s33,1
v_mad_u32_u24 v248,v254,s62,v248
v_add_u32 v249,917504,v248
v_add_u32 v250,1835008,v248
v_add_u32 v251,2752512,v248
v_and_b32 v255,1,v254
v_mul_lo_u32 v255,v255,s63
v_lshl_add_u32 v253,v246,2,s99
v_add_u32 v253,v255,v253
v_lshrrev_b32 v255,1,v254
v_lshlrev_b32 v254,5,v254
v_lshl_add_u32 v254,v255,20,v254
v_add_u32 v254,s101,v254
v_lshrrev_b32 v255,2,v246
v_lshl_add_u32 v254,v255,3,v254
v_and_b32 v255,3,v246
v_mul_u32_u24 v255,896,v255
v_add_u32 v254,v255,v254
v_and_b32 v255,1,v246
v_lshlrev_b32 v255,4,v255
v_lshlrev_b32 v255,v255,v244
v_lshrrev_b32 v247,1,v246
v_lshlrev_b32 v247,v247,1
v_bfe_i32 v244,v247,0,1
v_and_b32 v244,v255,v244
v_bfe_i32 v245,v247,1,1
v_and_b32 v245,v255,v245
v_bfe_i32 v246,v247,2,1
v_and_b32 v246,v255,v246
v_bfe_i32 v247,v247,3,1
v_and_b32 v247,v255,v247
s_nop 1
s_branch RS_130_RET
RS_131:
s_call_b64 s[58:59],RARE_1
v_mov_b32 v244,0x3f80
v_mbcnt_lo_u32_b32 v255,-1,0
v_mbcnt_hi_u32_b32 v255,-1,v255
s_mov_b32 s62,229376
v_and_b32 v246,15,v255
v_lshrrev_b32 v254,4,v255
v_lshl_add_u32 v252,v255,9,s98
v_lshl_add_u32 v248,v246,4,s100
v_writelane_b32 v252,s33,1
v_mad_u32_u24 v248,v254,s62,v248
v_add_u32 v249,917504,v248
v_add_u32 v250,1835008,v248
v_add_u32 v251,2752512,v248
v_and_b32 v255,1,v254
v_mul_lo_u32 v255,v255,s63
v_lshl_add_u32 v253,v246,2,s99
v_add_u32 v253,v255,v253
v_lshrrev_b32 v255,1,v254
v_lshlrev_b32 v254,5,v254
v_lshl_add_u32 v254,v255,20,v254
v_add_u32 v254,s101,v254
v_lshrrev_b32 v255,2,v246
v_lshl_add_u32 v254,v255,3,v254
v_and_b32 v255,3,v246
v_mul_u32_u24 v255,896,v255
v_add_u32 v254,v255,v254
v_and_b32 v255,1,v246
v_lshlrev_b32 v255,4,v255
v_lshlrev_b32 v255,v255,v244
v_lshrrev_b32 v247,1,v246
v_lshlrev_b32 v247,v247,1
v_bfe_i32 v244,v247,0,1
v_and_b32 v244,v255,v244
v_bfe_i32 v245,v247,1,1
v_and_b32 v245,v255,v245
v_bfe_i32 v246,v247,2,1
v_and_b32 v246,v255,v246
v_bfe_i32 v247,v247,3,1
v_and_b32 v247,v255,v247
s_nop 1
s_branch RS_131_RET
SP_3:
s_movk_i32 s35,0x7fff
SP_3_L:
buffer_load_dword v234,v253,s[28:31],0 offen sc1
s_waitcnt vmcnt(0)
v_cmp_gt_u32 vcc,1,v234
s_sub_u32 s35,s35,1
s_cbranch_scc1 SP_3_RET
s_cbranch_vccnz SP_3_L
s_branch SP_3_RET
SP_4:
s_movk_i32 s35,0x7fff
SP_4_L:
buffer_load_dword v234,v253,s[28:31],0 offen sc1
s_waitcnt vmcnt(0)
v_cmp_gt_u32 vcc,2,v234
s_sub_u32 s35,s35,1
s_cbranch_scc1 SP_4_RET
s_cbranch_vccnz SP_4_L
s_branch SP_4_RET
SP_5:
s_movk_i32 s35,0x7fff
SP_5_L:
buffer_load_dword v234,v253,s[28:31],0 offen sc1
s_waitcnt vmcnt(0)
v_cmp_gt_u32 vcc,3,v234
s_sub_u32 s35,s35,1
s_cbranch_scc1 SP_5_RET
s_cbranch_vccnz SP_5_L
s_branch SP_5_RET
SP_6:
s_movk_i32 s35,0x7fff
SP_6_L:
buffer_load_dword v234,v253,s[28:31],0 offen sc1
s_waitcnt vmcnt(0)
v_cmp_gt_u32 vcc,4,v234
s_sub_u32 s35,s35,1
s_cbranch_scc1 SP_6_RET
s_cbranch_vccnz SP_6_L
s_branch SP_6_RET
SP_7:
s_movk_i32 s35,0x7fff
SP_7_L:
buffer_load_dword v234,v253,s[28:31],0 offen sc1
s_waitcnt vmcnt(0)
v_cmp_gt_u32 vcc,5,v234
s_sub_u32 s35,s35,1
s_cbranch_scc1 SP_7_RET
s_cbranch_vccnz SP_7_L
s_branch SP_7_RET
SP_8:
s_movk_i32 s35,0x7fff
SP_8_L:
buffer_load_dword v234,v253,s[28:31],0 offen sc1
s_waitcnt vmcnt(0)
v_cmp_gt_u32 vcc,6,v234
s_sub_u32 s35,s35,1
s_cbranch_scc1 SP_8_RET
s_cbranch_vccnz SP_8_L
s_branch SP_8_RET
SP_9:
s_movk_i32 s35,0x7fff
SP_9_L:
buffer_load_dword v234,v253,s[28:31],0 offen sc1
s_waitcnt vmcnt(0)
v_cmp_gt_u32 vcc,7,v234
s_sub_u32 s35,s35,1
s_cbranch_scc1 SP_9_RET
s_cbranch_vccnz SP_9_L
s_branch SP_9_RET
SP_10:
s_movk_i32 s35,0x7fff
SP_10_L:
buffer_load_dword v234,v253,s[28:31],0 offen sc1
s_waitcnt vmcnt(0)
v_cmp_gt_u32 vcc,8,v234
s_sub_u32 s35,s35,1
s_cbranch_scc1 SP_10_RET
s_cbranch_vccnz SP_10_L
s_branch SP_10_RET
SP_11:
s_movk_i32 s35,0x7fff
SP_11_L:
buffer_load_dword v234,v253,s[28:31],0 offen sc1
s_waitcnt vmcnt(0)
v_cmp_gt_u32 vcc,9,v234
s_sub_u32 s35,s35,1
s_cbranch_scc1 SP_11_RET
s_cbranch_vccnz SP_11_L
s_branch SP_11_RET
SP_12:
s_movk_i32 s35,0x7fff
SP_12_L:
buffer_load_dword v234,v253,s[28:31],0 offen sc1
s_waitcnt vmcnt(0)
v_cmp_gt_u32 vcc,10,v234
s_sub_u32 s35,s35,1
s_cbranch_scc1 SP_12_RET
s_cbranch_vccnz SP_12_L
s_branch SP_12_RET
SP_13:
s_movk_i32 s35,0x7fff
SP_13_L:
buffer_load_dword v234,v253,s[28:31],0 offen sc1
s_waitcnt vmcnt(0)
v_cmp_gt_u32 vcc,11,v234
s_sub_u32 s35,s35,1
s_cbranch_scc1 SP_13_RET
s_cbranch_vccnz SP_13_L
s_branch SP_13_RET
SP_14:
s_movk_i32 s35,0x7fff
SP_14_L:
buffer_load_dword v234,v253,s[28:31],0 offen sc1
s_waitcnt vmcnt(0)
v_cmp_gt_u32 vcc,12,v234
s_sub_u32 s35,s35,1
s_cbranch_scc1 SP_14_RET
s_cbranch_vccnz SP_14_L
s_branch SP_14_RET
SP_15:
s_movk_i32 s35,0x7fff
SP_15_L:
buffer_load_dword v234,v255,s[28:31],0 offen sc1
s_waitcnt vmcnt(0)
v_cmp_gt_u32 vcc,14,v234
s_sub_u32 s35,s35,1
s_cbranch_scc1 SP_15_RET
s_cbranch_vccnz SP_15_L
s_branch SP_15_RET
RARE_0:
s_nop 7
s_nop 7
v_mbcnt_lo_u32_b32 v252,-1,0
v_mbcnt_hi_u32_b32 v252,-1,v252
v_and_b32 v253,15,v252
v_lshlrev_b32 v253,9,v253
v_lshrrev_b32 v252,4,v252
v_lshl_add_u32 v252,v252,4,v253
s_sub_u32 s61,s52,49152
buffer_load_dwordx4 v[244:247],v252,s[8:11],s61 offen offset:0
buffer_load_dwordx4 v[248:251],v252,s[8:11],s61 offen offset:64
s_waitcnt vmcnt(0)
v_mfma_f32_16x16x32_bf16 v[128:131],v[244:247],v[0:3],v[192:195]
v_mfma_f32_16x16x32_bf16 v[136:139],v[244:247],v[4:7],v[196:199]
v_mfma_f32_16x16x32_bf16 v[144:147],v[244:247],v[8:11],v[200:203]
v_mfma_f32_16x16x32_bf16 v[152:155],v[244:247],v[12:15],v[204:207]
v_mfma_f32_16x16x32_bf16 v[128:131],v[248:251],v[16:19],v[128:131]
v_mfma_f32_16x16x32_bf16 v[136:139],v[248:251],v[20:23],v[136:139]
v_mfma_f32_16x16x32_bf16 v[144:147],v[248:251],v[24:27],v[144:147]
v_mfma_f32_16x16x32_bf16 v[152:155],v[248:251],v[28:31],v[152:155]
s_nop 7
buffer_load_dwordx4 v[244:247],v252,s[8:11],s61 offen offset:128
buffer_load_dwordx4 v[248:251],v252,s[8:11],s61 offen offset:192
s_waitcnt vmcnt(0)
v_mfma_f32_16x16x32_bf16 v[128:131],v[244:247],v[32:35],v[128:131]
v_mfma_f32_16x16x32_bf16 v[136:139],v[244:247],v[36:39],v[136:139]
v_mfma_f32_16x16x32_bf16 v[144:147],v[244:247],v[40:43],v[144:147]
v_mfma_f32_16x16x32_bf16 v[152:155],v[244:247],v[44:47],v[152:155]
v_mfma_f32_16x16x32_bf16 v[128:131],v[248:251],v[48:51],v[128:131]
v_mfma_f32_16x16x32_bf16 v[136:139],v[248:251],v[52:55],v[136:139]
v_mfma_f32_16x16x32_bf16 v[144:147],v[248:251],v[56:59],v[144:147]
v_mfma_f32_16x16x32_bf16 v[152:155],v[248:251],v[60:63],v[152:155]
s_nop 7
buffer_load_dwordx4 v[244:247],v252,s[8:11],s61 offen offset:256
buffer_load_dwordx4 v[248:251],v252,s[8:11],s61 offen offset:320
s_waitcnt vmcnt(0)
v_mfma_f32_16x16x32_bf16 v[128:131],v[244:247],v[64:67],v[128:131]
v_mfma_f32_16x16x32_bf16 v[136:139],v[244:247],v[68:71],v[136:139]
v_mfma_f32_16x16x32_bf16 v[144:147],v[244:247],v[72:75],v[144:147]
v_mfma_f32_16x16x32_bf16 v[152:155],v[244:247],v[76:79],v[152:155]
v_mfma_f32_16x16x32_bf16 v[128:131],v[248:251],v[80:83],v[128:131]
v_mfma_f32_16x16x32_bf16 v[136:139],v[248:251],v[84:87],v[136:139]
v_mfma_f32_16x16x32_bf16 v[144:147],v[248:251],v[88:91],v[144:147]
v_mfma_f32_16x16x32_bf16 v[152:155],v[248:251],v[92:95],v[152:155]
s_nop 7
buffer_load_dwordx4 v[244:247],v252,s[8:11],s61 offen offset:384
buffer_load_dwordx4 v[248:251],v252,s[8:11],s61 offen offset:448
s_waitcnt vmcnt(0)
v_mfma_f32_16x16x32_bf16 v[128:131],v[244:247],v[96:99],v[128:131]
v_mfma_f32_16x16x32_bf16 v[136:139],v[244:247],v[100:103],v[136:139]
v_mfma_f32_16x16x32_bf16 v[144:147],v[244:247],v[104:107],v[144:147]
v_mfma_f32_16x16x32_bf16 v[152:155],v[244:247],v[108:111],v[152:155]
v_mfma_f32_16x16x32_bf16 v[128:131],v[248:251],v[112:115],v[128:131]
v_mfma_f32_16x16x32_bf16 v[136:139],v[248:251],v[116:119],v[136:139]
v_mfma_f32_16x16x32_bf16 v[144:147],v[248:251],v[120:123],v[144:147]
v_mfma_f32_16x16x32_bf16 v[152:155],v[248:251],v[124:127],v[152:155]
s_nop 7
s_add_u32 s61,s61,8192
buffer_load_dwordx4 v[244:247],v252,s[8:11],s61 offen offset:0
buffer_load_dwordx4 v[248:251],v252,s[8:11],s61 offen offset:64
s_waitcnt vmcnt(0)
v_mfma_f32_16x16x32_bf16 v[132:135],v[244:247],v[0:3],v[192:195]
v_mfma_f32_16x16x32_bf16 v[140:143],v[244:247],v[4:7],v[196:199]
v_mfma_f32_16x16x32_bf16 v[148:151],v[244:247],v[8:11],v[200:203]
v_mfma_f32_16x16x32_bf16 v[156:159],v[244:247],v[12:15],v[204:207]
v_mfma_f32_16x16x32_bf16 v[132:135],v[248:251],v[16:19],v[132:135]
v_mfma_f32_16x16x32_bf16 v[140:143],v[248:251],v[20:23],v[140:143]
v_mfma_f32_16x16x32_bf16 v[148:151],v[248:251],v[24:27],v[148:151]
v_mfma_f32_16x16x32_bf16 v[156:159],v[248:251],v[28:31],v[156:159]
s_nop 7
buffer_load_dwordx4 v[244:247],v252,s[8:11],s61 offen offset:128
buffer_load_dwordx4 v[248:251],v252,s[8:11],s61 offen offset:192
s_waitcnt vmcnt(0)
v_mfma_f32_16x16x32_bf16 v[132:135],v[244:247],v[32:35],v[132:135]
v_mfma_f32_16x16x32_bf16 v[140:143],v[244:247],v[36:39],v[140:143]
v_mfma_f32_16x16x32_bf16 v[148:151],v[244:247],v[40:43],v[148:151]
v_mfma_f32_16x16x32_bf16 v[156:159],v[244:247],v[44:47],v[156:159]
v_mfma_f32_16x16x32_bf16 v[132:135],v[248:251],v[48:51],v[132:135]
v_mfma_f32_16x16x32_bf16 v[140:143],v[248:251],v[52:55],v[140:143]
v_mfma_f32_16x16x32_bf16 v[148:151],v[248:251],v[56:59],v[148:151]
v_mfma_f32_16x16x32_bf16 v[156:159],v[248:251],v[60:63],v[156:159]
s_nop 7
buffer_load_dwordx4 v[244:247],v252,s[8:11],s61 offen offset:256
buffer_load_dwordx4 v[248:251],v252,s[8:11],s61 offen offset:320
s_waitcnt vmcnt(0)
v_mfma_f32_16x16x32_bf16 v[132:135],v[244:247],v[64:67],v[132:135]
v_mfma_f32_16x16x32_bf16 v[140:143],v[244:247],v[68:71],v[140:143]
v_mfma_f32_16x16x32_bf16 v[148:151],v[244:247],v[72:75],v[148:151]
v_mfma_f32_16x16x32_bf16 v[156:159],v[244:247],v[76:79],v[156:159]
v_mfma_f32_16x16x32_bf16 v[132:135],v[248:251],v[80:83],v[132:135]
v_mfma_f32_16x16x32_bf16 v[140:143],v[248:251],v[84:87],v[140:143]
v_mfma_f32_16x16x32_bf16 v[148:151],v[248:251],v[88:91],v[148:151]
v_mfma_f32_16x16x32_bf16 v[156:159],v[248:251],v[92:95],v[156:159]
s_nop 7
buffer_load_dwordx4 v[244:247],v252,s[8:11],s61 offen offset:384
buffer_load_dwordx4 v[248:251],v252,s[8:11],s61 offen offset:448
s_waitcnt vmcnt(0)
v_mfma_f32_16x16x32_bf16 v[132:135],v[244:247],v[96:99],v[132:135]
v_mfma_f32_16x16x32_bf16 v[140:143],v[244:247],v[100:103],v[140:143]
v_mfma_f32_16x16x32_bf16 v[148:151],v[244:247],v[104:107],v[148:151]
v_mfma_f32_16x16x32_bf16 v[156:159],v[244:247],v[108:111],v[156:159]
v_mfma_f32_16x16x32_bf16 v[132:135],v[248:251],v[112:115],v[132:135]
v_mfma_f32_16x16x32_bf16 v[140:143],v[248:251],v[116:119],v[140:143]
v_mfma_f32_16x16x32_bf16 v[148:151],v[248:251],v[120:123],v[148:151]
v_mfma_f32_16x16x32_bf16 v[156:159],v[248:251],v[124:127],v[156:159]
s_nop 7
s_nop 7
v_max3_f32 v253,v128,v129,v130
v_max3_f32 v253,v253,v131,v132
v_max3_f32 v253,v253,v133,v134
v_max_f32 v253,v253,v135
v_mov_b32 v254,v253
s_nop 1
v_permlane32_swap_b32 v253,v254
v_max_f32 v253,v253,v254
v_mov_b32 v254,v253
s_nop 1
v_permlane16_swap_b32 v253,v254
v_max_f32 v253,v253,v254
v_max_f32 v253,0,v253
v_exp_f32 v255,-v253
v_sub_f32 v192,v192,v253
v_sub_f32 v193,v193,v253
v_sub_f32 v194,v194,v253
v_sub_f32 v195,v195,v253
v_sub_f32 v160,v160,v253
v_sub_f32 v161,v161,v253
v_sub_f32 v162,v162,v253
v_sub_f32 v163,v163,v253
v_sub_f32 v164,v164,v253
v_sub_f32 v165,v165,v253
v_sub_f32 v166,v166,v253
v_sub_f32 v167,v167,v253
v_sub_f32 v128,v128,v253
v_sub_f32 v129,v129,v253
v_sub_f32 v130,v130,v253
v_sub_f32 v131,v131,v253
v_sub_f32 v132,v132,v253
v_sub_f32 v133,v133,v253
v_sub_f32 v134,v134,v253
v_sub_f32 v135,v135,v253
v_exp_f32 v128,v128
s_nop 0
v_exp_f32 v129,v129
s_nop 0
v_add_f32 v228,v128,v129
v_cvt_pk_bf16_f32 v128,v128,v129
v_exp_f32 v130,v130
s_nop 0
v_add_f32 v228,v228,v130
v_exp_f32 v131,v131
s_nop 0
v_add_f32 v228,v228,v131
v_cvt_pk_bf16_f32 v129,v130,v131
v_exp_f32 v132,v132
s_nop 0
v_add_f32 v228,v228,v132
v_exp_f32 v133,v133
s_nop 0
v_add_f32 v228,v228,v133
v_cvt_pk_bf16_f32 v130,v132,v133
v_exp_f32 v134,v134
s_nop 0
v_add_f32 v228,v228,v134
v_exp_f32 v135,v135
s_nop 0
v_add_f32 v228,v228,v135
v_cvt_pk_bf16_f32 v131,v134,v135
v_mul_f32 v224,v224,v255
v_accvgpr_read_b32 v244,a0
v_accvgpr_read_b32 v245,a1
v_accvgpr_read_b32 v246,a2
v_accvgpr_read_b32 v247,a3
v_accvgpr_read_b32 v248,a16
v_accvgpr_read_b32 v249,a17
v_accvgpr_read_b32 v250,a18
v_accvgpr_read_b32 v251,a19
v_mul_f32 v244,v244,v255
v_mul_f32 v245,v245,v255
v_mul_f32 v246,v246,v255
v_mul_f32 v247,v247,v255
v_mul_f32 v248,v248,v255
v_mul_f32 v249,v249,v255
v_mul_f32 v250,v250,v255
v_mul_f32 v251,v251,v255
v_accvgpr_write_b32 a0,v244
v_accvgpr_write_b32 a1,v245
v_accvgpr_write_b32 a2,v246
v_accvgpr_write_b32 a3,v247
v_accvgpr_write_b32 a16,v248
v_accvgpr_write_b32 a17,v249
v_accvgpr_write_b32 a18,v250
v_accvgpr_write_b32 a19,v251
v_accvgpr_read_b32 v244,a32
v_accvgpr_read_b32 v245,a33
v_accvgpr_read_b32 v246,a34
v_accvgpr_read_b32 v247,a35
v_accvgpr_read_b32 v248,a48
v_accvgpr_read_b32 v249,a49
v_accvgpr_read_b32 v250,a50
v_accvgpr_read_b32 v251,a51
v_mul_f32 v244,v244,v255
v_mul_f32 v245,v245,v255
v_mul_f32 v246,v246,v255
v_mul_f32 v247,v247,v255
v_mul_f32 v248,v248,v255
v_mul_f32 v249,v249,v255
v_mul_f32 v250,v250,v255
v_mul_f32 v251,v251,v255
v_accvgpr_write_b32 a32,v244
v_accvgpr_write_b32 a33,v245
v_accvgpr_write_b32 a34,v246
v_accvgpr_write_b32 a35,v247
v_accvgpr_write_b32 a48,v248
v_accvgpr_write_b32 a49,v249
v_accvgpr_write_b32 a50,v250
v_accvgpr_write_b32 a51,v251
v_accvgpr_read_b32 v244,a64
v_accvgpr_read_b32 v245,a65
v_accvgpr_read_b32 v246,a66
v_accvgpr_read_b32 v247,a67
v_accvgpr_read_b32 v248,a80
v_accvgpr_read_b32 v249,a81
v_accvgpr_read_b32 v250,a82
v_accvgpr_read_b32 v251,a83
v_mul_f32 v244,v244,v255
v_mul_f32 v245,v245,v255
v_mul_f32 v246,v246,v255
v_mul_f32 v247,v247,v255
v_mul_f32 v248,v248,v255
v_mul_f32 v249,v249,v255
v_mul_f32 v250,v250,v255
v_mul_f32 v251,v251,v255
v_accvgpr_write_b32 a64,v244
v_accvgpr_write_b32 a65,v245
v_accvgpr_write_b32 a66,v246
v_accvgpr_write_b32 a67,v247
v_accvgpr_write_b32 a80,v248
v_accvgpr_write_b32 a81,v249
v_accvgpr_write_b32 a82,v250
v_accvgpr_write_b32 a83,v251
v_accvgpr_read_b32 v244,a96
v_accvgpr_read_b32 v245,a97
v_accvgpr_read_b32 v246,a98
v_accvgpr_read_b32 v247,a99
v_accvgpr_read_b32 v248,a112
v_accvgpr_read_b32 v249,a113
v_accvgpr_read_b32 v250,a114
v_accvgpr_read_b32 v251,a115
v_mul_f32 v244,v244,v255
v_mul_f32 v245,v245,v255
v_mul_f32 v246,v246,v255
v_mul_f32 v247,v247,v255
v_mul_f32 v248,v248,v255
v_mul_f32 v249,v249,v255
v_mul_f32 v250,v250,v255
v_mul_f32 v251,v251,v255
v_accvgpr_write_b32 a96,v244
v_accvgpr_write_b32 a97,v245
v_accvgpr_write_b32 a98,v246
v_accvgpr_write_b32 a99,v247
v_accvgpr_write_b32 a112,v248
v_accvgpr_write_b32 a113,v249
v_accvgpr_write_b32 a114,v250
v_accvgpr_write_b32 a115,v251
v_accvgpr_read_b32 v244,a128
v_accvgpr_read_b32 v245,a129
v_accvgpr_read_b32 v246,a130
v_accvgpr_read_b32 v247,a131
v_accvgpr_read_b32 v248,a144
v_accvgpr_read_b32 v249,a145
v_accvgpr_read_b32 v250,a146
v_accvgpr_read_b32 v251,a147
v_mul_f32 v244,v244,v255
v_mul_f32 v245,v245,v255
v_mul_f32 v246,v246,v255
v_mul_f32 v247,v247,v255
v_mul_f32 v248,v248,v255
v_mul_f32 v249,v249,v255
v_mul_f32 v250,v250,v255
v_mul_f32 v251,v251,v255
v_accvgpr_write_b32 a128,v244
v_accvgpr_write_b32 a129,v245
v_accvgpr_write_b32 a130,v246
v_accvgpr_write_b32 a131,v247
v_accvgpr_write_b32 a144,v248
v_accvgpr_write_b32 a145,v249
v_accvgpr_write_b32 a146,v250
v_accvgpr_write_b32 a147,v251
v_accvgpr_read_b32 v244,a160
v_accvgpr_read_b32 v245,a161
v_accvgpr_read_b32 v246,a162
v_accvgpr_read_b32 v247,a163
v_accvgpr_read_b32 v248,a176
v_accvgpr_read_b32 v249,a177
v_accvgpr_read_b32 v250,a178
v_accvgpr_read_b32 v251,a179
v_mul_f32 v244,v244,v255
v_mul_f32 v245,v245,v255
v_mul_f32 v246,v246,v255
v_mul_f32 v247,v247,v255
v_mul_f32 v248,v248,v255
v_mul_f32 v249,v249,v255
v_mul_f32 v250,v250,v255
v_mul_f32 v251,v251,v255
v_accvgpr_write_b32 a160,v244
v_accvgpr_write_b32 a161,v245
v_accvgpr_write_b32 a162,v246
v_accvgpr_write_b32 a163,v247
v_accvgpr_write_b32 a176,v248
v_accvgpr_write_b32 a177,v249
v_accvgpr_write_b32 a178,v250
v_accvgpr_write_b32 a179,v251
v_accvgpr_read_b32 v244,a192
v_accvgpr_read_b32 v245,a193
v_accvgpr_read_b32 v246,a194
v_accvgpr_read_b32 v247,a195
v_accvgpr_read_b32 v248,a208
v_accvgpr_read_b32 v249,a209
v_accvgpr_read_b32 v250,a210
v_accvgpr_read_b32 v251,a211
v_mul_f32 v244,v244,v255
v_mul_f32 v245,v245,v255
v_mul_f32 v246,v246,v255
v_mul_f32 v247,v247,v255
v_mul_f32 v248,v248,v255
v_mul_f32 v249,v249,v255
v_mul_f32 v250,v250,v255
v_mul_f32 v251,v251,v255
v_accvgpr_write_b32 a192,v244
v_accvgpr_write_b32 a193,v245
v_accvgpr_write_b32 a194,v246
v_accvgpr_write_b32 a195,v247
v_accvgpr_write_b32 a208,v248
v_accvgpr_write_b32 a209,v249
v_accvgpr_write_b32 a210,v250
v_accvgpr_write_b32 a211,v251
v_accvgpr_read_b32 v244,a224
v_accvgpr_read_b32 v245,a225
v_accvgpr_read_b32 v246,a226
v_accvgpr_read_b32 v247,a227
v_accvgpr_read_b32 v248,a240
v_accvgpr_read_b32 v249,a241
v_accvgpr_read_b32 v250,a242
v_accvgpr_read_b32 v251,a243
v_mul_f32 v244,v244,v255
v_mul_f32 v245,v245,v255
v_mul_f32 v246,v246,v255
v_mul_f32 v247,v247,v255
v_mul_f32 v248,v248,v255
v_mul_f32 v249,v249,v255
v_mul_f32 v250,v250,v255
v_mul_f32 v251,v251,v255
v_accvgpr_write_b32 a224,v244
v_accvgpr_write_b32 a225,v245
v_accvgpr_write_b32 a226,v246
v_accvgpr_write_b32 a227,v247
v_accvgpr_write_b32 a240,v248
v_accvgpr_write_b32 a241,v249
v_accvgpr_write_b32 a242,v250
v_accvgpr_write_b32 a243,v251
v_max3_f32 v253,v136,v137,v138
v_max3_f32 v253,v253,v139,v140
v_max3_f32 v253,v253,v141,v142
v_max_f32 v253,v253,v143
v_mov_b32 v254,v253
s_nop 1
v_permlane32_swap_b32 v253,v254
v_max_f32 v253,v253,v254
v_mov_b32 v254,v253
s_nop 1
v_permlane16_swap_b32 v253,v254
v_max_f32 v253,v253,v254
v_max_f32 v253,0,v253
v_exp_f32 v255,-v253
v_sub_f32 v196,v196,v253
v_sub_f32 v197,v197,v253
v_sub_f32 v198,v198,v253
v_sub_f32 v199,v199,v253
v_sub_f32 v168,v168,v253
v_sub_f32 v169,v169,v253
v_sub_f32 v170,v170,v253
v_sub_f32 v171,v171,v253
v_sub_f32 v172,v172,v253
v_sub_f32 v173,v173,v253
v_sub_f32 v174,v174,v253
v_sub_f32 v175,v175,v253
v_sub_f32 v136,v136,v253
v_sub_f32 v137,v137,v253
v_sub_f32 v138,v138,v253
v_sub_f32 v139,v139,v253
v_sub_f32 v140,v140,v253
v_sub_f32 v141,v141,v253
v_sub_f32 v142,v142,v253
v_sub_f32 v143,v143,v253
v_exp_f32 v136,v136
s_nop 0
v_exp_f32 v137,v137
s_nop 0
v_add_f32 v229,v136,v137
v_cvt_pk_bf16_f32 v136,v136,v137
v_exp_f32 v138,v138
s_nop 0
v_add_f32 v229,v229,v138
v_exp_f32 v139,v139
s_nop 0
v_add_f32 v229,v229,v139
v_cvt_pk_bf16_f32 v137,v138,v139
v_exp_f32 v140,v140
s_nop 0
v_add_f32 v229,v229,v140
v_exp_f32 v141,v141
s_nop 0
v_add_f32 v229,v229,v141
v_cvt_pk_bf16_f32 v138,v140,v141
v_exp_f32 v142,v142
s_nop 0
v_add_f32 v229,v229,v142
v_exp_f32 v143,v143
s_nop 0
v_add_f32 v229,v229,v143
v_cvt_pk_bf16_f32 v139,v142,v143
v_mul_f32 v225,v225,v255
v_accvgpr_read_b32 v244,a4
v_accvgpr_read_b32 v245,a5
v_accvgpr_read_b32 v246,a6
v_accvgpr_read_b32 v247,a7
v_accvgpr_read_b32 v248,a20
v_accvgpr_read_b32 v249,a21
v_accvgpr_read_b32 v250,a22
v_accvgpr_read_b32 v251,a23
v_mul_f32 v244,v244,v255
v_mul_f32 v245,v245,v255
v_mul_f32 v246,v246,v255
v_mul_f32 v247,v247,v255
v_mul_f32 v248,v248,v255
v_mul_f32 v249,v249,v255
v_mul_f32 v250,v250,v255
v_mul_f32 v251,v251,v255
v_accvgpr_write_b32 a4,v244
v_accvgpr_write_b32 a5,v245
v_accvgpr_write_b32 a6,v246
v_accvgpr_write_b32 a7,v247
v_accvgpr_write_b32 a20,v248
v_accvgpr_write_b32 a21,v249
v_accvgpr_write_b32 a22,v250
v_accvgpr_write_b32 a23,v251
v_accvgpr_read_b32 v244,a36
v_accvgpr_read_b32 v245,a37
v_accvgpr_read_b32 v246,a38
v_accvgpr_read_b32 v247,a39
v_accvgpr_read_b32 v248,a52
v_accvgpr_read_b32 v249,a53
v_accvgpr_read_b32 v250,a54
v_accvgpr_read_b32 v251,a55
v_mul_f32 v244,v244,v255
v_mul_f32 v245,v245,v255
v_mul_f32 v246,v246,v255
v_mul_f32 v247,v247,v255
v_mul_f32 v248,v248,v255
v_mul_f32 v249,v249,v255
v_mul_f32 v250,v250,v255
v_mul_f32 v251,v251,v255
v_accvgpr_write_b32 a36,v244
v_accvgpr_write_b32 a37,v245
v_accvgpr_write_b32 a38,v246
v_accvgpr_write_b32 a39,v247
v_accvgpr_write_b32 a52,v248
v_accvgpr_write_b32 a53,v249
v_accvgpr_write_b32 a54,v250
v_accvgpr_write_b32 a55,v251
v_accvgpr_read_b32 v244,a68
v_accvgpr_read_b32 v245,a69
v_accvgpr_read_b32 v246,a70
v_accvgpr_read_b32 v247,a71
v_accvgpr_read_b32 v248,a84
v_accvgpr_read_b32 v249,a85
v_accvgpr_read_b32 v250,a86
v_accvgpr_read_b32 v251,a87
v_mul_f32 v244,v244,v255
v_mul_f32 v245,v245,v255
v_mul_f32 v246,v246,v255
v_mul_f32 v247,v247,v255
v_mul_f32 v248,v248,v255
v_mul_f32 v249,v249,v255
v_mul_f32 v250,v250,v255
v_mul_f32 v251,v251,v255
v_accvgpr_write_b32 a68,v244
v_accvgpr_write_b32 a69,v245
v_accvgpr_write_b32 a70,v246
v_accvgpr_write_b32 a71,v247
v_accvgpr_write_b32 a84,v248
v_accvgpr_write_b32 a85,v249
v_accvgpr_write_b32 a86,v250
v_accvgpr_write_b32 a87,v251
v_accvgpr_read_b32 v244,a100
v_accvgpr_read_b32 v245,a101
v_accvgpr_read_b32 v246,a102
v_accvgpr_read_b32 v247,a103
v_accvgpr_read_b32 v248,a116
v_accvgpr_read_b32 v249,a117
v_accvgpr_read_b32 v250,a118
v_accvgpr_read_b32 v251,a119
v_mul_f32 v244,v244,v255
v_mul_f32 v245,v245,v255
v_mul_f32 v246,v246,v255
v_mul_f32 v247,v247,v255
v_mul_f32 v248,v248,v255
v_mul_f32 v249,v249,v255
v_mul_f32 v250,v250,v255
v_mul_f32 v251,v251,v255
v_accvgpr_write_b32 a100,v244
v_accvgpr_write_b32 a101,v245
v_accvgpr_write_b32 a102,v246
v_accvgpr_write_b32 a103,v247
v_accvgpr_write_b32 a116,v248
v_accvgpr_write_b32 a117,v249
v_accvgpr_write_b32 a118,v250
v_accvgpr_write_b32 a119,v251
v_accvgpr_read_b32 v244,a132
v_accvgpr_read_b32 v245,a133
v_accvgpr_read_b32 v246,a134
v_accvgpr_read_b32 v247,a135
v_accvgpr_read_b32 v248,a148
v_accvgpr_read_b32 v249,a149
v_accvgpr_read_b32 v250,a150
v_accvgpr_read_b32 v251,a151
v_mul_f32 v244,v244,v255
v_mul_f32 v245,v245,v255
v_mul_f32 v246,v246,v255
v_mul_f32 v247,v247,v255
v_mul_f32 v248,v248,v255
v_mul_f32 v249,v249,v255
v_mul_f32 v250,v250,v255
v_mul_f32 v251,v251,v255
v_accvgpr_write_b32 a132,v244
v_accvgpr_write_b32 a133,v245
v_accvgpr_write_b32 a134,v246
v_accvgpr_write_b32 a135,v247
v_accvgpr_write_b32 a148,v248
v_accvgpr_write_b32 a149,v249
v_accvgpr_write_b32 a150,v250
v_accvgpr_write_b32 a151,v251
v_accvgpr_read_b32 v244,a164
v_accvgpr_read_b32 v245,a165
v_accvgpr_read_b32 v246,a166
v_accvgpr_read_b32 v247,a167
v_accvgpr_read_b32 v248,a180
v_accvgpr_read_b32 v249,a181
v_accvgpr_read_b32 v250,a182
v_accvgpr_read_b32 v251,a183
v_mul_f32 v244,v244,v255
v_mul_f32 v245,v245,v255
v_mul_f32 v246,v246,v255
v_mul_f32 v247,v247,v255
v_mul_f32 v248,v248,v255
v_mul_f32 v249,v249,v255
v_mul_f32 v250,v250,v255
v_mul_f32 v251,v251,v255
v_accvgpr_write_b32 a164,v244
v_accvgpr_write_b32 a165,v245
v_accvgpr_write_b32 a166,v246
v_accvgpr_write_b32 a167,v247
v_accvgpr_write_b32 a180,v248
v_accvgpr_write_b32 a181,v249
v_accvgpr_write_b32 a182,v250
v_accvgpr_write_b32 a183,v251
v_accvgpr_read_b32 v244,a196
v_accvgpr_read_b32 v245,a197
v_accvgpr_read_b32 v246,a198
v_accvgpr_read_b32 v247,a199
v_accvgpr_read_b32 v248,a212
v_accvgpr_read_b32 v249,a213
v_accvgpr_read_b32 v250,a214
v_accvgpr_read_b32 v251,a215
v_mul_f32 v244,v244,v255
v_mul_f32 v245,v245,v255
v_mul_f32 v246,v246,v255
v_mul_f32 v247,v247,v255
v_mul_f32 v248,v248,v255
v_mul_f32 v249,v249,v255
v_mul_f32 v250,v250,v255
v_mul_f32 v251,v251,v255
v_accvgpr_write_b32 a196,v244
v_accvgpr_write_b32 a197,v245
v_accvgpr_write_b32 a198,v246
v_accvgpr_write_b32 a199,v247
v_accvgpr_write_b32 a212,v248
v_accvgpr_write_b32 a213,v249
v_accvgpr_write_b32 a214,v250
v_accvgpr_write_b32 a215,v251
v_accvgpr_read_b32 v244,a228
v_accvgpr_read_b32 v245,a229
v_accvgpr_read_b32 v246,a230
v_accvgpr_read_b32 v247,a231
v_accvgpr_read_b32 v248,a244
v_accvgpr_read_b32 v249,a245
v_accvgpr_read_b32 v250,a246
v_accvgpr_read_b32 v251,a247
v_mul_f32 v244,v244,v255
v_mul_f32 v245,v245,v255
v_mul_f32 v246,v246,v255
v_mul_f32 v247,v247,v255
v_mul_f32 v248,v248,v255
v_mul_f32 v249,v249,v255
v_mul_f32 v250,v250,v255
v_mul_f32 v251,v251,v255
v_accvgpr_write_b32 a228,v244
v_accvgpr_write_b32 a229,v245
v_accvgpr_write_b32 a230,v246
v_accvgpr_write_b32 a231,v247
v_accvgpr_write_b32 a244,v248
v_accvgpr_write_b32 a245,v249
v_accvgpr_write_b32 a246,v250
v_accvgpr_write_b32 a247,v251
v_max3_f32 v253,v144,v145,v146
v_max3_f32 v253,v253,v147,v148
v_max3_f32 v253,v253,v149,v150
v_max_f32 v253,v253,v151
v_mov_b32 v254,v253
s_nop 1
v_permlane32_swap_b32 v253,v254
v_max_f32 v253,v253,v254
v_mov_b32 v254,v253
s_nop 1
v_permlane16_swap_b32 v253,v254
v_max_f32 v253,v253,v254
v_max_f32 v253,0,v253
v_exp_f32 v255,-v253
v_sub_f32 v200,v200,v253
v_sub_f32 v201,v201,v253
v_sub_f32 v202,v202,v253
v_sub_f32 v203,v203,v253
v_sub_f32 v176,v176,v253
v_sub_f32 v177,v177,v253
v_sub_f32 v178,v178,v253
v_sub_f32 v179,v179,v253
v_sub_f32 v180,v180,v253
v_sub_f32 v181,v181,v253
v_sub_f32 v182,v182,v253
v_sub_f32 v183,v183,v253
v_sub_f32 v144,v144,v253
v_sub_f32 v145,v145,v253
v_sub_f32 v146,v146,v253
v_sub_f32 v147,v147,v253
v_sub_f32 v148,v148,v253
v_sub_f32 v149,v149,v253
v_sub_f32 v150,v150,v253
v_sub_f32 v151,v151,v253
v_exp_f32 v144,v144
s_nop 0
v_exp_f32 v145,v145
s_nop 0
v_add_f32 v230,v144,v145
v_cvt_pk_bf16_f32 v144,v144,v145
v_exp_f32 v146,v146
s_nop 0
v_add_f32 v230,v230,v146
v_exp_f32 v147,v147
s_nop 0
v_add_f32 v230,v230,v147
v_cvt_pk_bf16_f32 v145,v146,v147
v_exp_f32 v148,v148
s_nop 0
v_add_f32 v230,v230,v148
v_exp_f32 v149,v149
s_nop 0
v_add_f32 v230,v230,v149
v_cvt_pk_bf16_f32 v146,v148,v149
v_exp_f32 v150,v150
s_nop 0
v_add_f32 v230,v230,v150
v_exp_f32 v151,v151
s_nop 0
v_add_f32 v230,v230,v151
v_cvt_pk_bf16_f32 v147,v150,v151
v_mul_f32 v226,v226,v255
v_accvgpr_read_b32 v244,a8
v_accvgpr_read_b32 v245,a9
v_accvgpr_read_b32 v246,a10
v_accvgpr_read_b32 v247,a11
v_accvgpr_read_b32 v248,a24
v_accvgpr_read_b32 v249,a25
v_accvgpr_read_b32 v250,a26
v_accvgpr_read_b32 v251,a27
v_mul_f32 v244,v244,v255
v_mul_f32 v245,v245,v255
v_mul_f32 v246,v246,v255
v_mul_f32 v247,v247,v255
v_mul_f32 v248,v248,v255
v_mul_f32 v249,v249,v255
v_mul_f32 v250,v250,v255
v_mul_f32 v251,v251,v255
v_accvgpr_write_b32 a8,v244
v_accvgpr_write_b32 a9,v245
v_accvgpr_write_b32 a10,v246
v_accvgpr_write_b32 a11,v247
v_accvgpr_write_b32 a24,v248
v_accvgpr_write_b32 a25,v249
v_accvgpr_write_b32 a26,v250
v_accvgpr_write_b32 a27,v251
v_accvgpr_read_b32 v244,a40
v_accvgpr_read_b32 v245,a41
v_accvgpr_read_b32 v246,a42
v_accvgpr_read_b32 v247,a43
v_accvgpr_read_b32 v248,a56
v_accvgpr_read_b32 v249,a57
v_accvgpr_read_b32 v250,a58
v_accvgpr_read_b32 v251,a59
v_mul_f32 v244,v244,v255
v_mul_f32 v245,v245,v255
v_mul_f32 v246,v246,v255
v_mul_f32 v247,v247,v255
v_mul_f32 v248,v248,v255
v_mul_f32 v249,v249,v255
v_mul_f32 v250,v250,v255
v_mul_f32 v251,v251,v255
v_accvgpr_write_b32 a40,v244
v_accvgpr_write_b32 a41,v245
v_accvgpr_write_b32 a42,v246
v_accvgpr_write_b32 a43,v247
v_accvgpr_write_b32 a56,v248
v_accvgpr_write_b32 a57,v249
v_accvgpr_write_b32 a58,v250
v_accvgpr_write_b32 a59,v251
v_accvgpr_read_b32 v244,a72
v_accvgpr_read_b32 v245,a73
v_accvgpr_read_b32 v246,a74
v_accvgpr_read_b32 v247,a75
v_accvgpr_read_b32 v248,a88
v_accvgpr_read_b32 v249,a89
v_accvgpr_read_b32 v250,a90
v_accvgpr_read_b32 v251,a91
v_mul_f32 v244,v244,v255
v_mul_f32 v245,v245,v255
v_mul_f32 v246,v246,v255
v_mul_f32 v247,v247,v255
v_mul_f32 v248,v248,v255
v_mul_f32 v249,v249,v255
v_mul_f32 v250,v250,v255
v_mul_f32 v251,v251,v255
v_accvgpr_write_b32 a72,v244
v_accvgpr_write_b32 a73,v245
v_accvgpr_write_b32 a74,v246
v_accvgpr_write_b32 a75,v247
v_accvgpr_write_b32 a88,v248
v_accvgpr_write_b32 a89,v249
v_accvgpr_write_b32 a90,v250
v_accvgpr_write_b32 a91,v251
v_accvgpr_read_b32 v244,a104
v_accvgpr_read_b32 v245,a105
v_accvgpr_read_b32 v246,a106
v_accvgpr_read_b32 v247,a107
v_accvgpr_read_b32 v248,a120
v_accvgpr_read_b32 v249,a121
v_accvgpr_read_b32 v250,a122
v_accvgpr_read_b32 v251,a123
v_mul_f32 v244,v244,v255
v_mul_f32 v245,v245,v255
v_mul_f32 v246,v246,v255
v_mul_f32 v247,v247,v255
v_mul_f32 v248,v248,v255
v_mul_f32 v249,v249,v255
v_mul_f32 v250,v250,v255
v_mul_f32 v251,v251,v255
v_accvgpr_write_b32 a104,v244
v_accvgpr_write_b32 a105,v245
v_accvgpr_write_b32 a106,v246
v_accvgpr_write_b32 a107,v247
v_accvgpr_write_b32 a120,v248
v_accvgpr_write_b32 a121,v249
v_accvgpr_write_b32 a122,v250
v_accvgpr_write_b32 a123,v251
v_accvgpr_read_b32 v244,a136
v_accvgpr_read_b32 v245,a137
v_accvgpr_read_b32 v246,a138
v_accvgpr_read_b32 v247,a139
v_accvgpr_read_b32 v248,a152
v_accvgpr_read_b32 v249,a153
v_accvgpr_read_b32 v250,a154
v_accvgpr_read_b32 v251,a155
v_mul_f32 v244,v244,v255
v_mul_f32 v245,v245,v255
v_mul_f32 v246,v246,v255
v_mul_f32 v247,v247,v255
v_mul_f32 v248,v248,v255
v_mul_f32 v249,v249,v255
v_mul_f32 v250,v250,v255
v_mul_f32 v251,v251,v255
v_accvgpr_write_b32 a136,v244
v_accvgpr_write_b32 a137,v245
v_accvgpr_write_b32 a138,v246
v_accvgpr_write_b32 a139,v247
v_accvgpr_write_b32 a152,v248
v_accvgpr_write_b32 a153,v249
v_accvgpr_write_b32 a154,v250
v_accvgpr_write_b32 a155,v251
v_accvgpr_read_b32 v244,a168
v_accvgpr_read_b32 v245,a169
v_accvgpr_read_b32 v246,a170
v_accvgpr_read_b32 v247,a171
v_accvgpr_read_b32 v248,a184
v_accvgpr_read_b32 v249,a185
v_accvgpr_read_b32 v250,a186
v_accvgpr_read_b32 v251,a187
v_mul_f32 v244,v244,v255
v_mul_f32 v245,v245,v255
v_mul_f32 v246,v246,v255
v_mul_f32 v247,v247,v255
v_mul_f32 v248,v248,v255
v_mul_f32 v249,v249,v255
v_mul_f32 v250,v250,v255
v_mul_f32 v251,v251,v255
v_accvgpr_write_b32 a168,v244
v_accvgpr_write_b32 a169,v245
v_accvgpr_write_b32 a170,v246
v_accvgpr_write_b32 a171,v247
v_accvgpr_write_b32 a184,v248
v_accvgpr_write_b32 a185,v249
v_accvgpr_write_b32 a186,v250
v_accvgpr_write_b32 a187,v251
v_accvgpr_read_b32 v244,a200
v_accvgpr_read_b32 v245,a201
v_accvgpr_read_b32 v246,a202
v_accvgpr_read_b32 v247,a203
v_accvgpr_read_b32 v248,a216
v_accvgpr_read_b32 v249,a217
v_accvgpr_read_b32 v250,a218
v_accvgpr_read_b32 v251,a219
v_mul_f32 v244,v244,v255
v_mul_f32 v245,v245,v255
v_mul_f32 v246,v246,v255
v_mul_f32 v247,v247,v255
v_mul_f32 v248,v248,v255
v_mul_f32 v249,v249,v255
v_mul_f32 v250,v250,v255
v_mul_f32 v251,v251,v255
v_accvgpr_write_b32 a200,v244
v_accvgpr_write_b32 a201,v245
v_accvgpr_write_b32 a202,v246
v_accvgpr_write_b32 a203,v247
v_accvgpr_write_b32 a216,v248
v_accvgpr_write_b32 a217,v249
v_accvgpr_write_b32 a218,v250
v_accvgpr_write_b32 a219,v251
v_accvgpr_read_b32 v244,a232
v_accvgpr_read_b32 v245,a233
v_accvgpr_read_b32 v246,a234
v_accvgpr_read_b32 v247,a235
v_accvgpr_read_b32 v248,a248
v_accvgpr_read_b32 v249,a249
v_accvgpr_read_b32 v250,a250
v_accvgpr_read_b32 v251,a251
v_mul_f32 v244,v244,v255
v_mul_f32 v245,v245,v255
v_mul_f32 v246,v246,v255
v_mul_f32 v247,v247,v255
v_mul_f32 v248,v248,v255
v_mul_f32 v249,v249,v255
v_mul_f32 v250,v250,v255
v_mul_f32 v251,v251,v255
v_accvgpr_write_b32 a232,v244
v_accvgpr_write_b32 a233,v245
v_accvgpr_write_b32 a234,v246
v_accvgpr_write_b32 a235,v247
v_accvgpr_write_b32 a248,v248
v_accvgpr_write_b32 a249,v249
v_accvgpr_write_b32 a250,v250
v_accvgpr_write_b32 a251,v251
v_max3_f32 v253,v152,v153,v154
v_max3_f32 v253,v253,v155,v156
v_max3_f32 v253,v253,v157,v158
v_max_f32 v253,v253,v159
v_mov_b32 v254,v253
s_nop 1
v_permlane32_swap_b32 v253,v254
v_max_f32 v253,v253,v254
v_mov_b32 v254,v253
s_nop 1
v_permlane16_swap_b32 v253,v254
v_max_f32 v253,v253,v254
v_max_f32 v253,0,v253
v_exp_f32 v255,-v253
v_sub_f32 v204,v204,v253
v_sub_f32 v205,v205,v253
v_sub_f32 v206,v206,v253
v_sub_f32 v207,v207,v253
v_sub_f32 v184,v184,v253
v_sub_f32 v185,v185,v253
v_sub_f32 v186,v186,v253
v_sub_f32 v187,v187,v253
v_sub_f32 v188,v188,v253
v_sub_f32 v189,v189,v253
v_sub_f32 v190,v190,v253
v_sub_f32 v191,v191,v253
v_sub_f32 v152,v152,v253
v_sub_f32 v153,v153,v253
v_sub_f32 v154,v154,v253
v_sub_f32 v155,v155,v253
v_sub_f32 v156,v156,v253
v_sub_f32 v157,v157,v253
v_sub_f32 v158,v158,v253
v_sub_f32 v159,v159,v253
v_exp_f32 v152,v152
s_nop 0
v_exp_f32 v153,v153
s_nop 0
v_add_f32 v231,v152,v153
v_cvt_pk_bf16_f32 v152,v152,v153
v_exp_f32 v154,v154
s_nop 0
v_add_f32 v231,v231,v154
v_exp_f32 v155,v155
s_nop 0
v_add_f32 v231,v231,v155
v_cvt_pk_bf16_f32 v153,v154,v155
v_exp_f32 v156,v156
s_nop 0
v_add_f32 v231,v231,v156
v_exp_f32 v157,v157
s_nop 0
v_add_f32 v231,v231,v157
v_cvt_pk_bf16_f32 v154,v156,v157
v_exp_f32 v158,v158
s_nop 0
v_add_f32 v231,v231,v158
v_exp_f32 v159,v159
s_nop 0
v_add_f32 v231,v231,v159
v_cvt_pk_bf16_f32 v155,v158,v159
v_mul_f32 v227,v227,v255
v_accvgpr_read_b32 v244,a12
v_accvgpr_read_b32 v245,a13
v_accvgpr_read_b32 v246,a14
v_accvgpr_read_b32 v247,a15
v_accvgpr_read_b32 v248,a28
v_accvgpr_read_b32 v249,a29
v_accvgpr_read_b32 v250,a30
v_accvgpr_read_b32 v251,a31
v_mul_f32 v244,v244,v255
v_mul_f32 v245,v245,v255
v_mul_f32 v246,v246,v255
v_mul_f32 v247,v247,v255
v_mul_f32 v248,v248,v255
v_mul_f32 v249,v249,v255
v_mul_f32 v250,v250,v255
v_mul_f32 v251,v251,v255
v_accvgpr_write_b32 a12,v244
v_accvgpr_write_b32 a13,v245
v_accvgpr_write_b32 a14,v246
v_accvgpr_write_b32 a15,v247
v_accvgpr_write_b32 a28,v248
v_accvgpr_write_b32 a29,v249
v_accvgpr_write_b32 a30,v250
v_accvgpr_write_b32 a31,v251
v_accvgpr_read_b32 v244,a44
v_accvgpr_read_b32 v245,a45
v_accvgpr_read_b32 v246,a46
v_accvgpr_read_b32 v247,a47
v_accvgpr_read_b32 v248,a60
v_accvgpr_read_b32 v249,a61
v_accvgpr_read_b32 v250,a62
v_accvgpr_read_b32 v251,a63
v_mul_f32 v244,v244,v255
v_mul_f32 v245,v245,v255
v_mul_f32 v246,v246,v255
v_mul_f32 v247,v247,v255
v_mul_f32 v248,v248,v255
v_mul_f32 v249,v249,v255
v_mul_f32 v250,v250,v255
v_mul_f32 v251,v251,v255
v_accvgpr_write_b32 a44,v244
v_accvgpr_write_b32 a45,v245
v_accvgpr_write_b32 a46,v246
v_accvgpr_write_b32 a47,v247
v_accvgpr_write_b32 a60,v248
v_accvgpr_write_b32 a61,v249
v_accvgpr_write_b32 a62,v250
v_accvgpr_write_b32 a63,v251
v_accvgpr_read_b32 v244,a76
v_accvgpr_read_b32 v245,a77
v_accvgpr_read_b32 v246,a78
v_accvgpr_read_b32 v247,a79
v_accvgpr_read_b32 v248,a92
v_accvgpr_read_b32 v249,a93
v_accvgpr_read_b32 v250,a94
v_accvgpr_read_b32 v251,a95
v_mul_f32 v244,v244,v255
v_mul_f32 v245,v245,v255
v_mul_f32 v246,v246,v255
v_mul_f32 v247,v247,v255
v_mul_f32 v248,v248,v255
v_mul_f32 v249,v249,v255
v_mul_f32 v250,v250,v255
v_mul_f32 v251,v251,v255
v_accvgpr_write_b32 a76,v244
v_accvgpr_write_b32 a77,v245
v_accvgpr_write_b32 a78,v246
v_accvgpr_write_b32 a79,v247
v_accvgpr_write_b32 a92,v248
v_accvgpr_write_b32 a93,v249
v_accvgpr_write_b32 a94,v250
v_accvgpr_write_b32 a95,v251
v_accvgpr_read_b32 v244,a108
v_accvgpr_read_b32 v245,a109
v_accvgpr_read_b32 v246,a110
v_accvgpr_read_b32 v247,a111
v_accvgpr_read_b32 v248,a124
v_accvgpr_read_b32 v249,a125
v_accvgpr_read_b32 v250,a126
v_accvgpr_read_b32 v251,a127
v_mul_f32 v244,v244,v255
v_mul_f32 v245,v245,v255
v_mul_f32 v246,v246,v255
v_mul_f32 v247,v247,v255
v_mul_f32 v248,v248,v255
v_mul_f32 v249,v249,v255
v_mul_f32 v250,v250,v255
v_mul_f32 v251,v251,v255
v_accvgpr_write_b32 a108,v244
v_accvgpr_write_b32 a109,v245
v_accvgpr_write_b32 a110,v246
v_accvgpr_write_b32 a111,v247
v_accvgpr_write_b32 a124,v248
v_accvgpr_write_b32 a125,v249
v_accvgpr_write_b32 a126,v250
v_accvgpr_write_b32 a127,v251
v_accvgpr_read_b32 v244,a140
v_accvgpr_read_b32 v245,a141
v_accvgpr_read_b32 v246,a142
v_accvgpr_read_b32 v247,a143
v_accvgpr_read_b32 v248,a156
v_accvgpr_read_b32 v249,a157
v_accvgpr_read_b32 v250,a158
v_accvgpr_read_b32 v251,a159
v_mul_f32 v244,v244,v255
v_mul_f32 v245,v245,v255
v_mul_f32 v246,v246,v255
v_mul_f32 v247,v247,v255
v_mul_f32 v248,v248,v255
v_mul_f32 v249,v249,v255
v_mul_f32 v250,v250,v255
v_mul_f32 v251,v251,v255
v_accvgpr_write_b32 a140,v244
v_accvgpr_write_b32 a141,v245
v_accvgpr_write_b32 a142,v246
v_accvgpr_write_b32 a143,v247
v_accvgpr_write_b32 a156,v248
v_accvgpr_write_b32 a157,v249
v_accvgpr_write_b32 a158,v250
v_accvgpr_write_b32 a159,v251
v_accvgpr_read_b32 v244,a172
v_accvgpr_read_b32 v245,a173
v_accvgpr_read_b32 v246,a174
v_accvgpr_read_b32 v247,a175
v_accvgpr_read_b32 v248,a188
v_accvgpr_read_b32 v249,a189
v_accvgpr_read_b32 v250,a190
v_accvgpr_read_b32 v251,a191
v_mul_f32 v244,v244,v255
v_mul_f32 v245,v245,v255
v_mul_f32 v246,v246,v255
v_mul_f32 v247,v247,v255
v_mul_f32 v248,v248,v255
v_mul_f32 v249,v249,v255
v_mul_f32 v250,v250,v255
v_mul_f32 v251,v251,v255
v_accvgpr_write_b32 a172,v244
v_accvgpr_write_b32 a173,v245
v_accvgpr_write_b32 a174,v246
v_accvgpr_write_b32 a175,v247
v_accvgpr_write_b32 a188,v248
v_accvgpr_write_b32 a189,v249
v_accvgpr_write_b32 a190,v250
v_accvgpr_write_b32 a191,v251
v_accvgpr_read_b32 v244,a204
v_accvgpr_read_b32 v245,a205
v_accvgpr_read_b32 v246,a206
v_accvgpr_read_b32 v247,a207
v_accvgpr_read_b32 v248,a220
v_accvgpr_read_b32 v249,a221
v_accvgpr_read_b32 v250,a222
v_accvgpr_read_b32 v251,a223
v_mul_f32 v244,v244,v255
v_mul_f32 v245,v245,v255
v_mul_f32 v246,v246,v255
v_mul_f32 v247,v247,v255
v_mul_f32 v248,v248,v255
v_mul_f32 v249,v249,v255
v_mul_f32 v250,v250,v255
v_mul_f32 v251,v251,v255
v_accvgpr_write_b32 a204,v244
v_accvgpr_write_b32 a205,v245
v_accvgpr_write_b32 a206,v246
v_accvgpr_write_b32 a207,v247
v_accvgpr_write_b32 a220,v248
v_accvgpr_write_b32 a221,v249
v_accvgpr_write_b32 a222,v250
v_accvgpr_write_b32 a223,v251
v_accvgpr_read_b32 v244,a236
v_accvgpr_read_b32 v245,a237
v_accvgpr_read_b32 v246,a238
v_accvgpr_read_b32 v247,a239
v_accvgpr_read_b32 v248,a252
v_accvgpr_read_b32 v249,a253
v_accvgpr_read_b32 v250,a254
v_accvgpr_read_b32 v251,a255
v_mul_f32 v244,v244,v255
v_mul_f32 v245,v245,v255
v_mul_f32 v246,v246,v255
v_mul_f32 v247,v247,v255
v_mul_f32 v248,v248,v255
v_mul_f32 v249,v249,v255
v_mul_f32 v250,v250,v255
v_mul_f32 v251,v251,v255
v_accvgpr_write_b32 a236,v244
v_accvgpr_write_b32 a237,v245
v_accvgpr_write_b32 a238,v246
v_accvgpr_write_b32 a239,v247
v_accvgpr_write_b32 a252,v248
v_accvgpr_write_b32 a253,v249
v_accvgpr_write_b32 a254,v250
v_accvgpr_write_b32 a255,v251
s_nop 1
s_setpc_b64 s[58:59]
RARE_1:
s_nop 7
s_nop 7
v_mbcnt_lo_u32_b32 v252,-1,0
v_mbcnt_hi_u32_b32 v252,-1,v252
v_and_b32 v253,15,v252
v_lshlrev_b32 v253,9,v253
v_lshrrev_b32 v252,4,v252
v_lshl_add_u32 v252,v252,4,v253
s_sub_u32 s61,s52,49152
buffer_load_dwordx4 v[244:247],v252,s[8:11],s61 offen offset:0
buffer_load_dwordx4 v[248:251],v252,s[8:11],s61 offen offset:64
s_waitcnt vmcnt(0)
v_mfma_f32_16x16x32_bf16 v[160:163],v[244:247],v[0:3],v[192:195]
v_mfma_f32_16x16x32_bf16 v[168:171],v[244:247],v[4:7],v[196:199]
v_mfma_f32_16x16x32_bf16 v[176:179],v[244:247],v[8:11],v[200:203]
v_mfma_f32_16x16x32_bf16 v[184:187],v[244:247],v[12:15],v[204:207]
v_mfma_f32_16x16x32_bf16 v[160:163],v[248:251],v[16:19],v[160:163]
v_mfma_f32_16x16x32_bf16 v[168:171],v[248:251],v[20:23],v[168:171]
v_mfma_f32_16x16x32_bf16 v[176:179],v[248:251],v[24:27],v[176:179]
v_mfma_f32_16x16x32_bf16 v[184:187],v[248:251],v[28:31],v[184:187]
s_nop 7
buffer_load_dwordx4 v[244:247],v252,s[8:11],s61 offen offset:128
buffer_load_dwordx4 v[248:251],v252,s[8:11],s61 offen offset:192
s_waitcnt vmcnt(0)
v_mfma_f32_16x16x32_bf16 v[160:163],v[244:247],v[32:35],v[160:163]
v_mfma_f32_16x16x32_bf16 v[168:171],v[244:247],v[36:39],v[168:171]
v_mfma_f32_16x16x32_bf16 v[176:179],v[244:247],v[40:43],v[176:179]
v_mfma_f32_16x16x32_bf16 v[184:187],v[244:247],v[44:47],v[184:187]
v_mfma_f32_16x16x32_bf16 v[160:163],v[248:251],v[48:51],v[160:163]
v_mfma_f32_16x16x32_bf16 v[168:171],v[248:251],v[52:55],v[168:171]
v_mfma_f32_16x16x32_bf16 v[176:179],v[248:251],v[56:59],v[176:179]
v_mfma_f32_16x16x32_bf16 v[184:187],v[248:251],v[60:63],v[184:187]
s_nop 7
buffer_load_dwordx4 v[244:247],v252,s[8:11],s61 offen offset:256
buffer_load_dwordx4 v[248:251],v252,s[8:11],s61 offen offset:320
s_waitcnt vmcnt(0)
v_mfma_f32_16x16x32_bf16 v[160:163],v[244:247],v[64:67],v[160:163]
v_mfma_f32_16x16x32_bf16 v[168:171],v[244:247],v[68:71],v[168:171]
v_mfma_f32_16x16x32_bf16 v[176:179],v[244:247],v[72:75],v[176:179]
v_mfma_f32_16x16x32_bf16 v[184:187],v[244:247],v[76:79],v[184:187]
v_mfma_f32_16x16x32_bf16 v[160:163],v[248:251],v[80:83],v[160:163]
v_mfma_f32_16x16x32_bf16 v[168:171],v[248:251],v[84:87],v[168:171]
v_mfma_f32_16x16x32_bf16 v[176:179],v[248:251],v[88:91],v[176:179]
v_mfma_f32_16x16x32_bf16 v[184:187],v[248:251],v[92:95],v[184:187]
s_nop 7
buffer_load_dwordx4 v[244:247],v252,s[8:11],s61 offen offset:384
buffer_load_dwordx4 v[248:251],v252,s[8:11],s61 offen offset:448
s_waitcnt vmcnt(0)
v_mfma_f32_16x16x32_bf16 v[160:163],v[244:247],v[96:99],v[160:163]
v_mfma_f32_16x16x32_bf16 v[168:171],v[244:247],v[100:103],v[168:171]
v_mfma_f32_16x16x32_bf16 v[176:179],v[244:247],v[104:107],v[176:179]
v_mfma_f32_16x16x32_bf16 v[184:187],v[244:247],v[108:111],v[184:187]
v_mfma_f32_16x16x32_bf16 v[160:163],v[248:251],v[112:115],v[160:163]
v_mfma_f32_16x16x32_bf16 v[168:171],v[248:251],v[116:119],v[168:171]
v_mfma_f32_16x16x32_bf16 v[176:179],v[248:251],v[120:123],v[176:179]
v_mfma_f32_16x16x32_bf16 v[184:187],v[248:251],v[124:127],v[184:187]
s_nop 7
s_add_u32 s61,s61,8192
buffer_load_dwordx4 v[244:247],v252,s[8:11],s61 offen offset:0
buffer_load_dwordx4 v[248:251],v252,s[8:11],s61 offen offset:64
s_waitcnt vmcnt(0)
v_mfma_f32_16x16x32_bf16 v[164:167],v[244:247],v[0:3],v[192:195]
v_mfma_f32_16x16x32_bf16 v[172:175],v[244:247],v[4:7],v[196:199]
v_mfma_f32_16x16x32_bf16 v[180:183],v[244:247],v[8:11],v[200:203]
v_mfma_f32_16x16x32_bf16 v[188:191],v[244:247],v[12:15],v[204:207]
v_mfma_f32_16x16x32_bf16 v[164:167],v[248:251],v[16:19],v[164:167]
v_mfma_f32_16x16x32_bf16 v[172:175],v[248:251],v[20:23],v[172:175]
v_mfma_f32_16x16x32_bf16 v[180:183],v[248:251],v[24:27],v[180:183]
v_mfma_f32_16x16x32_bf16 v[188:191],v[248:251],v[28:31],v[188:191]
s_nop 7
buffer_load_dwordx4 v[244:247],v252,s[8:11],s61 offen offset:128
buffer_load_dwordx4 v[248:251],v252,s[8:11],s61 offen offset:192
s_waitcnt vmcnt(0)
v_mfma_f32_16x16x32_bf16 v[164:167],v[244:247],v[32:35],v[164:167]
v_mfma_f32_16x16x32_bf16 v[172:175],v[244:247],v[36:39],v[172:175]
v_mfma_f32_16x16x32_bf16 v[180:183],v[244:247],v[40:43],v[180:183]
v_mfma_f32_16x16x32_bf16 v[188:191],v[244:247],v[44:47],v[188:191]
v_mfma_f32_16x16x32_bf16 v[164:167],v[248:251],v[48:51],v[164:167]
v_mfma_f32_16x16x32_bf16 v[172:175],v[248:251],v[52:55],v[172:175]
v_mfma_f32_16x16x32_bf16 v[180:183],v[248:251],v[56:59],v[180:183]
v_mfma_f32_16x16x32_bf16 v[188:191],v[248:251],v[60:63],v[188:191]
s_nop 7
buffer_load_dwordx4 v[244:247],v252,s[8:11],s61 offen offset:256
buffer_load_dwordx4 v[248:251],v252,s[8:11],s61 offen offset:320
s_waitcnt vmcnt(0)
v_mfma_f32_16x16x32_bf16 v[164:167],v[244:247],v[64:67],v[164:167]
v_mfma_f32_16x16x32_bf16 v[172:175],v[244:247],v[68:71],v[172:175]
v_mfma_f32_16x16x32_bf16 v[180:183],v[244:247],v[72:75],v[180:183]
v_mfma_f32_16x16x32_bf16 v[188:191],v[244:247],v[76:79],v[188:191]
v_mfma_f32_16x16x32_bf16 v[164:167],v[248:251],v[80:83],v[164:167]
v_mfma_f32_16x16x32_bf16 v[172:175],v[248:251],v[84:87],v[172:175]
v_mfma_f32_16x16x32_bf16 v[180:183],v[248:251],v[88:91],v[180:183]
v_mfma_f32_16x16x32_bf16 v[188:191],v[248:251],v[92:95],v[188:191]
s_nop 7
buffer_load_dwordx4 v[244:247],v252,s[8:11],s61 offen offset:384
buffer_load_dwordx4 v[248:251],v252,s[8:11],s61 offen offset:448
s_waitcnt vmcnt(0)
v_mfma_f32_16x16x32_bf16 v[164:167],v[244:247],v[96:99],v[164:167]
v_mfma_f32_16x16x32_bf16 v[172:175],v[244:247],v[100:103],v[172:175]
v_mfma_f32_16x16x32_bf16 v[180:183],v[244:247],v[104:107],v[180:183]
v_mfma_f32_16x16x32_bf16 v[188:191],v[244:247],v[108:111],v[188:191]
v_mfma_f32_16x16x32_bf16 v[164:167],v[248:251],v[112:115],v[164:167]
v_mfma_f32_16x16x32_bf16 v[172:175],v[248:251],v[116:119],v[172:175]
v_mfma_f32_16x16x32_bf16 v[180:183],v[248:251],v[120:123],v[180:183]
v_mfma_f32_16x16x32_bf16 v[188:191],v[248:251],v[124:127],v[188:191]
s_nop 7
s_nop 7
v_max3_f32 v253,v160,v161,v162
v_max3_f32 v253,v253,v163,v164
v_max3_f32 v253,v253,v165,v166
v_max_f32 v253,v253,v167
v_mov_b32 v254,v253
s_nop 1
v_permlane32_swap_b32 v253,v254
v_max_f32 v253,v253,v254
v_mov_b32 v254,v253
s_nop 1
v_permlane16_swap_b32 v253,v254
v_max_f32 v253,v253,v254
v_max_f32 v253,0,v253
v_exp_f32 v255,-v253
v_sub_f32 v192,v192,v253
v_sub_f32 v193,v193,v253
v_sub_f32 v194,v194,v253
v_sub_f32 v195,v195,v253
v_sub_f32 v128,v128,v253
v_sub_f32 v129,v129,v253
v_sub_f32 v130,v130,v253
v_sub_f32 v131,v131,v253
v_sub_f32 v132,v132,v253
v_sub_f32 v133,v133,v253
v_sub_f32 v134,v134,v253
v_sub_f32 v135,v135,v253
v_sub_f32 v160,v160,v253
v_sub_f32 v161,v161,v253
v_sub_f32 v162,v162,v253
v_sub_f32 v163,v163,v253
v_sub_f32 v164,v164,v253
v_sub_f32 v165,v165,v253
v_sub_f32 v166,v166,v253
v_sub_f32 v167,v167,v253
v_exp_f32 v160,v160
s_nop 0
v_exp_f32 v161,v161
s_nop 0
v_add_f32 v228,v160,v161
v_cvt_pk_bf16_f32 v160,v160,v161
v_exp_f32 v162,v162
s_nop 0
v_add_f32 v228,v228,v162
v_exp_f32 v163,v163
s_nop 0
v_add_f32 v228,v228,v163
v_cvt_pk_bf16_f32 v161,v162,v163
v_exp_f32 v164,v164
s_nop 0
v_add_f32 v228,v228,v164
v_exp_f32 v165,v165
s_nop 0
v_add_f32 v228,v228,v165
v_cvt_pk_bf16_f32 v162,v164,v165
v_exp_f32 v166,v166
s_nop 0
v_add_f32 v228,v228,v166
v_exp_f32 v167,v167
s_nop 0
v_add_f32 v228,v228,v167
v_cvt_pk_bf16_f32 v163,v166,v167
v_mul_f32 v224,v224,v255
v_accvgpr_read_b32 v244,a0
v_accvgpr_read_b32 v245,a1
v_accvgpr_read_b32 v246,a2
v_accvgpr_read_b32 v247,a3
v_accvgpr_read_b32 v248,a16
v_accvgpr_read_b32 v249,a17
v_accvgpr_read_b32 v250,a18
v_accvgpr_read_b32 v251,a19
v_mul_f32 v244,v244,v255
v_mul_f32 v245,v245,v255
v_mul_f32 v246,v246,v255
v_mul_f32 v247,v247,v255
v_mul_f32 v248,v248,v255
v_mul_f32 v249,v249,v255
v_mul_f32 v250,v250,v255
v_mul_f32 v251,v251,v255
v_accvgpr_write_b32 a0,v244
v_accvgpr_write_b32 a1,v245
v_accvgpr_write_b32 a2,v246
v_accvgpr_write_b32 a3,v247
v_accvgpr_write_b32 a16,v248
v_accvgpr_write_b32 a17,v249
v_accvgpr_write_b32 a18,v250
v_accvgpr_write_b32 a19,v251
v_accvgpr_read_b32 v244,a32
v_accvgpr_read_b32 v245,a33
v_accvgpr_read_b32 v246,a34
v_accvgpr_read_b32 v247,a35
v_accvgpr_read_b32 v248,a48
v_accvgpr_read_b32 v249,a49
v_accvgpr_read_b32 v250,a50
v_accvgpr_read_b32 v251,a51
v_mul_f32 v244,v244,v255
v_mul_f32 v245,v245,v255
v_mul_f32 v246,v246,v255
v_mul_f32 v247,v247,v255
v_mul_f32 v248,v248,v255
v_mul_f32 v249,v249,v255
v_mul_f32 v250,v250,v255
v_mul_f32 v251,v251,v255
v_accvgpr_write_b32 a32,v244
v_accvgpr_write_b32 a33,v245
v_accvgpr_write_b32 a34,v246
v_accvgpr_write_b32 a35,v247
v_accvgpr_write_b32 a48,v248
v_accvgpr_write_b32 a49,v249
v_accvgpr_write_b32 a50,v250
v_accvgpr_write_b32 a51,v251
v_accvgpr_read_b32 v244,a64
v_accvgpr_read_b32 v245,a65
v_accvgpr_read_b32 v246,a66
v_accvgpr_read_b32 v247,a67
v_accvgpr_read_b32 v248,a80
v_accvgpr_read_b32 v249,a81
v_accvgpr_read_b32 v250,a82
v_accvgpr_read_b32 v251,a83
v_mul_f32 v244,v244,v255
v_mul_f32 v245,v245,v255
v_mul_f32 v246,v246,v255
v_mul_f32 v247,v247,v255
v_mul_f32 v248,v248,v255
v_mul_f32 v249,v249,v255
v_mul_f32 v250,v250,v255
v_mul_f32 v251,v251,v255
v_accvgpr_write_b32 a64,v244
v_accvgpr_write_b32 a65,v245
v_accvgpr_write_b32 a66,v246
v_accvgpr_write_b32 a67,v247
v_accvgpr_write_b32 a80,v248
v_accvgpr_write_b32 a81,v249
v_accvgpr_write_b32 a82,v250
v_accvgpr_write_b32 a83,v251
v_accvgpr_read_b32 v244,a96
v_accvgpr_read_b32 v245,a97
v_accvgpr_read_b32 v246,a98
v_accvgpr_read_b32 v247,a99
v_accvgpr_read_b32 v248,a112
v_accvgpr_read_b32 v249,a113
v_accvgpr_read_b32 v250,a114
v_accvgpr_read_b32 v251,a115
v_mul_f32 v244,v244,v255
v_mul_f32 v245,v245,v255
v_mul_f32 v246,v246,v255
v_mul_f32 v247,v247,v255
v_mul_f32 v248,v248,v255
v_mul_f32 v249,v249,v255
v_mul_f32 v250,v250,v255
v_mul_f32 v251,v251,v255
v_accvgpr_write_b32 a96,v244
v_accvgpr_write_b32 a97,v245
v_accvgpr_write_b32 a98,v246
v_accvgpr_write_b32 a99,v247
v_accvgpr_write_b32 a112,v248
v_accvgpr_write_b32 a113,v249
v_accvgpr_write_b32 a114,v250
v_accvgpr_write_b32 a115,v251
v_accvgpr_read_b32 v244,a128
v_accvgpr_read_b32 v245,a129
v_accvgpr_read_b32 v246,a130
v_accvgpr_read_b32 v247,a131
v_accvgpr_read_b32 v248,a144
v_accvgpr_read_b32 v249,a145
v_accvgpr_read_b32 v250,a146
v_accvgpr_read_b32 v251,a147
v_mul_f32 v244,v244,v255
v_mul_f32 v245,v245,v255
v_mul_f32 v246,v246,v255
v_mul_f32 v247,v247,v255
v_mul_f32 v248,v248,v255
v_mul_f32 v249,v249,v255
v_mul_f32 v250,v250,v255
v_mul_f32 v251,v251,v255
v_accvgpr_write_b32 a128,v244
v_accvgpr_write_b32 a129,v245
v_accvgpr_write_b32 a130,v246
v_accvgpr_write_b32 a131,v247
v_accvgpr_write_b32 a144,v248
v_accvgpr_write_b32 a145,v249
v_accvgpr_write_b32 a146,v250
v_accvgpr_write_b32 a147,v251
v_accvgpr_read_b32 v244,a160
v_accvgpr_read_b32 v245,a161
v_accvgpr_read_b32 v246,a162
v_accvgpr_read_b32 v247,a163
v_accvgpr_read_b32 v248,a176
v_accvgpr_read_b32 v249,a177
v_accvgpr_read_b32 v250,a178
v_accvgpr_read_b32 v251,a179
v_mul_f32 v244,v244,v255
v_mul_f32 v245,v245,v255
v_mul_f32 v246,v246,v255
v_mul_f32 v247,v247,v255
v_mul_f32 v248,v248,v255
v_mul_f32 v249,v249,v255
v_mul_f32 v250,v250,v255
v_mul_f32 v251,v251,v255
v_accvgpr_write_b32 a160,v244
v_accvgpr_write_b32 a161,v245
v_accvgpr_write_b32 a162,v246
v_accvgpr_write_b32 a163,v247
v_accvgpr_write_b32 a176,v248
v_accvgpr_write_b32 a177,v249
v_accvgpr_write_b32 a178,v250
v_accvgpr_write_b32 a179,v251
v_accvgpr_read_b32 v244,a192
v_accvgpr_read_b32 v245,a193
v_accvgpr_read_b32 v246,a194
v_accvgpr_read_b32 v247,a195
v_accvgpr_read_b32 v248,a208
v_accvgpr_read_b32 v249,a209
v_accvgpr_read_b32 v250,a210
v_accvgpr_read_b32 v251,a211
v_mul_f32 v244,v244,v255
v_mul_f32 v245,v245,v255
v_mul_f32 v246,v246,v255
v_mul_f32 v247,v247,v255
v_mul_f32 v248,v248,v255
v_mul_f32 v249,v249,v255
v_mul_f32 v250,v250,v255
v_mul_f32 v251,v251,v255
v_accvgpr_write_b32 a192,v244
v_accvgpr_write_b32 a193,v245
v_accvgpr_write_b32 a194,v246
v_accvgpr_write_b32 a195,v247
v_accvgpr_write_b32 a208,v248
v_accvgpr_write_b32 a209,v249
v_accvgpr_write_b32 a210,v250
v_accvgpr_write_b32 a211,v251
v_accvgpr_read_b32 v244,a224
v_accvgpr_read_b32 v245,a225
v_accvgpr_read_b32 v246,a226
v_accvgpr_read_b32 v247,a227
v_accvgpr_read_b32 v248,a240
v_accvgpr_read_b32 v249,a241
v_accvgpr_read_b32 v250,a242
v_accvgpr_read_b32 v251,a243
v_mul_f32 v244,v244,v255
v_mul_f32 v245,v245,v255
v_mul_f32 v246,v246,v255
v_mul_f32 v247,v247,v255
v_mul_f32 v248,v248,v255
v_mul_f32 v249,v249,v255
v_mul_f32 v250,v250,v255
v_mul_f32 v251,v251,v255
v_accvgpr_write_b32 a224,v244
v_accvgpr_write_b32 a225,v245
v_accvgpr_write_b32 a226,v246
v_accvgpr_write_b32 a227,v247
v_accvgpr_write_b32 a240,v248
v_accvgpr_write_b32 a241,v249
v_accvgpr_write_b32 a242,v250
v_accvgpr_write_b32 a243,v251
v_max3_f32 v253,v168,v169,v170
v_max3_f32 v253,v253,v171,v172
v_max3_f32 v253,v253,v173,v174
v_max_f32 v253,v253,v175
v_mov_b32 v254,v253
s_nop 1
v_permlane32_swap_b32 v253,v254
v_max_f32 v253,v253,v254
v_mov_b32 v254,v253
s_nop 1
v_permlane16_swap_b32 v253,v254
v_max_f32 v253,v253,v254
v_max_f32 v253,0,v253
v_exp_f32 v255,-v253
v_sub_f32 v196,v196,v253
v_sub_f32 v197,v197,v253
v_sub_f32 v198,v198,v253
v_sub_f32 v199,v199,v253
v_sub_f32 v136,v136,v253
v_sub_f32 v137,v137,v253
v_sub_f32 v138,v138,v253
v_sub_f32 v139,v139,v253
v_sub_f32 v140,v140,v253
v_sub_f32 v141,v141,v253
v_sub_f32 v142,v142,v253
v_sub_f32 v143,v143,v253
v_sub_f32 v168,v168,v253
v_sub_f32 v169,v169,v253
v_sub_f32 v170,v170,v253
v_sub_f32 v171,v171,v253
v_sub_f32 v172,v172,v253
v_sub_f32 v173,v173,v253
v_sub_f32 v174,v174,v253
v_sub_f32 v175,v175,v253
v_exp_f32 v168,v168
s_nop 0
v_exp_f32 v169,v169
s_nop 0
v_add_f32 v229,v168,v169
v_cvt_pk_bf16_f32 v168,v168,v169
v_exp_f32 v170,v170
s_nop 0
v_add_f32 v229,v229,v170
v_exp_f32 v171,v171
s_nop 0
v_add_f32 v229,v229,v171
v_cvt_pk_bf16_f32 v169,v170,v171
v_exp_f32 v172,v172
s_nop 0
v_add_f32 v229,v229,v172
v_exp_f32 v173,v173
s_nop 0
v_add_f32 v229,v229,v173
v_cvt_pk_bf16_f32 v170,v172,v173
v_exp_f32 v174,v174
s_nop 0
v_add_f32 v229,v229,v174
v_exp_f32 v175,v175
s_nop 0
v_add_f32 v229,v229,v175
v_cvt_pk_bf16_f32 v171,v174,v175
v_mul_f32 v225,v225,v255
v_accvgpr_read_b32 v244,a4
v_accvgpr_read_b32 v245,a5
v_accvgpr_read_b32 v246,a6
v_accvgpr_read_b32 v247,a7
v_accvgpr_read_b32 v248,a20
v_accvgpr_read_b32 v249,a21
v_accvgpr_read_b32 v250,a22
v_accvgpr_read_b32 v251,a23
v_mul_f32 v244,v244,v255
v_mul_f32 v245,v245,v255
v_mul_f32 v246,v246,v255
v_mul_f32 v247,v247,v255
v_mul_f32 v248,v248,v255
v_mul_f32 v249,v249,v255
v_mul_f32 v250,v250,v255
v_mul_f32 v251,v251,v255
v_accvgpr_write_b32 a4,v244
v_accvgpr_write_b32 a5,v245
v_accvgpr_write_b32 a6,v246
v_accvgpr_write_b32 a7,v247
v_accvgpr_write_b32 a20,v248
v_accvgpr_write_b32 a21,v249
v_accvgpr_write_b32 a22,v250
v_accvgpr_write_b32 a23,v251
v_accvgpr_read_b32 v244,a36
v_accvgpr_read_b32 v245,a37
v_accvgpr_read_b32 v246,a38
v_accvgpr_read_b32 v247,a39
v_accvgpr_read_b32 v248,a52
v_accvgpr_read_b32 v249,a53
v_accvgpr_read_b32 v250,a54
v_accvgpr_read_b32 v251,a55
v_mul_f32 v244,v244,v255
v_mul_f32 v245,v245,v255
v_mul_f32 v246,v246,v255
v_mul_f32 v247,v247,v255
v_mul_f32 v248,v248,v255
v_mul_f32 v249,v249,v255
v_mul_f32 v250,v250,v255
v_mul_f32 v251,v251,v255
v_accvgpr_write_b32 a36,v244
v_accvgpr_write_b32 a37,v245
v_accvgpr_write_b32 a38,v246
v_accvgpr_write_b32 a39,v247
v_accvgpr_write_b32 a52,v248
v_accvgpr_write_b32 a53,v249
v_accvgpr_write_b32 a54,v250
v_accvgpr_write_b32 a55,v251
v_accvgpr_read_b32 v244,a68
v_accvgpr_read_b32 v245,a69
v_accvgpr_read_b32 v246,a70
v_accvgpr_read_b32 v247,a71
v_accvgpr_read_b32 v248,a84
v_accvgpr_read_b32 v249,a85
v_accvgpr_read_b32 v250,a86
v_accvgpr_read_b32 v251,a87
v_mul_f32 v244,v244,v255
v_mul_f32 v245,v245,v255
v_mul_f32 v246,v246,v255
v_mul_f32 v247,v247,v255
v_mul_f32 v248,v248,v255
v_mul_f32 v249,v249,v255
v_mul_f32 v250,v250,v255
v_mul_f32 v251,v251,v255
v_accvgpr_write_b32 a68,v244
v_accvgpr_write_b32 a69,v245
v_accvgpr_write_b32 a70,v246
v_accvgpr_write_b32 a71,v247
v_accvgpr_write_b32 a84,v248
v_accvgpr_write_b32 a85,v249
v_accvgpr_write_b32 a86,v250
v_accvgpr_write_b32 a87,v251
v_accvgpr_read_b32 v244,a100
v_accvgpr_read_b32 v245,a101
v_accvgpr_read_b32 v246,a102
v_accvgpr_read_b32 v247,a103
v_accvgpr_read_b32 v248,a116
v_accvgpr_read_b32 v249,a117
v_accvgpr_read_b32 v250,a118
v_accvgpr_read_b32 v251,a119
v_mul_f32 v244,v244,v255
v_mul_f32 v245,v245,v255
v_mul_f32 v246,v246,v255
v_mul_f32 v247,v247,v255
v_mul_f32 v248,v248,v255
v_mul_f32 v249,v249,v255
v_mul_f32 v250,v250,v255
v_mul_f32 v251,v251,v255
v_accvgpr_write_b32 a100,v244
v_accvgpr_write_b32 a101,v245
v_accvgpr_write_b32 a102,v246
v_accvgpr_write_b32 a103,v247
v_accvgpr_write_b32 a116,v248
v_accvgpr_write_b32 a117,v249
v_accvgpr_write_b32 a118,v250
v_accvgpr_write_b32 a119,v251
v_accvgpr_read_b32 v244,a132
v_accvgpr_read_b32 v245,a133
v_accvgpr_read_b32 v246,a134
v_accvgpr_read_b32 v247,a135
v_accvgpr_read_b32 v248,a148
v_accvgpr_read_b32 v249,a149
v_accvgpr_read_b32 v250,a150
v_accvgpr_read_b32 v251,a151
v_mul_f32 v244,v244,v255
v_mul_f32 v245,v245,v255
v_mul_f32 v246,v246,v255
v_mul_f32 v247,v247,v255
v_mul_f32 v248,v248,v255
v_mul_f32 v249,v249,v255
v_mul_f32 v250,v250,v255
v_mul_f32 v251,v251,v255
v_accvgpr_write_b32 a132,v244
v_accvgpr_write_b32 a133,v245
v_accvgpr_write_b32 a134,v246
v_accvgpr_write_b32 a135,v247
v_accvgpr_write_b32 a148,v248
v_accvgpr_write_b32 a149,v249
v_accvgpr_write_b32 a150,v250
v_accvgpr_write_b32 a151,v251
v_accvgpr_read_b32 v244,a164
v_accvgpr_read_b32 v245,a165
v_accvgpr_read_b32 v246,a166
v_accvgpr_read_b32 v247,a167
v_accvgpr_read_b32 v248,a180
v_accvgpr_read_b32 v249,a181
v_accvgpr_read_b32 v250,a182
v_accvgpr_read_b32 v251,a183
v_mul_f32 v244,v244,v255
v_mul_f32 v245,v245,v255
v_mul_f32 v246,v246,v255
v_mul_f32 v247,v247,v255
v_mul_f32 v248,v248,v255
v_mul_f32 v249,v249,v255
v_mul_f32 v250,v250,v255
v_mul_f32 v251,v251,v255
v_accvgpr_write_b32 a164,v244
v_accvgpr_write_b32 a165,v245
v_accvgpr_write_b32 a166,v246
v_accvgpr_write_b32 a167,v247
v_accvgpr_write_b32 a180,v248
v_accvgpr_write_b32 a181,v249
v_accvgpr_write_b32 a182,v250
v_accvgpr_write_b32 a183,v251
v_accvgpr_read_b32 v244,a196
v_accvgpr_read_b32 v245,a197
v_accvgpr_read_b32 v246,a198
v_accvgpr_read_b32 v247,a199
v_accvgpr_read_b32 v248,a212
v_accvgpr_read_b32 v249,a213
v_accvgpr_read_b32 v250,a214
v_accvgpr_read_b32 v251,a215
v_mul_f32 v244,v244,v255
v_mul_f32 v245,v245,v255
v_mul_f32 v246,v246,v255
v_mul_f32 v247,v247,v255
v_mul_f32 v248,v248,v255
v_mul_f32 v249,v249,v255
v_mul_f32 v250,v250,v255
v_mul_f32 v251,v251,v255
v_accvgpr_write_b32 a196,v244
v_accvgpr_write_b32 a197,v245
v_accvgpr_write_b32 a198,v246
v_accvgpr_write_b32 a199,v247
v_accvgpr_write_b32 a212,v248
v_accvgpr_write_b32 a213,v249
v_accvgpr_write_b32 a214,v250
v_accvgpr_write_b32 a215,v251
v_accvgpr_read_b32 v244,a228
v_accvgpr_read_b32 v245,a229
v_accvgpr_read_b32 v246,a230
v_accvgpr_read_b32 v247,a231
v_accvgpr_read_b32 v248,a244
v_accvgpr_read_b32 v249,a245
v_accvgpr_read_b32 v250,a246
v_accvgpr_read_b32 v251,a247
v_mul_f32 v244,v244,v255
v_mul_f32 v245,v245,v255
v_mul_f32 v246,v246,v255
v_mul_f32 v247,v247,v255
v_mul_f32 v248,v248,v255
v_mul_f32 v249,v249,v255
v_mul_f32 v250,v250,v255
v_mul_f32 v251,v251,v255
v_accvgpr_write_b32 a228,v244
v_accvgpr_write_b32 a229,v245
v_accvgpr_write_b32 a230,v246
v_accvgpr_write_b32 a231,v247
v_accvgpr_write_b32 a244,v248
v_accvgpr_write_b32 a245,v249
v_accvgpr_write_b32 a246,v250
v_accvgpr_write_b32 a247,v251
v_max3_f32 v253,v176,v177,v178
v_max3_f32 v253,v253,v179,v180
v_max3_f32 v253,v253,v181,v182
v_max_f32 v253,v253,v183
v_mov_b32 v254,v253
s_nop 1
v_permlane32_swap_b32 v253,v254
v_max_f32 v253,v253,v254
v_mov_b32 v254,v253
s_nop 1
v_permlane16_swap_b32 v253,v254
v_max_f32 v253,v253,v254
v_max_f32 v253,0,v253
v_exp_f32 v255,-v253
v_sub_f32 v200,v200,v253
v_sub_f32 v201,v201,v253
v_sub_f32 v202,v202,v253
v_sub_f32 v203,v203,v253
v_sub_f32 v144,v144,v253
v_sub_f32 v145,v145,v253
v_sub_f32 v146,v146,v253
v_sub_f32 v147,v147,v253
v_sub_f32 v148,v148,v253
v_sub_f32 v149,v149,v253
v_sub_f32 v150,v150,v253
v_sub_f32 v151,v151,v253
v_sub_f32 v176,v176,v253
v_sub_f32 v177,v177,v253
v_sub_f32 v178,v178,v253
v_sub_f32 v179,v179,v253
v_sub_f32 v180,v180,v253
v_sub_f32 v181,v181,v253
v_sub_f32 v182,v182,v253
v_sub_f32 v183,v183,v253
v_exp_f32 v176,v176
s_nop 0
v_exp_f32 v177,v177
s_nop 0
v_add_f32 v230,v176,v177
v_cvt_pk_bf16_f32 v176,v176,v177
v_exp_f32 v178,v178
s_nop 0
v_add_f32 v230,v230,v178
v_exp_f32 v179,v179
s_nop 0
v_add_f32 v230,v230,v179
v_cvt_pk_bf16_f32 v177,v178,v179
v_exp_f32 v180,v180
s_nop 0
v_add_f32 v230,v230,v180
v_exp_f32 v181,v181
s_nop 0
v_add_f32 v230,v230,v181
v_cvt_pk_bf16_f32 v178,v180,v181
v_exp_f32 v182,v182
s_nop 0
v_add_f32 v230,v230,v182
v_exp_f32 v183,v183
s_nop 0
v_add_f32 v230,v230,v183
v_cvt_pk_bf16_f32 v179,v182,v183
v_mul_f32 v226,v226,v255
v_accvgpr_read_b32 v244,a8
v_accvgpr_read_b32 v245,a9
v_accvgpr_read_b32 v246,a10
v_accvgpr_read_b32 v247,a11
v_accvgpr_read_b32 v248,a24
v_accvgpr_read_b32 v249,a25
v_accvgpr_read_b32 v250,a26
v_accvgpr_read_b32 v251,a27
v_mul_f32 v244,v244,v255
v_mul_f32 v245,v245,v255
v_mul_f32 v246,v246,v255
v_mul_f32 v247,v247,v255
v_mul_f32 v248,v248,v255
v_mul_f32 v249,v249,v255
v_mul_f32 v250,v250,v255
v_mul_f32 v251,v251,v255
v_accvgpr_write_b32 a8,v244
v_accvgpr_write_b32 a9,v245
v_accvgpr_write_b32 a10,v246
v_accvgpr_write_b32 a11,v247
v_accvgpr_write_b32 a24,v248
v_accvgpr_write_b32 a25,v249
v_accvgpr_write_b32 a26,v250
v_accvgpr_write_b32 a27,v251
v_accvgpr_read_b32 v244,a40
v_accvgpr_read_b32 v245,a41
v_accvgpr_read_b32 v246,a42
v_accvgpr_read_b32 v247,a43
v_accvgpr_read_b32 v248,a56
v_accvgpr_read_b32 v249,a57
v_accvgpr_read_b32 v250,a58
v_accvgpr_read_b32 v251,a59
v_mul_f32 v244,v244,v255
v_mul_f32 v245,v245,v255
v_mul_f32 v246,v246,v255
v_mul_f32 v247,v247,v255
v_mul_f32 v248,v248,v255
v_mul_f32 v249,v249,v255
v_mul_f32 v250,v250,v255
v_mul_f32 v251,v251,v255
v_accvgpr_write_b32 a40,v244
v_accvgpr_write_b32 a41,v245
v_accvgpr_write_b32 a42,v246
v_accvgpr_write_b32 a43,v247
v_accvgpr_write_b32 a56,v248
v_accvgpr_write_b32 a57,v249
v_accvgpr_write_b32 a58,v250
v_accvgpr_write_b32 a59,v251
v_accvgpr_read_b32 v244,a72
v_accvgpr_read_b32 v245,a73
v_accvgpr_read_b32 v246,a74
v_accvgpr_read_b32 v247,a75
v_accvgpr_read_b32 v248,a88
v_accvgpr_read_b32 v249,a89
v_accvgpr_read_b32 v250,a90
v_accvgpr_read_b32 v251,a91
v_mul_f32 v244,v244,v255
v_mul_f32 v245,v245,v255
v_mul_f32 v246,v246,v255
v_mul_f32 v247,v247,v255
v_mul_f32 v248,v248,v255
v_mul_f32 v249,v249,v255
v_mul_f32 v250,v250,v255
v_mul_f32 v251,v251,v255
v_accvgpr_write_b32 a72,v244
v_accvgpr_write_b32 a73,v245
v_accvgpr_write_b32 a74,v246
v_accvgpr_write_b32 a75,v247
v_accvgpr_write_b32 a88,v248
v_accvgpr_write_b32 a89,v249
v_accvgpr_write_b32 a90,v250
v_accvgpr_write_b32 a91,v251
v_accvgpr_read_b32 v244,a104
v_accvgpr_read_b32 v245,a105
v_accvgpr_read_b32 v246,a106
v_accvgpr_read_b32 v247,a107
v_accvgpr_read_b32 v248,a120
v_accvgpr_read_b32 v249,a121
v_accvgpr_read_b32 v250,a122
v_accvgpr_read_b32 v251,a123
v_mul_f32 v244,v244,v255
v_mul_f32 v245,v245,v255
v_mul_f32 v246,v246,v255
v_mul_f32 v247,v247,v255
v_mul_f32 v248,v248,v255
v_mul_f32 v249,v249,v255
v_mul_f32 v250,v250,v255
v_mul_f32 v251,v251,v255
v_accvgpr_write_b32 a104,v244
v_accvgpr_write_b32 a105,v245
v_accvgpr_write_b32 a106,v246
v_accvgpr_write_b32 a107,v247
v_accvgpr_write_b32 a120,v248
v_accvgpr_write_b32 a121,v249
v_accvgpr_write_b32 a122,v250
v_accvgpr_write_b32 a123,v251
v_accvgpr_read_b32 v244,a136
v_accvgpr_read_b32 v245,a137
v_accvgpr_read_b32 v246,a138
v_accvgpr_read_b32 v247,a139
v_accvgpr_read_b32 v248,a152
v_accvgpr_read_b32 v249,a153
v_accvgpr_read_b32 v250,a154
v_accvgpr_read_b32 v251,a155
v_mul_f32 v244,v244,v255
v_mul_f32 v245,v245,v255
v_mul_f32 v246,v246,v255
v_mul_f32 v247,v247,v255
v_mul_f32 v248,v248,v255
v_mul_f32 v249,v249,v255
v_mul_f32 v250,v250,v255
v_mul_f32 v251,v251,v255
v_accvgpr_write_b32 a136,v244
v_accvgpr_write_b32 a137,v245
v_accvgpr_write_b32 a138,v246
v_accvgpr_write_b32 a139,v247
v_accvgpr_write_b32 a152,v248
v_accvgpr_write_b32 a153,v249
v_accvgpr_write_b32 a154,v250
v_accvgpr_write_b32 a155,v251
v_accvgpr_read_b32 v244,a168
v_accvgpr_read_b32 v245,a169
v_accvgpr_read_b32 v246,a170
v_accvgpr_read_b32 v247,a171
v_accvgpr_read_b32 v248,a184
v_accvgpr_read_b32 v249,a185
v_accvgpr_read_b32 v250,a186
v_accvgpr_read_b32 v251,a187
v_mul_f32 v244,v244,v255
v_mul_f32 v245,v245,v255
v_mul_f32 v246,v246,v255
v_mul_f32 v247,v247,v255
v_mul_f32 v248,v248,v255
v_mul_f32 v249,v249,v255
v_mul_f32 v250,v250,v255
v_mul_f32 v251,v251,v255
v_accvgpr_write_b32 a168,v244
v_accvgpr_write_b32 a169,v245
v_accvgpr_write_b32 a170,v246
v_accvgpr_write_b32 a171,v247
v_accvgpr_write_b32 a184,v248
v_accvgpr_write_b32 a185,v249
v_accvgpr_write_b32 a186,v250
v_accvgpr_write_b32 a187,v251
v_accvgpr_read_b32 v244,a200
v_accvgpr_read_b32 v245,a201
v_accvgpr_read_b32 v246,a202
v_accvgpr_read_b32 v247,a203
v_accvgpr_read_b32 v248,a216
v_accvgpr_read_b32 v249,a217
v_accvgpr_read_b32 v250,a218
v_accvgpr_read_b32 v251,a219
v_mul_f32 v244,v244,v255
v_mul_f32 v245,v245,v255
v_mul_f32 v246,v246,v255
v_mul_f32 v247,v247,v255
v_mul_f32 v248,v248,v255
v_mul_f32 v249,v249,v255
v_mul_f32 v250,v250,v255
v_mul_f32 v251,v251,v255
v_accvgpr_write_b32 a200,v244
v_accvgpr_write_b32 a201,v245
v_accvgpr_write_b32 a202,v246
v_accvgpr_write_b32 a203,v247
v_accvgpr_write_b32 a216,v248
v_accvgpr_write_b32 a217,v249
v_accvgpr_write_b32 a218,v250
v_accvgpr_write_b32 a219,v251
v_accvgpr_read_b32 v244,a232
v_accvgpr_read_b32 v245,a233
v_accvgpr_read_b32 v246,a234
v_accvgpr_read_b32 v247,a235
v_accvgpr_read_b32 v248,a248
v_accvgpr_read_b32 v249,a249
v_accvgpr_read_b32 v250,a250
v_accvgpr_read_b32 v251,a251
v_mul_f32 v244,v244,v255
v_mul_f32 v245,v245,v255
v_mul_f32 v246,v246,v255
v_mul_f32 v247,v247,v255
v_mul_f32 v248,v248,v255
v_mul_f32 v249,v249,v255
v_mul_f32 v250,v250,v255
v_mul_f32 v251,v251,v255
v_accvgpr_write_b32 a232,v244
v_accvgpr_write_b32 a233,v245
v_accvgpr_write_b32 a234,v246
v_accvgpr_write_b32 a235,v247
v_accvgpr_write_b32 a248,v248
v_accvgpr_write_b32 a249,v249
v_accvgpr_write_b32 a250,v250
v_accvgpr_write_b32 a251,v251
v_max3_f32 v253,v184,v185,v186
v_max3_f32 v253,v253,v187,v188
v_max3_f32 v253,v253,v189,v190
v_max_f32 v253,v253,v191
v_mov_b32 v254,v253
s_nop 1
v_permlane32_swap_b32 v253,v254
v_max_f32 v253,v253,v254
v_mov_b32 v254,v253
s_nop 1
v_permlane16_swap_b32 v253,v254
v_max_f32 v253,v253,v254
v_max_f32 v253,0,v253
v_exp_f32 v255,-v253
v_sub_f32 v204,v204,v253
v_sub_f32 v205,v205,v253
v_sub_f32 v206,v206,v253
v_sub_f32 v207,v207,v253
v_sub_f32 v152,v152,v253
v_sub_f32 v153,v153,v253
v_sub_f32 v154,v154,v253
v_sub_f32 v155,v155,v253
v_sub_f32 v156,v156,v253
v_sub_f32 v157,v157,v253
v_sub_f32 v158,v158,v253
v_sub_f32 v159,v159,v253
v_sub_f32 v184,v184,v253
v_sub_f32 v185,v185,v253
v_sub_f32 v186,v186,v253
v_sub_f32 v187,v187,v253
v_sub_f32 v188,v188,v253
v_sub_f32 v189,v189,v253
v_sub_f32 v190,v190,v253
v_sub_f32 v191,v191,v253
v_exp_f32 v184,v184
s_nop 0
v_exp_f32 v185,v185
s_nop 0
v_add_f32 v231,v184,v185
v_cvt_pk_bf16_f32 v184,v184,v185
v_exp_f32 v186,v186
s_nop 0
v_add_f32 v231,v231,v186
v_exp_f32 v187,v187
s_nop 0
v_add_f32 v231,v231,v187
v_cvt_pk_bf16_f32 v185,v186,v187
v_exp_f32 v188,v188
s_nop 0
v_add_f32 v231,v231,v188
v_exp_f32 v189,v189
s_nop 0
v_add_f32 v231,v231,v189
v_cvt_pk_bf16_f32 v186,v188,v189
v_exp_f32 v190,v190
s_nop 0
v_add_f32 v231,v231,v190
v_exp_f32 v191,v191
s_nop 0
v_add_f32 v231,v231,v191
v_cvt_pk_bf16_f32 v187,v190,v191
v_mul_f32 v227,v227,v255
v_accvgpr_read_b32 v244,a12
v_accvgpr_read_b32 v245,a13
v_accvgpr_read_b32 v246,a14
v_accvgpr_read_b32 v247,a15
v_accvgpr_read_b32 v248,a28
v_accvgpr_read_b32 v249,a29
v_accvgpr_read_b32 v250,a30
v_accvgpr_read_b32 v251,a31
v_mul_f32 v244,v244,v255
v_mul_f32 v245,v245,v255
v_mul_f32 v246,v246,v255
v_mul_f32 v247,v247,v255
v_mul_f32 v248,v248,v255
v_mul_f32 v249,v249,v255
v_mul_f32 v250,v250,v255
v_mul_f32 v251,v251,v255
v_accvgpr_write_b32 a12,v244
v_accvgpr_write_b32 a13,v245
v_accvgpr_write_b32 a14,v246
v_accvgpr_write_b32 a15,v247
v_accvgpr_write_b32 a28,v248
v_accvgpr_write_b32 a29,v249
v_accvgpr_write_b32 a30,v250
v_accvgpr_write_b32 a31,v251
v_accvgpr_read_b32 v244,a44
v_accvgpr_read_b32 v245,a45
v_accvgpr_read_b32 v246,a46
v_accvgpr_read_b32 v247,a47
v_accvgpr_read_b32 v248,a60
v_accvgpr_read_b32 v249,a61
v_accvgpr_read_b32 v250,a62
v_accvgpr_read_b32 v251,a63
v_mul_f32 v244,v244,v255
v_mul_f32 v245,v245,v255
v_mul_f32 v246,v246,v255
v_mul_f32 v247,v247,v255
v_mul_f32 v248,v248,v255
v_mul_f32 v249,v249,v255
v_mul_f32 v250,v250,v255
v_mul_f32 v251,v251,v255
v_accvgpr_write_b32 a44,v244
v_accvgpr_write_b32 a45,v245
v_accvgpr_write_b32 a46,v246
v_accvgpr_write_b32 a47,v247
v_accvgpr_write_b32 a60,v248
v_accvgpr_write_b32 a61,v249
v_accvgpr_write_b32 a62,v250
v_accvgpr_write_b32 a63,v251
v_accvgpr_read_b32 v244,a76
v_accvgpr_read_b32 v245,a77
v_accvgpr_read_b32 v246,a78
v_accvgpr_read_b32 v247,a79
v_accvgpr_read_b32 v248,a92
v_accvgpr_read_b32 v249,a93
v_accvgpr_read_b32 v250,a94
v_accvgpr_read_b32 v251,a95
v_mul_f32 v244,v244,v255
v_mul_f32 v245,v245,v255
v_mul_f32 v246,v246,v255
v_mul_f32 v247,v247,v255
v_mul_f32 v248,v248,v255
v_mul_f32 v249,v249,v255
v_mul_f32 v250,v250,v255
v_mul_f32 v251,v251,v255
v_accvgpr_write_b32 a76,v244
v_accvgpr_write_b32 a77,v245
v_accvgpr_write_b32 a78,v246
v_accvgpr_write_b32 a79,v247
v_accvgpr_write_b32 a92,v248
v_accvgpr_write_b32 a93,v249
v_accvgpr_write_b32 a94,v250
v_accvgpr_write_b32 a95,v251
v_accvgpr_read_b32 v244,a108
v_accvgpr_read_b32 v245,a109
v_accvgpr_read_b32 v246,a110
v_accvgpr_read_b32 v247,a111
v_accvgpr_read_b32 v248,a124
v_accvgpr_read_b32 v249,a125
v_accvgpr_read_b32 v250,a126
v_accvgpr_read_b32 v251,a127
v_mul_f32 v244,v244,v255
v_mul_f32 v245,v245,v255
v_mul_f32 v246,v246,v255
v_mul_f32 v247,v247,v255
v_mul_f32 v248,v248,v255
v_mul_f32 v249,v249,v255
v_mul_f32 v250,v250,v255
v_mul_f32 v251,v251,v255
v_accvgpr_write_b32 a108,v244
v_accvgpr_write_b32 a109,v245
v_accvgpr_write_b32 a110,v246
v_accvgpr_write_b32 a111,v247
v_accvgpr_write_b32 a124,v248
v_accvgpr_write_b32 a125,v249
v_accvgpr_write_b32 a126,v250
v_accvgpr_write_b32 a127,v251
v_accvgpr_read_b32 v244,a140
v_accvgpr_read_b32 v245,a141
v_accvgpr_read_b32 v246,a142
v_accvgpr_read_b32 v247,a143
v_accvgpr_read_b32 v248,a156
v_accvgpr_read_b32 v249,a157
v_accvgpr_read_b32 v250,a158
v_accvgpr_read_b32 v251,a159
v_mul_f32 v244,v244,v255
v_mul_f32 v245,v245,v255
v_mul_f32 v246,v246,v255
v_mul_f32 v247,v247,v255
v_mul_f32 v248,v248,v255
v_mul_f32 v249,v249,v255
v_mul_f32 v250,v250,v255
v_mul_f32 v251,v251,v255
v_accvgpr_write_b32 a140,v244
v_accvgpr_write_b32 a141,v245
v_accvgpr_write_b32 a142,v246
v_accvgpr_write_b32 a143,v247
v_accvgpr_write_b32 a156,v248
v_accvgpr_write_b32 a157,v249
v_accvgpr_write_b32 a158,v250
v_accvgpr_write_b32 a159,v251
v_accvgpr_read_b32 v244,a172
v_accvgpr_read_b32 v245,a173
v_accvgpr_read_b32 v246,a174
v_accvgpr_read_b32 v247,a175
v_accvgpr_read_b32 v248,a188
v_accvgpr_read_b32 v249,a189
v_accvgpr_read_b32 v250,a190
v_accvgpr_read_b32 v251,a191
v_mul_f32 v244,v244,v255
v_mul_f32 v245,v245,v255
v_mul_f32 v246,v246,v255
v_mul_f32 v247,v247,v255
v_mul_f32 v248,v248,v255
v_mul_f32 v249,v249,v255
v_mul_f32 v250,v250,v255
v_mul_f32 v251,v251,v255
v_accvgpr_write_b32 a172,v244
v_accvgpr_write_b32 a173,v245
v_accvgpr_write_b32 a174,v246
v_accvgpr_write_b32 a175,v247
v_accvgpr_write_b32 a188,v248
v_accvgpr_write_b32 a189,v249
v_accvgpr_write_b32 a190,v250
v_accvgpr_write_b32 a191,v251
v_accvgpr_read_b32 v244,a204
v_accvgpr_read_b32 v245,a205
v_accvgpr_read_b32 v246,a206
v_accvgpr_read_b32 v247,a207
v_accvgpr_read_b32 v248,a220
v_accvgpr_read_b32 v249,a221
v_accvgpr_read_b32 v250,a222
v_accvgpr_read_b32 v251,a223
v_mul_f32 v244,v244,v255
v_mul_f32 v245,v245,v255
v_mul_f32 v246,v246,v255
v_mul_f32 v247,v247,v255
v_mul_f32 v248,v248,v255
v_mul_f32 v249,v249,v255
v_mul_f32 v250,v250,v255
v_mul_f32 v251,v251,v255
v_accvgpr_write_b32 a204,v244
v_accvgpr_write_b32 a205,v245
v_accvgpr_write_b32 a206,v246
v_accvgpr_write_b32 a207,v247
v_accvgpr_write_b32 a220,v248
v_accvgpr_write_b32 a221,v249
v_accvgpr_write_b32 a222,v250
v_accvgpr_write_b32 a223,v251
v_accvgpr_read_b32 v244,a236
v_accvgpr_read_b32 v245,a237
v_accvgpr_read_b32 v246,a238
v_accvgpr_read_b32 v247,a239
v_accvgpr_read_b32 v248,a252
v_accvgpr_read_b32 v249,a253
v_accvgpr_read_b32 v250,a254
v_accvgpr_read_b32 v251,a255
v_mul_f32 v244,v244,v255
v_mul_f32 v245,v245,v255
v_mul_f32 v246,v246,v255
v_mul_f32 v247,v247,v255
v_mul_f32 v248,v248,v255
v_mul_f32 v249,v249,v255
v_mul_f32 v250,v250,v255
v_mul_f32 v251,v251,v255
v_accvgpr_write_b32 a236,v244
v_accvgpr_write_b32 a237,v245
v_accvgpr_write_b32 a238,v246
v_accvgpr_write_b32 a239,v247
v_accvgpr_write_b32 a252,v248
v_accvgpr_write_b32 a253,v249
v_accvgpr_write_b32 a254,v250
v_accvgpr_write_b32 a255,v251
s_nop 1
s_setpc_b64 s[58:59]
L_DECIDE:
v_mbcnt_lo_u32_b32 v237,-1,0
v_lshl_add_u32 v237,v237,8,s6
s_mov_b32 s53,0x40000
L_DEC_A:
buffer_load_dword v236,off,s[20:23],s60 sc1
s_waitcnt vmcnt(0)
v_readfirstlane_b32 s34,v236
s_bitcmp1_b32 s34,5
s_cbranch_scc1 L_FAST
s_bitcmp1_b32 s34,6
s_cbranch_scc1 L_SLOW
s_bitcmp1_b32 s34,7
s_cbranch_scc0 L_DEC_V
s_xor_b32 s34,s34,s5
s_and_b32 s34,s34,15
s_cbranch_scc1 L_SLOW
s_sub_u32 s53,s53,1
s_cbranch_scc0 L_DEC_A
s_branch L_SLOW
L_DEC_V:
s_or_b32 s34,s5,64
v_mov_b32 v236,s34
buffer_store_byte v236,v237,s[20:23],s60 offen
s_waitcnt vmcnt(0)
buffer_load_dword v236,off,s[20:23],s60 sc1
s_waitcnt vmcnt(0)
v_readfirstlane_b32 s34,v236
s_bitcmp1_b32 s34,7
s_cbranch_scc1 L_DEC_A
L_SLOW:
v_mfma_f32_16x16x32_bf16 v[128:131],v[208:211],v[0:3],0
v_accvgpr_read_b32 v160,a128
v_accvgpr_read_b32 v161,a129
v_accvgpr_read_b32 v162,a130
v_accvgpr_read_b32 v163,a131
v_accvgpr_read_b32 v164,a144
v_mfma_f32_16x16x32_bf16 v[136:139],v[208:211],v[4:7],0
v_accvgpr_read_b32 v165,a145
v_accvgpr_read_b32 v166,a146
v_accvgpr_read_b32 v167,a147
v_cvt_pk_bf16_f32 v64,v160,v161
v_cvt_pk_bf16_f32 v65,v162,v163
v_mfma_f32_16x16x32_bf16 v[144:147],v[208:211],v[8:11],0
v_cvt_pk_bf16_f32 v66,v164,v165
v_cvt_pk_bf16_f32 v67,v166,v167
v_accvgpr_read_b32 v168,a132
v_accvgpr_read_b32 v169,a133
v_accvgpr_read_b32 v170,a134
v_mfma_f32_16x16x32_bf16 v[152:155],v[208:211],v[12:15],0
ds_read_b64_tr_b16 v[204:205],v239 offset:13056
ds_read_b64_tr_b16 v[206:207],v239 offset:15232
v_accvgpr_read_b32 v171,a135
v_accvgpr_read_b32 v172,a148
v_accvgpr_read_b32 v173,a149
v_mfma_f32_16x16x32_bf16 v[132:135],v[212:215],v[0:3],0
s_add_u32 m0,s32,87040
s_mov_b32 s34,114944
v_accvgpr_read_b32 v174,a150
v_accvgpr_read_b32 v175,a151
v_cvt_pk_bf16_f32 v68,v168,v169
v_mfma_f32_16x16x32_bf16 v[140:143],v[212:215],v[4:7],0
buffer_load_dwordx4 v235,s[24:27],s34 offen  lds
v_cvt_pk_bf16_f32 v69,v170,v171
v_cvt_pk_bf16_f32 v70,v172,v173
v_cvt_pk_bf16_f32 v71,v174,v175
v_mfma_f32_16x16x32_bf16 v[148:151],v[212:215],v[8:11],0
s_waitcnt lgkmcnt(8)
v_accvgpr_read_b32 v176,a136
v_accvgpr_read_b32 v177,a137
v_accvgpr_read_b32 v178,a138
v_accvgpr_read_b32 v179,a139
v_mfma_f32_16x16x32_bf16 v[156:159],v[212:215],v[12:15],0
ds_read_b64_tr_b16 v[208:209],v238 offset:17408
ds_read_b64_tr_b16 v[210:211],v238 offset:19584
v_accvgpr_read_b32 v180,a152
v_accvgpr_read_b32 v181,a153
v_accvgpr_read_b32 v182,a154
v_mfma_f32_16x16x32_bf16 v[128:131],v[216:219],v[16:19],v[128:131]
s_add_u32 m0,s32,88128
s_mov_b32 s34,122112
v_accvgpr_read_b32 v183,a155
v_cvt_pk_bf16_f32 v72,v176,v177
v_cvt_pk_bf16_f32 v73,v178,v179
v_mfma_f32_16x16x32_bf16 v[136:139],v[216:219],v[20:23],v[136:139]
buffer_load_dwordx4 v235,s[24:27],s34 offen  lds
v_cvt_pk_bf16_f32 v74,v180,v181
v_cvt_pk_bf16_f32 v75,v182,v183
v_accvgpr_read_b32 v184,a140
v_mfma_f32_16x16x32_bf16 v[144:147],v[216:219],v[24:27],v[144:147]
v_accvgpr_read_b32 v185,a141
v_accvgpr_read_b32 v186,a142
v_accvgpr_read_b32 v187,a143
v_accvgpr_read_b32 v188,a156
v_accvgpr_read_b32 v189,a157
v_mfma_f32_16x16x32_bf16 v[152:155],v[216:219],v[28:31],v[152:155]
ds_read_b64_tr_b16 v[212:213],v239 offset:17408
ds_read_b64_tr_b16 v[214:215],v239 offset:19584
v_accvgpr_read_b32 v190,a158
v_accvgpr_read_b32 v191,a159
v_cvt_pk_bf16_f32 v76,v184,v185
v_mfma_f32_16x16x32_bf16 v[132:135],v[220:223],v[16:19],v[132:135]
s_add_u32 m0,s32,89216
s_mov_b32 s34,129280
v_cvt_pk_bf16_f32 v77,v186,v187
v_cvt_pk_bf16_f32 v78,v188,v189
v_cvt_pk_bf16_f32 v79,v190,v191
v_mfma_f32_16x16x32_bf16 v[140:143],v[220:223],v[20:23],v[140:143]
buffer_load_dwordx4 v235,s[24:27],s34 offen  lds
v_accvgpr_read_b32 v160,a160
v_accvgpr_read_b32 v161,a161
v_accvgpr_read_b32 v162,a162
v_mfma_f32_16x16x32_bf16 v[148:151],v[220:223],v[24:27],v[148:151]
s_waitcnt lgkmcnt(8)
v_accvgpr_read_b32 v163,a163
v_accvgpr_read_b32 v164,a176
v_accvgpr_read_b32 v165,a177
v_accvgpr_read_b32 v166,a178
v_mfma_f32_16x16x32_bf16 v[156:159],v[220:223],v[28:31],v[156:159]
ds_read_b64_tr_b16 v[216:217],v238 offset:21760
ds_read_b64_tr_b16 v[218:219],v238 offset:23936
v_accvgpr_read_b32 v167,a179
v_cvt_pk_bf16_f32 v80,v160,v161
v_cvt_pk_bf16_f32 v81,v162,v163
v_mfma_f32_16x16x32_bf16 v[128:131],v[192:195],v[32:35],v[128:131]
s_add_u32 m0,s32,90304
s_mov_b32 s34,136448
v_cvt_pk_bf16_f32 v82,v164,v165
v_cvt_pk_bf16_f32 v83,v166,v167
v_accvgpr_read_b32 v168,a164
v_mfma_f32_16x16x32_bf16 v[136:139],v[192:195],v[36:39],v[136:139]
buffer_load_dwordx4 v235,s[24:27],s34 offen  lds
v_accvgpr_read_b32 v169,a165
v_accvgpr_read_b32 v170,a166
v_accvgpr_read_b32 v171,a167
v_mfma_f32_16x16x32_bf16 v[144:147],v[192:195],v[40:43],v[144:147]
v_accvgpr_read_b32 v172,a180
v_accvgpr_read_b32 v173,a181
v_accvgpr_read_b32 v174,a182
v_accvgpr_read_b32 v175,a183
v_cvt_pk_bf16_f32 v84,v168,v169
v_mfma_f32_16x16x32_bf16 v[152:155],v[192:195],v[44:47],v[152:155]
ds_read_b64_tr_b16 v[220:221],v239 offset:21760
ds_read_b64_tr_b16 v[222:223],v239 offset:23936
v_cvt_pk_bf16_f32 v85,v170,v171
v_cvt_pk_bf16_f32 v86,v172,v173
v_cvt_pk_bf16_f32 v87,v174,v175
v_mfma_f32_16x16x32_bf16 v[132:135],v[196:199],v[32:35],v[132:135]
v_accvgpr_read_b32 v176,a168
v_accvgpr_read_b32 v177,a169
v_accvgpr_read_b32 v178,a170
v_accvgpr_read_b32 v179,a171
v_accvgpr_read_b32 v180,a184
v_mfma_f32_16x16x32_bf16 v[140:143],v[196:199],v[36:39],v[140:143]
v_accvgpr_read_b32 v181,a185
v_accvgpr_read_b32 v182,a186
v_accvgpr_read_b32 v183,a187
v_cvt_pk_bf16_f32 v88,v176,v177
v_cvt_pk_bf16_f32 v89,v178,v179
v_mfma_f32_16x16x32_bf16 v[148:151],v[196:199],v[40:43],v[148:151]
s_waitcnt lgkmcnt(8)
v_cvt_pk_bf16_f32 v90,v180,v181
v_cvt_pk_bf16_f32 v91,v182,v183
v_accvgpr_read_b32 v184,a172
v_accvgpr_read_b32 v185,a173
v_mfma_f32_16x16x32_bf16 v[156:159],v[196:199],v[44:47],v[156:159]
ds_read_b64_tr_b16 v[192:193],v238 offset:26112
ds_read_b64_tr_b16 v[194:195],v238 offset:28288
v_accvgpr_read_b32 v186,a174
v_accvgpr_read_b32 v187,a175
v_accvgpr_read_b32 v188,a188
v_mfma_f32_16x16x32_bf16 v[128:131],v[200:203],v[48:51],v[128:131]
v_accvgpr_read_b32 v189,a189
v_accvgpr_read_b32 v190,a190
v_accvgpr_read_b32 v191,a191
v_cvt_pk_bf16_f32 v92,v184,v185
v_cvt_pk_bf16_f32 v93,v186,v187
v_mfma_f32_16x16x32_bf16 v[136:139],v[200:203],v[52:55],v[136:139]
v_cvt_pk_bf16_f32 v94,v188,v189
v_cvt_pk_bf16_f32 v95,v190,v191
v_accvgpr_read_b32 v160,a192
v_accvgpr_read_b32 v161,a193
v_accvgpr_read_b32 v162,a194
v_mfma_f32_16x16x32_bf16 v[144:147],v[200:203],v[56:59],v[144:147]
v_accvgpr_read_b32 v163,a195
v_accvgpr_read_b32 v164,a208
v_accvgpr_read_b32 v165,a209
v_accvgpr_read_b32 v166,a210
v_accvgpr_read_b32 v167,a211
v_mfma_f32_16x16x32_bf16 v[152:155],v[200:203],v[60:63],v[152:155]
ds_read_b64_tr_b16 v[196:197],v239 offset:26112
ds_read_b64_tr_b16 v[198:199],v239 offset:28288
v_cvt_pk_bf16_f32 v96,v160,v161
v_cvt_pk_bf16_f32 v97,v162,v163
v_cvt_pk_bf16_f32 v98,v164,v165
v_mfma_f32_16x16x32_bf16 v[132:135],v[204:207],v[48:51],v[132:135]
v_cvt_pk_bf16_f32 v99,v166,v167
v_accvgpr_read_b32 v168,a196
v_accvgpr_read_b32 v169,a197
v_accvgpr_read_b32 v170,a198
v_accvgpr_read_b32 v171,a199
v_mfma_f32_16x16x32_bf16 v[140:143],v[204:207],v[52:55],v[140:143]
v_accvgpr_read_b32 v172,a212
v_accvgpr_read_b32 v173,a213
v_accvgpr_read_b32 v174,a214
v_accvgpr_read_b32 v175,a215
v_cvt_pk_bf16_f32 v100,v168,v169
v_mfma_f32_16x16x32_bf16 v[148:151],v[204:207],v[56:59],v[148:151]
s_waitcnt lgkmcnt(8)
v_cvt_pk_bf16_f32 v101,v170,v171
v_cvt_pk_bf16_f32 v102,v172,v173
v_cvt_pk_bf16_f32 v103,v174,v175
v_accvgpr_read_b32 v176,a200
v_mfma_f32_16x16x32_bf16 v[156:159],v[204:207],v[60:63],v[156:159]
ds_read_b64_tr_b16 v[200:201],v238 offset:30464
ds_read_b64_tr_b16 v[202:203],v238 offset:32640
v_accvgpr_read_b32 v177,a201
v_accvgpr_read_b32 v178,a202
v_accvgpr_read_b32 v179,a203
v_mfma_f32_16x16x32_bf16 v[128:131],v[208:211],v[64:67],v[128:131]
v_accvgpr_read_b32 v180,a216
v_accvgpr_read_b32 v181,a217
v_accvgpr_read_b32 v182,a218
v_accvgpr_read_b32 v183,a219
v_cvt_pk_bf16_f32 v104,v176,v177
v_mfma_f32_16x16x32_bf16 v[136:139],v[208:211],v[68:71],v[136:139]
v_cvt_pk_bf16_f32 v105,v178,v179
v_cvt_pk_bf16_f32 v106,v180,v181
v_cvt_pk_bf16_f32 v107,v182,v183
v_accvgpr_read_b32 v184,a204
v_accvgpr_read_b32 v185,a205
v_mfma_f32_16x16x32_bf16 v[144:147],v[208:211],v[72:75],v[144:147]
v_accvgpr_read_b32 v186,a206
v_accvgpr_read_b32 v187,a207
v_accvgpr_read_b32 v188,a220
v_accvgpr_read_b32 v189,a221
v_accvgpr_read_b32 v190,a222
v_mfma_f32_16x16x32_bf16 v[152:155],v[208:211],v[76:79],v[152:155]
ds_read_b64_tr_b16 v[204:205],v239 offset:30464
ds_read_b64_tr_b16 v[206:207],v239 offset:32640
v_accvgpr_read_b32 v191,a223
v_cvt_pk_bf16_f32 v108,v184,v185
v_cvt_pk_bf16_f32 v109,v186,v187
v_mfma_f32_16x16x32_bf16 v[132:135],v[212:215],v[64:67],v[132:135]
v_subrev_u32 v238,121856,v238
v_subrev_u32 v239,121856,v239
v_cvt_pk_bf16_f32 v110,v188,v189
v_cvt_pk_bf16_f32 v111,v190,v191
v_accvgpr_read_b32 v160,a224
v_mfma_f32_16x16x32_bf16 v[140:143],v[212:215],v[68:71],v[140:143]
v_accvgpr_read_b32 v161,a225
v_accvgpr_read_b32 v162,a226
v_accvgpr_read_b32 v163,a227
v_accvgpr_read_b32 v164,a240
v_accvgpr_read_b32 v165,a241
v_mfma_f32_16x16x32_bf16 v[148:151],v[212:215],v[72:75],v[148:151]
s_waitcnt lgkmcnt(8)
v_accvgpr_read_b32 v166,a242
v_accvgpr_read_b32 v167,a243
v_cvt_pk_bf16_f32 v112,v160,v161
v_cvt_pk_bf16_f32 v113,v162,v163
v_mfma_f32_16x16x32_bf16 v[156:159],v[212:215],v[76:79],v[156:159]
ds_read_b64_tr_b16 v[208:209],v240 offset:0
ds_read_b64_tr_b16 v[210:211],v240 offset:2176
v_cvt_pk_bf16_f32 v114,v164,v165
v_cvt_pk_bf16_f32 v115,v166,v167
v_accvgpr_read_b32 v168,a228
v_mfma_f32_16x16x32_bf16 v[128:131],v[216:219],v[80:83],v[128:131]
v_accvgpr_read_b32 v169,a229
v_accvgpr_read_b32 v170,a230
v_accvgpr_read_b32 v171,a231
v_accvgpr_read_b32 v172,a244
v_accvgpr_read_b32 v173,a245
v_mfma_f32_16x16x32_bf16 v[136:139],v[216:219],v[84:87],v[136:139]
v_accvgpr_read_b32 v174,a246
v_accvgpr_read_b32 v175,a247
v_cvt_pk_bf16_f32 v116,v168,v169
v_cvt_pk_bf16_f32 v117,v170,v171
v_cvt_pk_bf16_f32 v118,v172,v173
v_mfma_f32_16x16x32_bf16 v[144:147],v[216:219],v[88:91],v[144:147]
v_cvt_pk_bf16_f32 v119,v174,v175
v_accvgpr_read_b32 v176,a232
v_accvgpr_read_b32 v177,a233
v_accvgpr_read_b32 v178,a234
v_accvgpr_read_b32 v179,a235
v_mfma_f32_16x16x32_bf16 v[152:155],v[216:219],v[92:95],v[152:155]
ds_read_b64_tr_b16 v[212:213],v240 offset:4352
ds_read_b64_tr_b16 v[214:215],v240 offset:6528
v_accvgpr_read_b32 v180,a248
v_accvgpr_read_b32 v181,a249
v_accvgpr_read_b32 v182,a250
v_mfma_f32_16x16x32_bf16 v[132:135],v[220:223],v[80:83],v[132:135]
v_accvgpr_read_b32 v183,a251
v_cvt_pk_bf16_f32 v120,v176,v177
v_cvt_pk_bf16_f32 v121,v178,v179
v_cvt_pk_bf16_f32 v122,v180,v181
v_cvt_pk_bf16_f32 v123,v182,v183
v_mfma_f32_16x16x32_bf16 v[140:143],v[220:223],v[84:87],v[140:143]
v_accvgpr_read_b32 v184,a236
v_accvgpr_read_b32 v185,a237
v_accvgpr_read_b32 v186,a238
v_accvgpr_read_b32 v187,a239
v_accvgpr_read_b32 v188,a252
v_mfma_f32_16x16x32_bf16 v[148:151],v[220:223],v[88:91],v[148:151]
s_waitcnt lgkmcnt(8)
v_accvgpr_read_b32 v189,a253
v_accvgpr_read_b32 v190,a254
v_accvgpr_read_b32 v191,a255
v_cvt_pk_bf16_f32 v124,v184,v185
v_mfma_f32_16x16x32_bf16 v[156:159],v[220:223],v[92:95],v[156:159]
ds_read_b64_tr_b16 v[216:217],v241 offset:0
ds_read_b64_tr_b16 v[218:219],v241 offset:2176
v_cvt_pk_bf16_f32 v125,v186,v187
v_cvt_pk_bf16_f32 v126,v188,v189
v_cvt_pk_bf16_f32 v127,v190,v191
v_mfma_f32_16x16x32_bf16 v[128:131],v[192:195],v[96:99],v[128:131]
v_mfma_f32_16x16x32_bf16 v[136:139],v[192:195],v[100:103],v[136:139]
v_mfma_f32_16x16x32_bf16 v[144:147],v[192:195],v[104:107],v[144:147]
v_mfma_f32_16x16x32_bf16 v[152:155],v[192:195],v[108:111],v[152:155]
ds_read_b64_tr_b16 v[220:221],v241 offset:4352
ds_read_b64_tr_b16 v[222:223],v241 offset:6528
v_mfma_f32_16x16x32_bf16 v[132:135],v[196:199],v[96:99],v[132:135]
v_mfma_f32_16x16x32_bf16 v[140:143],v[196:199],v[100:103],v[140:143]
v_mfma_f32_16x16x32_bf16 v[148:151],v[196:199],v[104:107],v[148:151]
s_waitcnt lgkmcnt(8)
v_mfma_f32_16x16x32_bf16 v[156:159],v[196:199],v[108:111],v[156:159]
ds_read_b64_tr_b16 v[192:193],v240 offset:8704
ds_read_b64_tr_b16 v[194:195],v240 offset:10880
v_mfma_f32_16x16x32_bf16 v[128:131],v[200:203],v[112:115],v[128:131]
v_mfma_f32_16x16x32_bf16 v[136:139],v[200:203],v[116:119],v[136:139]
v_mfma_f32_16x16x32_bf16 v[144:147],v[200:203],v[120:123],v[144:147]
v_mfma_f32_16x16x32_bf16 v[152:155],v[200:203],v[124:127],v[152:155]
ds_read_b64_tr_b16 v[196:197],v240 offset:13056
ds_read_b64_tr_b16 v[198:199],v240 offset:15232
v_mfma_f32_16x16x32_bf16 v[132:135],v[204:207],v[112:115],v[132:135]
v_mfma_f32_16x16x32_bf16 v[140:143],v[204:207],v[116:119],v[140:143]
v_mfma_f32_16x16x32_bf16 v[148:151],v[204:207],v[120:123],v[148:151]
s_waitcnt lgkmcnt(8)
v_mfma_f32_16x16x32_bf16 v[156:159],v[204:207],v[124:127],v[156:159]
ds_read_b64_tr_b16 v[200:201],v241 offset:8704
ds_read_b64_tr_b16 v[202:203],v241 offset:10880
v_mfma_f32_16x16x32_bf16 v[160:163],v[208:211],v[0:3],0
v_mul_f32 v128,v128,v224
v_mul_f32 v129,v129,v224
v_mfma_f32_16x16x32_bf16 v[160:163],v[212:215],v[16:19],v[160:163]
v_cvt_pk_bf16_f32 v128,v128,v129
v_mul_f32 v130,v130,v224
v_mfma_f32_16x16x32_bf16 v[168:171],v[208:211],v[4:7],0
v_mul_f32 v131,v131,v224
v_cvt_pk_bf16_f32 v129,v130,v131
v_mfma_f32_16x16x32_bf16 v[168:171],v[212:215],v[20:23],v[168:171]
ds_read_b64_tr_b16 v[204:205],v241 offset:13056
ds_read_b64_tr_b16 v[206:207],v241 offset:15232
v_mfma_f32_16x16x32_bf16 v[176:179],v[208:211],v[8:11],0
s_add_u32 m0,s32,34816
s_mov_b32 s34,384
v_mfma_f32_16x16x32_bf16 v[176:179],v[212:215],v[24:27],v[176:179]
buffer_load_dwordx4 v235,s[24:27],s34 offen  lds
v_mfma_f32_16x16x32_bf16 v[184:187],v[208:211],v[12:15],0
s_waitcnt lgkmcnt(8)
v_mul_f32 v132,v132,v224
v_mfma_f32_16x16x32_bf16 v[184:187],v[212:215],v[28:31],v[184:187]
ds_read_b64_tr_b16 v[208:209],v240 offset:17408
ds_read_b64_tr_b16 v[210:211],v240 offset:19584
v_mfma_f32_16x16x32_bf16 v[164:167],v[216:219],v[0:3],0
s_add_u32 m0,s32,35904
s_mov_b32 s34,7552
v_mfma_f32_16x16x32_bf16 v[164:167],v[220:223],v[16:19],v[164:167]
buffer_load_dwordx4 v235,s[24:27],s34 offen  lds
v_mfma_f32_16x16x32_bf16 v[172:175],v[216:219],v[4:7],0
v_mul_f32 v133,v133,v224
v_cvt_pk_bf16_f32 v130,v132,v133
v_mfma_f32_16x16x32_bf16 v[172:175],v[220:223],v[20:23],v[172:175]
ds_read_b64_tr_b16 v[212:213],v240 offset:21760
ds_read_b64_tr_b16 v[214:215],v240 offset:23936
v_mfma_f32_16x16x32_bf16 v[180:183],v[216:219],v[8:11],0
s_add_u32 m0,s32,36992
s_mov_b32 s34,14720
v_mfma_f32_16x16x32_bf16 v[180:183],v[220:223],v[24:27],v[180:183]
buffer_load_dwordx4 v235,s[24:27],s34 offen  lds
v_mfma_f32_16x16x32_bf16 v[188:191],v[216:219],v[12:15],0
s_waitcnt lgkmcnt(8)
v_mul_f32 v134,v134,v224
v_mfma_f32_16x16x32_bf16 v[188:191],v[220:223],v[28:31],v[188:191]
ds_read_b64_tr_b16 v[216:217],v241 offset:17408
ds_read_b64_tr_b16 v[218:219],v241 offset:19584
v_mfma_f32_16x16x32_bf16 v[160:163],v[192:195],v[32:35],v[160:163]
s_add_u32 m0,s32,38080
s_mov_b32 s34,21888
v_mfma_f32_16x16x32_bf16 v[160:163],v[196:199],v[48:51],v[160:163]
buffer_load_dwordx4 v235,s[24:27],s34 offen  lds
v_mfma_f32_16x16x32_bf16 v[168:171],v[192:195],v[36:39],v[168:171]
v_mul_f32 v135,v135,v224
v_cvt_pk_bf16_f32 v131,v134,v135
v_mfma_f32_16x16x32_bf16 v[168:171],v[196:199],v[52:55],v[168:171]
ds_read_b64_tr_b16 v[220:221],v241 offset:21760
ds_read_b64_tr_b16 v[222:223],v241 offset:23936
v_mfma_f32_16x16x32_bf16 v[176:179],v[192:195],v[40:43],v[176:179]
buffer_store_dwordx4 v[128:131],v242,s[28:31],s55 offen offset:0 sc1
v_mfma_f32_16x16x32_bf16 v[176:179],v[196:199],v[56:59],v[176:179]
v_mul_f32 v136,v136,v225
v_mul_f32 v137,v137,v225
v_mfma_f32_16x16x32_bf16 v[184:187],v[192:195],v[44:47],v[184:187]
s_waitcnt lgkmcnt(8)
v_cvt_pk_bf16_f32 v136,v136,v137
v_mfma_f32_16x16x32_bf16 v[184:187],v[196:199],v[60:63],v[184:187]
ds_read_b64_tr_b16 v[192:193],v240 offset:26112
ds_read_b64_tr_b16 v[194:195],v240 offset:28288
v_mfma_f32_16x16x32_bf16 v[164:167],v[200:203],v[32:35],v[164:167]
v_mul_f32 v138,v138,v225
v_mul_f32 v139,v139,v225
v_mfma_f32_16x16x32_bf16 v[164:167],v[204:207],v[48:51],v[164:167]
v_cvt_pk_bf16_f32 v137,v138,v139
v_mul_f32 v140,v140,v225
v_mfma_f32_16x16x32_bf16 v[172:175],v[200:203],v[36:39],v[172:175]
v_mul_f32 v141,v141,v225
v_cvt_pk_bf16_f32 v138,v140,v141
v_mfma_f32_16x16x32_bf16 v[172:175],v[204:207],v[52:55],v[172:175]
ds_read_b64_tr_b16 v[196:197],v240 offset:30464
ds_read_b64_tr_b16 v[198:199],v240 offset:32640
v_mfma_f32_16x16x32_bf16 v[180:183],v[200:203],v[40:43],v[180:183]
v_mul_f32 v142,v142,v225
v_mul_f32 v143,v143,v225
v_mfma_f32_16x16x32_bf16 v[180:183],v[204:207],v[56:59],v[180:183]
v_cvt_pk_bf16_f32 v139,v142,v143
v_mul_f32 v144,v144,v226
v_mfma_f32_16x16x32_bf16 v[188:191],v[200:203],v[44:47],v[188:191]
s_waitcnt lgkmcnt(8)
v_mul_f32 v145,v145,v226
v_mfma_f32_16x16x32_bf16 v[188:191],v[204:207],v[60:63],v[188:191]
ds_read_b64_tr_b16 v[200:201],v241 offset:26112
ds_read_b64_tr_b16 v[202:203],v241 offset:28288
v_mfma_f32_16x16x32_bf16 v[160:163],v[208:211],v[64:67],v[160:163]
buffer_store_dwordx4 v[136:139],v242,s[28:31],s55 offen offset:1024 sc1
v_mfma_f32_16x16x32_bf16 v[160:163],v[212:215],v[80:83],v[160:163]
v_cvt_pk_bf16_f32 v144,v144,v145
v_mul_f32 v146,v146,v226
v_mfma_f32_16x16x32_bf16 v[168:171],v[208:211],v[68:71],v[168:171]
v_mul_f32 v147,v147,v226
v_cvt_pk_bf16_f32 v145,v146,v147
v_mfma_f32_16x16x32_bf16 v[168:171],v[212:215],v[84:87],v[168:171]
ds_read_b64_tr_b16 v[204:205],v241 offset:30464
ds_read_b64_tr_b16 v[206:207],v241 offset:32640
v_mfma_f32_16x16x32_bf16 v[176:179],v[208:211],v[72:75],v[176:179]
v_subrev_u32 v240,121856,v240
v_subrev_u32 v241,121856,v241
v_mfma_f32_16x16x32_bf16 v[176:179],v[212:215],v[88:91],v[176:179]
v_mul_f32 v148,v148,v226
v_mul_f32 v149,v149,v226
v_mfma_f32_16x16x32_bf16 v[184:187],v[208:211],v[76:79],v[184:187]
s_waitcnt vmcnt(19) lgkmcnt(8)
s_barrier
v_mfma_f32_16x16x32_bf16 v[184:187],v[212:215],v[92:95],v[184:187]
ds_read_b64_tr_b16 v[208:209],v238 offset:0
ds_read_b64_tr_b16 v[210:211],v238 offset:2176
v_mfma_f32_16x16x32_bf16 v[164:167],v[216:219],v[64:67],v[164:167]
v_cvt_pk_bf16_f32 v146,v148,v149
v_mul_f32 v150,v150,v226
v_mfma_f32_16x16x32_bf16 v[164:167],v[220:223],v[80:83],v[164:167]
v_mul_f32 v151,v151,v226
v_cvt_pk_bf16_f32 v147,v150,v151
v_mfma_f32_16x16x32_bf16 v[172:175],v[216:219],v[68:71],v[172:175]
buffer_store_dwordx4 v[144:147],v242,s[28:31],s55 offen offset:2048 sc1
v_mfma_f32_16x16x32_bf16 v[172:175],v[220:223],v[84:87],v[172:175]
ds_read_b64_tr_b16 v[212:213],v238 offset:4352
ds_read_b64_tr_b16 v[214:215],v238 offset:6528
v_mfma_f32_16x16x32_bf16 v[180:183],v[216:219],v[72:75],v[180:183]
v_mul_f32 v152,v152,v227
v_mul_f32 v153,v153,v227
v_mfma_f32_16x16x32_bf16 v[180:183],v[220:223],v[88:91],v[180:183]
v_cvt_pk_bf16_f32 v152,v152,v153
v_mul_f32 v154,v154,v227
v_mfma_f32_16x16x32_bf16 v[188:191],v[216:219],v[76:79],v[188:191]
s_waitcnt lgkmcnt(8)
v_mul_f32 v155,v155,v227
v_mfma_f32_16x16x32_bf16 v[188:191],v[220:223],v[92:95],v[188:191]
ds_read_b64_tr_b16 v[216:217],v239 offset:0
ds_read_b64_tr_b16 v[218:219],v239 offset:2176
v_mfma_f32_16x16x32_bf16 v[160:163],v[192:195],v[96:99],v[160:163]
v_cvt_pk_bf16_f32 v153,v154,v155
v_mul_f32 v156,v156,v227
v_mfma_f32_16x16x32_bf16 v[160:163],v[196:199],v[112:115],v[160:163]
v_mul_f32 v157,v157,v227
v_cvt_pk_bf16_f32 v154,v156,v157
v_mfma_f32_16x16x32_bf16 v[168:171],v[192:195],v[100:103],v[168:171]
v_mul_f32 v158,v158,v227
v_mul_f32 v159,v159,v227
v_mfma_f32_16x16x32_bf16 v[168:171],v[196:199],v[116:119],v[168:171]
ds_read_b64_tr_b16 v[220:221],v239 offset:4352
ds_read_b64_tr_b16 v[222:223],v239 offset:6528
v_mfma_f32_16x16x32_bf16 v[176:179],v[192:195],v[104:107],v[176:179]
v_cvt_pk_bf16_f32 v155,v158,v159
v_mfma_f32_16x16x32_bf16 v[176:179],v[196:199],v[120:123],v[176:179]
buffer_store_dwordx4 v[152:155],v242,s[28:31],s55 offen offset:3072 sc1
v_mfma_f32_16x16x32_bf16 v[184:187],v[192:195],v[108:111],v[184:187]
s_waitcnt lgkmcnt(8)
s_add_u32 s55,s55,16384
v_mfma_f32_16x16x32_bf16 v[184:187],v[196:199],v[124:127],v[184:187]
ds_read_b64_tr_b16 v[192:193],v238 offset:8704
ds_read_b64_tr_b16 v[194:195],v238 offset:10880
v_mfma_f32_16x16x32_bf16 v[164:167],v[200:203],v[96:99],v[164:167]
v_mfma_f32_16x16x32_bf16 v[164:167],v[204:207],v[112:115],v[164:167]
v_mfma_f32_16x16x32_bf16 v[172:175],v[200:203],v[100:103],v[172:175]
v_mfma_f32_16x16x32_bf16 v[172:175],v[204:207],v[116:119],v[172:175]
ds_read_b64_tr_b16 v[196:197],v238 offset:13056
ds_read_b64_tr_b16 v[198:199],v238 offset:15232
v_mfma_f32_16x16x32_bf16 v[180:183],v[200:203],v[104:107],v[180:183]
v_mfma_f32_16x16x32_bf16 v[180:183],v[204:207],v[120:123],v[180:183]
v_mfma_f32_16x16x32_bf16 v[188:191],v[200:203],v[108:111],v[188:191]
s_waitcnt lgkmcnt(8)
v_mfma_f32_16x16x32_bf16 v[188:191],v[204:207],v[124:127],v[188:191]
ds_read_b64_tr_b16 v[200:201],v239 offset:8704
ds_read_b64_tr_b16 v[202:203],v239 offset:10880
v_mfma_f32_16x16x32_bf16 v[128:131],v[208:211],v[0:3],0
v_mul_f32 v160,v160,v224
v_mul_f32 v161,v161,v224
v_mfma_f32_16x16x32_bf16 v[128:131],v[212:215],v[16:19],v[128:131]
v_cvt_pk_bf16_f32 v160,v160,v161
v_mul_f32 v162,v162,v224
v_mfma_f32_16x16x32_bf16 v[136:139],v[208:211],v[4:7],0
v_mul_f32 v163,v163,v224
v_cvt_pk_bf16_f32 v161,v162,v163
v_mfma_f32_16x16x32_bf16 v[136:139],v[212:215],v[20:23],v[136:139]
ds_read_b64_tr_b16 v[204:205],v239 offset:13056
ds_read_b64_tr_b16 v[206:207],v239 offset:15232
v_mfma_f32_16x16x32_bf16 v[144:147],v[208:211],v[8:11],0
s_add_u32 m0,s32,52224
s_mov_b32 s34,115072
v_mfma_f32_16x16x32_bf16 v[144:147],v[212:215],v[24:27],v[144:147]
buffer_load_dwordx4 v235,s[24:27],s34 offen  lds
v_mfma_f32_16x16x32_bf16 v[152:155],v[208:211],v[12:15],0
s_waitcnt lgkmcnt(8)
v_mul_f32 v164,v164,v224
v_mfma_f32_16x16x32_bf16 v[152:155],v[212:215],v[28:31],v[152:155]
ds_read_b64_tr_b16 v[208:209],v238 offset:17408
ds_read_b64_tr_b16 v[210:211],v238 offset:19584
v_mfma_f32_16x16x32_bf16 v[132:135],v[216:219],v[0:3],0
s_add_u32 m0,s32,53312
s_mov_b32 s34,122240
v_mfma_f32_16x16x32_bf16 v[132:135],v[220:223],v[16:19],v[132:135]
buffer_load_dwordx4 v235,s[24:27],s34 offen  lds
v_mfma_f32_16x16x32_bf16 v[140:143],v[216:219],v[4:7],0
v_mul_f32 v165,v165,v224
v_cvt_pk_bf16_f32 v162,v164,v165
v_mfma_f32_16x16x32_bf16 v[140:143],v[220:223],v[20:23],v[140:143]
ds_read_b64_tr_b16 v[212:213],v238 offset:21760
ds_read_b64_tr_b16 v[214:215],v238 offset:23936
v_mfma_f32_16x16x32_bf16 v[148:151],v[216:219],v[8:11],0
s_add_u32 m0,s32,54400
s_mov_b32 s34,129408
v_mfma_f32_16x16x32_bf16 v[148:151],v[220:223],v[24:27],v[148:151]
buffer_load_dwordx4 v235,s[24:27],s34 offen  lds
v_mfma_f32_16x16x32_bf16 v[156:159],v[216:219],v[12:15],0
s_waitcnt lgkmcnt(8)
v_mul_f32 v166,v166,v224
v_mfma_f32_16x16x32_bf16 v[156:159],v[220:223],v[28:31],v[156:159]
ds_read_b64_tr_b16 v[216:217],v239 offset:17408
ds_read_b64_tr_b16 v[218:219],v239 offset:19584
v_mfma_f32_16x16x32_bf16 v[128:131],v[192:195],v[32:35],v[128:131]
s_add_u32 m0,s32,55488
s_mov_b32 s34,136576
v_mfma_f32_16x16x32_bf16 v[128:131],v[196:199],v[48:51],v[128:131]
buffer_load_dwordx4 v235,s[24:27],s34 offen  lds
v_mfma_f32_16x16x32_bf16 v[136:139],v[192:195],v[36:39],v[136:139]
v_mul_f32 v167,v167,v224
v_cvt_pk_bf16_f32 v163,v166,v167
v_mfma_f32_16x16x32_bf16 v[136:139],v[196:199],v[52:55],v[136:139]
ds_read_b64_tr_b16 v[220:221],v239 offset:21760
ds_read_b64_tr_b16 v[222:223],v239 offset:23936
v_mfma_f32_16x16x32_bf16 v[144:147],v[192:195],v[40:43],v[144:147]
buffer_store_dwordx4 v[160:163],v242,s[28:31],s55 offen offset:0 sc1
v_mfma_f32_16x16x32_bf16 v[144:147],v[196:199],v[56:59],v[144:147]
v_mul_f32 v168,v168,v225
v_mul_f32 v169,v169,v225
v_mfma_f32_16x16x32_bf16 v[152:155],v[192:195],v[44:47],v[152:155]
s_waitcnt lgkmcnt(8)
v_cvt_pk_bf16_f32 v168,v168,v169
v_mfma_f32_16x16x32_bf16 v[152:155],v[196:199],v[60:63],v[152:155]
ds_read_b64_tr_b16 v[192:193],v238 offset:26112
ds_read_b64_tr_b16 v[194:195],v238 offset:28288
v_mfma_f32_16x16x32_bf16 v[132:135],v[200:203],v[32:35],v[132:135]
v_mul_f32 v170,v170,v225
v_mul_f32 v171,v171,v225
v_mfma_f32_16x16x32_bf16 v[132:135],v[204:207],v[48:51],v[132:135]
v_cvt_pk_bf16_f32 v169,v170,v171
v_mul_f32 v172,v172,v225
v_mfma_f32_16x16x32_bf16 v[140:143],v[200:203],v[36:39],v[140:143]
v_mul_f32 v173,v173,v225
v_cvt_pk_bf16_f32 v170,v172,v173
v_mfma_f32_16x16x32_bf16 v[140:143],v[204:207],v[52:55],v[140:143]
ds_read_b64_tr_b16 v[196:197],v238 offset:30464
ds_read_b64_tr_b16 v[198:199],v238 offset:32640
v_mfma_f32_16x16x32_bf16 v[148:151],v[200:203],v[40:43],v[148:151]
v_mul_f32 v174,v174,v225
v_mul_f32 v175,v175,v225
v_mfma_f32_16x16x32_bf16 v[148:151],v[204:207],v[56:59],v[148:151]
v_cvt_pk_bf16_f32 v171,v174,v175
v_mul_f32 v176,v176,v226
v_mfma_f32_16x16x32_bf16 v[156:159],v[200:203],v[44:47],v[156:159]
s_waitcnt lgkmcnt(8)
v_mul_f32 v177,v177,v226
v_mfma_f32_16x16x32_bf16 v[156:159],v[204:207],v[60:63],v[156:159]
ds_read_b64_tr_b16 v[200:201],v239 offset:26112
ds_read_b64_tr_b16 v[202:203],v239 offset:28288
v_mfma_f32_16x16x32_bf16 v[128:131],v[208:211],v[64:67],v[128:131]
buffer_store_dwordx4 v[168:171],v242,s[28:31],s55 offen offset:1024 sc1
v_mfma_f32_16x16x32_bf16 v[128:131],v[212:215],v[80:83],v[128:131]
v_cvt_pk_bf16_f32 v176,v176,v177
v_mul_f32 v178,v178,v226
v_mfma_f32_16x16x32_bf16 v[136:139],v[208:211],v[68:71],v[136:139]
v_mul_f32 v179,v179,v226
v_cvt_pk_bf16_f32 v177,v178,v179
v_mfma_f32_16x16x32_bf16 v[136:139],v[212:215],v[84:87],v[136:139]
ds_read_b64_tr_b16 v[204:205],v239 offset:30464
ds_read_b64_tr_b16 v[206:207],v239 offset:32640
v_mfma_f32_16x16x32_bf16 v[144:147],v[208:211],v[72:75],v[144:147]
v_add_u32 v238,69632,v238
v_add_u32 v239,69632,v239
v_mfma_f32_16x16x32_bf16 v[144:147],v[212:215],v[88:91],v[144:147]
v_mul_f32 v180,v180,v226
v_mul_f32 v181,v181,v226
v_mfma_f32_16x16x32_bf16 v[152:155],v[208:211],v[76:79],v[152:155]
s_waitcnt lgkmcnt(8)
v_cvt_pk_bf16_f32 v178,v180,v181
v_mfma_f32_16x16x32_bf16 v[152:155],v[212:215],v[92:95],v[152:155]
ds_read_b64_tr_b16 v[208:209],v240 offset:0
ds_read_b64_tr_b16 v[210:211],v240 offset:2176
v_mfma_f32_16x16x32_bf16 v[132:135],v[216:219],v[64:67],v[132:135]
v_mul_f32 v182,v182,v226
v_mul_f32 v183,v183,v226
v_mfma_f32_16x16x32_bf16 v[132:135],v[220:223],v[80:83],v[132:135]
v_cvt_pk_bf16_f32 v179,v182,v183
v_mul_f32 v184,v184,v227
v_mfma_f32_16x16x32_bf16 v[140:143],v[216:219],v[68:71],v[140:143]
buffer_store_dwordx4 v[176:179],v242,s[28:31],s55 offen offset:2048 sc1
v_mfma_f32_16x16x32_bf16 v[140:143],v[220:223],v[84:87],v[140:143]
ds_read_b64_tr_b16 v[212:213],v240 offset:4352
ds_read_b64_tr_b16 v[214:215],v240 offset:6528
v_mfma_f32_16x16x32_bf16 v[148:151],v[216:219],v[72:75],v[148:151]
v_mul_f32 v185,v185,v227
v_cvt_pk_bf16_f32 v184,v184,v185
v_mfma_f32_16x16x32_bf16 v[148:151],v[220:223],v[88:91],v[148:151]
v_mul_f32 v186,v186,v227
v_mul_f32 v187,v187,v227
v_mfma_f32_16x16x32_bf16 v[156:159],v[216:219],v[76:79],v[156:159]
s_waitcnt lgkmcnt(8)
v_cvt_pk_bf16_f32 v185,v186,v187
v_mfma_f32_16x16x32_bf16 v[156:159],v[220:223],v[92:95],v[156:159]
ds_read_b64_tr_b16 v[216:217],v241 offset:0
ds_read_b64_tr_b16 v[218:219],v241 offset:2176
v_mfma_f32_16x16x32_bf16 v[128:131],v[192:195],v[96:99],v[128:131]
v_mul_f32 v188,v188,v227
v_mul_f32 v189,v189,v227
v_mfma_f32_16x16x32_bf16 v[128:131],v[196:199],v[112:115],v[128:131]
v_cvt_pk_bf16_f32 v186,v188,v189
v_mul_f32 v190,v190,v227
v_mfma_f32_16x16x32_bf16 v[136:139],v[192:195],v[100:103],v[136:139]
v_mul_f32 v191,v191,v227
v_cvt_pk_bf16_f32 v187,v190,v191
v_mfma_f32_16x16x32_bf16 v[136:139],v[196:199],v[116:119],v[136:139]
ds_read_b64_tr_b16 v[220:221],v241 offset:4352
ds_read_b64_tr_b16 v[222:223],v241 offset:6528
v_mfma_f32_16x16x32_bf16 v[144:147],v[192:195],v[104:107],v[144:147]
buffer_store_dwordx4 v[184:187],v242,s[28:31],s55 offen offset:3072 sc1
v_mfma_f32_16x16x32_bf16 v[144:147],v[196:199],v[120:123],v[144:147]
s_add_u32 s55,s55,16384
v_mfma_f32_16x16x32_bf16 v[152:155],v[192:195],v[108:111],v[152:155]
s_waitcnt lgkmcnt(8)
v_mfma_f32_16x16x32_bf16 v[152:155],v[196:199],v[124:127],v[152:155]
ds_read_b64_tr_b16 v[192:193],v240 offset:8704
ds_read_b64_tr_b16 v[194:195],v240 offset:10880
v_mfma_f32_16x16x32_bf16 v[132:135],v[200:203],v[96:99],v[132:135]
v_mfma_f32_16x16x32_bf16 v[132:135],v[204:207],v[112:115],v[132:135]
v_mfma_f32_16x16x32_bf16 v[140:143],v[200:203],v[100:103],v[140:143]
v_mfma_f32_16x16x32_bf16 v[140:143],v[204:207],v[116:119],v[140:143]
ds_read_b64_tr_b16 v[196:197],v240 offset:13056
ds_read_b64_tr_b16 v[198:199],v240 offset:15232
v_mfma_f32_16x16x32_bf16 v[148:151],v[200:203],v[104:107],v[148:151]
v_mfma_f32_16x16x32_bf16 v[148:151],v[204:207],v[120:123],v[148:151]
v_mfma_f32_16x16x32_bf16 v[156:159],v[200:203],v[108:111],v[156:159]
s_waitcnt lgkmcnt(8)
v_mfma_f32_16x16x32_bf16 v[156:159],v[204:207],v[124:127],v[156:159]
ds_read_b64_tr_b16 v[200:201],v241 offset:8704
ds_read_b64_tr_b16 v[202:203],v241 offset:10880
v_mfma_f32_16x16x32_bf16 v[160:163],v[208:211],v[0:3],0
v_mul_f32 v128,v128,v224
v_mul_f32 v129,v129,v224
v_mfma_f32_16x16x32_bf16 v[160:163],v[212:215],v[16:19],v[160:163]
v_cvt_pk_bf16_f32 v128,v128,v129
v_mul_f32 v130,v130,v224
v_mfma_f32_16x16x32_bf16 v[168:171],v[208:211],v[4:7],0
v_mul_f32 v131,v131,v224
v_cvt_pk_bf16_f32 v129,v130,v131
v_mfma_f32_16x16x32_bf16 v[168:171],v[212:215],v[20:23],v[168:171]
ds_read_b64_tr_b16 v[204:205],v241 offset:13056
ds_read_b64_tr_b16 v[206:207],v241 offset:15232
v_mfma_f32_16x16x32_bf16 v[176:179],v[208:211],v[8:11],0
s_add_u32 m0,s32,121856
s_mov_b32 s34,512
v_mfma_f32_16x16x32_bf16 v[176:179],v[212:215],v[24:27],v[176:179]
buffer_load_dwordx4 v235,s[24:27],s34 offen  lds
v_mfma_f32_16x16x32_bf16 v[184:187],v[208:211],v[12:15],0
s_waitcnt lgkmcnt(8)
v_mul_f32 v132,v132,v224
v_mfma_f32_16x16x32_bf16 v[184:187],v[212:215],v[28:31],v[184:187]
ds_read_b64_tr_b16 v[208:209],v240 offset:17408
ds_read_b64_tr_b16 v[210:211],v240 offset:19584
v_mfma_f32_16x16x32_bf16 v[164:167],v[216:219],v[0:3],0
s_add_u32 m0,s32,122944
s_mov_b32 s34,7680
v_mfma_f32_16x16x32_bf16 v[164:167],v[220:223],v[16:19],v[164:167]
buffer_load_dwordx4 v235,s[24:27],s34 offen  lds
v_mfma_f32_16x16x32_bf16 v[172:175],v[216:219],v[4:7],0
v_mul_f32 v133,v133,v224
v_cvt_pk_bf16_f32 v130,v132,v133
v_mfma_f32_16x16x32_bf16 v[172:175],v[220:223],v[20:23],v[172:175]
ds_read_b64_tr_b16 v[212:213],v240 offset:21760
ds_read_b64_tr_b16 v[214:215],v240 offset:23936
v_mfma_f32_16x16x32_bf16 v[180:183],v[216:219],v[8:11],0
s_add_u32 m0,s32,124032
s_mov_b32 s34,14848
v_mfma_f32_16x16x32_bf16 v[180:183],v[220:223],v[24:27],v[180:183]
buffer_load_dwordx4 v235,s[24:27],s34 offen  lds
v_mfma_f32_16x16x32_bf16 v[188:191],v[216:219],v[12:15],0
s_waitcnt lgkmcnt(8)
v_mul_f32 v134,v134,v224
v_mfma_f32_16x16x32_bf16 v[188:191],v[220:223],v[28:31],v[188:191]
ds_read_b64_tr_b16 v[216:217],v241 offset:17408
ds_read_b64_tr_b16 v[218:219],v241 offset:19584
v_mfma_f32_16x16x32_bf16 v[160:163],v[192:195],v[32:35],v[160:163]
s_add_u32 m0,s32,125120
s_mov_b32 s34,22016
v_mfma_f32_16x16x32_bf16 v[160:163],v[196:199],v[48:51],v[160:163]
buffer_load_dwordx4 v235,s[24:27],s34 offen  lds
v_mfma_f32_16x16x32_bf16 v[168:171],v[192:195],v[36:39],v[168:171]
v_mul_f32 v135,v135,v224
v_cvt_pk_bf16_f32 v131,v134,v135
v_mfma_f32_16x16x32_bf16 v[168:171],v[196:199],v[52:55],v[168:171]
ds_read_b64_tr_b16 v[220:221],v241 offset:21760
ds_read_b64_tr_b16 v[222:223],v241 offset:23936
v_mfma_f32_16x16x32_bf16 v[176:179],v[192:195],v[40:43],v[176:179]
buffer_store_dwordx4 v[128:131],v242,s[28:31],s55 offen offset:0 sc1
v_mfma_f32_16x16x32_bf16 v[176:179],v[196:199],v[56:59],v[176:179]
v_mul_f32 v136,v136,v225
v_mul_f32 v137,v137,v225
v_mfma_f32_16x16x32_bf16 v[184:187],v[192:195],v[44:47],v[184:187]
s_waitcnt lgkmcnt(8)
v_cvt_pk_bf16_f32 v136,v136,v137
v_mfma_f32_16x16x32_bf16 v[184:187],v[196:199],v[60:63],v[184:187]
ds_read_b64_tr_b16 v[192:193],v240 offset:26112
ds_read_b64_tr_b16 v[194:195],v240 offset:28288
v_mfma_f32_16x16x32_bf16 v[164:167],v[200:203],v[32:35],v[164:167]
v_mul_f32 v138,v138,v225
v_mul_f32 v139,v139,v225
v_mfma_f32_16x16x32_bf16 v[164:167],v[204:207],v[48:51],v[164:167]
v_cvt_pk_bf16_f32 v137,v138,v139
v_mul_f32 v140,v140,v225
v_mfma_f32_16x16x32_bf16 v[172:175],v[200:203],v[36:39],v[172:175]
v_mul_f32 v141,v141,v225
v_cvt_pk_bf16_f32 v138,v140,v141
v_mfma_f32_16x16x32_bf16 v[172:175],v[204:207],v[52:55],v[172:175]
ds_read_b64_tr_b16 v[196:197],v240 offset:30464
ds_read_b64_tr_b16 v[198:199],v240 offset:32640
v_mfma_f32_16x16x32_bf16 v[180:183],v[200:203],v[40:43],v[180:183]
v_mul_f32 v142,v142,v225
v_mul_f32 v143,v143,v225
v_mfma_f32_16x16x32_bf16 v[180:183],v[204:207],v[56:59],v[180:183]
v_cvt_pk_bf16_f32 v139,v142,v143
v_mul_f32 v144,v144,v226
v_mfma_f32_16x16x32_bf16 v[188:191],v[200:203],v[44:47],v[188:191]
s_waitcnt lgkmcnt(8)
v_mul_f32 v145,v145,v226
v_mfma_f32_16x16x32_bf16 v[188:191],v[204:207],v[60:63],v[188:191]
ds_read_b64_tr_b16 v[200:201],v241 offset:26112
ds_read_b64_tr_b16 v[202:203],v241 offset:28288
v_mfma_f32_16x16x32_bf16 v[160:163],v[208:211],v[64:67],v[160:163]
buffer_store_dwordx4 v[136:139],v242,s[28:31],s55 offen offset:1024 sc1
v_mfma_f32_16x16x32_bf16 v[160:163],v[212:215],v[80:83],v[160:163]
v_cvt_pk_bf16_f32 v144,v144,v145
v_mul_f32 v146,v146,v226
v_mfma_f32_16x16x32_bf16 v[168:171],v[208:211],v[68:71],v[168:171]
v_mul_f32 v147,v147,v226
v_cvt_pk_bf16_f32 v145,v146,v147
v_mfma_f32_16x16x32_bf16 v[168:171],v[212:215],v[84:87],v[168:171]
ds_read_b64_tr_b16 v[204:205],v241 offset:30464
ds_read_b64_tr_b16 v[206:207],v241 offset:32640
v_mfma_f32_16x16x32_bf16 v[176:179],v[208:211],v[72:75],v[176:179]
v_add_u32 v240,69632,v240
v_add_u32 v241,69632,v241
v_mfma_f32_16x16x32_bf16 v[176:179],v[212:215],v[88:91],v[176:179]
v_mul_f32 v148,v148,v226
v_mul_f32 v149,v149,v226
v_mfma_f32_16x16x32_bf16 v[184:187],v[208:211],v[76:79],v[184:187]
s_waitcnt vmcnt(22) lgkmcnt(8)
s_barrier
v_mfma_f32_16x16x32_bf16 v[184:187],v[212:215],v[92:95],v[184:187]
ds_read_b64_tr_b16 v[208:209],v238 offset:0
ds_read_b64_tr_b16 v[210:211],v238 offset:2176
v_mfma_f32_16x16x32_bf16 v[164:167],v[216:219],v[64:67],v[164:167]
v_cvt_pk_bf16_f32 v146,v148,v149
v_mul_f32 v150,v150,v226
v_mfma_f32_16x16x32_bf16 v[164:167],v[220:223],v[80:83],v[164:167]
v_mul_f32 v151,v151,v226
v_cvt_pk_bf16_f32 v147,v150,v151
v_mfma_f32_16x16x32_bf16 v[172:175],v[216:219],v[68:71],v[172:175]
buffer_store_dwordx4 v[144:147],v242,s[28:31],s55 offen offset:2048 sc1
v_mfma_f32_16x16x32_bf16 v[172:175],v[220:223],v[84:87],v[172:175]
ds_read_b64_tr_b16 v[212:213],v238 offset:4352
ds_read_b64_tr_b16 v[214:215],v238 offset:6528
v_mfma_f32_16x16x32_bf16 v[180:183],v[216:219],v[72:75],v[180:183]
v_mul_f32 v152,v152,v227
v_mul_f32 v153,v153,v227
v_mfma_f32_16x16x32_bf16 v[180:183],v[220:223],v[88:91],v[180:183]
v_cvt_pk_bf16_f32 v152,v152,v153
v_mul_f32 v154,v154,v227
v_mfma_f32_16x16x32_bf16 v[188:191],v[216:219],v[76:79],v[188:191]
s_waitcnt lgkmcnt(8)
v_mul_f32 v155,v155,v227
v_mfma_f32_16x16x32_bf16 v[188:191],v[220:223],v[92:95],v[188:191]
ds_read_b64_tr_b16 v[216:217],v239 offset:0
ds_read_b64_tr_b16 v[218:219],v239 offset:2176
v_mfma_f32_16x16x32_bf16 v[160:163],v[192:195],v[96:99],v[160:163]
v_cvt_pk_bf16_f32 v153,v154,v155
v_mul_f32 v156,v156,v227
v_mfma_f32_16x16x32_bf16 v[160:163],v[196:199],v[112:115],v[160:163]
v_mul_f32 v157,v157,v227
v_cvt_pk_bf16_f32 v154,v156,v157
v_mfma_f32_16x16x32_bf16 v[168:171],v[192:195],v[100:103],v[168:171]
v_mul_f32 v158,v158,v227
v_mul_f32 v159,v159,v227
v_mfma_f32_16x16x32_bf16 v[168:171],v[196:199],v[116:119],v[168:171]
ds_read_b64_tr_b16 v[220:221],v239 offset:4352
ds_read_b64_tr_b16 v[222:223],v239 offset:6528
v_mfma_f32_16x16x32_bf16 v[176:179],v[192:195],v[104:107],v[176:179]
v_cvt_pk_bf16_f32 v155,v158,v159
v_mfma_f32_16x16x32_bf16 v[176:179],v[196:199],v[120:123],v[176:179]
buffer_store_dwordx4 v[152:155],v242,s[28:31],s55 offen offset:3072 sc1
v_mfma_f32_16x16x32_bf16 v[184:187],v[192:195],v[108:111],v[184:187]
s_waitcnt lgkmcnt(8)
s_add_u32 s55,s55,16384
v_mfma_f32_16x16x32_bf16 v[184:187],v[196:199],v[124:127],v[184:187]
ds_read_b64_tr_b16 v[192:193],v238 offset:8704
ds_read_b64_tr_b16 v[194:195],v238 offset:10880
v_mfma_f32_16x16x32_bf16 v[164:167],v[200:203],v[96:99],v[164:167]
v_mfma_f32_16x16x32_bf16 v[164:167],v[204:207],v[112:115],v[164:167]
v_mfma_f32_16x16x32_bf16 v[172:175],v[200:203],v[100:103],v[172:175]
v_mfma_f32_16x16x32_bf16 v[172:175],v[204:207],v[116:119],v[172:175]
ds_read_b64_tr_b16 v[196:197],v238 offset:13056
ds_read_b64_tr_b16 v[198:199],v238 offset:15232
v_mfma_f32_16x16x32_bf16 v[180:183],v[200:203],v[104:107],v[180:183]
v_mfma_f32_16x16x32_bf16 v[180:183],v[204:207],v[120:123],v[180:183]
v_mfma_f32_16x16x32_bf16 v[188:191],v[200:203],v[108:111],v[188:191]
s_waitcnt lgkmcnt(8)
v_mfma_f32_16x16x32_bf16 v[188:191],v[204:207],v[124:127],v[188:191]
ds_read_b64_tr_b16 v[200:201],v239 offset:8704
ds_read_b64_tr_b16 v[202:203],v239 offset:10880
v_mfma_f32_16x16x32_bf16 v[128:131],v[208:211],v[0:3],0
v_mul_f32 v160,v160,v224
v_mul_f32 v161,v161,v224
v_mfma_f32_16x16x32_bf16 v[128:131],v[212:215],v[16:19],v[128:131]
v_cvt_pk_bf16_f32 v160,v160,v161
v_mul_f32 v162,v162,v224
v_mfma_f32_16x16x32_bf16 v[136:139],v[208:211],v[4:7],0
v_mul_f32 v163,v163,v224
v_cvt_pk_bf16_f32 v161,v162,v163
v_mfma_f32_16x16x32_bf16 v[136:139],v[212:215],v[20:23],v[136:139]
ds_read_b64_tr_b16 v[204:205],v239 offset:13056
ds_read_b64_tr_b16 v[206:207],v239 offset:15232
v_mfma_f32_16x16x32_bf16 v[144:147],v[208:211],v[8:11],0
s_add_u32 m0,s32,139264
s_mov_b32 s34,115200
v_mfma_f32_16x16x32_bf16 v[144:147],v[212:215],v[24:27],v[144:147]
buffer_load_dwordx4 v235,s[24:27],s34 offen  lds
v_mfma_f32_16x16x32_bf16 v[152:155],v[208:211],v[12:15],0
s_waitcnt lgkmcnt(8)
v_mul_f32 v164,v164,v224
v_mfma_f32_16x16x32_bf16 v[152:155],v[212:215],v[28:31],v[152:155]
ds_read_b64_tr_b16 v[208:209],v238 offset:17408
ds_read_b64_tr_b16 v[210:211],v238 offset:19584
v_mfma_f32_16x16x32_bf16 v[132:135],v[216:219],v[0:3],0
s_add_u32 m0,s32,140352
s_mov_b32 s34,122368
v_mfma_f32_16x16x32_bf16 v[132:135],v[220:223],v[16:19],v[132:135]
buffer_load_dwordx4 v235,s[24:27],s34 offen  lds
v_mfma_f32_16x16x32_bf16 v[140:143],v[216:219],v[4:7],0
v_mul_f32 v165,v165,v224
v_cvt_pk_bf16_f32 v162,v164,v165
v_mfma_f32_16x16x32_bf16 v[140:143],v[220:223],v[20:23],v[140:143]
ds_read_b64_tr_b16 v[212:213],v238 offset:21760
ds_read_b64_tr_b16 v[214:215],v238 offset:23936
v_mfma_f32_16x16x32_bf16 v[148:151],v[216:219],v[8:11],0
s_add_u32 m0,s32,141440
s_mov_b32 s34,129536
v_mfma_f32_16x16x32_bf16 v[148:151],v[220:223],v[24:27],v[148:151]
buffer_load_dwordx4 v235,s[24:27],s34 offen  lds
v_mfma_f32_16x16x32_bf16 v[156:159],v[216:219],v[12:15],0
s_waitcnt lgkmcnt(8)
v_mul_f32 v166,v166,v224
v_mfma_f32_16x16x32_bf16 v[156:159],v[220:223],v[28:31],v[156:159]
ds_read_b64_tr_b16 v[216:217],v239 offset:17408
ds_read_b64_tr_b16 v[218:219],v239 offset:19584
v_mfma_f32_16x16x32_bf16 v[128:131],v[192:195],v[32:35],v[128:131]
s_add_u32 m0,s32,142528
s_mov_b32 s34,136704
v_mfma_f32_16x16x32_bf16 v[128:131],v[196:199],v[48:51],v[128:131]
buffer_load_dwordx4 v235,s[24:27],s34 offen  lds
v_mfma_f32_16x16x32_bf16 v[136:139],v[192:195],v[36:39],v[136:139]
v_mul_f32 v167,v167,v224
v_cvt_pk_bf16_f32 v163,v166,v167
v_mfma_f32_16x16x32_bf16 v[136:139],v[196:199],v[52:55],v[136:139]
ds_read_b64_tr_b16 v[220:221],v239 offset:21760
ds_read_b64_tr_b16 v[222:223],v239 offset:23936
v_mfma_f32_16x16x32_bf16 v[144:147],v[192:195],v[40:43],v[144:147]
buffer_store_dwordx4 v[160:163],v242,s[28:31],s55 offen offset:0 sc1
v_mfma_f32_16x16x32_bf16 v[144:147],v[196:199],v[56:59],v[144:147]
v_mul_f32 v168,v168,v225
v_mul_f32 v169,v169,v225
v_mfma_f32_16x16x32_bf16 v[152:155],v[192:195],v[44:47],v[152:155]
s_waitcnt lgkmcnt(8)
v_cvt_pk_bf16_f32 v168,v168,v169
v_mfma_f32_16x16x32_bf16 v[152:155],v[196:199],v[60:63],v[152:155]
ds_read_b64_tr_b16 v[192:193],v238 offset:26112
ds_read_b64_tr_b16 v[194:195],v238 offset:28288
v_mfma_f32_16x16x32_bf16 v[132:135],v[200:203],v[32:35],v[132:135]
v_mul_f32 v170,v170,v225
v_mul_f32 v171,v171,v225
v_mfma_f32_16x16x32_bf16 v[132:135],v[204:207],v[48:51],v[132:135]
v_cvt_pk_bf16_f32 v169,v170,v171
v_mul_f32 v172,v172,v225
v_mfma_f32_16x16x32_bf16 v[140:143],v[200:203],v[36:39],v[140:143]
v_mul_f32 v173,v173,v225
v_cvt_pk_bf16_f32 v170,v172,v173
v_mfma_f32_16x16x32_bf16 v[140:143],v[204:207],v[52:55],v[140:143]
ds_read_b64_tr_b16 v[196:197],v238 offset:30464
ds_read_b64_tr_b16 v[198:199],v238 offset:32640
v_mfma_f32_16x16x32_bf16 v[148:151],v[200:203],v[40:43],v[148:151]
v_mul_f32 v174,v174,v225
v_mul_f32 v175,v175,v225
v_mfma_f32_16x16x32_bf16 v[148:151],v[204:207],v[56:59],v[148:151]
v_cvt_pk_bf16_f32 v171,v174,v175
v_mul_f32 v176,v176,v226
v_mfma_f32_16x16x32_bf16 v[156:159],v[200:203],v[44:47],v[156:159]
s_waitcnt lgkmcnt(8)
v_mul_f32 v177,v177,v226
v_mfma_f32_16x16x32_bf16 v[156:159],v[204:207],v[60:63],v[156:159]
ds_read_b64_tr_b16 v[200:201],v239 offset:26112
ds_read_b64_tr_b16 v[202:203],v239 offset:28288
v_mfma_f32_16x16x32_bf16 v[128:131],v[208:211],v[64:67],v[128:131]
buffer_store_dwordx4 v[168:171],v242,s[28:31],s55 offen offset:1024 sc1
v_mfma_f32_16x16x32_bf16 v[128:131],v[212:215],v[80:83],v[128:131]
v_cvt_pk_bf16_f32 v176,v176,v177
v_mul_f32 v178,v178,v226
v_mfma_f32_16x16x32_bf16 v[136:139],v[208:211],v[68:71],v[136:139]
v_mul_f32 v179,v179,v226
v_cvt_pk_bf16_f32 v177,v178,v179
v_mfma_f32_16x16x32_bf16 v[136:139],v[212:215],v[84:87],v[136:139]
ds_read_b64_tr_b16 v[204:205],v239 offset:30464
ds_read_b64_tr_b16 v[206:207],v239 offset:32640
v_mfma_f32_16x16x32_bf16 v[144:147],v[208:211],v[72:75],v[144:147]
v_subrev_u32 v238,34816,v238
v_subrev_u32 v239,34816,v239
v_mfma_f32_16x16x32_bf16 v[144:147],v[212:215],v[88:91],v[144:147]
v_mul_f32 v180,v180,v226
v_mul_f32 v181,v181,v226
v_mfma_f32_16x16x32_bf16 v[152:155],v[208:211],v[76:79],v[152:155]
s_waitcnt lgkmcnt(8)
v_cvt_pk_bf16_f32 v178,v180,v181
v_mfma_f32_16x16x32_bf16 v[152:155],v[212:215],v[92:95],v[152:155]
ds_read_b64_tr_b16 v[208:209],v240 offset:0
ds_read_b64_tr_b16 v[210:211],v240 offset:2176
v_mfma_f32_16x16x32_bf16 v[132:135],v[216:219],v[64:67],v[132:135]
v_mul_f32 v182,v182,v226
v_mul_f32 v183,v183,v226
v_mfma_f32_16x16x32_bf16 v[132:135],v[220:223],v[80:83],v[132:135]
v_cvt_pk_bf16_f32 v179,v182,v183
v_mul_f32 v184,v184,v227
v_mfma_f32_16x16x32_bf16 v[140:143],v[216:219],v[68:71],v[140:143]
buffer_store_dwordx4 v[176:179],v242,s[28:31],s55 offen offset:2048 sc1
v_mfma_f32_16x16x32_bf16 v[140:143],v[220:223],v[84:87],v[140:143]
ds_read_b64_tr_b16 v[212:213],v240 offset:4352
ds_read_b64_tr_b16 v[214:215],v240 offset:6528
v_mfma_f32_16x16x32_bf16 v[148:151],v[216:219],v[72:75],v[148:151]
v_mul_f32 v185,v185,v227
v_cvt_pk_bf16_f32 v184,v184,v185
v_mfma_f32_16x16x32_bf16 v[148:151],v[220:223],v[88:91],v[148:151]
v_mul_f32 v186,v186,v227
v_mul_f32 v187,v187,v227
v_mfma_f32_16x16x32_bf16 v[156:159],v[216:219],v[76:79],v[156:159]
s_waitcnt lgkmcnt(8)
v_cvt_pk_bf16_f32 v185,v186,v187
v_mfma_f32_16x16x32_bf16 v[156:159],v[220:223],v[92:95],v[156:159]
ds_read_b64_tr_b16 v[216:217],v241 offset:0
ds_read_b64_tr_b16 v[218:219],v241 offset:2176
v_mfma_f32_16x16x32_bf16 v[128:131],v[192:195],v[96:99],v[128:131]
v_mul_f32 v188,v188,v227
v_mul_f32 v189,v189,v227
v_mfma_f32_16x16x32_bf16 v[128:131],v[196:199],v[112:115],v[128:131]
v_cvt_pk_bf16_f32 v186,v188,v189
v_mul_f32 v190,v190,v227
v_mfma_f32_16x16x32_bf16 v[136:139],v[192:195],v[100:103],v[136:139]
v_mul_f32 v191,v191,v227
v_cvt_pk_bf16_f32 v187,v190,v191
v_mfma_f32_16x16x32_bf16 v[136:139],v[196:199],v[116:119],v[136:139]
ds_read_b64_tr_b16 v[220:221],v241 offset:4352
ds_read_b64_tr_b16 v[222:223],v241 offset:6528
v_mfma_f32_16x16x32_bf16 v[144:147],v[192:195],v[104:107],v[144:147]
buffer_store_dwordx4 v[184:187],v242,s[28:31],s55 offen offset:3072 sc1
v_mfma_f32_16x16x32_bf16 v[144:147],v[196:199],v[120:123],v[144:147]
s_add_u32 s55,s55,16384
v_mfma_f32_16x16x32_bf16 v[152:155],v[192:195],v[108:111],v[152:155]
s_waitcnt lgkmcnt(8)
v_mfma_f32_16x16x32_bf16 v[152:155],v[196:199],v[124:127],v[152:155]
ds_read_b64_tr_b16 v[192:193],v240 offset:8704
ds_read_b64_tr_b16 v[194:195],v240 offset:10880
v_mfma_f32_16x16x32_bf16 v[132:135],v[200:203],v[96:99],v[132:135]
v_mfma_f32_16x16x32_bf16 v[132:135],v[204:207],v[112:115],v[132:135]
v_mfma_f32_16x16x32_bf16 v[140:143],v[200:203],v[100:103],v[140:143]
v_mfma_f32_16x16x32_bf16 v[140:143],v[204:207],v[116:119],v[140:143]
ds_read_b64_tr_b16 v[196:197],v240 offset:13056
ds_read_b64_tr_b16 v[198:199],v240 offset:15232
v_mfma_f32_16x16x32_bf16 v[148:151],v[200:203],v[104:107],v[148:151]
v_mfma_f32_16x16x32_bf16 v[148:151],v[204:207],v[120:123],v[148:151]
v_mfma_f32_16x16x32_bf16 v[156:159],v[200:203],v[108:111],v[156:159]
s_waitcnt lgkmcnt(8)
v_mfma_f32_16x16x32_bf16 v[156:159],v[204:207],v[124:127],v[156:159]
ds_read_b64_tr_b16 v[200:201],v241 offset:8704
ds_read_b64_tr_b16 v[202:203],v241 offset:10880
v_mfma_f32_16x16x32_bf16 v[160:163],v[208:211],v[0:3],0
v_mul_f32 v128,v128,v224
v_mul_f32 v129,v129,v224
v_mfma_f32_16x16x32_bf16 v[160:163],v[212:215],v[16:19],v[160:163]
v_cvt_pk_bf16_f32 v128,v128,v129
v_mul_f32 v130,v130,v224
v_mfma_f32_16x16x32_bf16 v[168:171],v[208:211],v[4:7],0
v_mul_f32 v131,v131,v224
v_cvt_pk_bf16_f32 v129,v130,v131
v_mfma_f32_16x16x32_bf16 v[168:171],v[212:215],v[20:23],v[168:171]
ds_read_b64_tr_b16 v[204:205],v241 offset:13056
ds_read_b64_tr_b16 v[206:207],v241 offset:15232
v_mfma_f32_16x16x32_bf16 v[176:179],v[208:211],v[8:11],0
s_add_u32 m0,s32,0
s_mov_b32 s34,640
v_mfma_f32_16x16x32_bf16 v[176:179],v[212:215],v[24:27],v[176:179]
buffer_load_dwordx4 v235,s[24:27],s34 offen  lds
v_mfma_f32_16x16x32_bf16 v[184:187],v[208:211],v[12:15],0
s_waitcnt lgkmcnt(8)
v_mul_f32 v132,v132,v224
v_mfma_f32_16x16x32_bf16 v[184:187],v[212:215],v[28:31],v[184:187]
ds_read_b64_tr_b16 v[208:209],v240 offset:17408
ds_read_b64_tr_b16 v[210:211],v240 offset:19584
v_mfma_f32_16x16x32_bf16 v[164:167],v[216:219],v[0:3],0
s_add_u32 m0,s32,1088
s_mov_b32 s34,7808
v_mfma_f32_16x16x32_bf16 v[164:167],v[220:223],v[16:19],v[164:167]
buffer_load_dwordx4 v235,s[24:27],s34 offen  lds
v_mfma_f32_16x16x32_bf16 v[172:175],v[216:219],v[4:7],0
v_mul_f32 v133,v133,v224
v_cvt_pk_bf16_f32 v130,v132,v133
v_mfma_f32_16x16x32_bf16 v[172:175],v[220:223],v[20:23],v[172:175]
ds_read_b64_tr_b16 v[212:213],v240 offset:21760
ds_read_b64_tr_b16 v[214:215],v240 offset:23936
v_mfma_f32_16x16x32_bf16 v[180:183],v[216:219],v[8:11],0
s_add_u32 m0,s32,2176
s_mov_b32 s34,14976
v_mfma_f32_16x16x32_bf16 v[180:183],v[220:223],v[24:27],v[180:183]
buffer_load_dwordx4 v235,s[24:27],s34 offen  lds
v_mfma_f32_16x16x32_bf16 v[188:191],v[216:219],v[12:15],0
s_waitcnt lgkmcnt(8)
v_mul_f32 v134,v134,v224
v_mfma_f32_16x16x32_bf16 v[188:191],v[220:223],v[28:31],v[188:191]
ds_read_b64_tr_b16 v[216:217],v241 offset:17408
ds_read_b64_tr_b16 v[218:219],v241 offset:19584
v_mfma_f32_16x16x32_bf16 v[160:163],v[192:195],v[32:35],v[160:163]
s_add_u32 m0,s32,3264
s_mov_b32 s34,22144
v_mfma_f32_16x16x32_bf16 v[160:163],v[196:199],v[48:51],v[160:163]
buffer_load_dwordx4 v235,s[24:27],s34 offen  lds
v_mfma_f32_16x16x32_bf16 v[168:171],v[192:195],v[36:39],v[168:171]
v_mul_f32 v135,v135,v224
v_cvt_pk_bf16_f32 v131,v134,v135
v_mfma_f32_16x16x32_bf16 v[168:171],v[196:199],v[52:55],v[168:171]
ds_read_b64_tr_b16 v[220:221],v241 offset:21760
ds_read_b64_tr_b16 v[222:223],v241 offset:23936
v_mfma_f32_16x16x32_bf16 v[176:179],v[192:195],v[40:43],v[176:179]
buffer_store_dwordx4 v[128:131],v242,s[28:31],s55 offen offset:0 sc1
v_mfma_f32_16x16x32_bf16 v[176:179],v[196:199],v[56:59],v[176:179]
v_mul_f32 v136,v136,v225
v_mul_f32 v137,v137,v225
v_mfma_f32_16x16x32_bf16 v[184:187],v[192:195],v[44:47],v[184:187]
s_waitcnt lgkmcnt(8)
v_cvt_pk_bf16_f32 v136,v136,v137
v_mfma_f32_16x16x32_bf16 v[184:187],v[196:199],v[60:63],v[184:187]
ds_read_b64_tr_b16 v[192:193],v240 offset:26112
ds_read_b64_tr_b16 v[194:195],v240 offset:28288
v_mfma_f32_16x16x32_bf16 v[164:167],v[200:203],v[32:35],v[164:167]
v_mul_f32 v138,v138,v225
v_mul_f32 v139,v139,v225
v_mfma_f32_16x16x32_bf16 v[164:167],v[204:207],v[48:51],v[164:167]
v_cvt_pk_bf16_f32 v137,v138,v139
v_mul_f32 v140,v140,v225
v_mfma_f32_16x16x32_bf16 v[172:175],v[200:203],v[36:39],v[172:175]
v_mul_f32 v141,v141,v225
v_cvt_pk_bf16_f32 v138,v140,v141
v_mfma_f32_16x16x32_bf16 v[172:175],v[204:207],v[52:55],v[172:175]
ds_read_b64_tr_b16 v[196:197],v240 offset:30464
ds_read_b64_tr_b16 v[198:199],v240 offset:32640
v_mfma_f32_16x16x32_bf16 v[180:183],v[200:203],v[40:43],v[180:183]
v_mul_f32 v142,v142,v225
v_mul_f32 v143,v143,v225
v_mfma_f32_16x16x32_bf16 v[180:183],v[204:207],v[56:59],v[180:183]
v_cvt_pk_bf16_f32 v139,v142,v143
v_mul_f32 v144,v144,v226
v_mfma_f32_16x16x32_bf16 v[188:191],v[200:203],v[44:47],v[188:191]
s_waitcnt lgkmcnt(8)
v_mul_f32 v145,v145,v226
v_mfma_f32_16x16x32_bf16 v[188:191],v[204:207],v[60:63],v[188:191]
ds_read_b64_tr_b16 v[200:201],v241 offset:26112
ds_read_b64_tr_b16 v[202:203],v241 offset:28288
v_mfma_f32_16x16x32_bf16 v[160:163],v[208:211],v[64:67],v[160:163]
buffer_store_dwordx4 v[136:139],v242,s[28:31],s55 offen offset:1024 sc1
v_mfma_f32_16x16x32_bf16 v[160:163],v[212:215],v[80:83],v[160:163]
v_cvt_pk_bf16_f32 v144,v144,v145
v_mul_f32 v146,v146,v226
v_mfma_f32_16x16x32_bf16 v[168:171],v[208:211],v[68:71],v[168:171]
v_mul_f32 v147,v147,v226
v_cvt_pk_bf16_f32 v145,v146,v147
v_mfma_f32_16x16x32_bf16 v[168:171],v[212:215],v[84:87],v[168:171]
ds_read_b64_tr_b16 v[204:205],v241 offset:30464
ds_read_b64_tr_b16 v[206:207],v241 offset:32640
v_mfma_f32_16x16x32_bf16 v[176:179],v[208:211],v[72:75],v[176:179]
v_subrev_u32 v240,34816,v240
v_subrev_u32 v241,34816,v241
v_mfma_f32_16x16x32_bf16 v[176:179],v[212:215],v[88:91],v[176:179]
v_mul_f32 v148,v148,v226
v_mul_f32 v149,v149,v226
v_mfma_f32_16x16x32_bf16 v[184:187],v[208:211],v[76:79],v[184:187]
s_waitcnt vmcnt(26) lgkmcnt(8)
s_barrier
v_mfma_f32_16x16x32_bf16 v[184:187],v[212:215],v[92:95],v[184:187]
ds_read_b64_tr_b16 v[208:209],v238 offset:0
ds_read_b64_tr_b16 v[210:211],v238 offset:2176
v_mfma_f32_16x16x32_bf16 v[164:167],v[216:219],v[64:67],v[164:167]
v_cvt_pk_bf16_f32 v146,v148,v149
v_mul_f32 v150,v150,v226
v_mfma_f32_16x16x32_bf16 v[164:167],v[220:223],v[80:83],v[164:167]
v_mul_f32 v151,v151,v226
v_cvt_pk_bf16_f32 v147,v150,v151
v_mfma_f32_16x16x32_bf16 v[172:175],v[216:219],v[68:71],v[172:175]
buffer_store_dwordx4 v[144:147],v242,s[28:31],s55 offen offset:2048 sc1
v_mfma_f32_16x16x32_bf16 v[172:175],v[220:223],v[84:87],v[172:175]
ds_read_b64_tr_b16 v[212:213],v238 offset:4352
ds_read_b64_tr_b16 v[214:215],v238 offset:6528
v_mfma_f32_16x16x32_bf16 v[180:183],v[216:219],v[72:75],v[180:183]
v_mul_f32 v152,v152,v227
v_mul_f32 v153,v153,v227
v_mfma_f32_16x16x32_bf16 v[180:183],v[220:223],v[88:91],v[180:183]
v_cvt_pk_bf16_f32 v152,v152,v153
v_mul_f32 v154,v154,v227
v_mfma_f32_16x16x32_bf16 v[188:191],v[216:219],v[76:79],v[188:191]
s_waitcnt lgkmcnt(8)
v_mul_f32 v155,v155,v227
v_mfma_f32_16x16x32_bf16 v[188:191],v[220:223],v[92:95],v[188:191]
ds_read_b64_tr_b16 v[216:217],v239 offset:0
ds_read_b64_tr_b16 v[218:219],v239 offset:2176
v_mfma_f32_16x16x32_bf16 v[160:163],v[192:195],v[96:99],v[160:163]
v_cvt_pk_bf16_f32 v153,v154,v155
v_mul_f32 v156,v156,v227
v_mfma_f32_16x16x32_bf16 v[160:163],v[196:199],v[112:115],v[160:163]
v_mul_f32 v157,v157,v227
v_cvt_pk_bf16_f32 v154,v156,v157
v_mfma_f32_16x16x32_bf16 v[168:171],v[192:195],v[100:103],v[168:171]
v_mul_f32 v158,v158,v227
v_mul_f32 v159,v159,v227
v_mfma_f32_16x16x32_bf16 v[168:171],v[196:199],v[116:119],v[168:171]
ds_read_b64_tr_b16 v[220:221],v239 offset:4352
ds_read_b64_tr_b16 v[222:223],v239 offset:6528
v_mfma_f32_16x16x32_bf16 v[176:179],v[192:195],v[104:107],v[176:179]
v_cvt_pk_bf16_f32 v155,v158,v159
v_mfma_f32_16x16x32_bf16 v[176:179],v[196:199],v[120:123],v[176:179]
buffer_store_dwordx4 v[152:155],v242,s[28:31],s55 offen offset:3072 sc1
v_mfma_f32_16x16x32_bf16 v[184:187],v[192:195],v[108:111],v[184:187]
s_waitcnt lgkmcnt(8)
s_add_u32 s55,s55,16384
v_mfma_f32_16x16x32_bf16 v[184:187],v[196:199],v[124:127],v[184:187]
ds_read_b64_tr_b16 v[192:193],v238 offset:8704
ds_read_b64_tr_b16 v[194:195],v238 offset:10880
v_mfma_f32_16x16x32_bf16 v[164:167],v[200:203],v[96:99],v[164:167]
v_mfma_f32_16x16x32_bf16 v[164:167],v[204:207],v[112:115],v[164:167]
v_mfma_f32_16x16x32_bf16 v[172:175],v[200:203],v[100:103],v[172:175]
v_mfma_f32_16x16x32_bf16 v[172:175],v[204:207],v[116:119],v[172:175]
ds_read_b64_tr_b16 v[196:197],v238 offset:13056
ds_read_b64_tr_b16 v[198:199],v238 offset:15232
v_mfma_f32_16x16x32_bf16 v[180:183],v[200:203],v[104:107],v[180:183]
v_mfma_f32_16x16x32_bf16 v[180:183],v[204:207],v[120:123],v[180:183]
v_mfma_f32_16x16x32_bf16 v[188:191],v[200:203],v[108:111],v[188:191]
s_waitcnt lgkmcnt(8)
v_mfma_f32_16x16x32_bf16 v[188:191],v[204:207],v[124:127],v[188:191]
ds_read_b64_tr_b16 v[200:201],v239 offset:8704
ds_read_b64_tr_b16 v[202:203],v239 offset:10880
v_mfma_f32_16x16x32_bf16 v[128:131],v[208:211],v[0:3],0
v_mul_f32 v160,v160,v224
v_mul_f32 v161,v161,v224
v_mfma_f32_16x16x32_bf16 v[128:131],v[212:215],v[16:19],v[128:131]
v_cvt_pk_bf16_f32 v160,v160,v161
v_mul_f32 v162,v162,v224
v_mfma_f32_16x16x32_bf16 v[136:139],v[208:211],v[4:7],0
v_mul_f32 v163,v163,v224
v_cvt_pk_bf16_f32 v161,v162,v163
v_mfma_f32_16x16x32_bf16 v[136:139],v[212:215],v[20:23],v[136:139]
ds_read_b64_tr_b16 v[204:205],v239 offset:13056
ds_read_b64_tr_b16 v[206:207],v239 offset:15232
v_mfma_f32_16x16x32_bf16 v[144:147],v[208:211],v[8:11],0
s_add_u32 m0,s32,17408
s_mov_b32 s34,115328
v_mfma_f32_16x16x32_bf16 v[144:147],v[212:215],v[24:27],v[144:147]
buffer_load_dwordx4 v235,s[24:27],s34 offen  lds
v_mfma_f32_16x16x32_bf16 v[152:155],v[208:211],v[12:15],0
s_waitcnt lgkmcnt(8)
v_mul_f32 v164,v164,v224
v_mfma_f32_16x16x32_bf16 v[152:155],v[212:215],v[28:31],v[152:155]
ds_read_b64_tr_b16 v[208:209],v238 offset:17408
ds_read_b64_tr_b16 v[210:211],v238 offset:19584
v_mfma_f32_16x16x32_bf16 v[132:135],v[216:219],v[0:3],0
s_add_u32 m0,s32,18496
s_mov_b32 s34,122496
v_mfma_f32_16x16x32_bf16 v[132:135],v[220:223],v[16:19],v[132:135]
buffer_load_dwordx4 v235,s[24:27],s34 offen  lds
v_mfma_f32_16x16x32_bf16 v[140:143],v[216:219],v[4:7],0
v_mul_f32 v165,v165,v224
v_cvt_pk_bf16_f32 v162,v164,v165
v_mfma_f32_16x16x32_bf16 v[140:143],v[220:223],v[20:23],v[140:143]
ds_read_b64_tr_b16 v[212:213],v238 offset:21760
ds_read_b64_tr_b16 v[214:215],v238 offset:23936
v_mfma_f32_16x16x32_bf16 v[148:151],v[216:219],v[8:11],0
s_add_u32 m0,s32,19584
s_mov_b32 s34,129664
v_mfma_f32_16x16x32_bf16 v[148:151],v[220:223],v[24:27],v[148:151]
buffer_load_dwordx4 v235,s[24:27],s34 offen  lds
v_mfma_f32_16x16x32_bf16 v[156:159],v[216:219],v[12:15],0
s_waitcnt lgkmcnt(8)
v_mul_f32 v166,v166,v224
v_mfma_f32_16x16x32_bf16 v[156:159],v[220:223],v[28:31],v[156:159]
ds_read_b64_tr_b16 v[216:217],v239 offset:17408
ds_read_b64_tr_b16 v[218:219],v239 offset:19584
v_mfma_f32_16x16x32_bf16 v[128:131],v[192:195],v[32:35],v[128:131]
s_add_u32 m0,s32,20672
s_mov_b32 s34,136832
v_mfma_f32_16x16x32_bf16 v[128:131],v[196:199],v[48:51],v[128:131]
buffer_load_dwordx4 v235,s[24:27],s34 offen  lds
v_mfma_f32_16x16x32_bf16 v[136:139],v[192:195],v[36:39],v[136:139]
v_mul_f32 v167,v167,v224
v_cvt_pk_bf16_f32 v163,v166,v167
v_mfma_f32_16x16x32_bf16 v[136:139],v[196:199],v[52:55],v[136:139]
ds_read_b64_tr_b16 v[220:221],v239 offset:21760
ds_read_b64_tr_b16 v[222:223],v239 offset:23936
v_mfma_f32_16x16x32_bf16 v[144:147],v[192:195],v[40:43],v[144:147]
buffer_store_dwordx4 v[160:163],v242,s[28:31],s55 offen offset:0 sc1
v_mfma_f32_16x16x32_bf16 v[144:147],v[196:199],v[56:59],v[144:147]
v_mul_f32 v168,v168,v225
v_mul_f32 v169,v169,v225
v_mfma_f32_16x16x32_bf16 v[152:155],v[192:195],v[44:47],v[152:155]
s_waitcnt lgkmcnt(8)
v_cvt_pk_bf16_f32 v168,v168,v169
v_mfma_f32_16x16x32_bf16 v[152:155],v[196:199],v[60:63],v[152:155]
ds_read_b64_tr_b16 v[192:193],v238 offset:26112
ds_read_b64_tr_b16 v[194:195],v238 offset:28288
v_mfma_f32_16x16x32_bf16 v[132:135],v[200:203],v[32:35],v[132:135]
v_mul_f32 v170,v170,v225
v_mul_f32 v171,v171,v225
v_mfma_f32_16x16x32_bf16 v[132:135],v[204:207],v[48:51],v[132:135]
v_cvt_pk_bf16_f32 v169,v170,v171
v_mul_f32 v172,v172,v225
v_mfma_f32_16x16x32_bf16 v[140:143],v[200:203],v[36:39],v[140:143]
v_mul_f32 v173,v173,v225
v_cvt_pk_bf16_f32 v170,v172,v173
v_mfma_f32_16x16x32_bf16 v[140:143],v[204:207],v[52:55],v[140:143]
ds_read_b64_tr_b16 v[196:197],v238 offset:30464
ds_read_b64_tr_b16 v[198:199],v238 offset:32640
v_mfma_f32_16x16x32_bf16 v[148:151],v[200:203],v[40:43],v[148:151]
v_mul_f32 v174,v174,v225
v_mul_f32 v175,v175,v225
v_mfma_f32_16x16x32_bf16 v[148:151],v[204:207],v[56:59],v[148:151]
v_cvt_pk_bf16_f32 v171,v174,v175
v_mul_f32 v176,v176,v226
v_mfma_f32_16x16x32_bf16 v[156:159],v[200:203],v[44:47],v[156:159]
s_waitcnt lgkmcnt(8)
v_mul_f32 v177,v177,v226
v_mfma_f32_16x16x32_bf16 v[156:159],v[204:207],v[60:63],v[156:159]
ds_read_b64_tr_b16 v[200:201],v239 offset:26112
ds_read_b64_tr_b16 v[202:203],v239 offset:28288
v_mfma_f32_16x16x32_bf16 v[128:131],v[208:211],v[64:67],v[128:131]
buffer_store_dwordx4 v[168:171],v242,s[28:31],s55 offen offset:1024 sc1
v_mfma_f32_16x16x32_bf16 v[128:131],v[212:215],v[80:83],v[128:131]
v_cvt_pk_bf16_f32 v176,v176,v177
v_mul_f32 v178,v178,v226
v_mfma_f32_16x16x32_bf16 v[136:139],v[208:211],v[68:71],v[136:139]
v_mul_f32 v179,v179,v226
v_cvt_pk_bf16_f32 v177,v178,v179
v_mfma_f32_16x16x32_bf16 v[136:139],v[212:215],v[84:87],v[136:139]
ds_read_b64_tr_b16 v[204:205],v239 offset:30464
ds_read_b64_tr_b16 v[206:207],v239 offset:32640
v_mfma_f32_16x16x32_bf16 v[144:147],v[208:211],v[72:75],v[144:147]
v_add_u32 v238,87040,v238
v_add_u32 v239,87040,v239
v_mfma_f32_16x16x32_bf16 v[144:147],v[212:215],v[88:91],v[144:147]
v_mul_f32 v180,v180,v226
v_mul_f32 v181,v181,v226
v_mfma_f32_16x16x32_bf16 v[152:155],v[208:211],v[76:79],v[152:155]
s_waitcnt lgkmcnt(8)
v_cvt_pk_bf16_f32 v178,v180,v181
v_mfma_f32_16x16x32_bf16 v[152:155],v[212:215],v[92:95],v[152:155]
ds_read_b64_tr_b16 v[208:209],v240 offset:0
ds_read_b64_tr_b16 v[210:211],v240 offset:2176
v_mfma_f32_16x16x32_bf16 v[132:135],v[216:219],v[64:67],v[132:135]
v_mul_f32 v182,v182,v226
v_mul_f32 v183,v183,v226
v_mfma_f32_16x16x32_bf16 v[132:135],v[220:223],v[80:83],v[132:135]
v_cvt_pk_bf16_f32 v179,v182,v183
v_mul_f32 v184,v184,v227
v_mfma_f32_16x16x32_bf16 v[140:143],v[216:219],v[68:71],v[140:143]
buffer_store_dwordx4 v[176:179],v242,s[28:31],s55 offen offset:2048 sc1
v_mfma_f32_16x16x32_bf16 v[140:143],v[220:223],v[84:87],v[140:143]
ds_read_b64_tr_b16 v[212:213],v240 offset:4352
ds_read_b64_tr_b16 v[214:215],v240 offset:6528
v_mfma_f32_16x16x32_bf16 v[148:151],v[216:219],v[72:75],v[148:151]
v_mul_f32 v185,v185,v227
v_cvt_pk_bf16_f32 v184,v184,v185
v_mfma_f32_16x16x32_bf16 v[148:151],v[220:223],v[88:91],v[148:151]
v_mul_f32 v186,v186,v227
v_mul_f32 v187,v187,v227
v_mfma_f32_16x16x32_bf16 v[156:159],v[216:219],v[76:79],v[156:159]
s_waitcnt lgkmcnt(8)
v_cvt_pk_bf16_f32 v185,v186,v187
v_mfma_f32_16x16x32_bf16 v[156:159],v[220:223],v[92:95],v[156:159]
ds_read_b64_tr_b16 v[216:217],v241 offset:0
ds_read_b64_tr_b16 v[218:219],v241 offset:2176
v_mfma_f32_16x16x32_bf16 v[128:131],v[192:195],v[96:99],v[128:131]
v_mul_f32 v188,v188,v227
v_mul_f32 v189,v189,v227
v_mfma_f32_16x16x32_bf16 v[128:131],v[196:199],v[112:115],v[128:131]
v_cvt_pk_bf16_f32 v186,v188,v189
v_mul_f32 v190,v190,v227
v_mfma_f32_16x16x32_bf16 v[136:139],v[192:195],v[100:103],v[136:139]
v_mul_f32 v191,v191,v227
v_cvt_pk_bf16_f32 v187,v190,v191
v_mfma_f32_16x16x32_bf16 v[136:139],v[196:199],v[116:119],v[136:139]
ds_read_b64_tr_b16 v[220:221],v241 offset:4352
ds_read_b64_tr_b16 v[222:223],v241 offset:6528
v_mfma_f32_16x16x32_bf16 v[144:147],v[192:195],v[104:107],v[144:147]
buffer_store_dwordx4 v[184:187],v242,s[28:31],s55 offen offset:3072 sc1
v_mfma_f32_16x16x32_bf16 v[144:147],v[196:199],v[120:123],v[144:147]
s_add_u32 s55,s55,16384
v_mfma_f32_16x16x32_bf16 v[152:155],v[192:195],v[108:111],v[152:155]
s_waitcnt lgkmcnt(8)
v_mfma_f32_16x16x32_bf16 v[152:155],v[196:199],v[124:127],v[152:155]
ds_read_b64_tr_b16 v[192:193],v240 offset:8704
ds_read_b64_tr_b16 v[194:195],v240 offset:10880
v_mfma_f32_16x16x32_bf16 v[132:135],v[200:203],v[96:99],v[132:135]
v_mfma_f32_16x16x32_bf16 v[132:135],v[204:207],v[112:115],v[132:135]
v_mfma_f32_16x16x32_bf16 v[140:143],v[200:203],v[100:103],v[140:143]
v_mfma_f32_16x16x32_bf16 v[140:143],v[204:207],v[116:119],v[140:143]
ds_read_b64_tr_b16 v[196:197],v240 offset:13056
ds_read_b64_tr_b16 v[198:199],v240 offset:15232
v_mfma_f32_16x16x32_bf16 v[148:151],v[200:203],v[104:107],v[148:151]
v_mfma_f32_16x16x32_bf16 v[148:151],v[204:207],v[120:123],v[148:151]
v_mfma_f32_16x16x32_bf16 v[156:159],v[200:203],v[108:111],v[156:159]
s_waitcnt lgkmcnt(8)
v_mfma_f32_16x16x32_bf16 v[156:159],v[204:207],v[124:127],v[156:159]
ds_read_b64_tr_b16 v[200:201],v241 offset:8704
ds_read_b64_tr_b16 v[202:203],v241 offset:10880
v_mfma_f32_16x16x32_bf16 v[160:163],v[208:211],v[0:3],0
v_mul_f32 v128,v128,v224
v_mul_f32 v129,v129,v224
v_mfma_f32_16x16x32_bf16 v[160:163],v[212:215],v[16:19],v[160:163]
v_cvt_pk_bf16_f32 v128,v128,v129
v_mul_f32 v130,v130,v224
v_mfma_f32_16x16x32_bf16 v[168:171],v[208:211],v[4:7],0
v_mul_f32 v131,v131,v224
v_cvt_pk_bf16_f32 v129,v130,v131
v_mfma_f32_16x16x32_bf16 v[168:171],v[212:215],v[20:23],v[168:171]
ds_read_b64_tr_b16 v[204:205],v241 offset:13056
ds_read_b64_tr_b16 v[206:207],v241 offset:15232
v_mfma_f32_16x16x32_bf16 v[176:179],v[208:211],v[8:11],0
s_add_u32 m0,s32,69632
s_mov_b32 s34,768
v_mfma_f32_16x16x32_bf16 v[176:179],v[212:215],v[24:27],v[176:179]
buffer_load_dwordx4 v235,s[24:27],s34 offen  lds
v_mfma_f32_16x16x32_bf16 v[184:187],v[208:211],v[12:15],0
s_waitcnt lgkmcnt(8)
v_mul_f32 v132,v132,v224
v_mfma_f32_16x16x32_bf16 v[184:187],v[212:215],v[28:31],v[184:187]
ds_read_b64_tr_b16 v[208:209],v240 offset:17408
ds_read_b64_tr_b16 v[210:211],v240 offset:19584
v_mfma_f32_16x16x32_bf16 v[164:167],v[216:219],v[0:3],0
s_add_u32 m0,s32,70720
s_mov_b32 s34,7936
v_mfma_f32_16x16x32_bf16 v[164:167],v[220:223],v[16:19],v[164:167]
buffer_load_dwordx4 v235,s[24:27],s34 offen  lds
v_mfma_f32_16x16x32_bf16 v[172:175],v[216:219],v[4:7],0
v_mul_f32 v133,v133,v224
v_cvt_pk_bf16_f32 v130,v132,v133
v_mfma_f32_16x16x32_bf16 v[172:175],v[220:223],v[20:23],v[172:175]
ds_read_b64_tr_b16 v[212:213],v240 offset:21760
ds_read_b64_tr_b16 v[214:215],v240 offset:23936
v_mfma_f32_16x16x32_bf16 v[180:183],v[216:219],v[8:11],0
s_add_u32 m0,s32,71808
s_mov_b32 s34,15104
v_mfma_f32_16x16x32_bf16 v[180:183],v[220:223],v[24:27],v[180:183]
buffer_load_dwordx4 v235,s[24:27],s34 offen  lds
v_mfma_f32_16x16x32_bf16 v[188:191],v[216:219],v[12:15],0
s_waitcnt lgkmcnt(8)
v_mul_f32 v134,v134,v224
v_mfma_f32_16x16x32_bf16 v[188:191],v[220:223],v[28:31],v[188:191]
ds_read_b64_tr_b16 v[216:217],v241 offset:17408
ds_read_b64_tr_b16 v[218:219],v241 offset:19584
v_mfma_f32_16x16x32_bf16 v[160:163],v[192:195],v[32:35],v[160:163]
s_add_u32 m0,s32,72896
s_mov_b32 s34,22272
v_mfma_f32_16x16x32_bf16 v[160:163],v[196:199],v[48:51],v[160:163]
buffer_load_dwordx4 v235,s[24:27],s34 offen  lds
v_mfma_f32_16x16x32_bf16 v[168:171],v[192:195],v[36:39],v[168:171]
v_mul_f32 v135,v135,v224
v_cvt_pk_bf16_f32 v131,v134,v135
v_mfma_f32_16x16x32_bf16 v[168:171],v[196:199],v[52:55],v[168:171]
ds_read_b64_tr_b16 v[220:221],v241 offset:21760
ds_read_b64_tr_b16 v[222:223],v241 offset:23936
v_mfma_f32_16x16x32_bf16 v[176:179],v[192:195],v[40:43],v[176:179]
buffer_store_dwordx4 v[128:131],v242,s[28:31],s55 offen offset:0 sc1
v_mfma_f32_16x16x32_bf16 v[176:179],v[196:199],v[56:59],v[176:179]
v_mul_f32 v136,v136,v225
v_mul_f32 v137,v137,v225
v_mfma_f32_16x16x32_bf16 v[184:187],v[192:195],v[44:47],v[184:187]
s_waitcnt lgkmcnt(8)
v_cvt_pk_bf16_f32 v136,v136,v137
v_mfma_f32_16x16x32_bf16 v[184:187],v[196:199],v[60:63],v[184:187]
ds_read_b64_tr_b16 v[192:193],v240 offset:26112
ds_read_b64_tr_b16 v[194:195],v240 offset:28288
v_mfma_f32_16x16x32_bf16 v[164:167],v[200:203],v[32:35],v[164:167]
v_mul_f32 v138,v138,v225
v_mul_f32 v139,v139,v225
v_mfma_f32_16x16x32_bf16 v[164:167],v[204:207],v[48:51],v[164:167]
v_cvt_pk_bf16_f32 v137,v138,v139
v_mul_f32 v140,v140,v225
v_mfma_f32_16x16x32_bf16 v[172:175],v[200:203],v[36:39],v[172:175]
v_mul_f32 v141,v141,v225
v_cvt_pk_bf16_f32 v138,v140,v141
v_mfma_f32_16x16x32_bf16 v[172:175],v[204:207],v[52:55],v[172:175]
ds_read_b64_tr_b16 v[196:197],v240 offset:30464
ds_read_b64_tr_b16 v[198:199],v240 offset:32640
v_mfma_f32_16x16x32_bf16 v[180:183],v[200:203],v[40:43],v[180:183]
v_mul_f32 v142,v142,v225
v_mul_f32 v143,v143,v225
v_mfma_f32_16x16x32_bf16 v[180:183],v[204:207],v[56:59],v[180:183]
v_cvt_pk_bf16_f32 v139,v142,v143
v_mul_f32 v144,v144,v226
v_mfma_f32_16x16x32_bf16 v[188:191],v[200:203],v[44:47],v[188:191]
s_waitcnt lgkmcnt(8)
v_mul_f32 v145,v145,v226
v_mfma_f32_16x16x32_bf16 v[188:191],v[204:207],v[60:63],v[188:191]
ds_read_b64_tr_b16 v[200:201],v241 offset:26112
ds_read_b64_tr_b16 v[202:203],v241 offset:28288
v_mfma_f32_16x16x32_bf16 v[160:163],v[208:211],v[64:67],v[160:163]
buffer_store_dwordx4 v[136:139],v242,s[28:31],s55 offen offset:1024 sc1
v_mfma_f32_16x16x32_bf16 v[160:163],v[212:215],v[80:83],v[160:163]
v_cvt_pk_bf16_f32 v144,v144,v145
v_mul_f32 v146,v146,v226
v_mfma_f32_16x16x32_bf16 v[168:171],v[208:211],v[68:71],v[168:171]
v_mul_f32 v147,v147,v226
v_cvt_pk_bf16_f32 v145,v146,v147
v_mfma_f32_16x16x32_bf16 v[168:171],v[212:215],v[84:87],v[168:171]
ds_read_b64_tr_b16 v[204:205],v241 offset:30464
ds_read_b64_tr_b16 v[206:207],v241 offset:32640
v_mfma_f32_16x16x32_bf16 v[176:179],v[208:211],v[72:75],v[176:179]
v_add_u32 v240,87040,v240
v_add_u32 v241,87040,v241
v_mfma_f32_16x16x32_bf16 v[176:179],v[212:215],v[88:91],v[176:179]
v_mul_f32 v148,v148,v226
v_mul_f32 v149,v149,v226
v_mfma_f32_16x16x32_bf16 v[184:187],v[208:211],v[76:79],v[184:187]
s_waitcnt vmcnt(26) lgkmcnt(8)
s_barrier
v_mfma_f32_16x16x32_bf16 v[184:187],v[212:215],v[92:95],v[184:187]
ds_read_b64_tr_b16 v[208:209],v238 offset:0
ds_read_b64_tr_b16 v[210:211],v238 offset:2176
v_mfma_f32_16x16x32_bf16 v[164:167],v[216:219],v[64:67],v[164:167]
v_cvt_pk_bf16_f32 v146,v148,v149
v_mul_f32 v150,v150,v226
v_mfma_f32_16x16x32_bf16 v[164:167],v[220:223],v[80:83],v[164:167]
v_mul_f32 v151,v151,v226
v_cvt_pk_bf16_f32 v147,v150,v151
v_mfma_f32_16x16x32_bf16 v[172:175],v[216:219],v[68:71],v[172:175]
buffer_store_dwordx4 v[144:147],v242,s[28:31],s55 offen offset:2048 sc1
v_mfma_f32_16x16x32_bf16 v[172:175],v[220:223],v[84:87],v[172:175]
ds_read_b64_tr_b16 v[212:213],v238 offset:4352
ds_read_b64_tr_b16 v[214:215],v238 offset:6528
v_mfma_f32_16x16x32_bf16 v[180:183],v[216:219],v[72:75],v[180:183]
v_mul_f32 v152,v152,v227
v_mul_f32 v153,v153,v227
v_mfma_f32_16x16x32_bf16 v[180:183],v[220:223],v[88:91],v[180:183]
v_cvt_pk_bf16_f32 v152,v152,v153
v_mul_f32 v154,v154,v227
v_mfma_f32_16x16x32_bf16 v[188:191],v[216:219],v[76:79],v[188:191]
s_waitcnt lgkmcnt(8)
v_mul_f32 v155,v155,v227
v_mfma_f32_16x16x32_bf16 v[188:191],v[220:223],v[92:95],v[188:191]
ds_read_b64_tr_b16 v[216:217],v239 offset:0
ds_read_b64_tr_b16 v[218:219],v239 offset:2176
v_mfma_f32_16x16x32_bf16 v[160:163],v[192:195],v[96:99],v[160:163]
v_cvt_pk_bf16_f32 v153,v154,v155
v_mul_f32 v156,v156,v227
v_mfma_f32_16x16x32_bf16 v[160:163],v[196:199],v[112:115],v[160:163]
v_mul_f32 v157,v157,v227
v_cvt_pk_bf16_f32 v154,v156,v157
v_mfma_f32_16x16x32_bf16 v[168:171],v[192:195],v[100:103],v[168:171]
v_mul_f32 v158,v158,v227
v_mul_f32 v159,v159,v227
v_mfma_f32_16x16x32_bf16 v[168:171],v[196:199],v[116:119],v[168:171]
ds_read_b64_tr_b16 v[220:221],v239 offset:4352
ds_read_b64_tr_b16 v[222:223],v239 offset:6528
v_mfma_f32_16x16x32_bf16 v[176:179],v[192:195],v[104:107],v[176:179]
v_cvt_pk_bf16_f32 v155,v158,v159
v_mfma_f32_16x16x32_bf16 v[176:179],v[196:199],v[120:123],v[176:179]
buffer_store_dwordx4 v[152:155],v242,s[28:31],s55 offen offset:3072 sc1
v_mfma_f32_16x16x32_bf16 v[184:187],v[192:195],v[108:111],v[184:187]
s_waitcnt lgkmcnt(8)
s_add_u32 s55,s55,16384
v_mfma_f32_16x16x32_bf16 v[184:187],v[196:199],v[124:127],v[184:187]
ds_read_b64_tr_b16 v[192:193],v238 offset:8704
ds_read_b64_tr_b16 v[194:195],v238 offset:10880
v_mfma_f32_16x16x32_bf16 v[164:167],v[200:203],v[96:99],v[164:167]
v_mfma_f32_16x16x32_bf16 v[164:167],v[204:207],v[112:115],v[164:167]
v_mfma_f32_16x16x32_bf16 v[172:175],v[200:203],v[100:103],v[172:175]
v_mfma_f32_16x16x32_bf16 v[172:175],v[204:207],v[116:119],v[172:175]
ds_read_b64_tr_b16 v[196:197],v238 offset:13056
ds_read_b64_tr_b16 v[198:199],v238 offset:15232
v_mfma_f32_16x16x32_bf16 v[180:183],v[200:203],v[104:107],v[180:183]
v_mfma_f32_16x16x32_bf16 v[180:183],v[204:207],v[120:123],v[180:183]
v_mfma_f32_16x16x32_bf16 v[188:191],v[200:203],v[108:111],v[188:191]
s_waitcnt lgkmcnt(8)
v_mfma_f32_16x16x32_bf16 v[188:191],v[204:207],v[124:127],v[188:191]
ds_read_b64_tr_b16 v[200:201],v239 offset:8704
ds_read_b64_tr_b16 v[202:203],v239 offset:10880
v_mfma_f32_16x16x32_bf16 v[128:131],v[208:211],v[0:3],0
v_mul_f32 v160,v160,v224
v_mul_f32 v161,v161,v224
v_mfma_f32_16x16x32_bf16 v[128:131],v[212:215],v[16:19],v[128:131]
v_cvt_pk_bf16_f32 v160,v160,v161
v_mul_f32 v162,v162,v224
v_mfma_f32_16x16x32_bf16 v[136:139],v[208:211],v[4:7],0
v_mul_f32 v163,v163,v224
v_cvt_pk_bf16_f32 v161,v162,v163
v_mfma_f32_16x16x32_bf16 v[136:139],v[212:215],v[20:23],v[136:139]
ds_read_b64_tr_b16 v[204:205],v239 offset:13056
ds_read_b64_tr_b16 v[206:207],v239 offset:15232
v_mfma_f32_16x16x32_bf16 v[144:147],v[208:211],v[8:11],0
s_add_u32 m0,s32,87040
s_mov_b32 s34,115456
v_mfma_f32_16x16x32_bf16 v[144:147],v[212:215],v[24:27],v[144:147]
buffer_load_dwordx4 v235,s[24:27],s34 offen  lds
v_mfma_f32_16x16x32_bf16 v[152:155],v[208:211],v[12:15],0
s_waitcnt lgkmcnt(8)
v_mul_f32 v164,v164,v224
v_mfma_f32_16x16x32_bf16 v[152:155],v[212:215],v[28:31],v[152:155]
ds_read_b64_tr_b16 v[208:209],v238 offset:17408
ds_read_b64_tr_b16 v[210:211],v238 offset:19584
v_mfma_f32_16x16x32_bf16 v[132:135],v[216:219],v[0:3],0
s_add_u32 m0,s32,88128
s_mov_b32 s34,122624
v_mfma_f32_16x16x32_bf16 v[132:135],v[220:223],v[16:19],v[132:135]
buffer_load_dwordx4 v235,s[24:27],s34 offen  lds
v_mfma_f32_16x16x32_bf16 v[140:143],v[216:219],v[4:7],0
v_mul_f32 v165,v165,v224
v_cvt_pk_bf16_f32 v162,v164,v165
v_mfma_f32_16x16x32_bf16 v[140:143],v[220:223],v[20:23],v[140:143]
ds_read_b64_tr_b16 v[212:213],v238 offset:21760
ds_read_b64_tr_b16 v[214:215],v238 offset:23936
v_mfma_f32_16x16x32_bf16 v[148:151],v[216:219],v[8:11],0
s_add_u32 m0,s32,89216
s_mov_b32 s34,129792
v_mfma_f32_16x16x32_bf16 v[148:151],v[220:223],v[24:27],v[148:151]
buffer_load_dwordx4 v235,s[24:27],s34 offen  lds
v_mfma_f32_16x16x32_bf16 v[156:159],v[216:219],v[12:15],0
s_waitcnt lgkmcnt(8)
v_mul_f32 v166,v166,v224
v_mfma_f32_16x16x32_bf16 v[156:159],v[220:223],v[28:31],v[156:159]
ds_read_b64_tr_b16 v[216:217],v239 offset:17408
ds_read_b64_tr_b16 v[218:219],v239 offset:19584
v_mfma_f32_16x16x32_bf16 v[128:131],v[192:195],v[32:35],v[128:131]
s_add_u32 m0,s32,90304
s_mov_b32 s34,136960
v_mfma_f32_16x16x32_bf16 v[128:131],v[196:199],v[48:51],v[128:131]
buffer_load_dwordx4 v235,s[24:27],s34 offen  lds
v_mfma_f32_16x16x32_bf16 v[136:139],v[192:195],v[36:39],v[136:139]
v_mul_f32 v167,v167,v224
v_cvt_pk_bf16_f32 v163,v166,v167
v_mfma_f32_16x16x32_bf16 v[136:139],v[196:199],v[52:55],v[136:139]
ds_read_b64_tr_b16 v[220:221],v239 offset:21760
ds_read_b64_tr_b16 v[222:223],v239 offset:23936
v_mfma_f32_16x16x32_bf16 v[144:147],v[192:195],v[40:43],v[144:147]
buffer_store_dwordx4 v[160:163],v242,s[28:31],s55 offen offset:0 sc1
v_mfma_f32_16x16x32_bf16 v[144:147],v[196:199],v[56:59],v[144:147]
v_mul_f32 v168,v168,v225
v_mul_f32 v169,v169,v225
v_mfma_f32_16x16x32_bf16 v[152:155],v[192:195],v[44:47],v[152:155]
s_waitcnt lgkmcnt(8)
v_cvt_pk_bf16_f32 v168,v168,v169
v_mfma_f32_16x16x32_bf16 v[152:155],v[196:199],v[60:63],v[152:155]
ds_read_b64_tr_b16 v[192:193],v238 offset:26112
ds_read_b64_tr_b16 v[194:195],v238 offset:28288
v_mfma_f32_16x16x32_bf16 v[132:135],v[200:203],v[32:35],v[132:135]
v_mul_f32 v170,v170,v225
v_mul_f32 v171,v171,v225
v_mfma_f32_16x16x32_bf16 v[132:135],v[204:207],v[48:51],v[132:135]
v_cvt_pk_bf16_f32 v169,v170,v171
v_mul_f32 v172,v172,v225
v_mfma_f32_16x16x32_bf16 v[140:143],v[200:203],v[36:39],v[140:143]
v_mul_f32 v173,v173,v225
v_cvt_pk_bf16_f32 v170,v172,v173
v_mfma_f32_16x16x32_bf16 v[140:143],v[204:207],v[52:55],v[140:143]
ds_read_b64_tr_b16 v[196:197],v238 offset:30464
ds_read_b64_tr_b16 v[198:199],v238 offset:32640
v_mfma_f32_16x16x32_bf16 v[148:151],v[200:203],v[40:43],v[148:151]
v_mul_f32 v174,v174,v225
v_mul_f32 v175,v175,v225
v_mfma_f32_16x16x32_bf16 v[148:151],v[204:207],v[56:59],v[148:151]
v_cvt_pk_bf16_f32 v171,v174,v175
v_mul_f32 v176,v176,v226
v_mfma_f32_16x16x32_bf16 v[156:159],v[200:203],v[44:47],v[156:159]
s_waitcnt lgkmcnt(8)
v_mul_f32 v177,v177,v226
v_mfma_f32_16x16x32_bf16 v[156:159],v[204:207],v[60:63],v[156:159]
ds_read_b64_tr_b16 v[200:201],v239 offset:26112
ds_read_b64_tr_b16 v[202:203],v239 offset:28288
v_mfma_f32_16x16x32_bf16 v[128:131],v[208:211],v[64:67],v[128:131]
buffer_store_dwordx4 v[168:171],v242,s[28:31],s55 offen offset:1024 sc1
v_mfma_f32_16x16x32_bf16 v[128:131],v[212:215],v[80:83],v[128:131]
v_cvt_pk_bf16_f32 v176,v176,v177
v_mul_f32 v178,v178,v226
v_mfma_f32_16x16x32_bf16 v[136:139],v[208:211],v[68:71],v[136:139]
v_mul_f32 v179,v179,v226
v_cvt_pk_bf16_f32 v177,v178,v179
v_mfma_f32_16x16x32_bf16 v[136:139],v[212:215],v[84:87],v[136:139]
ds_read_b64_tr_b16 v[204:205],v239 offset:30464
ds_read_b64_tr_b16 v[206:207],v239 offset:32640
v_mfma_f32_16x16x32_bf16 v[144:147],v[208:211],v[72:75],v[144:147]
v_subrev_u32 v238,121856,v238
v_subrev_u32 v239,121856,v239
v_mfma_f32_16x16x32_bf16 v[144:147],v[212:215],v[88:91],v[144:147]
v_mul_f32 v180,v180,v226
v_mul_f32 v181,v181,v226
v_mfma_f32_16x16x32_bf16 v[152:155],v[208:211],v[76:79],v[152:155]
s_waitcnt lgkmcnt(8)
v_cvt_pk_bf16_f32 v178,v180,v181
v_mfma_f32_16x16x32_bf16 v[152:155],v[212:215],v[92:95],v[152:155]
ds_read_b64_tr_b16 v[208:209],v240 offset:0
ds_read_b64_tr_b16 v[210:211],v240 offset:2176
v_mfma_f32_16x16x32_bf16 v[132:135],v[216:219],v[64:67],v[132:135]
v_mul_f32 v182,v182,v226
v_mul_f32 v183,v183,v226
v_mfma_f32_16x16x32_bf16 v[132:135],v[220:223],v[80:83],v[132:135]
v_cvt_pk_bf16_f32 v179,v182,v183
v_mul_f32 v184,v184,v227
v_mfma_f32_16x16x32_bf16 v[140:143],v[216:219],v[68:71],v[140:143]
buffer_store_dwordx4 v[176:179],v242,s[28:31],s55 offen offset:2048 sc1
v_mfma_f32_16x16x32_bf16 v[140:143],v[220:223],v[84:87],v[140:143]
ds_read_b64_tr_b16 v[212:213],v240 offset:4352
ds_read_b64_tr_b16 v[214:215],v240 offset:6528
v_mfma_f32_16x16x32_bf16 v[148:151],v[216:219],v[72:75],v[148:151]
v_mul_f32 v185,v185,v227
v_cvt_pk_bf16_f32 v184,v184,v185
v_mfma_f32_16x16x32_bf16 v[148:151],v[220:223],v[88:91],v[148:151]
v_mul_f32 v186,v186,v227
v_mul_f32 v187,v187,v227
v_mfma_f32_16x16x32_bf16 v[156:159],v[216:219],v[76:79],v[156:159]
s_waitcnt lgkmcnt(8)
v_cvt_pk_bf16_f32 v185,v186,v187
v_mfma_f32_16x16x32_bf16 v[156:159],v[220:223],v[92:95],v[156:159]
ds_read_b64_tr_b16 v[216:217],v241 offset:0
ds_read_b64_tr_b16 v[218:219],v241 offset:2176
v_mfma_f32_16x16x32_bf16 v[128:131],v[192:195],v[96:99],v[128:131]
v_mul_f32 v188,v188,v227
v_mul_f32 v189,v189,v227
v_mfma_f32_16x16x32_bf16 v[128:131],v[196:199],v[112:115],v[128:131]
v_cvt_pk_bf16_f32 v186,v188,v189
v_mul_f32 v190,v190,v227
v_mfma_f32_16x16x32_bf16 v[136:139],v[192:195],v[100:103],v[136:139]
v_mul_f32 v191,v191,v227
v_cvt_pk_bf16_f32 v187,v190,v191
v_mfma_f32_16x16x32_bf16 v[136:139],v[196:199],v[116:119],v[136:139]
ds_read_b64_tr_b16 v[220:221],v241 offset:4352
ds_read_b64_tr_b16 v[222:223],v241 offset:6528
v_mfma_f32_16x16x32_bf16 v[144:147],v[192:195],v[104:107],v[144:147]
buffer_store_dwordx4 v[184:187],v242,s[28:31],s55 offen offset:3072 sc1
v_mfma_f32_16x16x32_bf16 v[144:147],v[196:199],v[120:123],v[144:147]
s_add_u32 s55,s55,16384
v_mfma_f32_16x16x32_bf16 v[152:155],v[192:195],v[108:111],v[152:155]
s_waitcnt lgkmcnt(8)
v_mfma_f32_16x16x32_bf16 v[152:155],v[196:199],v[124:127],v[152:155]
ds_read_b64_tr_b16 v[192:193],v240 offset:8704
ds_read_b64_tr_b16 v[194:195],v240 offset:10880
v_mfma_f32_16x16x32_bf16 v[132:135],v[200:203],v[96:99],v[132:135]
v_mfma_f32_16x16x32_bf16 v[132:135],v[204:207],v[112:115],v[132:135]
v_mfma_f32_16x16x32_bf16 v[140:143],v[200:203],v[100:103],v[140:143]
v_mfma_f32_16x16x32_bf16 v[140:143],v[204:207],v[116:119],v[140:143]
ds_read_b64_tr_b16 v[196:197],v240 offset:13056
ds_read_b64_tr_b16 v[198:199],v240 offset:15232
v_mfma_f32_16x16x32_bf16 v[148:151],v[200:203],v[104:107],v[148:151]
v_mfma_f32_16x16x32_bf16 v[148:151],v[204:207],v[120:123],v[148:151]
v_mfma_f32_16x16x32_bf16 v[156:159],v[200:203],v[108:111],v[156:159]
s_waitcnt lgkmcnt(8)
v_mfma_f32_16x16x32_bf16 v[156:159],v[204:207],v[124:127],v[156:159]
ds_read_b64_tr_b16 v[200:201],v241 offset:8704
ds_read_b64_tr_b16 v[202:203],v241 offset:10880
v_mfma_f32_16x16x32_bf16 v[160:163],v[208:211],v[0:3],0
v_mul_f32 v128,v128,v224
v_mul_f32 v129,v129,v224
v_mfma_f32_16x16x32_bf16 v[160:163],v[212:215],v[16:19],v[160:163]
v_cvt_pk_bf16_f32 v128,v128,v129
v_mul_f32 v130,v130,v224
v_mfma_f32_16x16x32_bf16 v[168:171],v[208:211],v[4:7],0
v_mul_f32 v131,v131,v224
v_cvt_pk_bf16_f32 v129,v130,v131
v_mfma_f32_16x16x32_bf16 v[168:171],v[212:215],v[20:23],v[168:171]
ds_read_b64_tr_b16 v[204:205],v241 offset:13056
ds_read_b64_tr_b16 v[206:207],v241 offset:15232
v_mfma_f32_16x16x32_bf16 v[176:179],v[208:211],v[8:11],0
v_mul_f32 v132,v132,v224
v_mul_f32 v133,v133,v224
v_mfma_f32_16x16x32_bf16 v[176:179],v[212:215],v[24:27],v[176:179]
v_cvt_pk_bf16_f32 v130,v132,v133
v_mul_f32 v134,v134,v224
v_mfma_f32_16x16x32_bf16 v[184:187],v[208:211],v[12:15],0
s_waitcnt lgkmcnt(8)
v_mul_f32 v135,v135,v224
v_mfma_f32_16x16x32_bf16 v[184:187],v[212:215],v[28:31],v[184:187]
ds_read_b64_tr_b16 v[208:209],v240 offset:17408
ds_read_b64_tr_b16 v[210:211],v240 offset:19584
v_mfma_f32_16x16x32_bf16 v[164:167],v[216:219],v[0:3],0
v_cvt_pk_bf16_f32 v131,v134,v135
v_mul_f32 v136,v136,v225
v_mfma_f32_16x16x32_bf16 v[164:167],v[220:223],v[16:19],v[164:167]
buffer_store_dwordx4 v[128:131],v242,s[28:31],s55 offen offset:0 sc1
v_mfma_f32_16x16x32_bf16 v[172:175],v[216:219],v[4:7],0
v_mul_f32 v137,v137,v225
v_cvt_pk_bf16_f32 v136,v136,v137
v_mfma_f32_16x16x32_bf16 v[172:175],v[220:223],v[20:23],v[172:175]
ds_read_b64_tr_b16 v[212:213],v240 offset:21760
ds_read_b64_tr_b16 v[214:215],v240 offset:23936
v_mfma_f32_16x16x32_bf16 v[180:183],v[216:219],v[8:11],0
v_mul_f32 v138,v138,v225
v_mul_f32 v139,v139,v225
v_mfma_f32_16x16x32_bf16 v[180:183],v[220:223],v[24:27],v[180:183]
v_cvt_pk_bf16_f32 v137,v138,v139
v_mul_f32 v140,v140,v225
v_mfma_f32_16x16x32_bf16 v[188:191],v[216:219],v[12:15],0
s_waitcnt lgkmcnt(8)
v_mul_f32 v141,v141,v225
v_mfma_f32_16x16x32_bf16 v[188:191],v[220:223],v[28:31],v[188:191]
ds_read_b64_tr_b16 v[216:217],v241 offset:17408
ds_read_b64_tr_b16 v[218:219],v241 offset:19584
v_mfma_f32_16x16x32_bf16 v[160:163],v[192:195],v[32:35],v[160:163]
v_cvt_pk_bf16_f32 v138,v140,v141
v_mul_f32 v142,v142,v225
v_mfma_f32_16x16x32_bf16 v[160:163],v[196:199],v[48:51],v[160:163]
v_mul_f32 v143,v143,v225
v_cvt_pk_bf16_f32 v139,v142,v143
v_mfma_f32_16x16x32_bf16 v[168:171],v[192:195],v[36:39],v[168:171]
buffer_store_dwordx4 v[136:139],v242,s[28:31],s55 offen offset:1024 sc1
v_mfma_f32_16x16x32_bf16 v[168:171],v[196:199],v[52:55],v[168:171]
ds_read_b64_tr_b16 v[220:221],v241 offset:21760
ds_read_b64_tr_b16 v[222:223],v241 offset:23936
v_mfma_f32_16x16x32_bf16 v[176:179],v[192:195],v[40:43],v[176:179]
v_mul_f32 v144,v144,v226
v_mul_f32 v145,v145,v226
v_mfma_f32_16x16x32_bf16 v[176:179],v[196:199],v[56:59],v[176:179]
v_cvt_pk_bf16_f32 v144,v144,v145
v_mul_f32 v146,v146,v226
v_mfma_f32_16x16x32_bf16 v[184:187],v[192:195],v[44:47],v[184:187]
s_waitcnt lgkmcnt(8)
v_mul_f32 v147,v147,v226
v_mfma_f32_16x16x32_bf16 v[184:187],v[196:199],v[60:63],v[184:187]
ds_read_b64_tr_b16 v[192:193],v240 offset:26112
ds_read_b64_tr_b16 v[194:195],v240 offset:28288
v_mfma_f32_16x16x32_bf16 v[164:167],v[200:203],v[32:35],v[164:167]
v_cvt_pk_bf16_f32 v145,v146,v147
v_mul_f32 v148,v148,v226
v_mfma_f32_16x16x32_bf16 v[164:167],v[204:207],v[48:51],v[164:167]
v_mul_f32 v149,v149,v226
v_cvt_pk_bf16_f32 v146,v148,v149
v_mfma_f32_16x16x32_bf16 v[172:175],v[200:203],v[36:39],v[172:175]
v_mul_f32 v150,v150,v226
v_mul_f32 v151,v151,v226
v_mfma_f32_16x16x32_bf16 v[172:175],v[204:207],v[52:55],v[172:175]
ds_read_b64_tr_b16 v[196:197],v240 offset:30464
ds_read_b64_tr_b16 v[198:199],v240 offset:32640
v_mfma_f32_16x16x32_bf16 v[180:183],v[200:203],v[40:43],v[180:183]
v_cvt_pk_bf16_f32 v147,v150,v151
v_mul_f32 v152,v152,v227
v_mfma_f32_16x16x32_bf16 v[180:183],v[204:207],v[56:59],v[180:183]
buffer_store_dwordx4 v[144:147],v242,s[28:31],s55 offen offset:2048 sc1
v_mfma_f32_16x16x32_bf16 v[188:191],v[200:203],v[44:47],v[188:191]
s_waitcnt lgkmcnt(8)
v_mul_f32 v153,v153,v227
v_mfma_f32_16x16x32_bf16 v[188:191],v[204:207],v[60:63],v[188:191]
ds_read_b64_tr_b16 v[200:201],v241 offset:26112
ds_read_b64_tr_b16 v[202:203],v241 offset:28288
v_mfma_f32_16x16x32_bf16 v[160:163],v[208:211],v[64:67],v[160:163]
v_cvt_pk_bf16_f32 v152,v152,v153
v_mul_f32 v154,v154,v227
v_mfma_f32_16x16x32_bf16 v[160:163],v[212:215],v[80:83],v[160:163]
v_mul_f32 v155,v155,v227
v_cvt_pk_bf16_f32 v153,v154,v155
v_mfma_f32_16x16x32_bf16 v[168:171],v[208:211],v[68:71],v[168:171]
v_mul_f32 v156,v156,v227
v_mul_f32 v157,v157,v227
v_mfma_f32_16x16x32_bf16 v[168:171],v[212:215],v[84:87],v[168:171]
ds_read_b64_tr_b16 v[204:205],v241 offset:30464
ds_read_b64_tr_b16 v[206:207],v241 offset:32640
v_mfma_f32_16x16x32_bf16 v[176:179],v[208:211],v[72:75],v[176:179]
v_subrev_u32 v240,121856,v240
v_subrev_u32 v241,121856,v241
v_mfma_f32_16x16x32_bf16 v[176:179],v[212:215],v[88:91],v[176:179]
v_cvt_pk_bf16_f32 v154,v156,v157
v_mul_f32 v158,v158,v227
v_mfma_f32_16x16x32_bf16 v[184:187],v[208:211],v[76:79],v[184:187]
s_waitcnt vmcnt(23) lgkmcnt(8)
s_barrier
v_mfma_f32_16x16x32_bf16 v[184:187],v[212:215],v[92:95],v[184:187]
ds_read_b64_tr_b16 v[208:209],v238 offset:0
ds_read_b64_tr_b16 v[210:211],v238 offset:2176
v_mfma_f32_16x16x32_bf16 v[164:167],v[216:219],v[64:67],v[164:167]
v_mul_f32 v159,v159,v227
v_cvt_pk_bf16_f32 v155,v158,v159
v_mfma_f32_16x16x32_bf16 v[164:167],v[220:223],v[80:83],v[164:167]
buffer_store_dwordx4 v[152:155],v242,s[28:31],s55 offen offset:3072 sc1
v_mfma_f32_16x16x32_bf16 v[172:175],v[216:219],v[68:71],v[172:175]
s_add_u32 s55,s55,16384
v_mfma_f32_16x16x32_bf16 v[172:175],v[220:223],v[84:87],v[172:175]
ds_read_b64_tr_b16 v[212:213],v238 offset:4352
ds_read_b64_tr_b16 v[214:215],v238 offset:6528
v_mfma_f32_16x16x32_bf16 v[180:183],v[216:219],v[72:75],v[180:183]
v_mfma_f32_16x16x32_bf16 v[180:183],v[220:223],v[88:91],v[180:183]
v_mfma_f32_16x16x32_bf16 v[188:191],v[216:219],v[76:79],v[188:191]
s_waitcnt lgkmcnt(8)
v_mfma_f32_16x16x32_bf16 v[188:191],v[220:223],v[92:95],v[188:191]
ds_read_b64_tr_b16 v[216:217],v239 offset:0
ds_read_b64_tr_b16 v[218:219],v239 offset:2176
v_mfma_f32_16x16x32_bf16 v[160:163],v[192:195],v[96:99],v[160:163]
v_mfma_f32_16x16x32_bf16 v[160:163],v[196:199],v[112:115],v[160:163]
v_mfma_f32_16x16x32_bf16 v[168:171],v[192:195],v[100:103],v[168:171]
v_mfma_f32_16x16x32_bf16 v[168:171],v[196:199],v[116:119],v[168:171]
ds_read_b64_tr_b16 v[220:221],v239 offset:4352
ds_read_b64_tr_b16 v[222:223],v239 offset:6528
v_mfma_f32_16x16x32_bf16 v[176:179],v[192:195],v[104:107],v[176:179]
v_mfma_f32_16x16x32_bf16 v[176:179],v[196:199],v[120:123],v[176:179]
v_mfma_f32_16x16x32_bf16 v[184:187],v[192:195],v[108:111],v[184:187]
s_waitcnt lgkmcnt(8)
v_mfma_f32_16x16x32_bf16 v[184:187],v[196:199],v[124:127],v[184:187]
ds_read_b64_tr_b16 v[192:193],v238 offset:8704
ds_read_b64_tr_b16 v[194:195],v238 offset:10880
v_mfma_f32_16x16x32_bf16 v[164:167],v[200:203],v[96:99],v[164:167]
v_mfma_f32_16x16x32_bf16 v[164:167],v[204:207],v[112:115],v[164:167]
v_mfma_f32_16x16x32_bf16 v[172:175],v[200:203],v[100:103],v[172:175]
v_mfma_f32_16x16x32_bf16 v[172:175],v[204:207],v[116:119],v[172:175]
ds_read_b64_tr_b16 v[196:197],v238 offset:13056
ds_read_b64_tr_b16 v[198:199],v238 offset:15232
v_mfma_f32_16x16x32_bf16 v[180:183],v[200:203],v[104:107],v[180:183]
v_mfma_f32_16x16x32_bf16 v[180:183],v[204:207],v[120:123],v[180:183]
v_mfma_f32_16x16x32_bf16 v[188:191],v[200:203],v[108:111],v[188:191]
s_waitcnt lgkmcnt(8)
v_mfma_f32_16x16x32_bf16 v[188:191],v[204:207],v[124:127],v[188:191]
ds_read_b64_tr_b16 v[200:201],v239 offset:8704
ds_read_b64_tr_b16 v[202:203],v239 offset:10880
v_mfma_f32_16x16x32_bf16 v[128:131],v[208:211],v[0:3],0
v_mul_f32 v160,v160,v224
v_mul_f32 v161,v161,v224
v_mfma_f32_16x16x32_bf16 v[128:131],v[212:215],v[16:19],v[128:131]
v_cvt_pk_bf16_f32 v160,v160,v161
v_mul_f32 v162,v162,v224
v_mfma_f32_16x16x32_bf16 v[136:139],v[208:211],v[4:7],0
v_mul_f32 v163,v163,v224
v_cvt_pk_bf16_f32 v161,v162,v163
v_mfma_f32_16x16x32_bf16 v[136:139],v[212:215],v[20:23],v[136:139]
ds_read_b64_tr_b16 v[204:205],v239 offset:13056
ds_read_b64_tr_b16 v[206:207],v239 offset:15232
v_mfma_f32_16x16x32_bf16 v[144:147],v[208:211],v[8:11],0
v_mul_f32 v164,v164,v224
v_mul_f32 v165,v165,v224
v_mfma_f32_16x16x32_bf16 v[144:147],v[212:215],v[24:27],v[144:147]
v_cvt_pk_bf16_f32 v162,v164,v165
v_mul_f32 v166,v166,v224
v_mfma_f32_16x16x32_bf16 v[152:155],v[208:211],v[12:15],0
s_waitcnt lgkmcnt(8)
v_mul_f32 v167,v167,v224
v_mfma_f32_16x16x32_bf16 v[152:155],v[212:215],v[28:31],v[152:155]
ds_read_b64_tr_b16 v[208:209],v238 offset:17408
ds_read_b64_tr_b16 v[210:211],v238 offset:19584
v_mfma_f32_16x16x32_bf16 v[132:135],v[216:219],v[0:3],0
v_cvt_pk_bf16_f32 v163,v166,v167
v_mul_f32 v168,v168,v225
v_mfma_f32_16x16x32_bf16 v[132:135],v[220:223],v[16:19],v[132:135]
buffer_store_dwordx4 v[160:163],v242,s[28:31],s55 offen offset:0 sc1
v_mfma_f32_16x16x32_bf16 v[140:143],v[216:219],v[4:7],0
v_mul_f32 v169,v169,v225
v_cvt_pk_bf16_f32 v168,v168,v169
v_mfma_f32_16x16x32_bf16 v[140:143],v[220:223],v[20:23],v[140:143]
ds_read_b64_tr_b16 v[212:213],v238 offset:21760
ds_read_b64_tr_b16 v[214:215],v238 offset:23936
v_mfma_f32_16x16x32_bf16 v[148:151],v[216:219],v[8:11],0
v_mul_f32 v170,v170,v225
v_mul_f32 v171,v171,v225
v_mfma_f32_16x16x32_bf16 v[148:151],v[220:223],v[24:27],v[148:151]
v_cvt_pk_bf16_f32 v169,v170,v171
v_mul_f32 v172,v172,v225
v_mfma_f32_16x16x32_bf16 v[156:159],v[216:219],v[12:15],0
s_waitcnt lgkmcnt(8)
v_mul_f32 v173,v173,v225
v_mfma_f32_16x16x32_bf16 v[156:159],v[220:223],v[28:31],v[156:159]
ds_read_b64_tr_b16 v[216:217],v239 offset:17408
ds_read_b64_tr_b16 v[218:219],v239 offset:19584
v_mfma_f32_16x16x32_bf16 v[128:131],v[192:195],v[32:35],v[128:131]
v_cvt_pk_bf16_f32 v170,v172,v173
v_mul_f32 v174,v174,v225
v_mfma_f32_16x16x32_bf16 v[128:131],v[196:199],v[48:51],v[128:131]
v_mul_f32 v175,v175,v225
v_cvt_pk_bf16_f32 v171,v174,v175
v_mfma_f32_16x16x32_bf16 v[136:139],v[192:195],v[36:39],v[136:139]
buffer_store_dwordx4 v[168:171],v242,s[28:31],s55 offen offset:1024 sc1
v_mfma_f32_16x16x32_bf16 v[136:139],v[196:199],v[52:55],v[136:139]
ds_read_b64_tr_b16 v[220:221],v239 offset:21760
ds_read_b64_tr_b16 v[222:223],v239 offset:23936
v_mfma_f32_16x16x32_bf16 v[144:147],v[192:195],v[40:43],v[144:147]
v_mul_f32 v176,v176,v226
v_mul_f32 v177,v177,v226
v_mfma_f32_16x16x32_bf16 v[144:147],v[196:199],v[56:59],v[144:147]
v_cvt_pk_bf16_f32 v176,v176,v177
v_mul_f32 v178,v178,v226
v_mfma_f32_16x16x32_bf16 v[152:155],v[192:195],v[44:47],v[152:155]
s_waitcnt lgkmcnt(8)
v_mul_f32 v179,v179,v226
v_mfma_f32_16x16x32_bf16 v[152:155],v[196:199],v[60:63],v[152:155]
ds_read_b64_tr_b16 v[192:193],v238 offset:26112
ds_read_b64_tr_b16 v[194:195],v238 offset:28288
v_mfma_f32_16x16x32_bf16 v[132:135],v[200:203],v[32:35],v[132:135]
v_cvt_pk_bf16_f32 v177,v178,v179
v_mul_f32 v180,v180,v226
v_mfma_f32_16x16x32_bf16 v[132:135],v[204:207],v[48:51],v[132:135]
v_mul_f32 v181,v181,v226
v_cvt_pk_bf16_f32 v178,v180,v181
v_mfma_f32_16x16x32_bf16 v[140:143],v[200:203],v[36:39],v[140:143]
v_mul_f32 v182,v182,v226
v_mul_f32 v183,v183,v226
v_mfma_f32_16x16x32_bf16 v[140:143],v[204:207],v[52:55],v[140:143]
ds_read_b64_tr_b16 v[196:197],v238 offset:30464
ds_read_b64_tr_b16 v[198:199],v238 offset:32640
v_mfma_f32_16x16x32_bf16 v[148:151],v[200:203],v[40:43],v[148:151]
v_cvt_pk_bf16_f32 v179,v182,v183
v_mul_f32 v184,v184,v227
v_mfma_f32_16x16x32_bf16 v[148:151],v[204:207],v[56:59],v[148:151]
buffer_store_dwordx4 v[176:179],v242,s[28:31],s55 offen offset:2048 sc1
v_mfma_f32_16x16x32_bf16 v[156:159],v[200:203],v[44:47],v[156:159]
s_waitcnt lgkmcnt(8)
v_mul_f32 v185,v185,v227
v_mfma_f32_16x16x32_bf16 v[156:159],v[204:207],v[60:63],v[156:159]
ds_read_b64_tr_b16 v[200:201],v239 offset:26112
ds_read_b64_tr_b16 v[202:203],v239 offset:28288
v_mfma_f32_16x16x32_bf16 v[128:131],v[208:211],v[64:67],v[128:131]
v_cvt_pk_bf16_f32 v184,v184,v185
v_mul_f32 v186,v186,v227
v_mfma_f32_16x16x32_bf16 v[128:131],v[212:215],v[80:83],v[128:131]
v_mul_f32 v187,v187,v227
v_cvt_pk_bf16_f32 v185,v186,v187
v_mfma_f32_16x16x32_bf16 v[136:139],v[208:211],v[68:71],v[136:139]
v_mul_f32 v188,v188,v227
v_mul_f32 v189,v189,v227
v_mfma_f32_16x16x32_bf16 v[136:139],v[212:215],v[84:87],v[136:139]
ds_read_b64_tr_b16 v[204:205],v239 offset:30464
ds_read_b64_tr_b16 v[206:207],v239 offset:32640
v_mfma_f32_16x16x32_bf16 v[144:147],v[208:211],v[72:75],v[144:147]
v_add_u32 v238,69632,v238
v_add_u32 v239,69632,v239
v_mfma_f32_16x16x32_bf16 v[144:147],v[212:215],v[88:91],v[144:147]
v_cvt_pk_bf16_f32 v186,v188,v189
v_mul_f32 v190,v190,v227
v_mfma_f32_16x16x32_bf16 v[152:155],v[208:211],v[76:79],v[152:155]
s_waitcnt lgkmcnt(8)
v_mul_f32 v191,v191,v227
v_mfma_f32_16x16x32_bf16 v[152:155],v[212:215],v[92:95],v[152:155]
ds_read_b64_tr_b16 v[208:209],v240 offset:0
ds_read_b64_tr_b16 v[210:211],v240 offset:2176
v_mfma_f32_16x16x32_bf16 v[132:135],v[216:219],v[64:67],v[132:135]
v_cvt_pk_bf16_f32 v187,v190,v191
v_mfma_f32_16x16x32_bf16 v[132:135],v[220:223],v[80:83],v[132:135]
buffer_store_dwordx4 v[184:187],v242,s[28:31],s55 offen offset:3072 sc1
v_mfma_f32_16x16x32_bf16 v[140:143],v[216:219],v[68:71],v[140:143]
s_add_u32 s55,s55,16384
v_mfma_f32_16x16x32_bf16 v[140:143],v[220:223],v[84:87],v[140:143]
ds_read_b64_tr_b16 v[212:213],v240 offset:4352
ds_read_b64_tr_b16 v[214:215],v240 offset:6528
v_mfma_f32_16x16x32_bf16 v[148:151],v[216:219],v[72:75],v[148:151]
v_mfma_f32_16x16x32_bf16 v[148:151],v[220:223],v[88:91],v[148:151]
v_mfma_f32_16x16x32_bf16 v[156:159],v[216:219],v[76:79],v[156:159]
s_waitcnt lgkmcnt(8)
v_mfma_f32_16x16x32_bf16 v[156:159],v[220:223],v[92:95],v[156:159]
ds_read_b64_tr_b16 v[216:217],v241 offset:0
ds_read_b64_tr_b16 v[218:219],v241 offset:2176
v_mfma_f32_16x16x32_bf16 v[128:131],v[192:195],v[96:99],v[128:131]
v_mfma_f32_16x16x32_bf16 v[128:131],v[196:199],v[112:115],v[128:131]
v_mfma_f32_16x16x32_bf16 v[136:139],v[192:195],v[100:103],v[136:139]
v_mfma_f32_16x16x32_bf16 v[136:139],v[196:199],v[116:119],v[136:139]
ds_read_b64_tr_b16 v[220:221],v241 offset:4352
ds_read_b64_tr_b16 v[222:223],v241 offset:6528
v_mfma_f32_16x16x32_bf16 v[144:147],v[192:195],v[104:107],v[144:147]
v_mfma_f32_16x16x32_bf16 v[144:147],v[196:199],v[120:123],v[144:147]
v_mfma_f32_16x16x32_bf16 v[152:155],v[192:195],v[108:111],v[152:155]
s_waitcnt lgkmcnt(8)
v_mfma_f32_16x16x32_bf16 v[152:155],v[196:199],v[124:127],v[152:155]
ds_read_b64_tr_b16 v[192:193],v240 offset:8704
ds_read_b64_tr_b16 v[194:195],v240 offset:10880
v_mfma_f32_16x16x32_bf16 v[132:135],v[200:203],v[96:99],v[132:135]
v_mfma_f32_16x16x32_bf16 v[132:135],v[204:207],v[112:115],v[132:135]
v_mfma_f32_16x16x32_bf16 v[140:143],v[200:203],v[100:103],v[140:143]
v_mfma_f32_16x16x32_bf16 v[140:143],v[204:207],v[116:119],v[140:143]
ds_read_b64_tr_b16 v[196:197],v240 offset:13056
ds_read_b64_tr_b16 v[198:199],v240 offset:15232
v_mfma_f32_16x16x32_bf16 v[148:151],v[200:203],v[104:107],v[148:151]
v_mfma_f32_16x16x32_bf16 v[148:151],v[204:207],v[120:123],v[148:151]
v_mfma_f32_16x16x32_bf16 v[156:159],v[200:203],v[108:111],v[156:159]
s_waitcnt lgkmcnt(8)
v_mfma_f32_16x16x32_bf16 v[156:159],v[204:207],v[124:127],v[156:159]
ds_read_b64_tr_b16 v[200:201],v241 offset:8704
ds_read_b64_tr_b16 v[202:203],v241 offset:10880
v_mfma_f32_16x16x32_bf16 v[160:163],v[208:211],v[0:3],0
v_mul_f32 v128,v128,v224
v_mul_f32 v129,v129,v224
v_mfma_f32_16x16x32_bf16 v[160:163],v[212:215],v[16:19],v[160:163]
v_cvt_pk_bf16_f32 v128,v128,v129
v_mul_f32 v130,v130,v224
v_mfma_f32_16x16x32_bf16 v[168:171],v[208:211],v[4:7],0
v_mul_f32 v131,v131,v224
v_cvt_pk_bf16_f32 v129,v130,v131
v_mfma_f32_16x16x32_bf16 v[168:171],v[212:215],v[20:23],v[168:171]
ds_read_b64_tr_b16 v[204:205],v241 offset:13056
ds_read_b64_tr_b16 v[206:207],v241 offset:15232
v_mfma_f32_16x16x32_bf16 v[176:179],v[208:211],v[8:11],0
v_mul_f32 v132,v132,v224
v_mul_f32 v133,v133,v224
v_mfma_f32_16x16x32_bf16 v[176:179],v[212:215],v[24:27],v[176:179]
v_cvt_pk_bf16_f32 v130,v132,v133
v_mul_f32 v134,v134,v224
v_mfma_f32_16x16x32_bf16 v[184:187],v[208:211],v[12:15],0
s_waitcnt lgkmcnt(8)
v_mul_f32 v135,v135,v224
v_mfma_f32_16x16x32_bf16 v[184:187],v[212:215],v[28:31],v[184:187]
ds_read_b64_tr_b16 v[208:209],v240 offset:17408
ds_read_b64_tr_b16 v[210:211],v240 offset:19584
v_mfma_f32_16x16x32_bf16 v[164:167],v[216:219],v[0:3],0
v_cvt_pk_bf16_f32 v131,v134,v135
v_mul_f32 v136,v136,v225
v_mfma_f32_16x16x32_bf16 v[164:167],v[220:223],v[16:19],v[164:167]
buffer_store_dwordx4 v[128:131],v242,s[28:31],s55 offen offset:0 sc1
v_mfma_f32_16x16x32_bf16 v[172:175],v[216:219],v[4:7],0
v_mul_f32 v137,v137,v225
v_cvt_pk_bf16_f32 v136,v136,v137
v_mfma_f32_16x16x32_bf16 v[172:175],v[220:223],v[20:23],v[172:175]
ds_read_b64_tr_b16 v[212:213],v240 offset:21760
ds_read_b64_tr_b16 v[214:215],v240 offset:23936
v_mfma_f32_16x16x32_bf16 v[180:183],v[216:219],v[8:11],0
v_mul_f32 v138,v138,v225
v_mul_f32 v139,v139,v225
v_mfma_f32_16x16x32_bf16 v[180:183],v[220:223],v[24:27],v[180:183]
v_cvt_pk_bf16_f32 v137,v138,v139
v_mul_f32 v140,v140,v225
v_mfma_f32_16x16x32_bf16 v[188:191],v[216:219],v[12:15],0
s_waitcnt lgkmcnt(8)
v_mul_f32 v141,v141,v225
v_mfma_f32_16x16x32_bf16 v[188:191],v[220:223],v[28:31],v[188:191]
ds_read_b64_tr_b16 v[216:217],v241 offset:17408
ds_read_b64_tr_b16 v[218:219],v241 offset:19584
v_mfma_f32_16x16x32_bf16 v[160:163],v[192:195],v[32:35],v[160:163]
v_cvt_pk_bf16_f32 v138,v140,v141
v_mul_f32 v142,v142,v225
v_mfma_f32_16x16x32_bf16 v[160:163],v[196:199],v[48:51],v[160:163]
v_mul_f32 v143,v143,v225
v_cvt_pk_bf16_f32 v139,v142,v143
v_mfma_f32_16x16x32_bf16 v[168:171],v[192:195],v[36:39],v[168:171]
buffer_store_dwordx4 v[136:139],v242,s[28:31],s55 offen offset:1024 sc1
v_mfma_f32_16x16x32_bf16 v[168:171],v[196:199],v[52:55],v[168:171]
ds_read_b64_tr_b16 v[220:221],v241 offset:21760
ds_read_b64_tr_b16 v[222:223],v241 offset:23936
v_mfma_f32_16x16x32_bf16 v[176:179],v[192:195],v[40:43],v[176:179]
v_mul_f32 v144,v144,v226
v_mul_f32 v145,v145,v226
v_mfma_f32_16x16x32_bf16 v[176:179],v[196:199],v[56:59],v[176:179]
v_cvt_pk_bf16_f32 v144,v144,v145
v_mul_f32 v146,v146,v226
v_mfma_f32_16x16x32_bf16 v[184:187],v[192:195],v[44:47],v[184:187]
s_waitcnt lgkmcnt(8)
v_mul_f32 v147,v147,v226
v_mfma_f32_16x16x32_bf16 v[184:187],v[196:199],v[60:63],v[184:187]
ds_read_b64_tr_b16 v[192:193],v240 offset:26112
ds_read_b64_tr_b16 v[194:195],v240 offset:28288
v_mfma_f32_16x16x32_bf16 v[164:167],v[200:203],v[32:35],v[164:167]
v_cvt_pk_bf16_f32 v145,v146,v147
v_mul_f32 v148,v148,v226
v_mfma_f32_16x16x32_bf16 v[164:167],v[204:207],v[48:51],v[164:167]
v_mul_f32 v149,v149,v226
v_cvt_pk_bf16_f32 v146,v148,v149
v_mfma_f32_16x16x32_bf16 v[172:175],v[200:203],v[36:39],v[172:175]
v_mul_f32 v150,v150,v226
v_mul_f32 v151,v151,v226
v_mfma_f32_16x16x32_bf16 v[172:175],v[204:207],v[52:55],v[172:175]
ds_read_b64_tr_b16 v[196:197],v240 offset:30464
ds_read_b64_tr_b16 v[198:199],v240 offset:32640
v_mfma_f32_16x16x32_bf16 v[180:183],v[200:203],v[40:43],v[180:183]
v_cvt_pk_bf16_f32 v147,v150,v151
v_mul_f32 v152,v152,v227
v_mfma_f32_16x16x32_bf16 v[180:183],v[204:207],v[56:59],v[180:183]
buffer_store_dwordx4 v[144:147],v242,s[28:31],s55 offen offset:2048 sc1
v_mfma_f32_16x16x32_bf16 v[188:191],v[200:203],v[44:47],v[188:191]
s_waitcnt lgkmcnt(8)
v_mul_f32 v153,v153,v227
v_mfma_f32_16x16x32_bf16 v[188:191],v[204:207],v[60:63],v[188:191]
ds_read_b64_tr_b16 v[200:201],v241 offset:26112
ds_read_b64_tr_b16 v[202:203],v241 offset:28288
v_mfma_f32_16x16x32_bf16 v[160:163],v[208:211],v[64:67],v[160:163]
v_cvt_pk_bf16_f32 v152,v152,v153
v_mul_f32 v154,v154,v227
v_mfma_f32_16x16x32_bf16 v[160:163],v[212:215],v[80:83],v[160:163]
v_mul_f32 v155,v155,v227
v_cvt_pk_bf16_f32 v153,v154,v155
v_mfma_f32_16x16x32_bf16 v[168:171],v[208:211],v[68:71],v[168:171]
v_mul_f32 v156,v156,v227
v_mul_f32 v157,v157,v227
v_mfma_f32_16x16x32_bf16 v[168:171],v[212:215],v[84:87],v[168:171]
ds_read_b64_tr_b16 v[204:205],v241 offset:30464
ds_read_b64_tr_b16 v[206:207],v241 offset:32640
v_mfma_f32_16x16x32_bf16 v[176:179],v[208:211],v[72:75],v[176:179]
v_add_u32 v240,69632,v240
v_add_u32 v241,69632,v241
v_mfma_f32_16x16x32_bf16 v[176:179],v[212:215],v[88:91],v[176:179]
v_cvt_pk_bf16_f32 v154,v156,v157
v_mul_f32 v158,v158,v227
v_mfma_f32_16x16x32_bf16 v[184:187],v[208:211],v[76:79],v[184:187]
s_waitcnt vmcnt(15) lgkmcnt(8)
s_barrier
v_mfma_f32_16x16x32_bf16 v[184:187],v[212:215],v[92:95],v[184:187]
ds_read_b64_tr_b16 v[208:209],v238 offset:0
ds_read_b64_tr_b16 v[210:211],v238 offset:2176
v_mfma_f32_16x16x32_bf16 v[164:167],v[216:219],v[64:67],v[164:167]
v_mul_f32 v159,v159,v227
v_cvt_pk_bf16_f32 v155,v158,v159
v_mfma_f32_16x16x32_bf16 v[164:167],v[220:223],v[80:83],v[164:167]
buffer_store_dwordx4 v[152:155],v242,s[28:31],s55 offen offset:3072 sc1
v_mfma_f32_16x16x32_bf16 v[172:175],v[216:219],v[68:71],v[172:175]
s_add_u32 s55,s55,16384
v_mfma_f32_16x16x32_bf16 v[172:175],v[220:223],v[84:87],v[172:175]
ds_read_b64_tr_b16 v[212:213],v238 offset:4352
ds_read_b64_tr_b16 v[214:215],v238 offset:6528
v_mfma_f32_16x16x32_bf16 v[180:183],v[216:219],v[72:75],v[180:183]
v_mfma_f32_16x16x32_bf16 v[180:183],v[220:223],v[88:91],v[180:183]
v_mfma_f32_16x16x32_bf16 v[188:191],v[216:219],v[76:79],v[188:191]
s_waitcnt lgkmcnt(8)
v_mfma_f32_16x16x32_bf16 v[188:191],v[220:223],v[92:95],v[188:191]
ds_read_b64_tr_b16 v[216:217],v239 offset:0
ds_read_b64_tr_b16 v[218:219],v239 offset:2176
v_mfma_f32_16x16x32_bf16 v[160:163],v[192:195],v[96:99],v[160:163]
v_mfma_f32_16x16x32_bf16 v[160:163],v[196:199],v[112:115],v[160:163]
v_mfma_f32_16x16x32_bf16 v[168:171],v[192:195],v[100:103],v[168:171]
v_mfma_f32_16x16x32_bf16 v[168:171],v[196:199],v[116:119],v[168:171]
ds_read_b64_tr_b16 v[220:221],v239 offset:4352
ds_read_b64_tr_b16 v[222:223],v239 offset:6528
v_mfma_f32_16x16x32_bf16 v[176:179],v[192:195],v[104:107],v[176:179]
v_mfma_f32_16x16x32_bf16 v[176:179],v[196:199],v[120:123],v[176:179]
v_mfma_f32_16x16x32_bf16 v[184:187],v[192:195],v[108:111],v[184:187]
s_waitcnt lgkmcnt(8)
v_mfma_f32_16x16x32_bf16 v[184:187],v[196:199],v[124:127],v[184:187]
ds_read_b64_tr_b16 v[192:193],v238 offset:8704
ds_read_b64_tr_b16 v[194:195],v238 offset:10880
v_mfma_f32_16x16x32_bf16 v[164:167],v[200:203],v[96:99],v[164:167]
v_mfma_f32_16x16x32_bf16 v[164:167],v[204:207],v[112:115],v[164:167]
v_mfma_f32_16x16x32_bf16 v[172:175],v[200:203],v[100:103],v[172:175]
v_mfma_f32_16x16x32_bf16 v[172:175],v[204:207],v[116:119],v[172:175]
ds_read_b64_tr_b16 v[196:197],v238 offset:13056
ds_read_b64_tr_b16 v[198:199],v238 offset:15232
v_mfma_f32_16x16x32_bf16 v[180:183],v[200:203],v[104:107],v[180:183]
v_mfma_f32_16x16x32_bf16 v[180:183],v[204:207],v[120:123],v[180:183]
v_mfma_f32_16x16x32_bf16 v[188:191],v[200:203],v[108:111],v[188:191]
s_waitcnt lgkmcnt(8)
v_mfma_f32_16x16x32_bf16 v[188:191],v[204:207],v[124:127],v[188:191]
ds_read_b64_tr_b16 v[200:201],v239 offset:8704
ds_read_b64_tr_b16 v[202:203],v239 offset:10880
v_mfma_f32_16x16x32_bf16 v[128:131],v[208:211],v[0:3],0
v_mul_f32 v160,v160,v224
v_mul_f32 v161,v161,v224
v_mfma_f32_16x16x32_bf16 v[128:131],v[212:215],v[16:19],v[128:131]
v_cvt_pk_bf16_f32 v160,v160,v161
v_mul_f32 v162,v162,v224
v_mfma_f32_16x16x32_bf16 v[136:139],v[208:211],v[4:7],0
v_mul_f32 v163,v163,v224
v_cvt_pk_bf16_f32 v161,v162,v163
v_mfma_f32_16x16x32_bf16 v[136:139],v[212:215],v[20:23],v[136:139]
ds_read_b64_tr_b16 v[204:205],v239 offset:13056
ds_read_b64_tr_b16 v[206:207],v239 offset:15232
v_mfma_f32_16x16x32_bf16 v[144:147],v[208:211],v[8:11],0
v_mul_f32 v164,v164,v224
v_mul_f32 v165,v165,v224
v_mfma_f32_16x16x32_bf16 v[144:147],v[212:215],v[24:27],v[144:147]
v_cvt_pk_bf16_f32 v162,v164,v165
v_mul_f32 v166,v166,v224
v_mfma_f32_16x16x32_bf16 v[152:155],v[208:211],v[12:15],0
s_waitcnt lgkmcnt(8)
v_mul_f32 v167,v167,v224
v_mfma_f32_16x16x32_bf16 v[152:155],v[212:215],v[28:31],v[152:155]
ds_read_b64_tr_b16 v[208:209],v238 offset:17408
ds_read_b64_tr_b16 v[210:211],v238 offset:19584
v_mfma_f32_16x16x32_bf16 v[132:135],v[216:219],v[0:3],0
v_cvt_pk_bf16_f32 v163,v166,v167
v_mul_f32 v168,v168,v225
v_mfma_f32_16x16x32_bf16 v[132:135],v[220:223],v[16:19],v[132:135]
buffer_store_dwordx4 v[160:163],v242,s[28:31],s55 offen offset:0 sc1
v_mfma_f32_16x16x32_bf16 v[140:143],v[216:219],v[4:7],0
v_mul_f32 v169,v169,v225
v_cvt_pk_bf16_f32 v168,v168,v169
v_mfma_f32_16x16x32_bf16 v[140:143],v[220:223],v[20:23],v[140:143]
ds_read_b64_tr_b16 v[212:213],v238 offset:21760
ds_read_b64_tr_b16 v[214:215],v238 offset:23936
v_mfma_f32_16x16x32_bf16 v[148:151],v[216:219],v[8:11],0
v_mul_f32 v170,v170,v225
v_mul_f32 v171,v171,v225
v_mfma_f32_16x16x32_bf16 v[148:151],v[220:223],v[24:27],v[148:151]
v_cvt_pk_bf16_f32 v169,v170,v171
v_mul_f32 v172,v172,v225
v_mfma_f32_16x16x32_bf16 v[156:159],v[216:219],v[12:15],0
s_waitcnt lgkmcnt(8)
v_mul_f32 v173,v173,v225
v_mfma_f32_16x16x32_bf16 v[156:159],v[220:223],v[28:31],v[156:159]
ds_read_b64_tr_b16 v[216:217],v239 offset:17408
ds_read_b64_tr_b16 v[218:219],v239 offset:19584
v_mfma_f32_16x16x32_bf16 v[128:131],v[192:195],v[32:35],v[128:131]
v_cvt_pk_bf16_f32 v170,v172,v173
v_mul_f32 v174,v174,v225
v_mfma_f32_16x16x32_bf16 v[128:131],v[196:199],v[48:51],v[128:131]
v_mul_f32 v175,v175,v225
v_cvt_pk_bf16_f32 v171,v174,v175
v_mfma_f32_16x16x32_bf16 v[136:139],v[192:195],v[36:39],v[136:139]
buffer_store_dwordx4 v[168:171],v242,s[28:31],s55 offen offset:1024 sc1
v_mfma_f32_16x16x32_bf16 v[136:139],v[196:199],v[52:55],v[136:139]
ds_read_b64_tr_b16 v[220:221],v239 offset:21760
ds_read_b64_tr_b16 v[222:223],v239 offset:23936
v_mfma_f32_16x16x32_bf16 v[144:147],v[192:195],v[40:43],v[144:147]
v_mul_f32 v176,v176,v226
v_mul_f32 v177,v177,v226
v_mfma_f32_16x16x32_bf16 v[144:147],v[196:199],v[56:59],v[144:147]
v_cvt_pk_bf16_f32 v176,v176,v177
v_mul_f32 v178,v178,v226
v_mfma_f32_16x16x32_bf16 v[152:155],v[192:195],v[44:47],v[152:155]
s_waitcnt lgkmcnt(8)
v_mul_f32 v179,v179,v226
v_mfma_f32_16x16x32_bf16 v[152:155],v[196:199],v[60:63],v[152:155]
ds_read_b64_tr_b16 v[192:193],v238 offset:26112
ds_read_b64_tr_b16 v[194:195],v238 offset:28288
v_mfma_f32_16x16x32_bf16 v[132:135],v[200:203],v[32:35],v[132:135]
v_cvt_pk_bf16_f32 v177,v178,v179
v_mul_f32 v180,v180,v226
v_mfma_f32_16x16x32_bf16 v[132:135],v[204:207],v[48:51],v[132:135]
v_mul_f32 v181,v181,v226
v_cvt_pk_bf16_f32 v178,v180,v181
v_mfma_f32_16x16x32_bf16 v[140:143],v[200:203],v[36:39],v[140:143]
v_mul_f32 v182,v182,v226
v_mul_f32 v183,v183,v226
v_mfma_f32_16x16x32_bf16 v[140:143],v[204:207],v[52:55],v[140:143]
ds_read_b64_tr_b16 v[196:197],v238 offset:30464
ds_read_b64_tr_b16 v[198:199],v238 offset:32640
v_mfma_f32_16x16x32_bf16 v[148:151],v[200:203],v[40:43],v[148:151]
v_cvt_pk_bf16_f32 v179,v182,v183
v_mul_f32 v184,v184,v227
v_mfma_f32_16x16x32_bf16 v[148:151],v[204:207],v[56:59],v[148:151]
buffer_store_dwordx4 v[176:179],v242,s[28:31],s55 offen offset:2048 sc1
v_mfma_f32_16x16x32_bf16 v[156:159],v[200:203],v[44:47],v[156:159]
s_waitcnt lgkmcnt(8)
v_mul_f32 v185,v185,v227
v_mfma_f32_16x16x32_bf16 v[156:159],v[204:207],v[60:63],v[156:159]
ds_read_b64_tr_b16 v[200:201],v239 offset:26112
ds_read_b64_tr_b16 v[202:203],v239 offset:28288
v_mfma_f32_16x16x32_bf16 v[128:131],v[208:211],v[64:67],v[128:131]
v_cvt_pk_bf16_f32 v184,v184,v185
v_mul_f32 v186,v186,v227
v_mfma_f32_16x16x32_bf16 v[128:131],v[212:215],v[80:83],v[128:131]
v_mul_f32 v187,v187,v227
v_cvt_pk_bf16_f32 v185,v186,v187
v_mfma_f32_16x16x32_bf16 v[136:139],v[208:211],v[68:71],v[136:139]
v_mul_f32 v188,v188,v227
v_mul_f32 v189,v189,v227
v_mfma_f32_16x16x32_bf16 v[136:139],v[212:215],v[84:87],v[136:139]
ds_read_b64_tr_b16 v[204:205],v239 offset:30464
ds_read_b64_tr_b16 v[206:207],v239 offset:32640
v_mfma_f32_16x16x32_bf16 v[144:147],v[208:211],v[72:75],v[144:147]
v_cvt_pk_bf16_f32 v186,v188,v189
v_mul_f32 v190,v190,v227
v_mfma_f32_16x16x32_bf16 v[144:147],v[212:215],v[88:91],v[144:147]
v_mul_f32 v191,v191,v227
v_cvt_pk_bf16_f32 v187,v190,v191
v_mfma_f32_16x16x32_bf16 v[152:155],v[208:211],v[76:79],v[152:155]
s_waitcnt lgkmcnt(8)
v_mfma_f32_16x16x32_bf16 v[152:155],v[212:215],v[92:95],v[152:155]
ds_read_b64_tr_b16 v[208:209],v240 offset:0
ds_read_b64_tr_b16 v[210:211],v240 offset:2176
v_mfma_f32_16x16x32_bf16 v[132:135],v[216:219],v[64:67],v[132:135]
buffer_store_dwordx4 v[184:187],v242,s[28:31],s55 offen offset:3072 sc1
v_mfma_f32_16x16x32_bf16 v[132:135],v[220:223],v[80:83],v[132:135]
s_add_u32 s55,s55,16384
v_mfma_f32_16x16x32_bf16 v[140:143],v[216:219],v[68:71],v[140:143]
v_mfma_f32_16x16x32_bf16 v[140:143],v[220:223],v[84:87],v[140:143]
ds_read_b64_tr_b16 v[212:213],v240 offset:4352
ds_read_b64_tr_b16 v[214:215],v240 offset:6528
v_mfma_f32_16x16x32_bf16 v[148:151],v[216:219],v[72:75],v[148:151]
v_mfma_f32_16x16x32_bf16 v[148:151],v[220:223],v[88:91],v[148:151]
v_mfma_f32_16x16x32_bf16 v[156:159],v[216:219],v[76:79],v[156:159]
s_waitcnt lgkmcnt(8)
v_mfma_f32_16x16x32_bf16 v[156:159],v[220:223],v[92:95],v[156:159]
ds_read_b64_tr_b16 v[216:217],v241 offset:0
ds_read_b64_tr_b16 v[218:219],v241 offset:2176
v_mfma_f32_16x16x32_bf16 v[128:131],v[192:195],v[96:99],v[128:131]
v_mfma_f32_16x16x32_bf16 v[128:131],v[196:199],v[112:115],v[128:131]
v_mfma_f32_16x16x32_bf16 v[136:139],v[192:195],v[100:103],v[136:139]
v_mfma_f32_16x16x32_bf16 v[136:139],v[196:199],v[116:119],v[136:139]
ds_read_b64_tr_b16 v[220:221],v241 offset:4352
ds_read_b64_tr_b16 v[222:223],v241 offset:6528
v_mfma_f32_16x16x32_bf16 v[144:147],v[192:195],v[104:107],v[144:147]
v_mfma_f32_16x16x32_bf16 v[144:147],v[196:199],v[120:123],v[144:147]
v_mfma_f32_16x16x32_bf16 v[152:155],v[192:195],v[108:111],v[152:155]
s_waitcnt lgkmcnt(8)
v_mfma_f32_16x16x32_bf16 v[152:155],v[196:199],v[124:127],v[152:155]
ds_read_b64_tr_b16 v[192:193],v240 offset:8704
ds_read_b64_tr_b16 v[194:195],v240 offset:10880
v_mfma_f32_16x16x32_bf16 v[132:135],v[200:203],v[96:99],v[132:135]
v_mfma_f32_16x16x32_bf16 v[132:135],v[204:207],v[112:115],v[132:135]
v_mfma_f32_16x16x32_bf16 v[140:143],v[200:203],v[100:103],v[140:143]
v_mfma_f32_16x16x32_bf16 v[140:143],v[204:207],v[116:119],v[140:143]
ds_read_b64_tr_b16 v[196:197],v240 offset:13056
ds_read_b64_tr_b16 v[198:199],v240 offset:15232
v_mfma_f32_16x16x32_bf16 v[148:151],v[200:203],v[104:107],v[148:151]
v_mfma_f32_16x16x32_bf16 v[148:151],v[204:207],v[120:123],v[148:151]
v_mfma_f32_16x16x32_bf16 v[156:159],v[200:203],v[108:111],v[156:159]
s_waitcnt lgkmcnt(8)
v_mfma_f32_16x16x32_bf16 v[156:159],v[204:207],v[124:127],v[156:159]
ds_read_b64_tr_b16 v[200:201],v241 offset:8704
ds_read_b64_tr_b16 v[202:203],v241 offset:10880
v_mfma_f32_16x16x32_bf16 v[160:163],v[208:211],v[0:3],0
v_mul_f32 v128,v128,v224
v_mul_f32 v129,v129,v224
v_mfma_f32_16x16x32_bf16 v[160:163],v[212:215],v[16:19],v[160:163]
v_cvt_pk_bf16_f32 v128,v128,v129
v_mul_f32 v130,v130,v224
v_mfma_f32_16x16x32_bf16 v[168:171],v[208:211],v[4:7],0
v_mul_f32 v131,v131,v224
v_cvt_pk_bf16_f32 v129,v130,v131
v_mfma_f32_16x16x32_bf16 v[168:171],v[212:215],v[20:23],v[168:171]
ds_read_b64_tr_b16 v[204:205],v241 offset:13056
ds_read_b64_tr_b16 v[206:207],v241 offset:15232
v_mfma_f32_16x16x32_bf16 v[176:179],v[208:211],v[8:11],0
v_mul_f32 v132,v132,v224
v_mul_f32 v133,v133,v224
v_mfma_f32_16x16x32_bf16 v[176:179],v[212:215],v[24:27],v[176:179]
v_cvt_pk_bf16_f32 v130,v132,v133
v_mul_f32 v134,v134,v224
v_mfma_f32_16x16x32_bf16 v[184:187],v[208:211],v[12:15],0
s_waitcnt lgkmcnt(8)
v_mul_f32 v135,v135,v224
v_mfma_f32_16x16x32_bf16 v[184:187],v[212:215],v[28:31],v[184:187]
ds_read_b64_tr_b16 v[208:209],v240 offset:17408
ds_read_b64_tr_b16 v[210:211],v240 offset:19584
v_mfma_f32_16x16x32_bf16 v[164:167],v[216:219],v[0:3],0
v_cvt_pk_bf16_f32 v131,v134,v135
v_mul_f32 v136,v136,v225
v_mfma_f32_16x16x32_bf16 v[164:167],v[220:223],v[16:19],v[164:167]
buffer_store_dwordx4 v[128:131],v242,s[28:31],s55 offen offset:0 sc1
v_mfma_f32_16x16x32_bf16 v[172:175],v[216:219],v[4:7],0
v_mul_f32 v137,v137,v225
v_cvt_pk_bf16_f32 v136,v136,v137
v_mfma_f32_16x16x32_bf16 v[172:175],v[220:223],v[20:23],v[172:175]
ds_read_b64_tr_b16 v[212:213],v240 offset:21760
ds_read_b64_tr_b16 v[214:215],v240 offset:23936
v_mfma_f32_16x16x32_bf16 v[180:183],v[216:219],v[8:11],0
v_mul_f32 v138,v138,v225
v_mul_f32 v139,v139,v225
v_mfma_f32_16x16x32_bf16 v[180:183],v[220:223],v[24:27],v[180:183]
v_cvt_pk_bf16_f32 v137,v138,v139
v_mul_f32 v140,v140,v225
v_mfma_f32_16x16x32_bf16 v[188:191],v[216:219],v[12:15],0
s_waitcnt lgkmcnt(8)
v_mul_f32 v141,v141,v225
v_mfma_f32_16x16x32_bf16 v[188:191],v[220:223],v[28:31],v[188:191]
ds_read_b64_tr_b16 v[216:217],v241 offset:17408
ds_read_b64_tr_b16 v[218:219],v241 offset:19584
v_mfma_f32_16x16x32_bf16 v[160:163],v[192:195],v[32:35],v[160:163]
v_cvt_pk_bf16_f32 v138,v140,v141
v_mul_f32 v142,v142,v225
v_mfma_f32_16x16x32_bf16 v[160:163],v[196:199],v[48:51],v[160:163]
v_mul_f32 v143,v143,v225
v_cvt_pk_bf16_f32 v139,v142,v143
v_mfma_f32_16x16x32_bf16 v[168:171],v[192:195],v[36:39],v[168:171]
buffer_store_dwordx4 v[136:139],v242,s[28:31],s55 offen offset:1024 sc1
v_mfma_f32_16x16x32_bf16 v[168:171],v[196:199],v[52:55],v[168:171]
ds_read_b64_tr_b16 v[220:221],v241 offset:21760
ds_read_b64_tr_b16 v[222:223],v241 offset:23936
v_mfma_f32_16x16x32_bf16 v[176:179],v[192:195],v[40:43],v[176:179]
v_mul_f32 v144,v144,v226
v_mul_f32 v145,v145,v226
v_mfma_f32_16x16x32_bf16 v[176:179],v[196:199],v[56:59],v[176:179]
v_cvt_pk_bf16_f32 v144,v144,v145
v_mul_f32 v146,v146,v226
v_mfma_f32_16x16x32_bf16 v[184:187],v[192:195],v[44:47],v[184:187]
s_waitcnt lgkmcnt(8)
v_mul_f32 v147,v147,v226
v_mfma_f32_16x16x32_bf16 v[184:187],v[196:199],v[60:63],v[184:187]
ds_read_b64_tr_b16 v[192:193],v240 offset:26112
ds_read_b64_tr_b16 v[194:195],v240 offset:28288
v_mfma_f32_16x16x32_bf16 v[164:167],v[200:203],v[32:35],v[164:167]
v_cvt_pk_bf16_f32 v145,v146,v147
v_mul_f32 v148,v148,v226
v_mfma_f32_16x16x32_bf16 v[164:167],v[204:207],v[48:51],v[164:167]
v_mul_f32 v149,v149,v226
v_cvt_pk_bf16_f32 v146,v148,v149
v_mfma_f32_16x16x32_bf16 v[172:175],v[200:203],v[36:39],v[172:175]
v_mul_f32 v150,v150,v226
v_mul_f32 v151,v151,v226
v_mfma_f32_16x16x32_bf16 v[172:175],v[204:207],v[52:55],v[172:175]
ds_read_b64_tr_b16 v[196:197],v240 offset:30464
ds_read_b64_tr_b16 v[198:199],v240 offset:32640
v_mfma_f32_16x16x32_bf16 v[180:183],v[200:203],v[40:43],v[180:183]
v_cvt_pk_bf16_f32 v147,v150,v151
v_mul_f32 v152,v152,v227
v_mfma_f32_16x16x32_bf16 v[180:183],v[204:207],v[56:59],v[180:183]
buffer_store_dwordx4 v[144:147],v242,s[28:31],s55 offen offset:2048 sc1
v_mfma_f32_16x16x32_bf16 v[188:191],v[200:203],v[44:47],v[188:191]
s_waitcnt lgkmcnt(8)
v_mul_f32 v153,v153,v227
v_mfma_f32_16x16x32_bf16 v[188:191],v[204:207],v[60:63],v[188:191]
ds_read_b64_tr_b16 v[200:201],v241 offset:26112
ds_read_b64_tr_b16 v[202:203],v241 offset:28288
v_mfma_f32_16x16x32_bf16 v[160:163],v[208:211],v[64:67],v[160:163]
v_cvt_pk_bf16_f32 v152,v152,v153
v_mul_f32 v154,v154,v227
v_mfma_f32_16x16x32_bf16 v[160:163],v[212:215],v[80:83],v[160:163]
v_mul_f32 v155,v155,v227
v_cvt_pk_bf16_f32 v153,v154,v155
v_mfma_f32_16x16x32_bf16 v[168:171],v[208:211],v[68:71],v[168:171]
v_mul_f32 v156,v156,v227
v_mul_f32 v157,v157,v227
v_mfma_f32_16x16x32_bf16 v[168:171],v[212:215],v[84:87],v[168:171]
ds_read_b64_tr_b16 v[204:205],v241 offset:30464
ds_read_b64_tr_b16 v[206:207],v241 offset:32640
v_mfma_f32_16x16x32_bf16 v[176:179],v[208:211],v[72:75],v[176:179]
v_cvt_pk_bf16_f32 v154,v156,v157
v_mul_f32 v158,v158,v227
v_mfma_f32_16x16x32_bf16 v[176:179],v[212:215],v[88:91],v[176:179]
v_mul_f32 v159,v159,v227
v_cvt_pk_bf16_f32 v155,v158,v159
v_mfma_f32_16x16x32_bf16 v[184:187],v[208:211],v[76:79],v[184:187]
s_waitcnt lgkmcnt(8)
v_mfma_f32_16x16x32_bf16 v[184:187],v[212:215],v[92:95],v[184:187]
buffer_store_dwordx4 v[152:155],v242,s[28:31],s55 offen offset:3072 sc1
v_mfma_f32_16x16x32_bf16 v[164:167],v[216:219],v[64:67],v[164:167]
s_add_u32 s55,s55,16384
v_mfma_f32_16x16x32_bf16 v[164:167],v[220:223],v[80:83],v[164:167]
v_mfma_f32_16x16x32_bf16 v[172:175],v[216:219],v[68:71],v[172:175]
v_mfma_f32_16x16x32_bf16 v[172:175],v[220:223],v[84:87],v[172:175]
v_mfma_f32_16x16x32_bf16 v[180:183],v[216:219],v[72:75],v[180:183]
v_mfma_f32_16x16x32_bf16 v[180:183],v[220:223],v[88:91],v[180:183]
v_mfma_f32_16x16x32_bf16 v[188:191],v[216:219],v[76:79],v[188:191]
s_waitcnt lgkmcnt(4)
v_mfma_f32_16x16x32_bf16 v[188:191],v[220:223],v[92:95],v[188:191]
v_mfma_f32_16x16x32_bf16 v[160:163],v[192:195],v[96:99],v[160:163]
v_mfma_f32_16x16x32_bf16 v[160:163],v[196:199],v[112:115],v[160:163]
v_mfma_f32_16x16x32_bf16 v[168:171],v[192:195],v[100:103],v[168:171]
v_mfma_f32_16x16x32_bf16 v[168:171],v[196:199],v[116:119],v[168:171]
v_mfma_f32_16x16x32_bf16 v[176:179],v[192:195],v[104:107],v[176:179]
v_mfma_f32_16x16x32_bf16 v[176:179],v[196:199],v[120:123],v[176:179]
v_mfma_f32_16x16x32_bf16 v[184:187],v[192:195],v[108:111],v[184:187]
s_waitcnt lgkmcnt(0)
v_mfma_f32_16x16x32_bf16 v[184:187],v[196:199],v[124:127],v[184:187]
v_mfma_f32_16x16x32_bf16 v[164:167],v[200:203],v[96:99],v[164:167]
v_mfma_f32_16x16x32_bf16 v[164:167],v[204:207],v[112:115],v[164:167]
v_mfma_f32_16x16x32_bf16 v[172:175],v[200:203],v[100:103],v[172:175]
v_mfma_f32_16x16x32_bf16 v[172:175],v[204:207],v[116:119],v[172:175]
v_mfma_f32_16x16x32_bf16 v[180:183],v[200:203],v[104:107],v[180:183]
v_mfma_f32_16x16x32_bf16 v[180:183],v[204:207],v[120:123],v[180:183]
v_mfma_f32_16x16x32_bf16 v[188:191],v[200:203],v[108:111],v[188:191]
v_mfma_f32_16x16x32_bf16 v[188:191],v[204:207],v[124:127],v[188:191]
s_nop 7
v_mul_f32 v160,v160,v224
v_mul_f32 v161,v161,v224
v_cvt_pk_bf16_f32 v160,v160,v161
v_mul_f32 v162,v162,v224
v_mul_f32 v163,v163,v224
v_cvt_pk_bf16_f32 v161,v162,v163
v_mul_f32 v164,v164,v224
v_mul_f32 v165,v165,v224
v_cvt_pk_bf16_f32 v162,v164,v165
v_mul_f32 v166,v166,v224
v_mul_f32 v167,v167,v224
v_cvt_pk_bf16_f32 v163,v166,v167
buffer_store_dwordx4 v[160:163],v242,s[28:31],s55 offen offset:0 sc1
v_mul_f32 v168,v168,v225
v_mul_f32 v169,v169,v225
v_cvt_pk_bf16_f32 v168,v168,v169
v_mul_f32 v170,v170,v225
v_mul_f32 v171,v171,v225
v_cvt_pk_bf16_f32 v169,v170,v171
v_mul_f32 v172,v172,v225
v_mul_f32 v173,v173,v225
v_cvt_pk_bf16_f32 v170,v172,v173
v_mul_f32 v174,v174,v225
v_mul_f32 v175,v175,v225
v_cvt_pk_bf16_f32 v171,v174,v175
buffer_store_dwordx4 v[168:171],v242,s[28:31],s55 offen offset:1024 sc1
v_mul_f32 v176,v176,v226
v_mul_f32 v177,v177,v226
v_cvt_pk_bf16_f32 v176,v176,v177
v_mul_f32 v178,v178,v226
v_mul_f32 v179,v179,v226
v_cvt_pk_bf16_f32 v177,v178,v179
v_mul_f32 v180,v180,v226
v_mul_f32 v181,v181,v226
v_cvt_pk_bf16_f32 v178,v180,v181
v_mul_f32 v182,v182,v226
v_mul_f32 v183,v183,v226
v_cvt_pk_bf16_f32 v179,v182,v183
buffer_store_dwordx4 v[176:179],v242,s[28:31],s55 offen offset:2048 sc1
v_mul_f32 v184,v184,v227
v_mul_f32 v185,v185,v227
v_cvt_pk_bf16_f32 v184,v184,v185
v_mul_f32 v186,v186,v227
v_mul_f32 v187,v187,v227
v_cvt_pk_bf16_f32 v185,v186,v187
v_mul_f32 v188,v188,v227
v_mul_f32 v189,v189,v227
v_cvt_pk_bf16_f32 v186,v188,v189
v_mul_f32 v190,v190,v227
v_mul_f32 v191,v191,v227
v_cvt_pk_bf16_f32 v187,v190,v191
buffer_store_dwordx4 v[184:187],v242,s[28:31],s55 offen offset:3072 sc1
s_sub_u32 s55,s55,212992
s_waitcnt vmcnt(0)
buffer_wbl2 sc1
s_waitcnt vmcnt(0)
s_barrier
s_cmp_eq_u32 s3,0
s_cbranch_scc0 L_END
s_and_b32 s34,s6,3
s_lshl_b32 s34,s34,3
s_lshl_b32 s34,16,s34
v_mov_b32 v236,s34
v_and_b32 v255,-4,v237
buffer_atomic_or v236,v255,s[20:23],s60 offen sc0 sc1
s_waitcnt vmcnt(0)
v_mbcnt_lo_u32_b32 v255,-1,0
v_lshrrev_b32 v236,2,v255
v_lshlrev_b32 v255,2,v255
v_lshl_add_u32 v255,v236,8,v255
v_mov_b32 v236,0
buffer_atomic_or v236,v255,s[20:23],s60 offen sc0 sc1
s_waitcnt vmcnt(0)
s_mov_b32 s34,0x10101010
v_and_b32 v236,s34,v236
v_cmp_eq_u32 vcc,s34,v236
s_nop 1
s_and_b32 s34,vcc_lo,15
s_cmp_eq_u32 s34,15
s_cbranch_scc0 L_END
buffer_inv sc1
s_waitcnt vmcnt(0)
v_subrev_u32 v248,s100,v248
v_subrev_u32 v249,s100,v249
v_subrev_u32 v250,s100,v250
v_subrev_u32 v251,s100,v251
v_subrev_u32 v254,s101,v254
s_mov_b32 s53,0
L_SLOOP:
s_lshl_b32 s60,s53,8
buffer_load_dwordx4 a[0:3],v248,s[28:31],s60 offen sc1
buffer_load_dwordx4 a[4:7],v249,s[28:31],s60 offen sc1
buffer_load_dwordx4 a[8:11],v250,s[28:31],s60 offen sc1
buffer_load_dwordx4 a[12:15],v251,s[28:31],s60 offen sc1
s_bfe_u32 s34,s53,0x40002
s_mul_i32 s34,s34,14336
s_and_b32 s35,s53,3
s_mul_i32 s35,s35,3584
s_add_u32 s34,s34,s35
s_andn2_b32 s35,s53,63
s_add_u32 s34,s34,s35
s_waitcnt vmcnt(0)
v_mfma_f32_16x16x32_bf16 v[228:231],v[244:247],a[0:3],0
v_mfma_f32_16x16x32_bf16 v[228:231],v[244:247],a[4:7],v[228:231]
v_mfma_f32_16x16x32_bf16 v[228:231],v[244:247],a[8:11],v[228:231]
v_mfma_f32_16x16x32_bf16 v[228:231],v[244:247],a[12:15],v[228:231]
s_nop 7
v_cvt_pk_bf16_f32 v232,v228,v229
v_cvt_pk_bf16_f32 v233,v230,v231
buffer_store_dwordx2 v[232:233],v254,s[16:19],s34 offen
s_add_u32 s53,s53,1
s_cmp_lt_u32 s53,896
s_cbranch_scc1 L_SLOOP
s_waitcnt vmcnt(0)
s_endpgm
.section .rodata,"a"
.p2align 6
.amdhsa_kernel standalone__mha_block_cached__near_ridge_kernel
  .amdhsa_next_free_vgpr 512
  .amdhsa_next_free_sgpr 102
  .amdhsa_accum_offset 256
  .amdhsa_group_segment_fixed_size 0
  .amdhsa_kernarg_size 64
  .amdhsa_user_sgpr_count 2
  .amdhsa_user_sgpr_kernarg_segment_ptr 1
  .amdhsa_system_sgpr_workgroup_id_x 1
.end_amdhsa_kernel
```
